```python
import torch

def _softmax(x, axis=-1):
    return torch.softmax(x, dim=axis)

def _gelu(x):
    return torch.nn.functional.gelu(x, approximate='tanh')

def _silu(x):
    return torch.nn.functional.silu(x)

def _sigmoid(x):
    return torch.sigmoid(x)

def _layernorm(x, axis=-1, eps=1e-05):
    m = x.mean(dim=axis, keepdim=True)
    v = x.var(dim=axis, keepdim=True, unbiased=False)
    return (x - m) / torch.sqrt(v + eps)

def _scatter_add(tgt, idx, src, axis=0):
    return tgt.clone().index_add_(axis, idx, src)

def _segment_sum(src, seg, n):
    out = torch.zeros((n,) + src.shape[1:], dtype=src.dtype)
    return out.index_add_(0, seg, src)

def _pad(x, pw):
    flat = tuple((v for pair in reversed(pw) for v in pair))
    return torch.nn.functional.pad(x, flat)
kernel_name = 'parallel_sum__memory_aug_recurrent_mem_tr__dense_activation_gelu__prompt'

def setup_inputs():

    _w = lambda a: (lambda t: t.to(torch.bfloat16) if t.is_floating_point() else t)(torch.as_tensor(a))

    def _A_setup():
        B, S, Dm = (1, 2048, 448)
        H, Dh = (16, 256)
        M, seg = (8, 32)
        seg = min(seg, S)
        S = S // seg * seg
        return {'x': _w((lambda *s: torch.randn(*s, dtype=torch.bfloat16) * 0.05)(B, S, Dm)), 'mem0': _w((lambda *s: torch.randn(*s, dtype=torch.bfloat16) * 0.2)(B, M, Dm)), 'Wq': _w((lambda *s: torch.randn(*s, dtype=torch.bfloat16) * 1.6)(Dm, H, Dh) * Dm ** (-0.5)), 'Wk': _w((lambda *s: torch.randn(*s, dtype=torch.bfloat16) * 1.6)(Dm, H, Dh) * Dm ** (-0.5)), 'Wv': _w((lambda *s: torch.randn(*s, dtype=torch.bfloat16) * 0.2)(Dm, H, Dh) * Dm ** (-0.5)), 'Wo': _w((lambda *s: torch.randn(*s, dtype=torch.bfloat16) * 0.2)(H, Dh, Dm) * (H * Dh) ** (-0.5)), 'seg_len': seg}
    _A_in = _A_setup()

    def _B_setup():
        B, S, D, F = (1, 2048, 448, 1792)
        return {'x': _w((lambda *s: torch.randn(*s, dtype=torch.bfloat16) * 0.05)(B, S, D)), 'w1': _w((lambda *s: torch.randn(*s, dtype=torch.bfloat16) * 0.4)(D, F) * D ** (-0.5)), 'b1': _w((lambda *s: torch.randn(*s, dtype=torch.bfloat16) * 12.8)(F) * 0.01), 'w2': _w((lambda *s: torch.randn(*s, dtype=torch.bfloat16) * 0.1)(F, D) * F ** (-0.5)), 'b2': _w((lambda *s: torch.randn(*s, dtype=torch.bfloat16) * 1.6)(D) * 0.01)}
    _B_in = _B_setup()
    return {'A_x': _A_in['x'], 'A_mem0': _A_in['mem0'], 'A_Wq': _A_in['Wq'], 'A_Wk': _A_in['Wk'], 'A_Wv': _A_in['Wv'], 'A_Wo': _A_in['Wo'], 'A_seg_len': _A_in['seg_len'], 'B_x': _B_in['x'], 'B_w1': _B_in['w1'], 'B_b1': _B_in['b1'], 'B_w2': _B_in['w2'], 'B_b2': _B_in['b2']}

def reference(A_x, A_mem0, A_Wq, A_Wk, A_Wv, A_Wo, A_seg_len, B_x, B_w1, B_b1, B_w2, B_b2):

    def _A_ref(x, mem0, Wq, Wk, Wv, Wo, seg_len):
        B, S, Dm = x.shape
        H, Dh = (Wq.shape[1], Wq.shape[2])
        M = mem0.shape[1]
        scale = Dh ** (-0.5)
        n_seg = S // seg_len
        L = M + seg_len
        idx = torch.arange(L)
        mask = (idx[:, None] < M) | (idx[:, None] >= idx[None, :])
        mem = mem0
        outs = []
        for s in range(n_seg):
            xs = x[:, s * seg_len:(s + 1) * seg_len, :].clone()
            h = torch.concatenate([mem, xs], axis=1)
            q = torch.einsum('btd,dhe->bhte', h, Wq)
            k = torch.einsum('btd,dhe->bhte', h, Wk)
            v = torch.einsum('btd,dhe->bhte', h, Wv)
            scores = torch.einsum('bhqe,bhke->bhqk', q, k) * scale
            scores = torch.where(mask[None, None], scores, -1000000000.0)
            p = _softmax(scores, axis=-1)
            o = torch.einsum('bhqk,bhke->bhqe', p, v)
            o = torch.einsum('bhte,hed->btd', o, Wo)
            mem = o[:, :M, :].clone()
            outs.append(o[:, M:, :])
        return torch.concatenate(outs, axis=1)

    def _B_ref(x, w1, b1, w2, b2):
        h = torch.einsum('bsd,df->bsf', x, w1) + b1
        h = _gelu(h)
        return torch.einsum('bsf,fd->bsd', h, w2) + b2
    x = A_x
    xn = _layernorm(x, axis=-1)
    return x + _A_ref(xn, A_mem0, A_Wq, A_Wk, A_Wv, A_Wo, A_seg_len) + _B_ref(xn, B_w1, B_b1, B_w2, B_b2)
```

```asm
; @launch kernel=prep_kernel grid=(2609,1,1) block=(256,1,1) lds=0
; @launch kernel=wprod_kernel grid=(128,1,1) block=(256,1,1) lds=0
; @launch kernel=main_kernel grid=(256,1,1) block=(256,1,1) lds=116736
.amdgcn_target "amdgcn-amd-amdhsa--gfx950"
.text
.globl prep_kernel
.p2align 8
.type prep_kernel,@function
prep_kernel:
    s_cmp_ge_u32 s2, 2609
    s_cbranch_scc1 K1_done
    s_load_dwordx2 s[8:9], s[0:1], 112
    s_mov_b32 s10, 268435456
    s_mov_b32 s11, 0x00020000
    v_lshrrev_b32 v1, 6, v0
    s_nop 0
    v_readfirstlane_b32 s4, v1
    v_and_b32 v0, 63, v0
    s_nop 2
    s_lshl_b32 s5, s2, 2
    s_add_u32 s5, s5, s4
    s_cmp_ge_u32 s5, 2048
    s_cbranch_scc1 K1_notln
    s_load_dwordx2 s[12:13], s[0:1], 0
    s_mov_b32 s14, 1835008
    s_mov_b32 s15, 0x00020000
    s_mul_i32 s6, s5, 896
    v_lshlrev_b32 v1, 4, v0
    v_mov_b32 v4, 0
    v_mov_b32 v5, 0
    v_mov_b32 v6, 0
    v_mov_b32 v7, 0
    v_mov_b32 v20, 0
    v_mov_b32 v21, 0
    s_waitcnt lgkmcnt(0)
    v_cmp_gt_u32 vcc, 56, v0
    s_and_saveexec_b64 s[20:21], vcc
    buffer_load_dwordx4 v[4:7], v1, s[12:15], s6 offen
    s_waitcnt vmcnt(0)
    v_lshlrev_b32 v8, 16, v4
    v_and_b32 v9, 0xffff0000, v4
    v_lshlrev_b32 v10, 16, v5
    v_and_b32 v11, 0xffff0000, v5
    v_lshlrev_b32 v12, 16, v6
    v_and_b32 v13, 0xffff0000, v6
    v_lshlrev_b32 v14, 16, v7
    v_and_b32 v15, 0xffff0000, v7
    v_add_f32 v20, v20, v8
    v_add_f32 v20, v20, v9
    v_add_f32 v20, v20, v10
    v_add_f32 v20, v20, v11
    v_add_f32 v20, v20, v12
    v_add_f32 v20, v20, v13
    v_add_f32 v20, v20, v14
    v_add_f32 v20, v20, v15
    s_mov_b64 exec, s[20:21]
    ds_swizzle_b32 v22, v20 offset:0x41f
    s_waitcnt lgkmcnt(0)
    v_add_f32 v20, v20, v22
    ds_swizzle_b32 v22, v20 offset:0x81f
    s_waitcnt lgkmcnt(0)
    v_add_f32 v20, v20, v22
    ds_swizzle_b32 v22, v20 offset:0x101f
    s_waitcnt lgkmcnt(0)
    v_add_f32 v20, v20, v22
    ds_swizzle_b32 v22, v20 offset:0x201f
    s_waitcnt lgkmcnt(0)
    v_add_f32 v20, v20, v22
    ds_swizzle_b32 v22, v20 offset:0x401f
    s_waitcnt lgkmcnt(0)
    v_add_f32 v20, v20, v22
    s_nop 1
    v_readlane_b32 s24, v20, 0
    v_readlane_b32 s25, v20, 32
    s_nop 1
    v_mov_b32 v20, s24
    v_add_f32 v20, s25, v20
    v_mul_f32 v20, 0x3b124925, v20
    s_and_saveexec_b64 s[20:21], vcc
    v_sub_f32 v22, v8, v20
    v_fmac_f32 v21, v22, v22
    v_sub_f32 v22, v9, v20
    v_fmac_f32 v21, v22, v22
    v_sub_f32 v22, v10, v20
    v_fmac_f32 v21, v22, v22
    v_sub_f32 v22, v11, v20
    v_fmac_f32 v21, v22, v22
    v_sub_f32 v22, v12, v20
    v_fmac_f32 v21, v22, v22
    v_sub_f32 v22, v13, v20
    v_fmac_f32 v21, v22, v22
    v_sub_f32 v22, v14, v20
    v_fmac_f32 v21, v22, v22
    v_sub_f32 v22, v15, v20
    v_fmac_f32 v21, v22, v22
    s_mov_b64 exec, s[20:21]
    ds_swizzle_b32 v22, v21 offset:0x41f
    s_waitcnt lgkmcnt(0)
    v_add_f32 v21, v21, v22
    ds_swizzle_b32 v22, v21 offset:0x81f
    s_waitcnt lgkmcnt(0)
    v_add_f32 v21, v21, v22
    ds_swizzle_b32 v22, v21 offset:0x101f
    s_waitcnt lgkmcnt(0)
    v_add_f32 v21, v21, v22
    ds_swizzle_b32 v22, v21 offset:0x201f
    s_waitcnt lgkmcnt(0)
    v_add_f32 v21, v21, v22
    ds_swizzle_b32 v22, v21 offset:0x401f
    s_waitcnt lgkmcnt(0)
    v_add_f32 v21, v21, v22
    s_nop 1
    v_readlane_b32 s24, v21, 0
    v_readlane_b32 s25, v21, 32
    s_nop 1
    v_mov_b32 v21, s24
    v_add_f32 v21, s25, v21
    v_mul_f32 v21, 0x3b124925, v21
    v_cvt_pk_bf16_f32 v20, v20, v20
    v_lshlrev_b32 v20, 16, v20
    v_cvt_pk_bf16_f32 v21, v21, v21
    v_lshlrev_b32 v21, 16, v21
    v_add_f32 v21, 0x3727c5ac, v21
    v_cvt_pk_bf16_f32 v21, v21, v21
    v_lshlrev_b32 v21, 16, v21
    v_sqrt_f32 v21, v21
    s_nop 0
    v_cvt_pk_bf16_f32 v21, v21, v21
    v_lshlrev_b32 v21, 16, v21
    v_rcp_f32 v21, v21
    s_nop 0
    v_sub_f32 v8, v8, v20
    v_cvt_pk_bf16_f32 v8, v8, v8
    v_lshlrev_b32 v8, 16, v8
    v_mul_f32 v8, v8, v21
    v_sub_f32 v9, v9, v20
    v_cvt_pk_bf16_f32 v9, v9, v9
    v_lshlrev_b32 v9, 16, v9
    v_mul_f32 v9, v9, v21
    v_sub_f32 v10, v10, v20
    v_cvt_pk_bf16_f32 v10, v10, v10
    v_lshlrev_b32 v10, 16, v10
    v_mul_f32 v10, v10, v21
    v_sub_f32 v11, v11, v20
    v_cvt_pk_bf16_f32 v11, v11, v11
    v_lshlrev_b32 v11, 16, v11
    v_mul_f32 v11, v11, v21
    v_sub_f32 v12, v12, v20
    v_cvt_pk_bf16_f32 v12, v12, v12
    v_lshlrev_b32 v12, 16, v12
    v_mul_f32 v12, v12, v21
    v_sub_f32 v13, v13, v20
    v_cvt_pk_bf16_f32 v13, v13, v13
    v_lshlrev_b32 v13, 16, v13
    v_mul_f32 v13, v13, v21
    v_sub_f32 v14, v14, v20
    v_cvt_pk_bf16_f32 v14, v14, v14
    v_lshlrev_b32 v14, 16, v14
    v_mul_f32 v14, v14, v21
    v_sub_f32 v15, v15, v20
    v_cvt_pk_bf16_f32 v15, v15, v15
    v_lshlrev_b32 v15, 16, v15
    v_mul_f32 v15, v15, v21
    v_cvt_pk_bf16_f32 v4, v8, v9
    v_cvt_pk_bf16_f32 v5, v10, v11
    v_cvt_pk_bf16_f32 v6, v12, v13
    v_cvt_pk_bf16_f32 v7, v14, v15
    s_and_saveexec_b64 s[20:21], vcc
    buffer_store_dwordx4 v[4:7], v1, s[8:11], s6 offen
    s_branch K1_done
K1_notln:
    s_sub_u32 s5, s5, 2048
    s_cmp_ge_u32 s5, 3584
    s_cbranch_scc1 K1_t1
    s_load_dwordx2 s[12:13], s[0:1], 40
    s_mov_b32 s14, 3670016
    s_mov_b32 s15, 0x00020000
    s_mov_b32 s16, 896
    s_mov_b32 s17, 613566757
    s_mov_b32 s18, 7
    s_mov_b32 s19, 8
    s_mov_b32 s22, 16777216
    s_branch K1_tr
K1_t1:
    s_sub_u32 s5, s5, 3584
    s_cmp_ge_u32 s5, 1568
    s_cbranch_scc1 K1_t2
    s_load_dwordx2 s[12:13], s[0:1], 64
    s_mov_b32 s14, 1605632
    s_mov_b32 s15, 0x00020000
    s_mov_b32 s16, 3584
    s_mov_b32 s17, 153391690
    s_mov_b32 s18, 28
    s_mov_b32 s19, 31
    s_mov_b32 s22, 14942208
    s_branch K1_tr
K1_t2:
    s_sub_u32 s5, s5, 1568
    s_cmp_ge_u32 s5, 1568
    s_cbranch_scc1 K1_t3
    s_load_dwordx2 s[12:13], s[0:1], 80
    s_mov_b32 s14, 1605632
    s_mov_b32 s15, 0x00020000
    s_mov_b32 s16, 896
    s_mov_b32 s17, 613566757
    s_mov_b32 s18, 7
    s_mov_b32 s19, 30
    s_mov_b32 s22, 20971520
    s_branch K1_tr
K1_t3:
    s_sub_u32 s5, s5, 1568
    s_cmp_ge_u32 s5, 1654
    s_cbranch_scc1 K1_s0
    s_lshl_b32 s6, s5, 10
    s_add_u32 s6, s6, 89143296
    v_lshlrev_b32 v1, 4, v0
    v_mov_b32 v4, 0
    v_mov_b32 v5, 0
    v_mov_b32 v6, 0
    v_mov_b32 v7, 0
    s_waitcnt lgkmcnt(0)
    buffer_store_dwordx4 v[4:7], v1, s[8:11], s6 offen
    s_branch K1_done
K1_s0:
    s_sub_u32 s5, s5, 1654
    s_load_dwordx2 s[12:13], s[0:1], 8
    s_mov_b32 s14, 7168
    s_mov_b32 s15, 0x00020000
    v_lshrrev_b32 v1, 3, v0
    v_mul_u32_u24 v1, 896, v1
    v_and_b32 v2, 7, v0
    v_lshlrev_b32 v2, 3, v2
    v_add_u32 v1, v1, v2
    s_lshl_b32 s6, s5, 6
    s_waitcnt lgkmcnt(0)
    buffer_load_dwordx2 v[4:5], v1, s[12:15], s6 offen
    s_waitcnt vmcnt(0)
    v_lshlrev_b32 v8, 16, v4
    v_and_b32 v9, 0xffff0000, v4
    v_lshlrev_b32 v10, 16, v5
    v_and_b32 v11, 0xffff0000, v5
    v_or_b32 v8, 23130, v8
    v_or_b32 v9, 23130, v9
    v_or_b32 v10, 23130, v10
    v_or_b32 v11, 23130, v11
    v_lshlrev_b32 v1, 4, v0
    s_lshl_b32 s6, s5, 10
    s_add_u32 s6, s6, 89128960
    buffer_store_dwordx4 v[8:11], v1, s[8:11], s6 offen
    s_branch K1_done
K1_tr:
    s_mul_hi_u32 s23, s5, s17
    s_mul_i32 s24, s23, s18
    s_sub_u32 s24, s5, s24
    s_lshl_b32 s23, s23, 3
    s_lshl_b32 s24, s24, 6
    v_add_u32 v1, s24, v0
    v_lshlrev_b32 v2, 1, v1
    s_mul_i32 s25, s23, s16
    s_waitcnt lgkmcnt(0)
    buffer_load_ushort v4, v2, s[12:15], s25 offen
    s_add_u32 s25, s25, s16
    buffer_load_ushort v5, v2, s[12:15], s25 offen
    s_add_u32 s25, s25, s16
    buffer_load_ushort v6, v2, s[12:15], s25 offen
    s_add_u32 s25, s25, s16
    buffer_load_ushort v7, v2, s[12:15], s25 offen
    s_add_u32 s25, s25, s16
    buffer_load_ushort v8, v2, s[12:15], s25 offen
    s_add_u32 s25, s25, s16
    buffer_load_ushort v9, v2, s[12:15], s25 offen
    s_add_u32 s25, s25, s16
    buffer_load_ushort v10, v2, s[12:15], s25 offen
    s_add_u32 s25, s25, s16
    buffer_load_ushort v11, v2, s[12:15], s25 offen
    s_add_u32 s25, s25, s16
    s_cmp_eq_u32 s19, 8
    s_cbranch_scc0 K1_tr_b
    s_lshr_b32 s26, s23, 8
    s_mul_i32 s26, s26, 229376
    s_and_b32 s27, s23, 255
    s_lshl_b32 s27, s27, 1
    s_add_u32 s26, s26, s27
    s_mov_b32 s27, 512
    s_branch K1_tr_c
K1_tr_b:
    s_lshl_b32 s26, s23, 1
    s_mov_b32 s27, 896
    s_cmp_eq_u32 s19, 31
    s_cbranch_scc1 K1_tr_c
    s_mov_b32 s27, 3584
K1_tr_c:
    s_add_u32 s26, s26, s22
    v_mul_lo_u32 v3, v1, s27
    s_waitcnt vmcnt(0)
    v_lshl_or_b32 v12, v5, 16, v4
    v_lshl_or_b32 v13, v7, 16, v6
    v_lshl_or_b32 v14, v9, 16, v8
    v_lshl_or_b32 v15, v11, 16, v10
    buffer_store_dwordx4 v[12:15], v3, s[8:11], s26 offen
K1_done:
    s_endpgm
.globl wprod_kernel
.p2align 8
.type wprod_kernel,@function
wprod_kernel:
    s_cmp_ge_u32 s2, 128
    s_cbranch_scc1 K2_done
    s_load_dwordx2 s[8:9], s[0:1], 112
    s_mov_b32 s10, 268435456
    s_mov_b32 s11, 0x00020000
    v_lshrrev_b32 v1, 6, v0
    s_nop 0
    v_readfirstlane_b32 s4, v1
    v_and_b32 v0, 63, v0
    s_nop 2
    s_lshr_b32 s5, s2, 6
    s_lshr_b32 s6, s2, 2
    s_and_b32 s6, s6, 15
    s_and_b32 s7, s2, 3
    s_cmp_eq_u32 s5, 0
    s_cbranch_scc0 K2_b
    s_load_dwordx2 s[12:13], s[0:1], 16
    s_mov_b32 s14, 3670016
    s_mov_b32 s15, 0x00020000
    s_load_dwordx2 s[16:17], s[0:1], 24
    s_mov_b32 s18, 3670016
    s_mov_b32 s19, 0x00020000
    s_mov_b32 s20, 8192
    s_lshl_b32 s21, s6, 9
    s_branch K2_c
K2_b:
    s_load_dwordx2 s[12:13], s[0:1], 32
    s_mov_b32 s14, 3670016
    s_mov_b32 s15, 0x00020000
    s_load_dwordx2 s[16:17], s[0:1], 112
    s_mov_b32 s18, 268435456
    s_mov_b32 s19, 0x00020000
    s_mov_b32 s20, 512
    s_mul_i32 s21, s6, 229376
    s_add_u32 s21, s21, 16777216
K2_c:
    v_and_b32 v1, 15, v0
    v_lshrrev_b32 v2, 4, v0
    s_mul_i32 s22, s7, 112
    v_add_u32 v3, s22, v1
    v_lshlrev_b32 v3, 13, v3
    s_lshl_b32 s23, s6, 9
    v_lshl_add_u32 v3, v2, 4, v3
    v_add_u32 v3, s23, v3
    s_mul_i32 s23, s4, 112
    v_add_u32 v4, s23, v1
    v_mul_lo_u32 v5, v4, s20
    v_lshl_add_u32 v5, v2, 4, v5
    v_add_u32 v5, s21, v5
    s_lshl_b32 s24, s20, 4
    v_add_u32 v6, 0, v3
    v_mov_b32 v130, v5
    v_add_u32 v7, 131072, v3
    v_add_u32 v131, s24, v130
    v_add_u32 v8, 262144, v3
    v_add_u32 v132, s24, v131
    v_add_u32 v9, 393216, v3
    v_add_u32 v133, s24, v132
    v_add_u32 v10, 524288, v3
    v_add_u32 v134, s24, v133
    v_add_u32 v11, 655360, v3
    v_add_u32 v135, s24, v134
    v_add_u32 v12, 786432, v3
    v_add_u32 v136, s24, v135
    v_accvgpr_write_b32 a0, 0
    v_accvgpr_write_b32 a1, 0
    v_accvgpr_write_b32 a2, 0
    v_accvgpr_write_b32 a3, 0
    v_accvgpr_write_b32 a4, 0
    v_accvgpr_write_b32 a5, 0
    v_accvgpr_write_b32 a6, 0
    v_accvgpr_write_b32 a7, 0
    v_accvgpr_write_b32 a8, 0
    v_accvgpr_write_b32 a9, 0
    v_accvgpr_write_b32 a10, 0
    v_accvgpr_write_b32 a11, 0
    v_accvgpr_write_b32 a12, 0
    v_accvgpr_write_b32 a13, 0
    v_accvgpr_write_b32 a14, 0
    v_accvgpr_write_b32 a15, 0
    v_accvgpr_write_b32 a16, 0
    v_accvgpr_write_b32 a17, 0
    v_accvgpr_write_b32 a18, 0
    v_accvgpr_write_b32 a19, 0
    v_accvgpr_write_b32 a20, 0
    v_accvgpr_write_b32 a21, 0
    v_accvgpr_write_b32 a22, 0
    v_accvgpr_write_b32 a23, 0
    v_accvgpr_write_b32 a24, 0
    v_accvgpr_write_b32 a25, 0
    v_accvgpr_write_b32 a26, 0
    v_accvgpr_write_b32 a27, 0
    v_accvgpr_write_b32 a28, 0
    v_accvgpr_write_b32 a29, 0
    v_accvgpr_write_b32 a30, 0
    v_accvgpr_write_b32 a31, 0
    v_accvgpr_write_b32 a32, 0
    v_accvgpr_write_b32 a33, 0
    v_accvgpr_write_b32 a34, 0
    v_accvgpr_write_b32 a35, 0
    v_accvgpr_write_b32 a36, 0
    v_accvgpr_write_b32 a37, 0
    v_accvgpr_write_b32 a38, 0
    v_accvgpr_write_b32 a39, 0
    v_accvgpr_write_b32 a40, 0
    v_accvgpr_write_b32 a41, 0
    v_accvgpr_write_b32 a42, 0
    v_accvgpr_write_b32 a43, 0
    v_accvgpr_write_b32 a44, 0
    v_accvgpr_write_b32 a45, 0
    v_accvgpr_write_b32 a46, 0
    v_accvgpr_write_b32 a47, 0
    v_accvgpr_write_b32 a48, 0
    v_accvgpr_write_b32 a49, 0
    v_accvgpr_write_b32 a50, 0
    v_accvgpr_write_b32 a51, 0
    v_accvgpr_write_b32 a52, 0
    v_accvgpr_write_b32 a53, 0
    v_accvgpr_write_b32 a54, 0
    v_accvgpr_write_b32 a55, 0
    v_accvgpr_write_b32 a56, 0
    v_accvgpr_write_b32 a57, 0
    v_accvgpr_write_b32 a58, 0
    v_accvgpr_write_b32 a59, 0
    v_accvgpr_write_b32 a60, 0
    v_accvgpr_write_b32 a61, 0
    v_accvgpr_write_b32 a62, 0
    v_accvgpr_write_b32 a63, 0
    v_accvgpr_write_b32 a64, 0
    v_accvgpr_write_b32 a65, 0
    v_accvgpr_write_b32 a66, 0
    v_accvgpr_write_b32 a67, 0
    v_accvgpr_write_b32 a68, 0
    v_accvgpr_write_b32 a69, 0
    v_accvgpr_write_b32 a70, 0
    v_accvgpr_write_b32 a71, 0
    v_accvgpr_write_b32 a72, 0
    v_accvgpr_write_b32 a73, 0
    v_accvgpr_write_b32 a74, 0
    v_accvgpr_write_b32 a75, 0
    v_accvgpr_write_b32 a76, 0
    v_accvgpr_write_b32 a77, 0
    v_accvgpr_write_b32 a78, 0
    v_accvgpr_write_b32 a79, 0
    v_accvgpr_write_b32 a80, 0
    v_accvgpr_write_b32 a81, 0
    v_accvgpr_write_b32 a82, 0
    v_accvgpr_write_b32 a83, 0
    v_accvgpr_write_b32 a84, 0
    v_accvgpr_write_b32 a85, 0
    v_accvgpr_write_b32 a86, 0
    v_accvgpr_write_b32 a87, 0
    v_accvgpr_write_b32 a88, 0
    v_accvgpr_write_b32 a89, 0
    v_accvgpr_write_b32 a90, 0
    v_accvgpr_write_b32 a91, 0
    v_accvgpr_write_b32 a92, 0
    v_accvgpr_write_b32 a93, 0
    v_accvgpr_write_b32 a94, 0
    v_accvgpr_write_b32 a95, 0
    v_accvgpr_write_b32 a96, 0
    v_accvgpr_write_b32 a97, 0
    v_accvgpr_write_b32 a98, 0
    v_accvgpr_write_b32 a99, 0
    v_accvgpr_write_b32 a100, 0
    v_accvgpr_write_b32 a101, 0
    v_accvgpr_write_b32 a102, 0
    v_accvgpr_write_b32 a103, 0
    v_accvgpr_write_b32 a104, 0
    v_accvgpr_write_b32 a105, 0
    v_accvgpr_write_b32 a106, 0
    v_accvgpr_write_b32 a107, 0
    v_accvgpr_write_b32 a108, 0
    v_accvgpr_write_b32 a109, 0
    v_accvgpr_write_b32 a110, 0
    v_accvgpr_write_b32 a111, 0
    v_accvgpr_write_b32 a112, 0
    v_accvgpr_write_b32 a113, 0
    v_accvgpr_write_b32 a114, 0
    v_accvgpr_write_b32 a115, 0
    v_accvgpr_write_b32 a116, 0
    v_accvgpr_write_b32 a117, 0
    v_accvgpr_write_b32 a118, 0
    v_accvgpr_write_b32 a119, 0
    v_accvgpr_write_b32 a120, 0
    v_accvgpr_write_b32 a121, 0
    v_accvgpr_write_b32 a122, 0
    v_accvgpr_write_b32 a123, 0
    v_accvgpr_write_b32 a124, 0
    v_accvgpr_write_b32 a125, 0
    v_accvgpr_write_b32 a126, 0
    v_accvgpr_write_b32 a127, 0
    v_accvgpr_write_b32 a128, 0
    v_accvgpr_write_b32 a129, 0
    v_accvgpr_write_b32 a130, 0
    v_accvgpr_write_b32 a131, 0
    v_accvgpr_write_b32 a132, 0
    v_accvgpr_write_b32 a133, 0
    v_accvgpr_write_b32 a134, 0
    v_accvgpr_write_b32 a135, 0
    v_accvgpr_write_b32 a136, 0
    v_accvgpr_write_b32 a137, 0
    v_accvgpr_write_b32 a138, 0
    v_accvgpr_write_b32 a139, 0
    v_accvgpr_write_b32 a140, 0
    v_accvgpr_write_b32 a141, 0
    v_accvgpr_write_b32 a142, 0
    v_accvgpr_write_b32 a143, 0
    v_accvgpr_write_b32 a144, 0
    v_accvgpr_write_b32 a145, 0
    v_accvgpr_write_b32 a146, 0
    v_accvgpr_write_b32 a147, 0
    v_accvgpr_write_b32 a148, 0
    v_accvgpr_write_b32 a149, 0
    v_accvgpr_write_b32 a150, 0
    v_accvgpr_write_b32 a151, 0
    v_accvgpr_write_b32 a152, 0
    v_accvgpr_write_b32 a153, 0
    v_accvgpr_write_b32 a154, 0
    v_accvgpr_write_b32 a155, 0
    v_accvgpr_write_b32 a156, 0
    v_accvgpr_write_b32 a157, 0
    v_accvgpr_write_b32 a158, 0
    v_accvgpr_write_b32 a159, 0
    v_accvgpr_write_b32 a160, 0
    v_accvgpr_write_b32 a161, 0
    v_accvgpr_write_b32 a162, 0
    v_accvgpr_write_b32 a163, 0
    v_accvgpr_write_b32 a164, 0
    v_accvgpr_write_b32 a165, 0
    v_accvgpr_write_b32 a166, 0
    v_accvgpr_write_b32 a167, 0
    v_accvgpr_write_b32 a168, 0
    v_accvgpr_write_b32 a169, 0
    v_accvgpr_write_b32 a170, 0
    v_accvgpr_write_b32 a171, 0
    v_accvgpr_write_b32 a172, 0
    v_accvgpr_write_b32 a173, 0
    v_accvgpr_write_b32 a174, 0
    v_accvgpr_write_b32 a175, 0
    v_accvgpr_write_b32 a176, 0
    v_accvgpr_write_b32 a177, 0
    v_accvgpr_write_b32 a178, 0
    v_accvgpr_write_b32 a179, 0
    v_accvgpr_write_b32 a180, 0
    v_accvgpr_write_b32 a181, 0
    v_accvgpr_write_b32 a182, 0
    v_accvgpr_write_b32 a183, 0
    v_accvgpr_write_b32 a184, 0
    v_accvgpr_write_b32 a185, 0
    v_accvgpr_write_b32 a186, 0
    v_accvgpr_write_b32 a187, 0
    v_accvgpr_write_b32 a188, 0
    v_accvgpr_write_b32 a189, 0
    v_accvgpr_write_b32 a190, 0
    v_accvgpr_write_b32 a191, 0
    v_accvgpr_write_b32 a192, 0
    v_accvgpr_write_b32 a193, 0
    v_accvgpr_write_b32 a194, 0
    v_accvgpr_write_b32 a195, 0
    s_waitcnt lgkmcnt(0)
    buffer_load_dwordx4 v[16:19], v6, s[12:15], 0 offen offset:0
    buffer_load_dwordx4 v[20:23], v7, s[12:15], 0 offen offset:0
    buffer_load_dwordx4 v[24:27], v8, s[12:15], 0 offen offset:0
    buffer_load_dwordx4 v[28:31], v9, s[12:15], 0 offen offset:0
    buffer_load_dwordx4 v[32:35], v10, s[12:15], 0 offen offset:0
    buffer_load_dwordx4 v[36:39], v11, s[12:15], 0 offen offset:0
    buffer_load_dwordx4 v[40:43], v12, s[12:15], 0 offen offset:0
    buffer_load_dwordx4 v[72:75], v130, s[16:19], 0 offen offset:0
    buffer_load_dwordx4 v[76:79], v131, s[16:19], 0 offen offset:0
    buffer_load_dwordx4 v[80:83], v132, s[16:19], 0 offen offset:0
    buffer_load_dwordx4 v[84:87], v133, s[16:19], 0 offen offset:0
    buffer_load_dwordx4 v[88:91], v134, s[16:19], 0 offen offset:0
    buffer_load_dwordx4 v[92:95], v135, s[16:19], 0 offen offset:0
    buffer_load_dwordx4 v[96:99], v136, s[16:19], 0 offen offset:0
    buffer_load_dwordx4 v[44:47], v6, s[12:15], 0 offen offset:64
    buffer_load_dwordx4 v[48:51], v7, s[12:15], 0 offen offset:64
    buffer_load_dwordx4 v[52:55], v8, s[12:15], 0 offen offset:64
    buffer_load_dwordx4 v[56:59], v9, s[12:15], 0 offen offset:64
    buffer_load_dwordx4 v[60:63], v10, s[12:15], 0 offen offset:64
    buffer_load_dwordx4 v[64:67], v11, s[12:15], 0 offen offset:64
    buffer_load_dwordx4 v[68:71], v12, s[12:15], 0 offen offset:64
    buffer_load_dwordx4 v[100:103], v130, s[16:19], 0 offen offset:64
    buffer_load_dwordx4 v[104:107], v131, s[16:19], 0 offen offset:64
    buffer_load_dwordx4 v[108:111], v132, s[16:19], 0 offen offset:64
    buffer_load_dwordx4 v[112:115], v133, s[16:19], 0 offen offset:64
    buffer_load_dwordx4 v[116:119], v134, s[16:19], 0 offen offset:64
    buffer_load_dwordx4 v[120:123], v135, s[16:19], 0 offen offset:64
    buffer_load_dwordx4 v[124:127], v136, s[16:19], 0 offen offset:64
    s_waitcnt vmcnt(14)
    v_mfma_f32_16x16x32_bf16 a[0:3], v[16:19], v[72:75], a[0:3]
    v_mfma_f32_16x16x32_bf16 a[4:7], v[16:19], v[76:79], a[4:7]
    v_mfma_f32_16x16x32_bf16 a[8:11], v[16:19], v[80:83], a[8:11]
    v_mfma_f32_16x16x32_bf16 a[12:15], v[16:19], v[84:87], a[12:15]
    v_mfma_f32_16x16x32_bf16 a[16:19], v[16:19], v[88:91], a[16:19]
    v_mfma_f32_16x16x32_bf16 a[20:23], v[16:19], v[92:95], a[20:23]
    v_mfma_f32_16x16x32_bf16 a[24:27], v[16:19], v[96:99], a[24:27]
    v_mfma_f32_16x16x32_bf16 a[28:31], v[20:23], v[72:75], a[28:31]
    v_mfma_f32_16x16x32_bf16 a[32:35], v[20:23], v[76:79], a[32:35]
    v_mfma_f32_16x16x32_bf16 a[36:39], v[20:23], v[80:83], a[36:39]
    v_mfma_f32_16x16x32_bf16 a[40:43], v[20:23], v[84:87], a[40:43]
    v_mfma_f32_16x16x32_bf16 a[44:47], v[20:23], v[88:91], a[44:47]
    v_mfma_f32_16x16x32_bf16 a[48:51], v[20:23], v[92:95], a[48:51]
    v_mfma_f32_16x16x32_bf16 a[52:55], v[20:23], v[96:99], a[52:55]
    v_mfma_f32_16x16x32_bf16 a[56:59], v[24:27], v[72:75], a[56:59]
    v_mfma_f32_16x16x32_bf16 a[60:63], v[24:27], v[76:79], a[60:63]
    v_mfma_f32_16x16x32_bf16 a[64:67], v[24:27], v[80:83], a[64:67]
    v_mfma_f32_16x16x32_bf16 a[68:71], v[24:27], v[84:87], a[68:71]
    v_mfma_f32_16x16x32_bf16 a[72:75], v[24:27], v[88:91], a[72:75]
    v_mfma_f32_16x16x32_bf16 a[76:79], v[24:27], v[92:95], a[76:79]
    v_mfma_f32_16x16x32_bf16 a[80:83], v[24:27], v[96:99], a[80:83]
    v_mfma_f32_16x16x32_bf16 a[84:87], v[28:31], v[72:75], a[84:87]
    v_mfma_f32_16x16x32_bf16 a[88:91], v[28:31], v[76:79], a[88:91]
    v_mfma_f32_16x16x32_bf16 a[92:95], v[28:31], v[80:83], a[92:95]
    v_mfma_f32_16x16x32_bf16 a[96:99], v[28:31], v[84:87], a[96:99]
    v_mfma_f32_16x16x32_bf16 a[100:103], v[28:31], v[88:91], a[100:103]
    v_mfma_f32_16x16x32_bf16 a[104:107], v[28:31], v[92:95], a[104:107]
    v_mfma_f32_16x16x32_bf16 a[108:111], v[28:31], v[96:99], a[108:111]
    v_mfma_f32_16x16x32_bf16 a[112:115], v[32:35], v[72:75], a[112:115]
    v_mfma_f32_16x16x32_bf16 a[116:119], v[32:35], v[76:79], a[116:119]
    v_mfma_f32_16x16x32_bf16 a[120:123], v[32:35], v[80:83], a[120:123]
    v_mfma_f32_16x16x32_bf16 a[124:127], v[32:35], v[84:87], a[124:127]
    v_mfma_f32_16x16x32_bf16 a[128:131], v[32:35], v[88:91], a[128:131]
    v_mfma_f32_16x16x32_bf16 a[132:135], v[32:35], v[92:95], a[132:135]
    v_mfma_f32_16x16x32_bf16 a[136:139], v[32:35], v[96:99], a[136:139]
    v_mfma_f32_16x16x32_bf16 a[140:143], v[36:39], v[72:75], a[140:143]
    v_mfma_f32_16x16x32_bf16 a[144:147], v[36:39], v[76:79], a[144:147]
    v_mfma_f32_16x16x32_bf16 a[148:151], v[36:39], v[80:83], a[148:151]
    v_mfma_f32_16x16x32_bf16 a[152:155], v[36:39], v[84:87], a[152:155]
    v_mfma_f32_16x16x32_bf16 a[156:159], v[36:39], v[88:91], a[156:159]
    v_mfma_f32_16x16x32_bf16 a[160:163], v[36:39], v[92:95], a[160:163]
    v_mfma_f32_16x16x32_bf16 a[164:167], v[36:39], v[96:99], a[164:167]
    v_mfma_f32_16x16x32_bf16 a[168:171], v[40:43], v[72:75], a[168:171]
    v_mfma_f32_16x16x32_bf16 a[172:175], v[40:43], v[76:79], a[172:175]
    v_mfma_f32_16x16x32_bf16 a[176:179], v[40:43], v[80:83], a[176:179]
    v_mfma_f32_16x16x32_bf16 a[180:183], v[40:43], v[84:87], a[180:183]
    v_mfma_f32_16x16x32_bf16 a[184:187], v[40:43], v[88:91], a[184:187]
    v_mfma_f32_16x16x32_bf16 a[188:191], v[40:43], v[92:95], a[188:191]
    v_mfma_f32_16x16x32_bf16 a[192:195], v[40:43], v[96:99], a[192:195]
    buffer_load_dwordx4 v[16:19], v6, s[12:15], 0 offen offset:128
    buffer_load_dwordx4 v[20:23], v7, s[12:15], 0 offen offset:128
    buffer_load_dwordx4 v[24:27], v8, s[12:15], 0 offen offset:128
    buffer_load_dwordx4 v[28:31], v9, s[12:15], 0 offen offset:128
    buffer_load_dwordx4 v[32:35], v10, s[12:15], 0 offen offset:128
    buffer_load_dwordx4 v[36:39], v11, s[12:15], 0 offen offset:128
    buffer_load_dwordx4 v[40:43], v12, s[12:15], 0 offen offset:128
    buffer_load_dwordx4 v[72:75], v130, s[16:19], 0 offen offset:128
    buffer_load_dwordx4 v[76:79], v131, s[16:19], 0 offen offset:128
    buffer_load_dwordx4 v[80:83], v132, s[16:19], 0 offen offset:128
    buffer_load_dwordx4 v[84:87], v133, s[16:19], 0 offen offset:128
    buffer_load_dwordx4 v[88:91], v134, s[16:19], 0 offen offset:128
    buffer_load_dwordx4 v[92:95], v135, s[16:19], 0 offen offset:128
    buffer_load_dwordx4 v[96:99], v136, s[16:19], 0 offen offset:128
    s_waitcnt vmcnt(14)
    v_mfma_f32_16x16x32_bf16 a[0:3], v[44:47], v[100:103], a[0:3]
    v_mfma_f32_16x16x32_bf16 a[4:7], v[44:47], v[104:107], a[4:7]
    v_mfma_f32_16x16x32_bf16 a[8:11], v[44:47], v[108:111], a[8:11]
    v_mfma_f32_16x16x32_bf16 a[12:15], v[44:47], v[112:115], a[12:15]
    v_mfma_f32_16x16x32_bf16 a[16:19], v[44:47], v[116:119], a[16:19]
    v_mfma_f32_16x16x32_bf16 a[20:23], v[44:47], v[120:123], a[20:23]
    v_mfma_f32_16x16x32_bf16 a[24:27], v[44:47], v[124:127], a[24:27]
    v_mfma_f32_16x16x32_bf16 a[28:31], v[48:51], v[100:103], a[28:31]
    v_mfma_f32_16x16x32_bf16 a[32:35], v[48:51], v[104:107], a[32:35]
    v_mfma_f32_16x16x32_bf16 a[36:39], v[48:51], v[108:111], a[36:39]
    v_mfma_f32_16x16x32_bf16 a[40:43], v[48:51], v[112:115], a[40:43]
    v_mfma_f32_16x16x32_bf16 a[44:47], v[48:51], v[116:119], a[44:47]
    v_mfma_f32_16x16x32_bf16 a[48:51], v[48:51], v[120:123], a[48:51]
    v_mfma_f32_16x16x32_bf16 a[52:55], v[48:51], v[124:127], a[52:55]
    v_mfma_f32_16x16x32_bf16 a[56:59], v[52:55], v[100:103], a[56:59]
    v_mfma_f32_16x16x32_bf16 a[60:63], v[52:55], v[104:107], a[60:63]
    v_mfma_f32_16x16x32_bf16 a[64:67], v[52:55], v[108:111], a[64:67]
    v_mfma_f32_16x16x32_bf16 a[68:71], v[52:55], v[112:115], a[68:71]
    v_mfma_f32_16x16x32_bf16 a[72:75], v[52:55], v[116:119], a[72:75]
    v_mfma_f32_16x16x32_bf16 a[76:79], v[52:55], v[120:123], a[76:79]
    v_mfma_f32_16x16x32_bf16 a[80:83], v[52:55], v[124:127], a[80:83]
    v_mfma_f32_16x16x32_bf16 a[84:87], v[56:59], v[100:103], a[84:87]
    v_mfma_f32_16x16x32_bf16 a[88:91], v[56:59], v[104:107], a[88:91]
    v_mfma_f32_16x16x32_bf16 a[92:95], v[56:59], v[108:111], a[92:95]
    v_mfma_f32_16x16x32_bf16 a[96:99], v[56:59], v[112:115], a[96:99]
    v_mfma_f32_16x16x32_bf16 a[100:103], v[56:59], v[116:119], a[100:103]
    v_mfma_f32_16x16x32_bf16 a[104:107], v[56:59], v[120:123], a[104:107]
    v_mfma_f32_16x16x32_bf16 a[108:111], v[56:59], v[124:127], a[108:111]
    v_mfma_f32_16x16x32_bf16 a[112:115], v[60:63], v[100:103], a[112:115]
    v_mfma_f32_16x16x32_bf16 a[116:119], v[60:63], v[104:107], a[116:119]
    v_mfma_f32_16x16x32_bf16 a[120:123], v[60:63], v[108:111], a[120:123]
    v_mfma_f32_16x16x32_bf16 a[124:127], v[60:63], v[112:115], a[124:127]
    v_mfma_f32_16x16x32_bf16 a[128:131], v[60:63], v[116:119], a[128:131]
    v_mfma_f32_16x16x32_bf16 a[132:135], v[60:63], v[120:123], a[132:135]
    v_mfma_f32_16x16x32_bf16 a[136:139], v[60:63], v[124:127], a[136:139]
    v_mfma_f32_16x16x32_bf16 a[140:143], v[64:67], v[100:103], a[140:143]
    v_mfma_f32_16x16x32_bf16 a[144:147], v[64:67], v[104:107], a[144:147]
    v_mfma_f32_16x16x32_bf16 a[148:151], v[64:67], v[108:111], a[148:151]
    v_mfma_f32_16x16x32_bf16 a[152:155], v[64:67], v[112:115], a[152:155]
    v_mfma_f32_16x16x32_bf16 a[156:159], v[64:67], v[116:119], a[156:159]
    v_mfma_f32_16x16x32_bf16 a[160:163], v[64:67], v[120:123], a[160:163]
    v_mfma_f32_16x16x32_bf16 a[164:167], v[64:67], v[124:127], a[164:167]
    v_mfma_f32_16x16x32_bf16 a[168:171], v[68:71], v[100:103], a[168:171]
    v_mfma_f32_16x16x32_bf16 a[172:175], v[68:71], v[104:107], a[172:175]
    v_mfma_f32_16x16x32_bf16 a[176:179], v[68:71], v[108:111], a[176:179]
    v_mfma_f32_16x16x32_bf16 a[180:183], v[68:71], v[112:115], a[180:183]
    v_mfma_f32_16x16x32_bf16 a[184:187], v[68:71], v[116:119], a[184:187]
    v_mfma_f32_16x16x32_bf16 a[188:191], v[68:71], v[120:123], a[188:191]
    v_mfma_f32_16x16x32_bf16 a[192:195], v[68:71], v[124:127], a[192:195]
    buffer_load_dwordx4 v[44:47], v6, s[12:15], 0 offen offset:192
    buffer_load_dwordx4 v[48:51], v7, s[12:15], 0 offen offset:192
    buffer_load_dwordx4 v[52:55], v8, s[12:15], 0 offen offset:192
    buffer_load_dwordx4 v[56:59], v9, s[12:15], 0 offen offset:192
    buffer_load_dwordx4 v[60:63], v10, s[12:15], 0 offen offset:192
    buffer_load_dwordx4 v[64:67], v11, s[12:15], 0 offen offset:192
    buffer_load_dwordx4 v[68:71], v12, s[12:15], 0 offen offset:192
    buffer_load_dwordx4 v[100:103], v130, s[16:19], 0 offen offset:192
    buffer_load_dwordx4 v[104:107], v131, s[16:19], 0 offen offset:192
    buffer_load_dwordx4 v[108:111], v132, s[16:19], 0 offen offset:192
    buffer_load_dwordx4 v[112:115], v133, s[16:19], 0 offen offset:192
    buffer_load_dwordx4 v[116:119], v134, s[16:19], 0 offen offset:192
    buffer_load_dwordx4 v[120:123], v135, s[16:19], 0 offen offset:192
    buffer_load_dwordx4 v[124:127], v136, s[16:19], 0 offen offset:192
    s_waitcnt vmcnt(14)
    v_mfma_f32_16x16x32_bf16 a[0:3], v[16:19], v[72:75], a[0:3]
    v_mfma_f32_16x16x32_bf16 a[4:7], v[16:19], v[76:79], a[4:7]
    v_mfma_f32_16x16x32_bf16 a[8:11], v[16:19], v[80:83], a[8:11]
    v_mfma_f32_16x16x32_bf16 a[12:15], v[16:19], v[84:87], a[12:15]
    v_mfma_f32_16x16x32_bf16 a[16:19], v[16:19], v[88:91], a[16:19]
    v_mfma_f32_16x16x32_bf16 a[20:23], v[16:19], v[92:95], a[20:23]
    v_mfma_f32_16x16x32_bf16 a[24:27], v[16:19], v[96:99], a[24:27]
    v_mfma_f32_16x16x32_bf16 a[28:31], v[20:23], v[72:75], a[28:31]
    v_mfma_f32_16x16x32_bf16 a[32:35], v[20:23], v[76:79], a[32:35]
    v_mfma_f32_16x16x32_bf16 a[36:39], v[20:23], v[80:83], a[36:39]
    v_mfma_f32_16x16x32_bf16 a[40:43], v[20:23], v[84:87], a[40:43]
    v_mfma_f32_16x16x32_bf16 a[44:47], v[20:23], v[88:91], a[44:47]
    v_mfma_f32_16x16x32_bf16 a[48:51], v[20:23], v[92:95], a[48:51]
    v_mfma_f32_16x16x32_bf16 a[52:55], v[20:23], v[96:99], a[52:55]
    v_mfma_f32_16x16x32_bf16 a[56:59], v[24:27], v[72:75], a[56:59]
    v_mfma_f32_16x16x32_bf16 a[60:63], v[24:27], v[76:79], a[60:63]
    v_mfma_f32_16x16x32_bf16 a[64:67], v[24:27], v[80:83], a[64:67]
    v_mfma_f32_16x16x32_bf16 a[68:71], v[24:27], v[84:87], a[68:71]
    v_mfma_f32_16x16x32_bf16 a[72:75], v[24:27], v[88:91], a[72:75]
    v_mfma_f32_16x16x32_bf16 a[76:79], v[24:27], v[92:95], a[76:79]
    v_mfma_f32_16x16x32_bf16 a[80:83], v[24:27], v[96:99], a[80:83]
    v_mfma_f32_16x16x32_bf16 a[84:87], v[28:31], v[72:75], a[84:87]
    v_mfma_f32_16x16x32_bf16 a[88:91], v[28:31], v[76:79], a[88:91]
    v_mfma_f32_16x16x32_bf16 a[92:95], v[28:31], v[80:83], a[92:95]
    v_mfma_f32_16x16x32_bf16 a[96:99], v[28:31], v[84:87], a[96:99]
    v_mfma_f32_16x16x32_bf16 a[100:103], v[28:31], v[88:91], a[100:103]
    v_mfma_f32_16x16x32_bf16 a[104:107], v[28:31], v[92:95], a[104:107]
    v_mfma_f32_16x16x32_bf16 a[108:111], v[28:31], v[96:99], a[108:111]
    v_mfma_f32_16x16x32_bf16 a[112:115], v[32:35], v[72:75], a[112:115]
    v_mfma_f32_16x16x32_bf16 a[116:119], v[32:35], v[76:79], a[116:119]
    v_mfma_f32_16x16x32_bf16 a[120:123], v[32:35], v[80:83], a[120:123]
    v_mfma_f32_16x16x32_bf16 a[124:127], v[32:35], v[84:87], a[124:127]
    v_mfma_f32_16x16x32_bf16 a[128:131], v[32:35], v[88:91], a[128:131]
    v_mfma_f32_16x16x32_bf16 a[132:135], v[32:35], v[92:95], a[132:135]
    v_mfma_f32_16x16x32_bf16 a[136:139], v[32:35], v[96:99], a[136:139]
    v_mfma_f32_16x16x32_bf16 a[140:143], v[36:39], v[72:75], a[140:143]
    v_mfma_f32_16x16x32_bf16 a[144:147], v[36:39], v[76:79], a[144:147]
    v_mfma_f32_16x16x32_bf16 a[148:151], v[36:39], v[80:83], a[148:151]
    v_mfma_f32_16x16x32_bf16 a[152:155], v[36:39], v[84:87], a[152:155]
    v_mfma_f32_16x16x32_bf16 a[156:159], v[36:39], v[88:91], a[156:159]
    v_mfma_f32_16x16x32_bf16 a[160:163], v[36:39], v[92:95], a[160:163]
    v_mfma_f32_16x16x32_bf16 a[164:167], v[36:39], v[96:99], a[164:167]
    v_mfma_f32_16x16x32_bf16 a[168:171], v[40:43], v[72:75], a[168:171]
    v_mfma_f32_16x16x32_bf16 a[172:175], v[40:43], v[76:79], a[172:175]
    v_mfma_f32_16x16x32_bf16 a[176:179], v[40:43], v[80:83], a[176:179]
    v_mfma_f32_16x16x32_bf16 a[180:183], v[40:43], v[84:87], a[180:183]
    v_mfma_f32_16x16x32_bf16 a[184:187], v[40:43], v[88:91], a[184:187]
    v_mfma_f32_16x16x32_bf16 a[188:191], v[40:43], v[92:95], a[188:191]
    v_mfma_f32_16x16x32_bf16 a[192:195], v[40:43], v[96:99], a[192:195]
    buffer_load_dwordx4 v[16:19], v6, s[12:15], 0 offen offset:256
    buffer_load_dwordx4 v[20:23], v7, s[12:15], 0 offen offset:256
    buffer_load_dwordx4 v[24:27], v8, s[12:15], 0 offen offset:256
    buffer_load_dwordx4 v[28:31], v9, s[12:15], 0 offen offset:256
    buffer_load_dwordx4 v[32:35], v10, s[12:15], 0 offen offset:256
    buffer_load_dwordx4 v[36:39], v11, s[12:15], 0 offen offset:256
    buffer_load_dwordx4 v[40:43], v12, s[12:15], 0 offen offset:256
    buffer_load_dwordx4 v[72:75], v130, s[16:19], 0 offen offset:256
    buffer_load_dwordx4 v[76:79], v131, s[16:19], 0 offen offset:256
    buffer_load_dwordx4 v[80:83], v132, s[16:19], 0 offen offset:256
    buffer_load_dwordx4 v[84:87], v133, s[16:19], 0 offen offset:256
    buffer_load_dwordx4 v[88:91], v134, s[16:19], 0 offen offset:256
    buffer_load_dwordx4 v[92:95], v135, s[16:19], 0 offen offset:256
    buffer_load_dwordx4 v[96:99], v136, s[16:19], 0 offen offset:256
    s_waitcnt vmcnt(14)
    v_mfma_f32_16x16x32_bf16 a[0:3], v[44:47], v[100:103], a[0:3]
    v_mfma_f32_16x16x32_bf16 a[4:7], v[44:47], v[104:107], a[4:7]
    v_mfma_f32_16x16x32_bf16 a[8:11], v[44:47], v[108:111], a[8:11]
    v_mfma_f32_16x16x32_bf16 a[12:15], v[44:47], v[112:115], a[12:15]
    v_mfma_f32_16x16x32_bf16 a[16:19], v[44:47], v[116:119], a[16:19]
    v_mfma_f32_16x16x32_bf16 a[20:23], v[44:47], v[120:123], a[20:23]
    v_mfma_f32_16x16x32_bf16 a[24:27], v[44:47], v[124:127], a[24:27]
    v_mfma_f32_16x16x32_bf16 a[28:31], v[48:51], v[100:103], a[28:31]
    v_mfma_f32_16x16x32_bf16 a[32:35], v[48:51], v[104:107], a[32:35]
    v_mfma_f32_16x16x32_bf16 a[36:39], v[48:51], v[108:111], a[36:39]
    v_mfma_f32_16x16x32_bf16 a[40:43], v[48:51], v[112:115], a[40:43]
    v_mfma_f32_16x16x32_bf16 a[44:47], v[48:51], v[116:119], a[44:47]
    v_mfma_f32_16x16x32_bf16 a[48:51], v[48:51], v[120:123], a[48:51]
    v_mfma_f32_16x16x32_bf16 a[52:55], v[48:51], v[124:127], a[52:55]
    v_mfma_f32_16x16x32_bf16 a[56:59], v[52:55], v[100:103], a[56:59]
    v_mfma_f32_16x16x32_bf16 a[60:63], v[52:55], v[104:107], a[60:63]
    v_mfma_f32_16x16x32_bf16 a[64:67], v[52:55], v[108:111], a[64:67]
    v_mfma_f32_16x16x32_bf16 a[68:71], v[52:55], v[112:115], a[68:71]
    v_mfma_f32_16x16x32_bf16 a[72:75], v[52:55], v[116:119], a[72:75]
    v_mfma_f32_16x16x32_bf16 a[76:79], v[52:55], v[120:123], a[76:79]
    v_mfma_f32_16x16x32_bf16 a[80:83], v[52:55], v[124:127], a[80:83]
    v_mfma_f32_16x16x32_bf16 a[84:87], v[56:59], v[100:103], a[84:87]
    v_mfma_f32_16x16x32_bf16 a[88:91], v[56:59], v[104:107], a[88:91]
    v_mfma_f32_16x16x32_bf16 a[92:95], v[56:59], v[108:111], a[92:95]
    v_mfma_f32_16x16x32_bf16 a[96:99], v[56:59], v[112:115], a[96:99]
    v_mfma_f32_16x16x32_bf16 a[100:103], v[56:59], v[116:119], a[100:103]
    v_mfma_f32_16x16x32_bf16 a[104:107], v[56:59], v[120:123], a[104:107]
    v_mfma_f32_16x16x32_bf16 a[108:111], v[56:59], v[124:127], a[108:111]
    v_mfma_f32_16x16x32_bf16 a[112:115], v[60:63], v[100:103], a[112:115]
    v_mfma_f32_16x16x32_bf16 a[116:119], v[60:63], v[104:107], a[116:119]
    v_mfma_f32_16x16x32_bf16 a[120:123], v[60:63], v[108:111], a[120:123]
    v_mfma_f32_16x16x32_bf16 a[124:127], v[60:63], v[112:115], a[124:127]
    v_mfma_f32_16x16x32_bf16 a[128:131], v[60:63], v[116:119], a[128:131]
    v_mfma_f32_16x16x32_bf16 a[132:135], v[60:63], v[120:123], a[132:135]
    v_mfma_f32_16x16x32_bf16 a[136:139], v[60:63], v[124:127], a[136:139]
    v_mfma_f32_16x16x32_bf16 a[140:143], v[64:67], v[100:103], a[140:143]
    v_mfma_f32_16x16x32_bf16 a[144:147], v[64:67], v[104:107], a[144:147]
    v_mfma_f32_16x16x32_bf16 a[148:151], v[64:67], v[108:111], a[148:151]
    v_mfma_f32_16x16x32_bf16 a[152:155], v[64:67], v[112:115], a[152:155]
    v_mfma_f32_16x16x32_bf16 a[156:159], v[64:67], v[116:119], a[156:159]
    v_mfma_f32_16x16x32_bf16 a[160:163], v[64:67], v[120:123], a[160:163]
    v_mfma_f32_16x16x32_bf16 a[164:167], v[64:67], v[124:127], a[164:167]
    v_mfma_f32_16x16x32_bf16 a[168:171], v[68:71], v[100:103], a[168:171]
    v_mfma_f32_16x16x32_bf16 a[172:175], v[68:71], v[104:107], a[172:175]
    v_mfma_f32_16x16x32_bf16 a[176:179], v[68:71], v[108:111], a[176:179]
    v_mfma_f32_16x16x32_bf16 a[180:183], v[68:71], v[112:115], a[180:183]
    v_mfma_f32_16x16x32_bf16 a[184:187], v[68:71], v[116:119], a[184:187]
    v_mfma_f32_16x16x32_bf16 a[188:191], v[68:71], v[120:123], a[188:191]
    v_mfma_f32_16x16x32_bf16 a[192:195], v[68:71], v[124:127], a[192:195]
    buffer_load_dwordx4 v[44:47], v6, s[12:15], 0 offen offset:320
    buffer_load_dwordx4 v[48:51], v7, s[12:15], 0 offen offset:320
    buffer_load_dwordx4 v[52:55], v8, s[12:15], 0 offen offset:320
    buffer_load_dwordx4 v[56:59], v9, s[12:15], 0 offen offset:320
    buffer_load_dwordx4 v[60:63], v10, s[12:15], 0 offen offset:320
    buffer_load_dwordx4 v[64:67], v11, s[12:15], 0 offen offset:320
    buffer_load_dwordx4 v[68:71], v12, s[12:15], 0 offen offset:320
    buffer_load_dwordx4 v[100:103], v130, s[16:19], 0 offen offset:320
    buffer_load_dwordx4 v[104:107], v131, s[16:19], 0 offen offset:320
    buffer_load_dwordx4 v[108:111], v132, s[16:19], 0 offen offset:320
    buffer_load_dwordx4 v[112:115], v133, s[16:19], 0 offen offset:320
    buffer_load_dwordx4 v[116:119], v134, s[16:19], 0 offen offset:320
    buffer_load_dwordx4 v[120:123], v135, s[16:19], 0 offen offset:320
    buffer_load_dwordx4 v[124:127], v136, s[16:19], 0 offen offset:320
    s_waitcnt vmcnt(14)
    v_mfma_f32_16x16x32_bf16 a[0:3], v[16:19], v[72:75], a[0:3]
    v_mfma_f32_16x16x32_bf16 a[4:7], v[16:19], v[76:79], a[4:7]
    v_mfma_f32_16x16x32_bf16 a[8:11], v[16:19], v[80:83], a[8:11]
    v_mfma_f32_16x16x32_bf16 a[12:15], v[16:19], v[84:87], a[12:15]
    v_mfma_f32_16x16x32_bf16 a[16:19], v[16:19], v[88:91], a[16:19]
    v_mfma_f32_16x16x32_bf16 a[20:23], v[16:19], v[92:95], a[20:23]
    v_mfma_f32_16x16x32_bf16 a[24:27], v[16:19], v[96:99], a[24:27]
    v_mfma_f32_16x16x32_bf16 a[28:31], v[20:23], v[72:75], a[28:31]
    v_mfma_f32_16x16x32_bf16 a[32:35], v[20:23], v[76:79], a[32:35]
    v_mfma_f32_16x16x32_bf16 a[36:39], v[20:23], v[80:83], a[36:39]
    v_mfma_f32_16x16x32_bf16 a[40:43], v[20:23], v[84:87], a[40:43]
    v_mfma_f32_16x16x32_bf16 a[44:47], v[20:23], v[88:91], a[44:47]
    v_mfma_f32_16x16x32_bf16 a[48:51], v[20:23], v[92:95], a[48:51]
    v_mfma_f32_16x16x32_bf16 a[52:55], v[20:23], v[96:99], a[52:55]
    v_mfma_f32_16x16x32_bf16 a[56:59], v[24:27], v[72:75], a[56:59]
    v_mfma_f32_16x16x32_bf16 a[60:63], v[24:27], v[76:79], a[60:63]
    v_mfma_f32_16x16x32_bf16 a[64:67], v[24:27], v[80:83], a[64:67]
    v_mfma_f32_16x16x32_bf16 a[68:71], v[24:27], v[84:87], a[68:71]
    v_mfma_f32_16x16x32_bf16 a[72:75], v[24:27], v[88:91], a[72:75]
    v_mfma_f32_16x16x32_bf16 a[76:79], v[24:27], v[92:95], a[76:79]
    v_mfma_f32_16x16x32_bf16 a[80:83], v[24:27], v[96:99], a[80:83]
    v_mfma_f32_16x16x32_bf16 a[84:87], v[28:31], v[72:75], a[84:87]
    v_mfma_f32_16x16x32_bf16 a[88:91], v[28:31], v[76:79], a[88:91]
    v_mfma_f32_16x16x32_bf16 a[92:95], v[28:31], v[80:83], a[92:95]
    v_mfma_f32_16x16x32_bf16 a[96:99], v[28:31], v[84:87], a[96:99]
    v_mfma_f32_16x16x32_bf16 a[100:103], v[28:31], v[88:91], a[100:103]
    v_mfma_f32_16x16x32_bf16 a[104:107], v[28:31], v[92:95], a[104:107]
    v_mfma_f32_16x16x32_bf16 a[108:111], v[28:31], v[96:99], a[108:111]
    v_mfma_f32_16x16x32_bf16 a[112:115], v[32:35], v[72:75], a[112:115]
    v_mfma_f32_16x16x32_bf16 a[116:119], v[32:35], v[76:79], a[116:119]
    v_mfma_f32_16x16x32_bf16 a[120:123], v[32:35], v[80:83], a[120:123]
    v_mfma_f32_16x16x32_bf16 a[124:127], v[32:35], v[84:87], a[124:127]
    v_mfma_f32_16x16x32_bf16 a[128:131], v[32:35], v[88:91], a[128:131]
    v_mfma_f32_16x16x32_bf16 a[132:135], v[32:35], v[92:95], a[132:135]
    v_mfma_f32_16x16x32_bf16 a[136:139], v[32:35], v[96:99], a[136:139]
    v_mfma_f32_16x16x32_bf16 a[140:143], v[36:39], v[72:75], a[140:143]
    v_mfma_f32_16x16x32_bf16 a[144:147], v[36:39], v[76:79], a[144:147]
    v_mfma_f32_16x16x32_bf16 a[148:151], v[36:39], v[80:83], a[148:151]
    v_mfma_f32_16x16x32_bf16 a[152:155], v[36:39], v[84:87], a[152:155]
    v_mfma_f32_16x16x32_bf16 a[156:159], v[36:39], v[88:91], a[156:159]
    v_mfma_f32_16x16x32_bf16 a[160:163], v[36:39], v[92:95], a[160:163]
    v_mfma_f32_16x16x32_bf16 a[164:167], v[36:39], v[96:99], a[164:167]
    v_mfma_f32_16x16x32_bf16 a[168:171], v[40:43], v[72:75], a[168:171]
    v_mfma_f32_16x16x32_bf16 a[172:175], v[40:43], v[76:79], a[172:175]
    v_mfma_f32_16x16x32_bf16 a[176:179], v[40:43], v[80:83], a[176:179]
    v_mfma_f32_16x16x32_bf16 a[180:183], v[40:43], v[84:87], a[180:183]
    v_mfma_f32_16x16x32_bf16 a[184:187], v[40:43], v[88:91], a[184:187]
    v_mfma_f32_16x16x32_bf16 a[188:191], v[40:43], v[92:95], a[188:191]
    v_mfma_f32_16x16x32_bf16 a[192:195], v[40:43], v[96:99], a[192:195]
    buffer_load_dwordx4 v[16:19], v6, s[12:15], 0 offen offset:384
    buffer_load_dwordx4 v[20:23], v7, s[12:15], 0 offen offset:384
    buffer_load_dwordx4 v[24:27], v8, s[12:15], 0 offen offset:384
    buffer_load_dwordx4 v[28:31], v9, s[12:15], 0 offen offset:384
    buffer_load_dwordx4 v[32:35], v10, s[12:15], 0 offen offset:384
    buffer_load_dwordx4 v[36:39], v11, s[12:15], 0 offen offset:384
    buffer_load_dwordx4 v[40:43], v12, s[12:15], 0 offen offset:384
    buffer_load_dwordx4 v[72:75], v130, s[16:19], 0 offen offset:384
    buffer_load_dwordx4 v[76:79], v131, s[16:19], 0 offen offset:384
    buffer_load_dwordx4 v[80:83], v132, s[16:19], 0 offen offset:384
    buffer_load_dwordx4 v[84:87], v133, s[16:19], 0 offen offset:384
    buffer_load_dwordx4 v[88:91], v134, s[16:19], 0 offen offset:384
    buffer_load_dwordx4 v[92:95], v135, s[16:19], 0 offen offset:384
    buffer_load_dwordx4 v[96:99], v136, s[16:19], 0 offen offset:384
    s_waitcnt vmcnt(14)
    v_mfma_f32_16x16x32_bf16 a[0:3], v[44:47], v[100:103], a[0:3]
    v_mfma_f32_16x16x32_bf16 a[4:7], v[44:47], v[104:107], a[4:7]
    v_mfma_f32_16x16x32_bf16 a[8:11], v[44:47], v[108:111], a[8:11]
    v_mfma_f32_16x16x32_bf16 a[12:15], v[44:47], v[112:115], a[12:15]
    v_mfma_f32_16x16x32_bf16 a[16:19], v[44:47], v[116:119], a[16:19]
    v_mfma_f32_16x16x32_bf16 a[20:23], v[44:47], v[120:123], a[20:23]
    v_mfma_f32_16x16x32_bf16 a[24:27], v[44:47], v[124:127], a[24:27]
    v_mfma_f32_16x16x32_bf16 a[28:31], v[48:51], v[100:103], a[28:31]
    v_mfma_f32_16x16x32_bf16 a[32:35], v[48:51], v[104:107], a[32:35]
    v_mfma_f32_16x16x32_bf16 a[36:39], v[48:51], v[108:111], a[36:39]
    v_mfma_f32_16x16x32_bf16 a[40:43], v[48:51], v[112:115], a[40:43]
    v_mfma_f32_16x16x32_bf16 a[44:47], v[48:51], v[116:119], a[44:47]
    v_mfma_f32_16x16x32_bf16 a[48:51], v[48:51], v[120:123], a[48:51]
    v_mfma_f32_16x16x32_bf16 a[52:55], v[48:51], v[124:127], a[52:55]
    v_mfma_f32_16x16x32_bf16 a[56:59], v[52:55], v[100:103], a[56:59]
    v_mfma_f32_16x16x32_bf16 a[60:63], v[52:55], v[104:107], a[60:63]
    v_mfma_f32_16x16x32_bf16 a[64:67], v[52:55], v[108:111], a[64:67]
    v_mfma_f32_16x16x32_bf16 a[68:71], v[52:55], v[112:115], a[68:71]
    v_mfma_f32_16x16x32_bf16 a[72:75], v[52:55], v[116:119], a[72:75]
    v_mfma_f32_16x16x32_bf16 a[76:79], v[52:55], v[120:123], a[76:79]
    v_mfma_f32_16x16x32_bf16 a[80:83], v[52:55], v[124:127], a[80:83]
    v_mfma_f32_16x16x32_bf16 a[84:87], v[56:59], v[100:103], a[84:87]
    v_mfma_f32_16x16x32_bf16 a[88:91], v[56:59], v[104:107], a[88:91]
    v_mfma_f32_16x16x32_bf16 a[92:95], v[56:59], v[108:111], a[92:95]
    v_mfma_f32_16x16x32_bf16 a[96:99], v[56:59], v[112:115], a[96:99]
    v_mfma_f32_16x16x32_bf16 a[100:103], v[56:59], v[116:119], a[100:103]
    v_mfma_f32_16x16x32_bf16 a[104:107], v[56:59], v[120:123], a[104:107]
    v_mfma_f32_16x16x32_bf16 a[108:111], v[56:59], v[124:127], a[108:111]
    v_mfma_f32_16x16x32_bf16 a[112:115], v[60:63], v[100:103], a[112:115]
    v_mfma_f32_16x16x32_bf16 a[116:119], v[60:63], v[104:107], a[116:119]
    v_mfma_f32_16x16x32_bf16 a[120:123], v[60:63], v[108:111], a[120:123]
    v_mfma_f32_16x16x32_bf16 a[124:127], v[60:63], v[112:115], a[124:127]
    v_mfma_f32_16x16x32_bf16 a[128:131], v[60:63], v[116:119], a[128:131]
    v_mfma_f32_16x16x32_bf16 a[132:135], v[60:63], v[120:123], a[132:135]
    v_mfma_f32_16x16x32_bf16 a[136:139], v[60:63], v[124:127], a[136:139]
    v_mfma_f32_16x16x32_bf16 a[140:143], v[64:67], v[100:103], a[140:143]
    v_mfma_f32_16x16x32_bf16 a[144:147], v[64:67], v[104:107], a[144:147]
    v_mfma_f32_16x16x32_bf16 a[148:151], v[64:67], v[108:111], a[148:151]
    v_mfma_f32_16x16x32_bf16 a[152:155], v[64:67], v[112:115], a[152:155]
    v_mfma_f32_16x16x32_bf16 a[156:159], v[64:67], v[116:119], a[156:159]
    v_mfma_f32_16x16x32_bf16 a[160:163], v[64:67], v[120:123], a[160:163]
    v_mfma_f32_16x16x32_bf16 a[164:167], v[64:67], v[124:127], a[164:167]
    v_mfma_f32_16x16x32_bf16 a[168:171], v[68:71], v[100:103], a[168:171]
    v_mfma_f32_16x16x32_bf16 a[172:175], v[68:71], v[104:107], a[172:175]
    v_mfma_f32_16x16x32_bf16 a[176:179], v[68:71], v[108:111], a[176:179]
    v_mfma_f32_16x16x32_bf16 a[180:183], v[68:71], v[112:115], a[180:183]
    v_mfma_f32_16x16x32_bf16 a[184:187], v[68:71], v[116:119], a[184:187]
    v_mfma_f32_16x16x32_bf16 a[188:191], v[68:71], v[120:123], a[188:191]
    v_mfma_f32_16x16x32_bf16 a[192:195], v[68:71], v[124:127], a[192:195]
    buffer_load_dwordx4 v[44:47], v6, s[12:15], 0 offen offset:448
    buffer_load_dwordx4 v[48:51], v7, s[12:15], 0 offen offset:448
    buffer_load_dwordx4 v[52:55], v8, s[12:15], 0 offen offset:448
    buffer_load_dwordx4 v[56:59], v9, s[12:15], 0 offen offset:448
    buffer_load_dwordx4 v[60:63], v10, s[12:15], 0 offen offset:448
    buffer_load_dwordx4 v[64:67], v11, s[12:15], 0 offen offset:448
    buffer_load_dwordx4 v[68:71], v12, s[12:15], 0 offen offset:448
    buffer_load_dwordx4 v[100:103], v130, s[16:19], 0 offen offset:448
    buffer_load_dwordx4 v[104:107], v131, s[16:19], 0 offen offset:448
    buffer_load_dwordx4 v[108:111], v132, s[16:19], 0 offen offset:448
    buffer_load_dwordx4 v[112:115], v133, s[16:19], 0 offen offset:448
    buffer_load_dwordx4 v[116:119], v134, s[16:19], 0 offen offset:448
    buffer_load_dwordx4 v[120:123], v135, s[16:19], 0 offen offset:448
    buffer_load_dwordx4 v[124:127], v136, s[16:19], 0 offen offset:448
    s_waitcnt vmcnt(14)
    v_mfma_f32_16x16x32_bf16 a[0:3], v[16:19], v[72:75], a[0:3]
    v_mfma_f32_16x16x32_bf16 a[4:7], v[16:19], v[76:79], a[4:7]
    v_mfma_f32_16x16x32_bf16 a[8:11], v[16:19], v[80:83], a[8:11]
    v_mfma_f32_16x16x32_bf16 a[12:15], v[16:19], v[84:87], a[12:15]
    v_mfma_f32_16x16x32_bf16 a[16:19], v[16:19], v[88:91], a[16:19]
    v_mfma_f32_16x16x32_bf16 a[20:23], v[16:19], v[92:95], a[20:23]
    v_mfma_f32_16x16x32_bf16 a[24:27], v[16:19], v[96:99], a[24:27]
    v_mfma_f32_16x16x32_bf16 a[28:31], v[20:23], v[72:75], a[28:31]
    v_mfma_f32_16x16x32_bf16 a[32:35], v[20:23], v[76:79], a[32:35]
    v_mfma_f32_16x16x32_bf16 a[36:39], v[20:23], v[80:83], a[36:39]
    v_mfma_f32_16x16x32_bf16 a[40:43], v[20:23], v[84:87], a[40:43]
    v_mfma_f32_16x16x32_bf16 a[44:47], v[20:23], v[88:91], a[44:47]
    v_mfma_f32_16x16x32_bf16 a[48:51], v[20:23], v[92:95], a[48:51]
    v_mfma_f32_16x16x32_bf16 a[52:55], v[20:23], v[96:99], a[52:55]
    v_mfma_f32_16x16x32_bf16 a[56:59], v[24:27], v[72:75], a[56:59]
    v_mfma_f32_16x16x32_bf16 a[60:63], v[24:27], v[76:79], a[60:63]
    v_mfma_f32_16x16x32_bf16 a[64:67], v[24:27], v[80:83], a[64:67]
    v_mfma_f32_16x16x32_bf16 a[68:71], v[24:27], v[84:87], a[68:71]
    v_mfma_f32_16x16x32_bf16 a[72:75], v[24:27], v[88:91], a[72:75]
    v_mfma_f32_16x16x32_bf16 a[76:79], v[24:27], v[92:95], a[76:79]
    v_mfma_f32_16x16x32_bf16 a[80:83], v[24:27], v[96:99], a[80:83]
    v_mfma_f32_16x16x32_bf16 a[84:87], v[28:31], v[72:75], a[84:87]
    v_mfma_f32_16x16x32_bf16 a[88:91], v[28:31], v[76:79], a[88:91]
    v_mfma_f32_16x16x32_bf16 a[92:95], v[28:31], v[80:83], a[92:95]
    v_mfma_f32_16x16x32_bf16 a[96:99], v[28:31], v[84:87], a[96:99]
    v_mfma_f32_16x16x32_bf16 a[100:103], v[28:31], v[88:91], a[100:103]
    v_mfma_f32_16x16x32_bf16 a[104:107], v[28:31], v[92:95], a[104:107]
    v_mfma_f32_16x16x32_bf16 a[108:111], v[28:31], v[96:99], a[108:111]
    v_mfma_f32_16x16x32_bf16 a[112:115], v[32:35], v[72:75], a[112:115]
    v_mfma_f32_16x16x32_bf16 a[116:119], v[32:35], v[76:79], a[116:119]
    v_mfma_f32_16x16x32_bf16 a[120:123], v[32:35], v[80:83], a[120:123]
    v_mfma_f32_16x16x32_bf16 a[124:127], v[32:35], v[84:87], a[124:127]
    v_mfma_f32_16x16x32_bf16 a[128:131], v[32:35], v[88:91], a[128:131]
    v_mfma_f32_16x16x32_bf16 a[132:135], v[32:35], v[92:95], a[132:135]
    v_mfma_f32_16x16x32_bf16 a[136:139], v[32:35], v[96:99], a[136:139]
    v_mfma_f32_16x16x32_bf16 a[140:143], v[36:39], v[72:75], a[140:143]
    v_mfma_f32_16x16x32_bf16 a[144:147], v[36:39], v[76:79], a[144:147]
    v_mfma_f32_16x16x32_bf16 a[148:151], v[36:39], v[80:83], a[148:151]
    v_mfma_f32_16x16x32_bf16 a[152:155], v[36:39], v[84:87], a[152:155]
    v_mfma_f32_16x16x32_bf16 a[156:159], v[36:39], v[88:91], a[156:159]
    v_mfma_f32_16x16x32_bf16 a[160:163], v[36:39], v[92:95], a[160:163]
    v_mfma_f32_16x16x32_bf16 a[164:167], v[36:39], v[96:99], a[164:167]
    v_mfma_f32_16x16x32_bf16 a[168:171], v[40:43], v[72:75], a[168:171]
    v_mfma_f32_16x16x32_bf16 a[172:175], v[40:43], v[76:79], a[172:175]
    v_mfma_f32_16x16x32_bf16 a[176:179], v[40:43], v[80:83], a[176:179]
    v_mfma_f32_16x16x32_bf16 a[180:183], v[40:43], v[84:87], a[180:183]
    v_mfma_f32_16x16x32_bf16 a[184:187], v[40:43], v[88:91], a[184:187]
    v_mfma_f32_16x16x32_bf16 a[188:191], v[40:43], v[92:95], a[188:191]
    v_mfma_f32_16x16x32_bf16 a[192:195], v[40:43], v[96:99], a[192:195]
    s_waitcnt vmcnt(0)
    v_mfma_f32_16x16x32_bf16 a[0:3], v[44:47], v[100:103], a[0:3]
    v_mfma_f32_16x16x32_bf16 a[4:7], v[44:47], v[104:107], a[4:7]
    v_mfma_f32_16x16x32_bf16 a[8:11], v[44:47], v[108:111], a[8:11]
    v_mfma_f32_16x16x32_bf16 a[12:15], v[44:47], v[112:115], a[12:15]
    v_mfma_f32_16x16x32_bf16 a[16:19], v[44:47], v[116:119], a[16:19]
    v_mfma_f32_16x16x32_bf16 a[20:23], v[44:47], v[120:123], a[20:23]
    v_mfma_f32_16x16x32_bf16 a[24:27], v[44:47], v[124:127], a[24:27]
    v_mfma_f32_16x16x32_bf16 a[28:31], v[48:51], v[100:103], a[28:31]
    v_mfma_f32_16x16x32_bf16 a[32:35], v[48:51], v[104:107], a[32:35]
    v_mfma_f32_16x16x32_bf16 a[36:39], v[48:51], v[108:111], a[36:39]
    v_mfma_f32_16x16x32_bf16 a[40:43], v[48:51], v[112:115], a[40:43]
    v_mfma_f32_16x16x32_bf16 a[44:47], v[48:51], v[116:119], a[44:47]
    v_mfma_f32_16x16x32_bf16 a[48:51], v[48:51], v[120:123], a[48:51]
    v_mfma_f32_16x16x32_bf16 a[52:55], v[48:51], v[124:127], a[52:55]
    v_mfma_f32_16x16x32_bf16 a[56:59], v[52:55], v[100:103], a[56:59]
    v_mfma_f32_16x16x32_bf16 a[60:63], v[52:55], v[104:107], a[60:63]
    v_mfma_f32_16x16x32_bf16 a[64:67], v[52:55], v[108:111], a[64:67]
    v_mfma_f32_16x16x32_bf16 a[68:71], v[52:55], v[112:115], a[68:71]
    v_mfma_f32_16x16x32_bf16 a[72:75], v[52:55], v[116:119], a[72:75]
    v_mfma_f32_16x16x32_bf16 a[76:79], v[52:55], v[120:123], a[76:79]
    v_mfma_f32_16x16x32_bf16 a[80:83], v[52:55], v[124:127], a[80:83]
    v_mfma_f32_16x16x32_bf16 a[84:87], v[56:59], v[100:103], a[84:87]
    v_mfma_f32_16x16x32_bf16 a[88:91], v[56:59], v[104:107], a[88:91]
    v_mfma_f32_16x16x32_bf16 a[92:95], v[56:59], v[108:111], a[92:95]
    v_mfma_f32_16x16x32_bf16 a[96:99], v[56:59], v[112:115], a[96:99]
    v_mfma_f32_16x16x32_bf16 a[100:103], v[56:59], v[116:119], a[100:103]
    v_mfma_f32_16x16x32_bf16 a[104:107], v[56:59], v[120:123], a[104:107]
    v_mfma_f32_16x16x32_bf16 a[108:111], v[56:59], v[124:127], a[108:111]
    v_mfma_f32_16x16x32_bf16 a[112:115], v[60:63], v[100:103], a[112:115]
    v_mfma_f32_16x16x32_bf16 a[116:119], v[60:63], v[104:107], a[116:119]
    v_mfma_f32_16x16x32_bf16 a[120:123], v[60:63], v[108:111], a[120:123]
    v_mfma_f32_16x16x32_bf16 a[124:127], v[60:63], v[112:115], a[124:127]
    v_mfma_f32_16x16x32_bf16 a[128:131], v[60:63], v[116:119], a[128:131]
    v_mfma_f32_16x16x32_bf16 a[132:135], v[60:63], v[120:123], a[132:135]
    v_mfma_f32_16x16x32_bf16 a[136:139], v[60:63], v[124:127], a[136:139]
    v_mfma_f32_16x16x32_bf16 a[140:143], v[64:67], v[100:103], a[140:143]
    v_mfma_f32_16x16x32_bf16 a[144:147], v[64:67], v[104:107], a[144:147]
    v_mfma_f32_16x16x32_bf16 a[148:151], v[64:67], v[108:111], a[148:151]
    v_mfma_f32_16x16x32_bf16 a[152:155], v[64:67], v[112:115], a[152:155]
    v_mfma_f32_16x16x32_bf16 a[156:159], v[64:67], v[116:119], a[156:159]
    v_mfma_f32_16x16x32_bf16 a[160:163], v[64:67], v[120:123], a[160:163]
    v_mfma_f32_16x16x32_bf16 a[164:167], v[64:67], v[124:127], a[164:167]
    v_mfma_f32_16x16x32_bf16 a[168:171], v[68:71], v[100:103], a[168:171]
    v_mfma_f32_16x16x32_bf16 a[172:175], v[68:71], v[104:107], a[172:175]
    v_mfma_f32_16x16x32_bf16 a[176:179], v[68:71], v[108:111], a[176:179]
    v_mfma_f32_16x16x32_bf16 a[180:183], v[68:71], v[112:115], a[180:183]
    v_mfma_f32_16x16x32_bf16 a[184:187], v[68:71], v[116:119], a[184:187]
    v_mfma_f32_16x16x32_bf16 a[188:191], v[68:71], v[120:123], a[188:191]
    v_mfma_f32_16x16x32_bf16 a[192:195], v[68:71], v[124:127], a[192:195]
    s_nop 7
    s_nop 7
    s_mul_i32 s25, s5, 7168
    s_mul_i32 s26, s6, 448
    s_add_u32 s25, s25, s26
    v_add_u32 v4, s25, v4
    v_mul_u32_u24 v4, 896, v4
    v_lshl_add_u32 v4, v2, 3, v4
    s_lshl_b32 s22, s22, 1
    s_add_u32 s22, s22, 2097152
    v_add_u32 v4, s22, v4
    v_accvgpr_read_b32 v140, a0
    v_accvgpr_read_b32 v141, a1
    v_accvgpr_read_b32 v142, a2
    v_accvgpr_read_b32 v143, a3
    v_cvt_pk_bf16_f32 v144, v140, v141
    v_cvt_pk_bf16_f32 v145, v142, v143
    buffer_store_dwordx2 v[144:145], v4, s[8:11], 0 offen offset:0
    s_nop 1
    v_accvgpr_read_b32 v140, a28
    v_accvgpr_read_b32 v141, a29
    v_accvgpr_read_b32 v142, a30
    v_accvgpr_read_b32 v143, a31
    v_cvt_pk_bf16_f32 v144, v140, v141
    v_cvt_pk_bf16_f32 v145, v142, v143
    buffer_store_dwordx2 v[144:145], v4, s[8:11], 0 offen offset:32
    s_nop 1
    v_accvgpr_read_b32 v140, a56
    v_accvgpr_read_b32 v141, a57
    v_accvgpr_read_b32 v142, a58
    v_accvgpr_read_b32 v143, a59
    v_cvt_pk_bf16_f32 v144, v140, v141
    v_cvt_pk_bf16_f32 v145, v142, v143
    buffer_store_dwordx2 v[144:145], v4, s[8:11], 0 offen offset:64
    s_nop 1
    v_accvgpr_read_b32 v140, a84
    v_accvgpr_read_b32 v141, a85
    v_accvgpr_read_b32 v142, a86
    v_accvgpr_read_b32 v143, a87
    v_cvt_pk_bf16_f32 v144, v140, v141
    v_cvt_pk_bf16_f32 v145, v142, v143
    buffer_store_dwordx2 v[144:145], v4, s[8:11], 0 offen offset:96
    s_nop 1
    v_accvgpr_read_b32 v140, a112
    v_accvgpr_read_b32 v141, a113
    v_accvgpr_read_b32 v142, a114
    v_accvgpr_read_b32 v143, a115
    v_cvt_pk_bf16_f32 v144, v140, v141
    v_cvt_pk_bf16_f32 v145, v142, v143
    buffer_store_dwordx2 v[144:145], v4, s[8:11], 0 offen offset:128
    s_nop 1
    v_accvgpr_read_b32 v140, a140
    v_accvgpr_read_b32 v141, a141
    v_accvgpr_read_b32 v142, a142
    v_accvgpr_read_b32 v143, a143
    v_cvt_pk_bf16_f32 v144, v140, v141
    v_cvt_pk_bf16_f32 v145, v142, v143
    buffer_store_dwordx2 v[144:145], v4, s[8:11], 0 offen offset:160
    s_nop 1
    v_accvgpr_read_b32 v140, a168
    v_accvgpr_read_b32 v141, a169
    v_accvgpr_read_b32 v142, a170
    v_accvgpr_read_b32 v143, a171
    v_cvt_pk_bf16_f32 v144, v140, v141
    v_cvt_pk_bf16_f32 v145, v142, v143
    buffer_store_dwordx2 v[144:145], v4, s[8:11], 0 offen offset:192
    s_nop 1
    v_add_u32 v4, 14336, v4
    v_accvgpr_read_b32 v140, a4
    v_accvgpr_read_b32 v141, a5
    v_accvgpr_read_b32 v142, a6
    v_accvgpr_read_b32 v143, a7
    v_cvt_pk_bf16_f32 v144, v140, v141
    v_cvt_pk_bf16_f32 v145, v142, v143
    buffer_store_dwordx2 v[144:145], v4, s[8:11], 0 offen offset:0
    s_nop 1
    v_accvgpr_read_b32 v140, a32
    v_accvgpr_read_b32 v141, a33
    v_accvgpr_read_b32 v142, a34
    v_accvgpr_read_b32 v143, a35
    v_cvt_pk_bf16_f32 v144, v140, v141
    v_cvt_pk_bf16_f32 v145, v142, v143
    buffer_store_dwordx2 v[144:145], v4, s[8:11], 0 offen offset:32
    s_nop 1
    v_accvgpr_read_b32 v140, a60
    v_accvgpr_read_b32 v141, a61
    v_accvgpr_read_b32 v142, a62
    v_accvgpr_read_b32 v143, a63
    v_cvt_pk_bf16_f32 v144, v140, v141
    v_cvt_pk_bf16_f32 v145, v142, v143
    buffer_store_dwordx2 v[144:145], v4, s[8:11], 0 offen offset:64
    s_nop 1
    v_accvgpr_read_b32 v140, a88
    v_accvgpr_read_b32 v141, a89
    v_accvgpr_read_b32 v142, a90
    v_accvgpr_read_b32 v143, a91
    v_cvt_pk_bf16_f32 v144, v140, v141
    v_cvt_pk_bf16_f32 v145, v142, v143
    buffer_store_dwordx2 v[144:145], v4, s[8:11], 0 offen offset:96
    s_nop 1
    v_accvgpr_read_b32 v140, a116
    v_accvgpr_read_b32 v141, a117
    v_accvgpr_read_b32 v142, a118
    v_accvgpr_read_b32 v143, a119
    v_cvt_pk_bf16_f32 v144, v140, v141
    v_cvt_pk_bf16_f32 v145, v142, v143
    buffer_store_dwordx2 v[144:145], v4, s[8:11], 0 offen offset:128
    s_nop 1
    v_accvgpr_read_b32 v140, a144
    v_accvgpr_read_b32 v141, a145
    v_accvgpr_read_b32 v142, a146
    v_accvgpr_read_b32 v143, a147
    v_cvt_pk_bf16_f32 v144, v140, v141
    v_cvt_pk_bf16_f32 v145, v142, v143
    buffer_store_dwordx2 v[144:145], v4, s[8:11], 0 offen offset:160
    s_nop 1
    v_accvgpr_read_b32 v140, a172
    v_accvgpr_read_b32 v141, a173
    v_accvgpr_read_b32 v142, a174
    v_accvgpr_read_b32 v143, a175
    v_cvt_pk_bf16_f32 v144, v140, v141
    v_cvt_pk_bf16_f32 v145, v142, v143
    buffer_store_dwordx2 v[144:145], v4, s[8:11], 0 offen offset:192
    s_nop 1
    v_add_u32 v4, 14336, v4
    v_accvgpr_read_b32 v140, a8
    v_accvgpr_read_b32 v141, a9
    v_accvgpr_read_b32 v142, a10
    v_accvgpr_read_b32 v143, a11
    v_cvt_pk_bf16_f32 v144, v140, v141
    v_cvt_pk_bf16_f32 v145, v142, v143
    buffer_store_dwordx2 v[144:145], v4, s[8:11], 0 offen offset:0
    s_nop 1
    v_accvgpr_read_b32 v140, a36
    v_accvgpr_read_b32 v141, a37
    v_accvgpr_read_b32 v142, a38
    v_accvgpr_read_b32 v143, a39
    v_cvt_pk_bf16_f32 v144, v140, v141
    v_cvt_pk_bf16_f32 v145, v142, v143
    buffer_store_dwordx2 v[144:145], v4, s[8:11], 0 offen offset:32
    s_nop 1
    v_accvgpr_read_b32 v140, a64
    v_accvgpr_read_b32 v141, a65
    v_accvgpr_read_b32 v142, a66
    v_accvgpr_read_b32 v143, a67
    v_cvt_pk_bf16_f32 v144, v140, v141
    v_cvt_pk_bf16_f32 v145, v142, v143
    buffer_store_dwordx2 v[144:145], v4, s[8:11], 0 offen offset:64
    s_nop 1
    v_accvgpr_read_b32 v140, a92
    v_accvgpr_read_b32 v141, a93
    v_accvgpr_read_b32 v142, a94
    v_accvgpr_read_b32 v143, a95
    v_cvt_pk_bf16_f32 v144, v140, v141
    v_cvt_pk_bf16_f32 v145, v142, v143
    buffer_store_dwordx2 v[144:145], v4, s[8:11], 0 offen offset:96
    s_nop 1
    v_accvgpr_read_b32 v140, a120
    v_accvgpr_read_b32 v141, a121
    v_accvgpr_read_b32 v142, a122
    v_accvgpr_read_b32 v143, a123
    v_cvt_pk_bf16_f32 v144, v140, v141
    v_cvt_pk_bf16_f32 v145, v142, v143
    buffer_store_dwordx2 v[144:145], v4, s[8:11], 0 offen offset:128
    s_nop 1
    v_accvgpr_read_b32 v140, a148
    v_accvgpr_read_b32 v141, a149
    v_accvgpr_read_b32 v142, a150
    v_accvgpr_read_b32 v143, a151
    v_cvt_pk_bf16_f32 v144, v140, v141
    v_cvt_pk_bf16_f32 v145, v142, v143
    buffer_store_dwordx2 v[144:145], v4, s[8:11], 0 offen offset:160
    s_nop 1
    v_accvgpr_read_b32 v140, a176
    v_accvgpr_read_b32 v141, a177
    v_accvgpr_read_b32 v142, a178
    v_accvgpr_read_b32 v143, a179
    v_cvt_pk_bf16_f32 v144, v140, v141
    v_cvt_pk_bf16_f32 v145, v142, v143
    buffer_store_dwordx2 v[144:145], v4, s[8:11], 0 offen offset:192
    s_nop 1
    v_add_u32 v4, 14336, v4
    v_accvgpr_read_b32 v140, a12
    v_accvgpr_read_b32 v141, a13
    v_accvgpr_read_b32 v142, a14
    v_accvgpr_read_b32 v143, a15
    v_cvt_pk_bf16_f32 v144, v140, v141
    v_cvt_pk_bf16_f32 v145, v142, v143
    buffer_store_dwordx2 v[144:145], v4, s[8:11], 0 offen offset:0
    s_nop 1
    v_accvgpr_read_b32 v140, a40
    v_accvgpr_read_b32 v141, a41
    v_accvgpr_read_b32 v142, a42
    v_accvgpr_read_b32 v143, a43
    v_cvt_pk_bf16_f32 v144, v140, v141
    v_cvt_pk_bf16_f32 v145, v142, v143
    buffer_store_dwordx2 v[144:145], v4, s[8:11], 0 offen offset:32
    s_nop 1
    v_accvgpr_read_b32 v140, a68
    v_accvgpr_read_b32 v141, a69
    v_accvgpr_read_b32 v142, a70
    v_accvgpr_read_b32 v143, a71
    v_cvt_pk_bf16_f32 v144, v140, v141
    v_cvt_pk_bf16_f32 v145, v142, v143
    buffer_store_dwordx2 v[144:145], v4, s[8:11], 0 offen offset:64
    s_nop 1
    v_accvgpr_read_b32 v140, a96
    v_accvgpr_read_b32 v141, a97
    v_accvgpr_read_b32 v142, a98
    v_accvgpr_read_b32 v143, a99
    v_cvt_pk_bf16_f32 v144, v140, v141
    v_cvt_pk_bf16_f32 v145, v142, v143
    buffer_store_dwordx2 v[144:145], v4, s[8:11], 0 offen offset:96
    s_nop 1
    v_accvgpr_read_b32 v140, a124
    v_accvgpr_read_b32 v141, a125
    v_accvgpr_read_b32 v142, a126
    v_accvgpr_read_b32 v143, a127
    v_cvt_pk_bf16_f32 v144, v140, v141
    v_cvt_pk_bf16_f32 v145, v142, v143
    buffer_store_dwordx2 v[144:145], v4, s[8:11], 0 offen offset:128
    s_nop 1
    v_accvgpr_read_b32 v140, a152
    v_accvgpr_read_b32 v141, a153
    v_accvgpr_read_b32 v142, a154
    v_accvgpr_read_b32 v143, a155
    v_cvt_pk_bf16_f32 v144, v140, v141
    v_cvt_pk_bf16_f32 v145, v142, v143
    buffer_store_dwordx2 v[144:145], v4, s[8:11], 0 offen offset:160
    s_nop 1
    v_accvgpr_read_b32 v140, a180
    v_accvgpr_read_b32 v141, a181
    v_accvgpr_read_b32 v142, a182
    v_accvgpr_read_b32 v143, a183
    v_cvt_pk_bf16_f32 v144, v140, v141
    v_cvt_pk_bf16_f32 v145, v142, v143
    buffer_store_dwordx2 v[144:145], v4, s[8:11], 0 offen offset:192
    s_nop 1
    v_add_u32 v4, 14336, v4
    v_accvgpr_read_b32 v140, a16
    v_accvgpr_read_b32 v141, a17
    v_accvgpr_read_b32 v142, a18
    v_accvgpr_read_b32 v143, a19
    v_cvt_pk_bf16_f32 v144, v140, v141
    v_cvt_pk_bf16_f32 v145, v142, v143
    buffer_store_dwordx2 v[144:145], v4, s[8:11], 0 offen offset:0
    s_nop 1
    v_accvgpr_read_b32 v140, a44
    v_accvgpr_read_b32 v141, a45
    v_accvgpr_read_b32 v142, a46
    v_accvgpr_read_b32 v143, a47
    v_cvt_pk_bf16_f32 v144, v140, v141
    v_cvt_pk_bf16_f32 v145, v142, v143
    buffer_store_dwordx2 v[144:145], v4, s[8:11], 0 offen offset:32
    s_nop 1
    v_accvgpr_read_b32 v140, a72
    v_accvgpr_read_b32 v141, a73
    v_accvgpr_read_b32 v142, a74
    v_accvgpr_read_b32 v143, a75
    v_cvt_pk_bf16_f32 v144, v140, v141
    v_cvt_pk_bf16_f32 v145, v142, v143
    buffer_store_dwordx2 v[144:145], v4, s[8:11], 0 offen offset:64
    s_nop 1
    v_accvgpr_read_b32 v140, a100
    v_accvgpr_read_b32 v141, a101
    v_accvgpr_read_b32 v142, a102
    v_accvgpr_read_b32 v143, a103
    v_cvt_pk_bf16_f32 v144, v140, v141
    v_cvt_pk_bf16_f32 v145, v142, v143
    buffer_store_dwordx2 v[144:145], v4, s[8:11], 0 offen offset:96
    s_nop 1
    v_accvgpr_read_b32 v140, a128
    v_accvgpr_read_b32 v141, a129
    v_accvgpr_read_b32 v142, a130
    v_accvgpr_read_b32 v143, a131
    v_cvt_pk_bf16_f32 v144, v140, v141
    v_cvt_pk_bf16_f32 v145, v142, v143
    buffer_store_dwordx2 v[144:145], v4, s[8:11], 0 offen offset:128
    s_nop 1
    v_accvgpr_read_b32 v140, a156
    v_accvgpr_read_b32 v141, a157
    v_accvgpr_read_b32 v142, a158
    v_accvgpr_read_b32 v143, a159
    v_cvt_pk_bf16_f32 v144, v140, v141
    v_cvt_pk_bf16_f32 v145, v142, v143
    buffer_store_dwordx2 v[144:145], v4, s[8:11], 0 offen offset:160
    s_nop 1
    v_accvgpr_read_b32 v140, a184
    v_accvgpr_read_b32 v141, a185
    v_accvgpr_read_b32 v142, a186
    v_accvgpr_read_b32 v143, a187
    v_cvt_pk_bf16_f32 v144, v140, v141
    v_cvt_pk_bf16_f32 v145, v142, v143
    buffer_store_dwordx2 v[144:145], v4, s[8:11], 0 offen offset:192
    s_nop 1
    v_add_u32 v4, 14336, v4
    v_accvgpr_read_b32 v140, a20
    v_accvgpr_read_b32 v141, a21
    v_accvgpr_read_b32 v142, a22
    v_accvgpr_read_b32 v143, a23
    v_cvt_pk_bf16_f32 v144, v140, v141
    v_cvt_pk_bf16_f32 v145, v142, v143
    buffer_store_dwordx2 v[144:145], v4, s[8:11], 0 offen offset:0
    s_nop 1
    v_accvgpr_read_b32 v140, a48
    v_accvgpr_read_b32 v141, a49
    v_accvgpr_read_b32 v142, a50
    v_accvgpr_read_b32 v143, a51
    v_cvt_pk_bf16_f32 v144, v140, v141
    v_cvt_pk_bf16_f32 v145, v142, v143
    buffer_store_dwordx2 v[144:145], v4, s[8:11], 0 offen offset:32
    s_nop 1
    v_accvgpr_read_b32 v140, a76
    v_accvgpr_read_b32 v141, a77
    v_accvgpr_read_b32 v142, a78
    v_accvgpr_read_b32 v143, a79
    v_cvt_pk_bf16_f32 v144, v140, v141
    v_cvt_pk_bf16_f32 v145, v142, v143
    buffer_store_dwordx2 v[144:145], v4, s[8:11], 0 offen offset:64
    s_nop 1
    v_accvgpr_read_b32 v140, a104
    v_accvgpr_read_b32 v141, a105
    v_accvgpr_read_b32 v142, a106
    v_accvgpr_read_b32 v143, a107
    v_cvt_pk_bf16_f32 v144, v140, v141
    v_cvt_pk_bf16_f32 v145, v142, v143
    buffer_store_dwordx2 v[144:145], v4, s[8:11], 0 offen offset:96
    s_nop 1
    v_accvgpr_read_b32 v140, a132
    v_accvgpr_read_b32 v141, a133
    v_accvgpr_read_b32 v142, a134
    v_accvgpr_read_b32 v143, a135
    v_cvt_pk_bf16_f32 v144, v140, v141
    v_cvt_pk_bf16_f32 v145, v142, v143
    buffer_store_dwordx2 v[144:145], v4, s[8:11], 0 offen offset:128
    s_nop 1
    v_accvgpr_read_b32 v140, a160
    v_accvgpr_read_b32 v141, a161
    v_accvgpr_read_b32 v142, a162
    v_accvgpr_read_b32 v143, a163
    v_cvt_pk_bf16_f32 v144, v140, v141
    v_cvt_pk_bf16_f32 v145, v142, v143
    buffer_store_dwordx2 v[144:145], v4, s[8:11], 0 offen offset:160
    s_nop 1
    v_accvgpr_read_b32 v140, a188
    v_accvgpr_read_b32 v141, a189
    v_accvgpr_read_b32 v142, a190
    v_accvgpr_read_b32 v143, a191
    v_cvt_pk_bf16_f32 v144, v140, v141
    v_cvt_pk_bf16_f32 v145, v142, v143
    buffer_store_dwordx2 v[144:145], v4, s[8:11], 0 offen offset:192
    s_nop 1
    v_add_u32 v4, 14336, v4
    v_accvgpr_read_b32 v140, a24
    v_accvgpr_read_b32 v141, a25
    v_accvgpr_read_b32 v142, a26
    v_accvgpr_read_b32 v143, a27
    v_cvt_pk_bf16_f32 v144, v140, v141
    v_cvt_pk_bf16_f32 v145, v142, v143
    buffer_store_dwordx2 v[144:145], v4, s[8:11], 0 offen offset:0
    s_nop 1
    v_accvgpr_read_b32 v140, a52
    v_accvgpr_read_b32 v141, a53
    v_accvgpr_read_b32 v142, a54
    v_accvgpr_read_b32 v143, a55
    v_cvt_pk_bf16_f32 v144, v140, v141
    v_cvt_pk_bf16_f32 v145, v142, v143
    buffer_store_dwordx2 v[144:145], v4, s[8:11], 0 offen offset:32
    s_nop 1
    v_accvgpr_read_b32 v140, a80
    v_accvgpr_read_b32 v141, a81
    v_accvgpr_read_b32 v142, a82
    v_accvgpr_read_b32 v143, a83
    v_cvt_pk_bf16_f32 v144, v140, v141
    v_cvt_pk_bf16_f32 v145, v142, v143
    buffer_store_dwordx2 v[144:145], v4, s[8:11], 0 offen offset:64
    s_nop 1
    v_accvgpr_read_b32 v140, a108
    v_accvgpr_read_b32 v141, a109
    v_accvgpr_read_b32 v142, a110
    v_accvgpr_read_b32 v143, a111
    v_cvt_pk_bf16_f32 v144, v140, v141
    v_cvt_pk_bf16_f32 v145, v142, v143
    buffer_store_dwordx2 v[144:145], v4, s[8:11], 0 offen offset:96
    s_nop 1
    v_accvgpr_read_b32 v140, a136
    v_accvgpr_read_b32 v141, a137
    v_accvgpr_read_b32 v142, a138
    v_accvgpr_read_b32 v143, a139
    v_cvt_pk_bf16_f32 v144, v140, v141
    v_cvt_pk_bf16_f32 v145, v142, v143
    buffer_store_dwordx2 v[144:145], v4, s[8:11], 0 offen offset:128
    s_nop 1
    v_accvgpr_read_b32 v140, a164
    v_accvgpr_read_b32 v141, a165
    v_accvgpr_read_b32 v142, a166
    v_accvgpr_read_b32 v143, a167
    v_cvt_pk_bf16_f32 v144, v140, v141
    v_cvt_pk_bf16_f32 v145, v142, v143
    buffer_store_dwordx2 v[144:145], v4, s[8:11], 0 offen offset:160
    s_nop 1
    v_accvgpr_read_b32 v140, a192
    v_accvgpr_read_b32 v141, a193
    v_accvgpr_read_b32 v142, a194
    v_accvgpr_read_b32 v143, a195
    v_cvt_pk_bf16_f32 v144, v140, v141
    v_cvt_pk_bf16_f32 v145, v142, v143
    buffer_store_dwordx2 v[144:145], v4, s[8:11], 0 offen offset:192
    s_nop 1
    v_add_u32 v4, 14336, v4
K2_done:
    s_endpgm
.globl main_kernel
.p2align 8
.type main_kernel,@function
main_kernel:
    s_cmp_ge_u32 s2, 256
    s_cbranch_scc1 K4_done
    s_load_dwordx2 s[8:9], s[0:1], 112
    s_mov_b32 s10, 268435456
    s_mov_b32 s11, 0x00020000
    v_lshrrev_b32 v1, 6, v0
    s_nop 0
    v_readfirstlane_b32 s4, v1
    v_and_b32 v0, 63, v0
    s_nop 2
    s_waitcnt lgkmcnt(0)
    s_cmp_ge_u32 s2, 44
    s_cbranch_scc1 K3_entry
    v_lshlrev_b32 v2, 4, v0
    v_lshrrev_b32 v3, 3, v0
    v_mul_u32_u24 v3, 912, v3
    v_and_b32 v1, 7, v0
    v_lshl_add_u32 v3, v1, 3, v3
    s_add_u32 s38, s4, 0
    s_lshl_b32 s34, s38, 10
    s_lshl_b32 s38, s38, 6
    s_add_u32 s39, s4, 4
    s_lshl_b32 s35, s39, 10
    s_lshl_b32 s39, s39, 6
    s_add_u32 s40, s4, 8
    s_lshl_b32 s36, s40, 10
    s_lshl_b32 s40, s40, 6
    s_add_u32 s41, s4, 12
    s_min_u32 s41, s41, 13
    s_lshl_b32 s37, s41, 10
    s_lshl_b32 s41, s41, 6
    s_mov_b32 s29, 0x07060302
    s_mov_b32 s42, 0
    v_and_b32 v116, 15, v0
    v_lshrrev_b32 v117, 4, v0
    s_waitcnt lgkmcnt(0)
    s_cmp_ge_u32 s2, 16
    s_cbranch_scc1 K4_B
    s_mul_i32 s5, s2, 448
    s_mul_i32 s6, s4, 112
    s_add_u32 s5, s5, s6
    v_add_u32 v20, s5, v116
    v_mul_u32_u24 v20, 896, v20
    v_lshl_add_u32 v20, v117, 4, v20
    v_add_u32 v20, 2097152, v20
    buffer_load_dwordx4 a[0:3], v20, s[8:11], 0 offen offset:0
    buffer_load_dwordx4 a[4:7], v20, s[8:11], 0 offen offset:64
    buffer_load_dwordx4 a[8:11], v20, s[8:11], 0 offen offset:128
    buffer_load_dwordx4 a[12:15], v20, s[8:11], 0 offen offset:192
    buffer_load_dwordx4 a[16:19], v20, s[8:11], 0 offen offset:256
    buffer_load_dwordx4 a[20:23], v20, s[8:11], 0 offen offset:320
    buffer_load_dwordx4 a[24:27], v20, s[8:11], 0 offen offset:384
    buffer_load_dwordx4 a[28:31], v20, s[8:11], 0 offen offset:448
    buffer_load_dwordx4 a[32:35], v20, s[8:11], 0 offen offset:512
    buffer_load_dwordx4 a[36:39], v20, s[8:11], 0 offen offset:576
    buffer_load_dwordx4 a[40:43], v20, s[8:11], 0 offen offset:640
    buffer_load_dwordx4 a[44:47], v20, s[8:11], 0 offen offset:704
    buffer_load_dwordx4 a[48:51], v20, s[8:11], 0 offen offset:768
    buffer_load_dwordx4 a[52:55], v20, s[8:11], 0 offen offset:832
    v_add_u32 v20, 14336, v20
    buffer_load_dwordx4 a[56:59], v20, s[8:11], 0 offen offset:0
    buffer_load_dwordx4 a[60:63], v20, s[8:11], 0 offen offset:64
    buffer_load_dwordx4 a[64:67], v20, s[8:11], 0 offen offset:128
    buffer_load_dwordx4 a[68:71], v20, s[8:11], 0 offen offset:192
    buffer_load_dwordx4 a[72:75], v20, s[8:11], 0 offen offset:256
    buffer_load_dwordx4 a[76:79], v20, s[8:11], 0 offen offset:320
    buffer_load_dwordx4 a[80:83], v20, s[8:11], 0 offen offset:384
    buffer_load_dwordx4 a[84:87], v20, s[8:11], 0 offen offset:448
    buffer_load_dwordx4 a[88:91], v20, s[8:11], 0 offen offset:512
    buffer_load_dwordx4 a[92:95], v20, s[8:11], 0 offen offset:576
    buffer_load_dwordx4 a[96:99], v20, s[8:11], 0 offen offset:640
    buffer_load_dwordx4 a[100:103], v20, s[8:11], 0 offen offset:704
    buffer_load_dwordx4 a[104:107], v20, s[8:11], 0 offen offset:768
    buffer_load_dwordx4 a[108:111], v20, s[8:11], 0 offen offset:832
    v_add_u32 v20, 14336, v20
    buffer_load_dwordx4 a[112:115], v20, s[8:11], 0 offen offset:0
    buffer_load_dwordx4 a[116:119], v20, s[8:11], 0 offen offset:64
    buffer_load_dwordx4 a[120:123], v20, s[8:11], 0 offen offset:128
    buffer_load_dwordx4 a[124:127], v20, s[8:11], 0 offen offset:192
    buffer_load_dwordx4 a[128:131], v20, s[8:11], 0 offen offset:256
    buffer_load_dwordx4 a[132:135], v20, s[8:11], 0 offen offset:320
    buffer_load_dwordx4 a[136:139], v20, s[8:11], 0 offen offset:384
    buffer_load_dwordx4 a[140:143], v20, s[8:11], 0 offen offset:448
    buffer_load_dwordx4 a[144:147], v20, s[8:11], 0 offen offset:512
    buffer_load_dwordx4 a[148:151], v20, s[8:11], 0 offen offset:576
    buffer_load_dwordx4 a[152:155], v20, s[8:11], 0 offen offset:640
    buffer_load_dwordx4 a[156:159], v20, s[8:11], 0 offen offset:704
    buffer_load_dwordx4 a[160:163], v20, s[8:11], 0 offen offset:768
    buffer_load_dwordx4 a[164:167], v20, s[8:11], 0 offen offset:832
    v_add_u32 v20, 14336, v20
    buffer_load_dwordx4 a[168:171], v20, s[8:11], 0 offen offset:0
    buffer_load_dwordx4 a[172:175], v20, s[8:11], 0 offen offset:64
    buffer_load_dwordx4 a[176:179], v20, s[8:11], 0 offen offset:128
    buffer_load_dwordx4 a[180:183], v20, s[8:11], 0 offen offset:192
    buffer_load_dwordx4 a[184:187], v20, s[8:11], 0 offen offset:256
    buffer_load_dwordx4 a[188:191], v20, s[8:11], 0 offen offset:320
    buffer_load_dwordx4 a[192:195], v20, s[8:11], 0 offen offset:384
    buffer_load_dwordx4 a[196:199], v20, s[8:11], 0 offen offset:448
    buffer_load_dwordx4 a[200:203], v20, s[8:11], 0 offen offset:512
    buffer_load_dwordx4 a[204:207], v20, s[8:11], 0 offen offset:576
    buffer_load_dwordx4 a[208:211], v20, s[8:11], 0 offen offset:640
    buffer_load_dwordx4 a[212:215], v20, s[8:11], 0 offen offset:704
    buffer_load_dwordx4 a[216:219], v20, s[8:11], 0 offen offset:768
    buffer_load_dwordx4 a[220:223], v20, s[8:11], 0 offen offset:832
    v_add_u32 v20, 14336, v20
    buffer_load_dwordx4 a[224:227], v20, s[8:11], 0 offen offset:0
    buffer_load_dwordx4 a[228:231], v20, s[8:11], 0 offen offset:64
    buffer_load_dwordx4 a[232:235], v20, s[8:11], 0 offen offset:128
    buffer_load_dwordx4 a[236:239], v20, s[8:11], 0 offen offset:192
    buffer_load_dwordx4 a[240:243], v20, s[8:11], 0 offen offset:256
    buffer_load_dwordx4 a[244:247], v20, s[8:11], 0 offen offset:320
    buffer_load_dwordx4 a[248:251], v20, s[8:11], 0 offen offset:384
    buffer_load_dwordx4 a[252:255], v20, s[8:11], 0 offen offset:448
    buffer_load_dwordx4 v[120:123], v20, s[8:11], 0 offen offset:512
    buffer_load_dwordx4 v[124:127], v20, s[8:11], 0 offen offset:576
    buffer_load_dwordx4 v[128:131], v20, s[8:11], 0 offen offset:640
    buffer_load_dwordx4 v[132:135], v20, s[8:11], 0 offen offset:704
    buffer_load_dwordx4 v[136:139], v20, s[8:11], 0 offen offset:768
    buffer_load_dwordx4 v[140:143], v20, s[8:11], 0 offen offset:832
    v_add_u32 v20, 14336, v20
    buffer_load_dwordx4 v[144:147], v20, s[8:11], 0 offen offset:0
    buffer_load_dwordx4 v[148:151], v20, s[8:11], 0 offen offset:64
    buffer_load_dwordx4 v[152:155], v20, s[8:11], 0 offen offset:128
    buffer_load_dwordx4 v[156:159], v20, s[8:11], 0 offen offset:192
    buffer_load_dwordx4 v[160:163], v20, s[8:11], 0 offen offset:256
    buffer_load_dwordx4 v[164:167], v20, s[8:11], 0 offen offset:320
    buffer_load_dwordx4 v[168:171], v20, s[8:11], 0 offen offset:384
    buffer_load_dwordx4 v[172:175], v20, s[8:11], 0 offen offset:448
    buffer_load_dwordx4 v[176:179], v20, s[8:11], 0 offen offset:512
    buffer_load_dwordx4 v[180:183], v20, s[8:11], 0 offen offset:576
    buffer_load_dwordx4 v[184:187], v20, s[8:11], 0 offen offset:640
    buffer_load_dwordx4 v[188:191], v20, s[8:11], 0 offen offset:704
    buffer_load_dwordx4 v[192:195], v20, s[8:11], 0 offen offset:768
    buffer_load_dwordx4 v[196:199], v20, s[8:11], 0 offen offset:832
    v_add_u32 v20, 14336, v20
    buffer_load_dwordx4 v[200:203], v20, s[8:11], 0 offen offset:0
    buffer_load_dwordx4 v[204:207], v20, s[8:11], 0 offen offset:64
    buffer_load_dwordx4 v[208:211], v20, s[8:11], 0 offen offset:128
    buffer_load_dwordx4 v[212:215], v20, s[8:11], 0 offen offset:192
    buffer_load_dwordx4 v[216:219], v20, s[8:11], 0 offen offset:256
    buffer_load_dwordx4 v[220:223], v20, s[8:11], 0 offen offset:320
    buffer_load_dwordx4 v[224:227], v20, s[8:11], 0 offen offset:384
    buffer_load_dwordx4 v[228:231], v20, s[8:11], 0 offen offset:448
    buffer_load_dwordx4 v[232:235], v20, s[8:11], 0 offen offset:512
    buffer_load_dwordx4 v[236:239], v20, s[8:11], 0 offen offset:576
    buffer_load_dwordx4 v[240:243], v20, s[8:11], 0 offen offset:640
    buffer_load_dwordx4 v[244:247], v20, s[8:11], 0 offen offset:704
    buffer_load_dwordx4 v[248:251], v20, s[8:11], 0 offen offset:768
    buffer_load_dwordx4 v[252:255], v20, s[8:11], 0 offen offset:832
    v_add_u32 v20, 14336, v20
    s_mov_b32 s30, 89128960
    s_lshl_b32 s31, s4, 3
    s_mul_i32 s31, s31, 896
    s_mul_i32 s32, s2, 640
    s_add_u32 s32, s32, 90177536
    s_mov_b32 s33, 0
    s_lshl_b32 s5, s4, 3
    s_add_u32 s5, s5, 8
    s_mul_i32 s5, s5, 912
    v_add_u32 v118, s5, v2
    v_and_b32 v119, 7, v116
    v_mul_u32_u24 v119, 912, v119
    v_lshl_add_u32 v119, v117, 4, v119
    v_mul_u32_u24 v23, 912, v116
    v_lshl_add_u32 v23, v117, 3, v23
    s_mul_i32 s5, s4, 224
    v_add_u32 v23, s5, v23
    s_mul_i32 s5, s4, 1536
    s_add_u32 s5, s5, 45056
    v_mul_u32_u24 v24, 192, v116
    v_lshl_add_u32 v24, v117, 4, v24
    v_add_u32 v24, s5, v24
    v_lshrrev_b32 v26, 3, v0
    v_mul_u32_u24 v25, 192, v26
    v_lshl_add_u32 v25, v1, 5, v25
    v_add_u32 v25, 45056, v25
    v_mul_u32_u24 v26, 80, v26
    v_lshl_add_u32 v26, v1, 4, v26
K4A_loop:
    v_cmp_gt_u32 vcc, 56, v0
    s_and_saveexec_b64 s[20:21], vcc
    s_mov_b32 s5, s31
    buffer_load_dwordx4 v[32:35], v2, s[8:11], s5 offen
    s_add_u32 s5, s5, 896
    buffer_load_dwordx4 v[36:39], v2, s[8:11], s5 offen
    s_add_u32 s5, s5, 896
    buffer_load_dwordx4 v[40:43], v2, s[8:11], s5 offen
    s_add_u32 s5, s5, 896
    buffer_load_dwordx4 v[44:47], v2, s[8:11], s5 offen
    s_add_u32 s5, s5, 896
    buffer_load_dwordx4 v[48:51], v2, s[8:11], s5 offen
    s_add_u32 s5, s5, 896
    buffer_load_dwordx4 v[52:55], v2, s[8:11], s5 offen
    s_add_u32 s5, s5, 896
    buffer_load_dwordx4 v[56:59], v2, s[8:11], s5 offen
    s_add_u32 s5, s5, 896
    buffer_load_dwordx4 v[60:63], v2, s[8:11], s5 offen
    s_add_u32 s5, s5, 896
    s_waitcnt vmcnt(7)
    ds_write_b128 v118, v[32:35] offset:0
    s_waitcnt vmcnt(6)
    ds_write_b128 v118, v[36:39] offset:912
    s_waitcnt vmcnt(5)
    ds_write_b128 v118, v[40:43] offset:1824
    s_waitcnt vmcnt(4)
    ds_write_b128 v118, v[44:47] offset:2736
    s_waitcnt vmcnt(3)
    ds_write_b128 v118, v[48:51] offset:3648
    s_waitcnt vmcnt(2)
    ds_write_b128 v118, v[52:55] offset:4560
    s_waitcnt vmcnt(1)
    ds_write_b128 v118, v[56:59] offset:5472
    s_waitcnt vmcnt(0)
    ds_write_b128 v118, v[60:63] offset:6384
    s_mov_b64 exec, s[20:21]
K4A_poll:
    s_add_u32 s28, s30, s34
    buffer_load_dwordx4 v[4:7], v2, s[8:11], s28 offen sc1
    s_add_u32 s28, s30, s35
    buffer_load_dwordx4 v[8:11], v2, s[8:11], s28 offen sc1
    s_add_u32 s28, s30, s36
    buffer_load_dwordx4 v[12:15], v2, s[8:11], s28 offen sc1
    s_add_u32 s28, s30, s37
    buffer_load_dwordx4 v[16:19], v2, s[8:11], s28 offen sc1
    s_waitcnt vmcnt(0)
    v_and_b32 v20, v4, v5
    v_and_b32 v20, v20, v6
    v_and_b32 v20, v20, v7
    v_and_b32 v20, v20, v8
    v_and_b32 v20, v20, v9
    v_and_b32 v20, v20, v10
    v_and_b32 v20, v20, v11
    v_and_b32 v20, v20, v12
    v_and_b32 v20, v20, v13
    v_and_b32 v20, v20, v14
    v_and_b32 v20, v20, v15
    v_and_b32 v20, v20, v16
    v_and_b32 v20, v20, v17
    v_and_b32 v20, v20, v18
    v_and_b32 v20, v20, v19
    v_and_b32 v20, 0xffff, v20
    v_cmp_ne_u32 vcc, 23130, v20
    s_add_u32 s42, s42, 1
    s_cmp_gt_u32 s42, 0x400000
    s_cbranch_scc1 K4A_pout
    s_cbranch_vccnz K4A_poll
K4A_pout:
    v_perm_b32 v20, v5, v4, s29
    v_perm_b32 v21, v7, v6, s29
    v_add_u32 v22, s38, v3
    ds_write_b64 v22, v[20:21]
    v_perm_b32 v20, v9, v8, s29
    v_perm_b32 v21, v11, v10, s29
    v_add_u32 v22, s39, v3
    ds_write_b64 v22, v[20:21]
    v_perm_b32 v20, v13, v12, s29
    v_perm_b32 v21, v15, v14, s29
    v_add_u32 v22, s40, v3
    ds_write_b64 v22, v[20:21]
    v_perm_b32 v20, v17, v16, s29
    v_perm_b32 v21, v19, v18, s29
    v_add_u32 v22, s41, v3
    ds_write_b64 v22, v[20:21]
    s_waitcnt lgkmcnt(0)
    s_barrier
    ds_read_b128 v[32:35], v119 offset:0
    ds_read_b128 v[36:39], v119 offset:64
    ds_read_b128 v[40:43], v119 offset:128
    ds_read_b128 v[44:47], v119 offset:192
    ds_read_b128 v[48:51], v119 offset:256
    ds_read_b128 v[52:55], v119 offset:320
    ds_read_b128 v[56:59], v119 offset:384
    ds_read_b128 v[60:63], v119 offset:448
    ds_read_b128 v[64:67], v119 offset:512
    ds_read_b128 v[68:71], v119 offset:576
    ds_read_b128 v[72:75], v119 offset:640
    ds_read_b128 v[76:79], v119 offset:704
    ds_read_b128 v[80:83], v119 offset:768
    ds_read_b128 v[84:87], v119 offset:832
    v_mov_b32 v88, 0
    v_mov_b32 v89, 0
    v_mov_b32 v90, 0
    v_mov_b32 v91, 0
    v_mov_b32 v92, 0
    v_mov_b32 v93, 0
    v_mov_b32 v94, 0
    v_mov_b32 v95, 0
    v_mov_b32 v96, 0
    v_mov_b32 v97, 0
    v_mov_b32 v98, 0
    v_mov_b32 v99, 0
    v_mov_b32 v100, 0
    v_mov_b32 v101, 0
    v_mov_b32 v102, 0
    v_mov_b32 v103, 0
    v_mov_b32 v104, 0
    v_mov_b32 v105, 0
    v_mov_b32 v106, 0
    v_mov_b32 v107, 0
    v_mov_b32 v108, 0
    v_mov_b32 v109, 0
    v_mov_b32 v110, 0
    v_mov_b32 v111, 0
    v_mov_b32 v112, 0
    v_mov_b32 v113, 0
    v_mov_b32 v114, 0
    v_mov_b32 v115, 0
    s_waitcnt lgkmcnt(13)
    v_mfma_f32_16x16x32_bf16 v[88:91], a[0:3], v[32:35], v[88:91]
    v_mfma_f32_16x16x32_bf16 v[92:95], a[56:59], v[32:35], v[92:95]
    v_mfma_f32_16x16x32_bf16 v[96:99], a[112:115], v[32:35], v[96:99]
    v_mfma_f32_16x16x32_bf16 v[100:103], a[168:171], v[32:35], v[100:103]
    v_mfma_f32_16x16x32_bf16 v[104:107], a[224:227], v[32:35], v[104:107]
    v_mfma_f32_16x16x32_bf16 v[108:111], v[144:147], v[32:35], v[108:111]
    v_mfma_f32_16x16x32_bf16 v[112:115], v[200:203], v[32:35], v[112:115]
    s_waitcnt lgkmcnt(12)
    v_mfma_f32_16x16x32_bf16 v[88:91], a[4:7], v[36:39], v[88:91]
    v_mfma_f32_16x16x32_bf16 v[92:95], a[60:63], v[36:39], v[92:95]
    v_mfma_f32_16x16x32_bf16 v[96:99], a[116:119], v[36:39], v[96:99]
    v_mfma_f32_16x16x32_bf16 v[100:103], a[172:175], v[36:39], v[100:103]
    v_mfma_f32_16x16x32_bf16 v[104:107], a[228:231], v[36:39], v[104:107]
    v_mfma_f32_16x16x32_bf16 v[108:111], v[148:151], v[36:39], v[108:111]
    v_mfma_f32_16x16x32_bf16 v[112:115], v[204:207], v[36:39], v[112:115]
    s_waitcnt lgkmcnt(11)
    v_mfma_f32_16x16x32_bf16 v[88:91], a[8:11], v[40:43], v[88:91]
    v_mfma_f32_16x16x32_bf16 v[92:95], a[64:67], v[40:43], v[92:95]
    v_mfma_f32_16x16x32_bf16 v[96:99], a[120:123], v[40:43], v[96:99]
    v_mfma_f32_16x16x32_bf16 v[100:103], a[176:179], v[40:43], v[100:103]
    v_mfma_f32_16x16x32_bf16 v[104:107], a[232:235], v[40:43], v[104:107]
    v_mfma_f32_16x16x32_bf16 v[108:111], v[152:155], v[40:43], v[108:111]
    v_mfma_f32_16x16x32_bf16 v[112:115], v[208:211], v[40:43], v[112:115]
    s_waitcnt lgkmcnt(10)
    v_mfma_f32_16x16x32_bf16 v[88:91], a[12:15], v[44:47], v[88:91]
    v_mfma_f32_16x16x32_bf16 v[92:95], a[68:71], v[44:47], v[92:95]
    v_mfma_f32_16x16x32_bf16 v[96:99], a[124:127], v[44:47], v[96:99]
    v_mfma_f32_16x16x32_bf16 v[100:103], a[180:183], v[44:47], v[100:103]
    v_mfma_f32_16x16x32_bf16 v[104:107], a[236:239], v[44:47], v[104:107]
    v_mfma_f32_16x16x32_bf16 v[108:111], v[156:159], v[44:47], v[108:111]
    v_mfma_f32_16x16x32_bf16 v[112:115], v[212:215], v[44:47], v[112:115]
    s_waitcnt lgkmcnt(9)
    v_mfma_f32_16x16x32_bf16 v[88:91], a[16:19], v[48:51], v[88:91]
    v_mfma_f32_16x16x32_bf16 v[92:95], a[72:75], v[48:51], v[92:95]
    v_mfma_f32_16x16x32_bf16 v[96:99], a[128:131], v[48:51], v[96:99]
    v_mfma_f32_16x16x32_bf16 v[100:103], a[184:187], v[48:51], v[100:103]
    v_mfma_f32_16x16x32_bf16 v[104:107], a[240:243], v[48:51], v[104:107]
    v_mfma_f32_16x16x32_bf16 v[108:111], v[160:163], v[48:51], v[108:111]
    v_mfma_f32_16x16x32_bf16 v[112:115], v[216:219], v[48:51], v[112:115]
    s_waitcnt lgkmcnt(8)
    v_mfma_f32_16x16x32_bf16 v[88:91], a[20:23], v[52:55], v[88:91]
    v_mfma_f32_16x16x32_bf16 v[92:95], a[76:79], v[52:55], v[92:95]
    v_mfma_f32_16x16x32_bf16 v[96:99], a[132:135], v[52:55], v[96:99]
    v_mfma_f32_16x16x32_bf16 v[100:103], a[188:191], v[52:55], v[100:103]
    v_mfma_f32_16x16x32_bf16 v[104:107], a[244:247], v[52:55], v[104:107]
    v_mfma_f32_16x16x32_bf16 v[108:111], v[164:167], v[52:55], v[108:111]
    v_mfma_f32_16x16x32_bf16 v[112:115], v[220:223], v[52:55], v[112:115]
    s_waitcnt lgkmcnt(7)
    v_mfma_f32_16x16x32_bf16 v[88:91], a[24:27], v[56:59], v[88:91]
    v_mfma_f32_16x16x32_bf16 v[92:95], a[80:83], v[56:59], v[92:95]
    v_mfma_f32_16x16x32_bf16 v[96:99], a[136:139], v[56:59], v[96:99]
    v_mfma_f32_16x16x32_bf16 v[100:103], a[192:195], v[56:59], v[100:103]
    v_mfma_f32_16x16x32_bf16 v[104:107], a[248:251], v[56:59], v[104:107]
    v_mfma_f32_16x16x32_bf16 v[108:111], v[168:171], v[56:59], v[108:111]
    v_mfma_f32_16x16x32_bf16 v[112:115], v[224:227], v[56:59], v[112:115]
    s_waitcnt lgkmcnt(6)
    v_mfma_f32_16x16x32_bf16 v[88:91], a[28:31], v[60:63], v[88:91]
    v_mfma_f32_16x16x32_bf16 v[92:95], a[84:87], v[60:63], v[92:95]
    v_mfma_f32_16x16x32_bf16 v[96:99], a[140:143], v[60:63], v[96:99]
    v_mfma_f32_16x16x32_bf16 v[100:103], a[196:199], v[60:63], v[100:103]
    v_mfma_f32_16x16x32_bf16 v[104:107], a[252:255], v[60:63], v[104:107]
    v_mfma_f32_16x16x32_bf16 v[108:111], v[172:175], v[60:63], v[108:111]
    v_mfma_f32_16x16x32_bf16 v[112:115], v[228:231], v[60:63], v[112:115]
    s_waitcnt lgkmcnt(5)
    v_mfma_f32_16x16x32_bf16 v[88:91], a[32:35], v[64:67], v[88:91]
    v_mfma_f32_16x16x32_bf16 v[92:95], a[88:91], v[64:67], v[92:95]
    v_mfma_f32_16x16x32_bf16 v[96:99], a[144:147], v[64:67], v[96:99]
    v_mfma_f32_16x16x32_bf16 v[100:103], a[200:203], v[64:67], v[100:103]
    v_mfma_f32_16x16x32_bf16 v[104:107], v[120:123], v[64:67], v[104:107]
    v_mfma_f32_16x16x32_bf16 v[108:111], v[176:179], v[64:67], v[108:111]
    v_mfma_f32_16x16x32_bf16 v[112:115], v[232:235], v[64:67], v[112:115]
    s_waitcnt lgkmcnt(4)
    v_mfma_f32_16x16x32_bf16 v[88:91], a[36:39], v[68:71], v[88:91]
    v_mfma_f32_16x16x32_bf16 v[92:95], a[92:95], v[68:71], v[92:95]
    v_mfma_f32_16x16x32_bf16 v[96:99], a[148:151], v[68:71], v[96:99]
    v_mfma_f32_16x16x32_bf16 v[100:103], a[204:207], v[68:71], v[100:103]
    v_mfma_f32_16x16x32_bf16 v[104:107], v[124:127], v[68:71], v[104:107]
    v_mfma_f32_16x16x32_bf16 v[108:111], v[180:183], v[68:71], v[108:111]
    v_mfma_f32_16x16x32_bf16 v[112:115], v[236:239], v[68:71], v[112:115]
    s_waitcnt lgkmcnt(3)
    v_mfma_f32_16x16x32_bf16 v[88:91], a[40:43], v[72:75], v[88:91]
    v_mfma_f32_16x16x32_bf16 v[92:95], a[96:99], v[72:75], v[92:95]
    v_mfma_f32_16x16x32_bf16 v[96:99], a[152:155], v[72:75], v[96:99]
    v_mfma_f32_16x16x32_bf16 v[100:103], a[208:211], v[72:75], v[100:103]
    v_mfma_f32_16x16x32_bf16 v[104:107], v[128:131], v[72:75], v[104:107]
    v_mfma_f32_16x16x32_bf16 v[108:111], v[184:187], v[72:75], v[108:111]
    v_mfma_f32_16x16x32_bf16 v[112:115], v[240:243], v[72:75], v[112:115]
    s_waitcnt lgkmcnt(2)
    v_mfma_f32_16x16x32_bf16 v[88:91], a[44:47], v[76:79], v[88:91]
    v_mfma_f32_16x16x32_bf16 v[92:95], a[100:103], v[76:79], v[92:95]
    v_mfma_f32_16x16x32_bf16 v[96:99], a[156:159], v[76:79], v[96:99]
    v_mfma_f32_16x16x32_bf16 v[100:103], a[212:215], v[76:79], v[100:103]
    v_mfma_f32_16x16x32_bf16 v[104:107], v[132:135], v[76:79], v[104:107]
    v_mfma_f32_16x16x32_bf16 v[108:111], v[188:191], v[76:79], v[108:111]
    v_mfma_f32_16x16x32_bf16 v[112:115], v[244:247], v[76:79], v[112:115]
    s_waitcnt lgkmcnt(1)
    v_mfma_f32_16x16x32_bf16 v[88:91], a[48:51], v[80:83], v[88:91]
    v_mfma_f32_16x16x32_bf16 v[92:95], a[104:107], v[80:83], v[92:95]
    v_mfma_f32_16x16x32_bf16 v[96:99], a[160:163], v[80:83], v[96:99]
    v_mfma_f32_16x16x32_bf16 v[100:103], a[216:219], v[80:83], v[100:103]
    v_mfma_f32_16x16x32_bf16 v[104:107], v[136:139], v[80:83], v[104:107]
    v_mfma_f32_16x16x32_bf16 v[108:111], v[192:195], v[80:83], v[108:111]
    v_mfma_f32_16x16x32_bf16 v[112:115], v[248:251], v[80:83], v[112:115]
    s_waitcnt lgkmcnt(0)
    v_mfma_f32_16x16x32_bf16 v[88:91], a[52:55], v[84:87], v[88:91]
    v_mfma_f32_16x16x32_bf16 v[92:95], a[108:111], v[84:87], v[92:95]
    v_mfma_f32_16x16x32_bf16 v[96:99], a[164:167], v[84:87], v[96:99]
    v_mfma_f32_16x16x32_bf16 v[100:103], a[220:223], v[84:87], v[100:103]
    v_mfma_f32_16x16x32_bf16 v[104:107], v[140:143], v[84:87], v[104:107]
    v_mfma_f32_16x16x32_bf16 v[108:111], v[196:199], v[84:87], v[108:111]
    v_mfma_f32_16x16x32_bf16 v[112:115], v[252:255], v[84:87], v[112:115]
    ds_read_b64 v[46:47], v23 offset:0
    ds_read_b64 v[48:49], v23 offset:32
    ds_read_b64 v[50:51], v23 offset:64
    ds_read_b64 v[52:53], v23 offset:96
    ds_read_b64 v[54:55], v23 offset:128
    ds_read_b64 v[56:57], v23 offset:160
    ds_read_b64 v[58:59], v23 offset:192
    ds_read_b64 v[60:61], v23 offset:14592
    ds_read_b64 v[62:63], v23 offset:14624
    ds_read_b64 v[64:65], v23 offset:14656
    ds_read_b64 v[66:67], v23 offset:14688
    ds_read_b64 v[68:69], v23 offset:14720
    ds_read_b64 v[70:71], v23 offset:14752
    ds_read_b64 v[72:73], v23 offset:14784
    ds_read_b64 v[74:75], v23 offset:29184
    ds_read_b64 v[76:77], v23 offset:29216
    ds_read_b64 v[78:79], v23 offset:29248
    ds_read_b64 v[80:81], v23 offset:29280
    ds_read_b64 v[82:83], v23 offset:29312
    ds_read_b64 v[84:85], v23 offset:29344
    ds_read_b64 v[86:87], v23 offset:29376
    s_nop 4
    v_cvt_pk_bf16_f32 v32, v88, v89
    v_cvt_pk_bf16_f32 v33, v90, v91
    v_cvt_pk_bf16_f32 v34, v92, v93
    v_cvt_pk_bf16_f32 v35, v94, v95
    v_cvt_pk_bf16_f32 v36, v96, v97
    v_cvt_pk_bf16_f32 v37, v98, v99
    v_cvt_pk_bf16_f32 v38, v100, v101
    v_cvt_pk_bf16_f32 v39, v102, v103
    v_cvt_pk_bf16_f32 v40, v104, v105
    v_cvt_pk_bf16_f32 v41, v106, v107
    v_cvt_pk_bf16_f32 v42, v108, v109
    v_cvt_pk_bf16_f32 v43, v110, v111
    v_cvt_pk_bf16_f32 v44, v112, v113
    v_cvt_pk_bf16_f32 v45, v114, v115
    v_mov_b32 v4, 0
    v_mov_b32 v5, 0
    v_mov_b32 v6, 0
    v_mov_b32 v7, 0
    v_mov_b32 v8, 0
    v_mov_b32 v9, 0
    v_mov_b32 v10, 0
    v_mov_b32 v11, 0
    v_mov_b32 v12, 0
    v_mov_b32 v13, 0
    v_mov_b32 v14, 0
    v_mov_b32 v15, 0
    s_waitcnt lgkmcnt(0)
    v_mfma_f32_16x16x32_bf16 v[4:7], v[46:49], v[32:35], v[4:7]
    v_mfma_f32_16x16x32_bf16 v[4:7], v[50:53], v[36:39], v[4:7]
    v_mfma_f32_16x16x32_bf16 v[4:7], v[54:57], v[40:43], v[4:7]
    v_mfma_f32_16x16x16_bf16 v[4:7], v[58:59], v[44:45], v[4:7]
    v_mfma_f32_16x16x32_bf16 v[8:11], v[60:63], v[32:35], v[8:11]
    v_mfma_f32_16x16x32_bf16 v[8:11], v[64:67], v[36:39], v[8:11]
    v_mfma_f32_16x16x32_bf16 v[8:11], v[68:71], v[40:43], v[8:11]
    v_mfma_f32_16x16x16_bf16 v[8:11], v[72:73], v[44:45], v[8:11]
    v_mfma_f32_16x16x32_bf16 v[12:15], v[74:77], v[32:35], v[12:15]
    v_mfma_f32_16x16x32_bf16 v[12:15], v[78:81], v[36:39], v[12:15]
    v_mfma_f32_16x16x32_bf16 v[12:15], v[82:85], v[40:43], v[12:15]
    v_mfma_f32_16x16x16_bf16 v[12:15], v[86:87], v[44:45], v[12:15]
    s_nop 7
    s_nop 1
    v_cmp_gt_u32 vcc, 8, v116
    s_and_saveexec_b64 s[20:21], vcc
    ds_write_b128 v24, v[4:7] offset:0
    ds_write_b128 v24, v[8:11] offset:64
    ds_write_b128 v24, v[12:15] offset:128
    s_mov_b64 exec, s[20:21]
    s_waitcnt lgkmcnt(0)
    s_barrier
    s_cmp_eq_u32 s4, 0
    s_cbranch_scc0 K4A_next
    ds_read_b128 v[32:35], v25 offset:0
    ds_read_b128 v[36:39], v25 offset:16
    ds_read_b128 v[40:43], v25 offset:1536
    ds_read_b128 v[44:47], v25 offset:1552
    ds_read_b128 v[48:51], v25 offset:3072
    ds_read_b128 v[52:55], v25 offset:3088
    ds_read_b128 v[56:59], v25 offset:4608
    ds_read_b128 v[60:63], v25 offset:4624
    s_waitcnt lgkmcnt(0)
    v_cmp_gt_u32 vcc, 5, v1
    v_mov_b32 v21, 0xff800000
    v_add_f32 v32, v32, v40
    v_add_f32 v48, v48, v56
    v_add_f32 v32, v32, v48
    v_cndmask_b32 v32, v21, v32, vcc
    v_add_f32 v33, v33, v41
    v_add_f32 v49, v49, v57
    v_add_f32 v33, v33, v49
    v_cndmask_b32 v33, v21, v33, vcc
    v_add_f32 v34, v34, v42
    v_add_f32 v50, v50, v58
    v_add_f32 v34, v34, v50
    v_cndmask_b32 v34, v21, v34, vcc
    v_add_f32 v35, v35, v43
    v_add_f32 v51, v51, v59
    v_add_f32 v35, v35, v51
    v_cndmask_b32 v35, v21, v35, vcc
    v_add_f32 v36, v36, v44
    v_add_f32 v52, v52, v60
    v_add_f32 v36, v36, v52
    v_cndmask_b32 v36, v21, v36, vcc
    v_add_f32 v37, v37, v45
    v_add_f32 v53, v53, v61
    v_add_f32 v37, v37, v53
    v_cndmask_b32 v37, v21, v37, vcc
    v_add_f32 v38, v38, v46
    v_add_f32 v54, v54, v62
    v_add_f32 v38, v38, v54
    v_cndmask_b32 v38, v21, v38, vcc
    v_add_f32 v39, v39, v47
    v_add_f32 v55, v55, v63
    v_add_f32 v39, v39, v55
    v_cndmask_b32 v39, v21, v39, vcc
    v_max_f32 v20, v32, v33
    v_max_f32 v20, v20, v34
    v_max_f32 v20, v20, v35
    v_max_f32 v20, v20, v36
    v_max_f32 v20, v20, v37
    v_max_f32 v20, v20, v38
    v_max_f32 v20, v20, v39
    ds_swizzle_b32 v22, v20 offset:0x41f
    s_waitcnt lgkmcnt(0)
    v_max_f32 v20, v20, v22
    ds_swizzle_b32 v22, v20 offset:0x81f
    s_waitcnt lgkmcnt(0)
    v_max_f32 v20, v20, v22
    ds_swizzle_b32 v22, v20 offset:0x101f
    s_waitcnt lgkmcnt(0)
    v_max_f32 v20, v20, v22
    v_mov_b32 v21, 0
    v_sub_f32 v32, v32, v20
    v_mul_f32 v32, 0x3db8aa3b, v32
    v_exp_f32 v32, v32
    s_nop 0
    v_add_f32 v21, v21, v32
    v_sub_f32 v33, v33, v20
    v_mul_f32 v33, 0x3db8aa3b, v33
    v_exp_f32 v33, v33
    s_nop 0
    v_add_f32 v21, v21, v33
    v_sub_f32 v34, v34, v20
    v_mul_f32 v34, 0x3db8aa3b, v34
    v_exp_f32 v34, v34
    s_nop 0
    v_add_f32 v21, v21, v34
    v_sub_f32 v35, v35, v20
    v_mul_f32 v35, 0x3db8aa3b, v35
    v_exp_f32 v35, v35
    s_nop 0
    v_add_f32 v21, v21, v35
    v_sub_f32 v36, v36, v20
    v_mul_f32 v36, 0x3db8aa3b, v36
    v_exp_f32 v36, v36
    s_nop 0
    v_add_f32 v21, v21, v36
    v_sub_f32 v37, v37, v20
    v_mul_f32 v37, 0x3db8aa3b, v37
    v_exp_f32 v37, v37
    s_nop 0
    v_add_f32 v21, v21, v37
    v_sub_f32 v38, v38, v20
    v_mul_f32 v38, 0x3db8aa3b, v38
    v_exp_f32 v38, v38
    s_nop 0
    v_add_f32 v21, v21, v38
    v_sub_f32 v39, v39, v20
    v_mul_f32 v39, 0x3db8aa3b, v39
    v_exp_f32 v39, v39
    s_nop 0
    v_add_f32 v21, v21, v39
    ds_swizzle_b32 v22, v21 offset:0x41f
    s_waitcnt lgkmcnt(0)
    v_add_f32 v21, v21, v22
    ds_swizzle_b32 v22, v21 offset:0x81f
    s_waitcnt lgkmcnt(0)
    v_add_f32 v21, v21, v22
    ds_swizzle_b32 v22, v21 offset:0x101f
    s_waitcnt lgkmcnt(0)
    v_add_f32 v21, v21, v22
    v_rcp_f32 v21, v21
    s_nop 0
    v_mul_f32 v32, v32, v21
    v_mul_f32 v33, v33, v21
    v_mul_f32 v34, v34, v21
    v_mul_f32 v35, v35, v21
    v_mul_f32 v36, v36, v21
    v_mul_f32 v37, v37, v21
    v_mul_f32 v38, v38, v21
    v_mul_f32 v39, v39, v21
    v_cvt_pk_bf16_f32 v40, v32, v33
    v_or_b32 v40, 0x80008000, v40
    v_cvt_pk_bf16_f32 v41, v34, v35
    v_or_b32 v41, 0x80008000, v41
    v_cvt_pk_bf16_f32 v42, v36, v37
    v_or_b32 v42, 0x80008000, v42
    v_cvt_pk_bf16_f32 v43, v38, v39
    v_or_b32 v43, 0x80008000, v43
    s_and_saveexec_b64 s[20:21], vcc
    buffer_store_dwordx4 v[40:43], v26, s[8:11], s32 offen sc1
    s_mov_b64 exec, s[20:21]
K4A_next:
    s_add_u32 s30, s30, 14336
    s_add_u32 s31, s31, 28672
    s_add_u32 s32, s32, 10240
    s_add_u32 s33, s33, 1
    s_cmp_lt_u32 s33, 64
    s_cbranch_scc1 K4A_loop
    s_branch K4_done
K4_B:
    s_sub_u32 s6, s2, 16
    s_lshl_b32 s5, s4, 2
    s_mul_i32 s5, s5, 448
    s_lshl_b32 s7, s6, 4
    s_add_u32 s5, s5, s7
    s_add_u32 s5, s5, 7168
    v_add_u32 v20, s5, v116
    v_mul_u32_u24 v20, 896, v20
    v_lshl_add_u32 v20, v117, 4, v20
    v_add_u32 v20, 2097152, v20
    buffer_load_dwordx4 a[0:3], v20, s[8:11], 0 offen offset:0
    buffer_load_dwordx4 a[4:7], v20, s[8:11], 0 offen offset:64
    buffer_load_dwordx4 a[8:11], v20, s[8:11], 0 offen offset:128
    buffer_load_dwordx4 a[12:15], v20, s[8:11], 0 offen offset:192
    buffer_load_dwordx4 a[16:19], v20, s[8:11], 0 offen offset:256
    buffer_load_dwordx4 a[20:23], v20, s[8:11], 0 offen offset:320
    buffer_load_dwordx4 a[24:27], v20, s[8:11], 0 offen offset:384
    buffer_load_dwordx4 a[28:31], v20, s[8:11], 0 offen offset:448
    buffer_load_dwordx4 a[32:35], v20, s[8:11], 0 offen offset:512
    buffer_load_dwordx4 a[36:39], v20, s[8:11], 0 offen offset:576
    buffer_load_dwordx4 a[40:43], v20, s[8:11], 0 offen offset:640
    buffer_load_dwordx4 a[44:47], v20, s[8:11], 0 offen offset:704
    buffer_load_dwordx4 a[48:51], v20, s[8:11], 0 offen offset:768
    buffer_load_dwordx4 a[52:55], v20, s[8:11], 0 offen offset:832
    v_add_u32 v20, 401408, v20
    buffer_load_dwordx4 a[56:59], v20, s[8:11], 0 offen offset:0
    buffer_load_dwordx4 a[60:63], v20, s[8:11], 0 offen offset:64
    buffer_load_dwordx4 a[64:67], v20, s[8:11], 0 offen offset:128
    buffer_load_dwordx4 a[68:71], v20, s[8:11], 0 offen offset:192
    buffer_load_dwordx4 a[72:75], v20, s[8:11], 0 offen offset:256
    buffer_load_dwordx4 a[76:79], v20, s[8:11], 0 offen offset:320
    buffer_load_dwordx4 a[80:83], v20, s[8:11], 0 offen offset:384
    buffer_load_dwordx4 a[84:87], v20, s[8:11], 0 offen offset:448
    buffer_load_dwordx4 a[88:91], v20, s[8:11], 0 offen offset:512
    buffer_load_dwordx4 a[92:95], v20, s[8:11], 0 offen offset:576
    buffer_load_dwordx4 a[96:99], v20, s[8:11], 0 offen offset:640
    buffer_load_dwordx4 a[100:103], v20, s[8:11], 0 offen offset:704
    buffer_load_dwordx4 a[104:107], v20, s[8:11], 0 offen offset:768
    buffer_load_dwordx4 a[108:111], v20, s[8:11], 0 offen offset:832
    v_add_u32 v20, 401408, v20
    buffer_load_dwordx4 a[112:115], v20, s[8:11], 0 offen offset:0
    buffer_load_dwordx4 a[116:119], v20, s[8:11], 0 offen offset:64
    buffer_load_dwordx4 a[120:123], v20, s[8:11], 0 offen offset:128
    buffer_load_dwordx4 a[124:127], v20, s[8:11], 0 offen offset:192
    buffer_load_dwordx4 a[128:131], v20, s[8:11], 0 offen offset:256
    buffer_load_dwordx4 a[132:135], v20, s[8:11], 0 offen offset:320
    buffer_load_dwordx4 a[136:139], v20, s[8:11], 0 offen offset:384
    buffer_load_dwordx4 a[140:143], v20, s[8:11], 0 offen offset:448
    buffer_load_dwordx4 a[144:147], v20, s[8:11], 0 offen offset:512
    buffer_load_dwordx4 a[148:151], v20, s[8:11], 0 offen offset:576
    buffer_load_dwordx4 a[152:155], v20, s[8:11], 0 offen offset:640
    buffer_load_dwordx4 a[156:159], v20, s[8:11], 0 offen offset:704
    buffer_load_dwordx4 a[160:163], v20, s[8:11], 0 offen offset:768
    buffer_load_dwordx4 a[164:167], v20, s[8:11], 0 offen offset:832
    v_add_u32 v20, 401408, v20
    buffer_load_dwordx4 a[168:171], v20, s[8:11], 0 offen offset:0
    buffer_load_dwordx4 a[172:175], v20, s[8:11], 0 offen offset:64
    buffer_load_dwordx4 a[176:179], v20, s[8:11], 0 offen offset:128
    buffer_load_dwordx4 a[180:183], v20, s[8:11], 0 offen offset:192
    buffer_load_dwordx4 a[184:187], v20, s[8:11], 0 offen offset:256
    buffer_load_dwordx4 a[188:191], v20, s[8:11], 0 offen offset:320
    buffer_load_dwordx4 a[192:195], v20, s[8:11], 0 offen offset:384
    buffer_load_dwordx4 a[196:199], v20, s[8:11], 0 offen offset:448
    buffer_load_dwordx4 a[200:203], v20, s[8:11], 0 offen offset:512
    buffer_load_dwordx4 a[204:207], v20, s[8:11], 0 offen offset:576
    buffer_load_dwordx4 a[208:211], v20, s[8:11], 0 offen offset:640
    buffer_load_dwordx4 a[212:215], v20, s[8:11], 0 offen offset:704
    buffer_load_dwordx4 a[216:219], v20, s[8:11], 0 offen offset:768
    buffer_load_dwordx4 a[220:223], v20, s[8:11], 0 offen offset:832
    v_add_u32 v20, 401408, v20
    s_mov_b32 s30, 89128960
    s_lshl_b32 s31, s6, 4
    s_lshl_b32 s5, s4, 2
    s_add_u32 s31, s31, s5
    s_lshl_b32 s7, s31, 8
    s_lshl_b32 s31, s31, 10
    s_add_u32 s31, s31, 52428800
    s_add_u32 s7, s7, 91226112
    v_lshlrev_b32 v118, 6, v116
    v_lshl_add_u32 v118, v117, 4, v118
    v_and_b32 v119, 7, v116
    v_mul_u32_u24 v23, 80, v119
    v_mul_u32_u24 v119, 912, v119
    v_lshl_add_u32 v119, v117, 4, v119
    v_lshl_add_u32 v24, v117, 4, v23
    v_add_u32 v24, 16, v24
    v_mul_u32_u24 v25, 640, v117
    v_add_u32 v25, v25, v23
    s_lshl_b32 s32, s4, 2
    s_mul_i32 s32, s32, 640
    s_add_u32 s32, s32, 90177536
    s_lshl_b32 s5, s4, 10
    s_add_u32 s5, s5, 8192
    v_lshlrev_b32 v28, 4, v116
    v_lshl_add_u32 v28, v117, 3, v28
    v_add_u32 v26, s5, v28
    v_lshlrev_b32 v27, 4, v116
    v_lshl_add_u32 v27, v117, 8, v27
    v_add_u32 v27, s5, v27
    s_lshl_b32 s5, s4, 9
    s_add_u32 s5, s5, 16384
    v_lshlrev_b32 v29, 2, v116
    v_lshl_add_u32 v29, v117, 8, v29
    v_add_u32 v29, s5, v29
    v_lshrrev_b32 v31, 2, v0
    v_and_b32 v21, 3, v0
    v_lshlrev_b32 v21, 4, v21
    v_lshl_add_u32 v30, v31, 6, v21
    v_add_u32 v30, 16384, v30
    v_lshl_add_u32 v31, v31, 7, v21
    s_lshr_b32 s16, s6, 1
    s_lshl_b32 s16, s16, 10
    s_and_b32 s17, s6, 1
    s_lshl_b32 s17, s17, 6
    s_add_u32 s16, s16, s17
    s_add_u32 s16, s16, 89143296
    s_mov_b32 s33, 0
K4B_loop:
    s_lshr_b32 s28, s33, 2
    s_lshl_b32 s28, s28, 6
    s_add_u32 s28, s28, 90832896
    v_mov_b32 v21, 0
K4Bc_cp:
    buffer_load_dword v20, v21, s[8:11], s28 offen sc1
    s_waitcnt vmcnt(0)
    v_cmp_ne_u32 vcc, 63, v20
    s_add_u32 s42, s42, 1
    s_cmp_gt_u32 s42, 0x400000
    s_cbranch_scc1 K4Bc_cpo
    s_cbranch_vccnz K4Bc_cp
K4Bc_cpo:
    buffer_load_dwordx4 v[96:99], v118, s[8:11], s31 offen offset:0 sc1
    buffer_load_dwordx4 v[100:103], v118, s[8:11], s31 offen offset:1024 sc1
    buffer_load_dwordx4 v[104:107], v118, s[8:11], s31 offen offset:2048 sc1
    buffer_load_dwordx4 v[108:111], v118, s[8:11], s31 offen offset:3072 sc1
K4B_poll:
    s_add_u32 s28, s30, s34
    buffer_load_dwordx4 v[4:7], v2, s[8:11], s28 offen sc1
    s_add_u32 s28, s30, s35
    buffer_load_dwordx4 v[8:11], v2, s[8:11], s28 offen sc1
    s_add_u32 s28, s30, s36
    buffer_load_dwordx4 v[12:15], v2, s[8:11], s28 offen sc1
    s_add_u32 s28, s30, s37
    buffer_load_dwordx4 v[16:19], v2, s[8:11], s28 offen sc1
    s_waitcnt vmcnt(0)
    v_and_b32 v20, v4, v5
    v_and_b32 v20, v20, v6
    v_and_b32 v20, v20, v7
    v_and_b32 v20, v20, v8
    v_and_b32 v20, v20, v9
    v_and_b32 v20, v20, v10
    v_and_b32 v20, v20, v11
    v_and_b32 v20, v20, v12
    v_and_b32 v20, v20, v13
    v_and_b32 v20, v20, v14
    v_and_b32 v20, v20, v15
    v_and_b32 v20, v20, v16
    v_and_b32 v20, v20, v17
    v_and_b32 v20, v20, v18
    v_and_b32 v20, v20, v19
    v_and_b32 v20, 0xffff, v20
    v_cmp_ne_u32 vcc, 23130, v20
    s_add_u32 s42, s42, 1
    s_cmp_gt_u32 s42, 0x400000
    s_cbranch_scc1 K4B_pout
    s_cbranch_vccnz K4B_poll
K4B_pout:
    v_perm_b32 v20, v5, v4, s29
    v_perm_b32 v21, v7, v6, s29
    v_add_u32 v22, s38, v3
    ds_write_b64 v22, v[20:21]
    v_perm_b32 v20, v9, v8, s29
    v_perm_b32 v21, v11, v10, s29
    v_add_u32 v22, s39, v3
    ds_write_b64 v22, v[20:21]
    v_perm_b32 v20, v13, v12, s29
    v_perm_b32 v21, v15, v14, s29
    v_add_u32 v22, s40, v3
    ds_write_b64 v22, v[20:21]
    v_perm_b32 v20, v17, v16, s29
    v_perm_b32 v21, v19, v18, s29
    v_add_u32 v22, s41, v3
    ds_write_b64 v22, v[20:21]
    s_waitcnt lgkmcnt(0)
    s_barrier
    ds_read_b128 v[32:35], v119 offset:0
    ds_read_b128 v[36:39], v119 offset:64
    ds_read_b128 v[40:43], v119 offset:128
    ds_read_b128 v[44:47], v119 offset:192
    ds_read_b128 v[48:51], v119 offset:256
    ds_read_b128 v[52:55], v119 offset:320
    ds_read_b128 v[56:59], v119 offset:384
    ds_read_b128 v[60:63], v119 offset:448
    ds_read_b128 v[64:67], v119 offset:512
    ds_read_b128 v[68:71], v119 offset:576
    ds_read_b128 v[72:75], v119 offset:640
    ds_read_b128 v[76:79], v119 offset:704
    ds_read_b128 v[80:83], v119 offset:768
    ds_read_b128 v[84:87], v119 offset:832
    v_mov_b32 v120, 0
    v_mov_b32 v121, 0
    v_mov_b32 v122, 0
    v_mov_b32 v123, 0
    v_mov_b32 v124, 0
    v_mov_b32 v125, 0
    v_mov_b32 v126, 0
    v_mov_b32 v127, 0
    v_mov_b32 v128, 0
    v_mov_b32 v129, 0
    v_mov_b32 v130, 0
    v_mov_b32 v131, 0
    v_mov_b32 v132, 0
    v_mov_b32 v133, 0
    v_mov_b32 v134, 0
    v_mov_b32 v135, 0
    s_waitcnt lgkmcnt(13)
    v_mfma_f32_16x16x32_bf16 v[120:123], v[32:35], a[0:3], v[120:123]
    v_mfma_f32_16x16x32_bf16 v[124:127], v[32:35], a[56:59], v[124:127]
    v_mfma_f32_16x16x32_bf16 v[128:131], v[32:35], a[112:115], v[128:131]
    v_mfma_f32_16x16x32_bf16 v[132:135], v[32:35], a[168:171], v[132:135]
    s_waitcnt lgkmcnt(12)
    v_mfma_f32_16x16x32_bf16 v[120:123], v[36:39], a[4:7], v[120:123]
    v_mfma_f32_16x16x32_bf16 v[124:127], v[36:39], a[60:63], v[124:127]
    v_mfma_f32_16x16x32_bf16 v[128:131], v[36:39], a[116:119], v[128:131]
    v_mfma_f32_16x16x32_bf16 v[132:135], v[36:39], a[172:175], v[132:135]
    s_waitcnt lgkmcnt(11)
    v_mfma_f32_16x16x32_bf16 v[120:123], v[40:43], a[8:11], v[120:123]
    v_mfma_f32_16x16x32_bf16 v[124:127], v[40:43], a[64:67], v[124:127]
    v_mfma_f32_16x16x32_bf16 v[128:131], v[40:43], a[120:123], v[128:131]
    v_mfma_f32_16x16x32_bf16 v[132:135], v[40:43], a[176:179], v[132:135]
    s_waitcnt lgkmcnt(10)
    v_mfma_f32_16x16x32_bf16 v[120:123], v[44:47], a[12:15], v[120:123]
    v_mfma_f32_16x16x32_bf16 v[124:127], v[44:47], a[68:71], v[124:127]
    v_mfma_f32_16x16x32_bf16 v[128:131], v[44:47], a[124:127], v[128:131]
    v_mfma_f32_16x16x32_bf16 v[132:135], v[44:47], a[180:183], v[132:135]
    s_waitcnt lgkmcnt(9)
    v_mfma_f32_16x16x32_bf16 v[120:123], v[48:51], a[16:19], v[120:123]
    v_mfma_f32_16x16x32_bf16 v[124:127], v[48:51], a[72:75], v[124:127]
    v_mfma_f32_16x16x32_bf16 v[128:131], v[48:51], a[128:131], v[128:131]
    v_mfma_f32_16x16x32_bf16 v[132:135], v[48:51], a[184:187], v[132:135]
    s_waitcnt lgkmcnt(8)
    v_mfma_f32_16x16x32_bf16 v[120:123], v[52:55], a[20:23], v[120:123]
    v_mfma_f32_16x16x32_bf16 v[124:127], v[52:55], a[76:79], v[124:127]
    v_mfma_f32_16x16x32_bf16 v[128:131], v[52:55], a[132:135], v[128:131]
    v_mfma_f32_16x16x32_bf16 v[132:135], v[52:55], a[188:191], v[132:135]
    s_waitcnt lgkmcnt(7)
    v_mfma_f32_16x16x32_bf16 v[120:123], v[56:59], a[24:27], v[120:123]
    v_mfma_f32_16x16x32_bf16 v[124:127], v[56:59], a[80:83], v[124:127]
    v_mfma_f32_16x16x32_bf16 v[128:131], v[56:59], a[136:139], v[128:131]
    v_mfma_f32_16x16x32_bf16 v[132:135], v[56:59], a[192:195], v[132:135]
    s_waitcnt lgkmcnt(6)
    v_mfma_f32_16x16x32_bf16 v[120:123], v[60:63], a[28:31], v[120:123]
    v_mfma_f32_16x16x32_bf16 v[124:127], v[60:63], a[84:87], v[124:127]
    v_mfma_f32_16x16x32_bf16 v[128:131], v[60:63], a[140:143], v[128:131]
    v_mfma_f32_16x16x32_bf16 v[132:135], v[60:63], a[196:199], v[132:135]
    s_waitcnt lgkmcnt(5)
    v_mfma_f32_16x16x32_bf16 v[120:123], v[64:67], a[32:35], v[120:123]
    v_mfma_f32_16x16x32_bf16 v[124:127], v[64:67], a[88:91], v[124:127]
    v_mfma_f32_16x16x32_bf16 v[128:131], v[64:67], a[144:147], v[128:131]
    v_mfma_f32_16x16x32_bf16 v[132:135], v[64:67], a[200:203], v[132:135]
    s_waitcnt lgkmcnt(4)
    v_mfma_f32_16x16x32_bf16 v[120:123], v[68:71], a[36:39], v[120:123]
    v_mfma_f32_16x16x32_bf16 v[124:127], v[68:71], a[92:95], v[124:127]
    v_mfma_f32_16x16x32_bf16 v[128:131], v[68:71], a[148:151], v[128:131]
    v_mfma_f32_16x16x32_bf16 v[132:135], v[68:71], a[204:207], v[132:135]
    s_waitcnt lgkmcnt(3)
    v_mfma_f32_16x16x32_bf16 v[120:123], v[72:75], a[40:43], v[120:123]
    v_mfma_f32_16x16x32_bf16 v[124:127], v[72:75], a[96:99], v[124:127]
    v_mfma_f32_16x16x32_bf16 v[128:131], v[72:75], a[152:155], v[128:131]
    v_mfma_f32_16x16x32_bf16 v[132:135], v[72:75], a[208:211], v[132:135]
    s_waitcnt lgkmcnt(2)
    v_mfma_f32_16x16x32_bf16 v[120:123], v[76:79], a[44:47], v[120:123]
    v_mfma_f32_16x16x32_bf16 v[124:127], v[76:79], a[100:103], v[124:127]
    v_mfma_f32_16x16x32_bf16 v[128:131], v[76:79], a[156:159], v[128:131]
    v_mfma_f32_16x16x32_bf16 v[132:135], v[76:79], a[212:215], v[132:135]
    s_waitcnt lgkmcnt(1)
    v_mfma_f32_16x16x32_bf16 v[120:123], v[80:83], a[48:51], v[120:123]
    v_mfma_f32_16x16x32_bf16 v[124:127], v[80:83], a[104:107], v[124:127]
    v_mfma_f32_16x16x32_bf16 v[128:131], v[80:83], a[160:163], v[128:131]
    v_mfma_f32_16x16x32_bf16 v[132:135], v[80:83], a[216:219], v[132:135]
    s_waitcnt lgkmcnt(0)
    v_mfma_f32_16x16x32_bf16 v[120:123], v[84:87], a[52:55], v[120:123]
    v_mfma_f32_16x16x32_bf16 v[124:127], v[84:87], a[108:111], v[124:127]
    v_mfma_f32_16x16x32_bf16 v[128:131], v[84:87], a[164:167], v[128:131]
    v_mfma_f32_16x16x32_bf16 v[132:135], v[84:87], a[220:223], v[132:135]
    s_nop 7
    s_nop 1
    v_cmp_gt_u32 vcc, 2, v117
    s_and_saveexec_b64 s[20:21], vcc
    v_cvt_pk_bf16_f32 v136, v120, v121
    v_cvt_pk_bf16_f32 v137, v122, v123
    ds_write_b64 v26, v[136:137] offset:0
    buffer_store_dwordx2 v[136:137], v28, s[8:11], s7 offen offset:0 sc1
    v_cvt_pk_bf16_f32 v138, v124, v125
    v_cvt_pk_bf16_f32 v139, v126, v127
    ds_write_b64 v26, v[138:139] offset:256
    buffer_store_dwordx2 v[138:139], v28, s[8:11], s7 offen offset:256 sc1
    v_cvt_pk_bf16_f32 v140, v128, v129
    v_cvt_pk_bf16_f32 v141, v130, v131
    ds_write_b64 v26, v[140:141] offset:512
    buffer_store_dwordx2 v[140:141], v28, s[8:11], s7 offen offset:512 sc1
    v_cvt_pk_bf16_f32 v142, v132, v133
    v_cvt_pk_bf16_f32 v143, v134, v135
    ds_write_b64 v26, v[142:143] offset:768
    buffer_store_dwordx2 v[142:143], v28, s[8:11], s7 offen offset:768 sc1
    s_mov_b64 exec, s[20:21]
    s_waitcnt lgkmcnt(0)
    ds_read_b128 v[112:115], v27
K4B_pp:
    buffer_load_dwordx4 v[32:35], v24, s[8:11], s32 offen offset:0 sc1
    buffer_load_dwordx4 v[36:39], v24, s[8:11], s32 offen offset:640 sc1
    buffer_load_dwordx4 v[40:43], v24, s[8:11], s32 offen offset:1280 sc1
    buffer_load_dwordx4 v[44:47], v24, s[8:11], s32 offen offset:1920 sc1
    buffer_load_dwordx4 v[48:51], v25, s[8:11], s32 offen sc1
    s_waitcnt vmcnt(0)
    v_and_b32 v20, v32, v33
    v_and_b32 v20, v20, v34
    v_and_b32 v20, v20, v35
    v_and_b32 v20, v20, v36
    v_and_b32 v20, v20, v37
    v_and_b32 v20, v20, v38
    v_and_b32 v20, v20, v39
    v_and_b32 v20, v20, v40
    v_and_b32 v20, v20, v41
    v_and_b32 v20, v20, v42
    v_and_b32 v20, v20, v43
    v_and_b32 v20, v20, v44
    v_and_b32 v20, v20, v45
    v_and_b32 v20, v20, v46
    v_and_b32 v20, v20, v47
    v_and_b32 v20, v20, v48
    v_and_b32 v20, v20, v49
    v_and_b32 v20, v20, v50
    v_and_b32 v20, v20, v51
    v_and_b32 v20, 0x80008000, v20
    v_cmp_ne_u32 vcc, 0x80008000, v20
    s_add_u32 s42, s42, 1
    s_cmp_gt_u32 s42, 0x400000
    s_cbranch_scc1 K4B_ppo
    s_cbranch_vccnz K4B_pp
K4B_ppo:
    v_and_b32 v32, 0x7fff7fff, v32
    v_and_b32 v33, 0x7fff7fff, v33
    v_and_b32 v34, 0x7fff7fff, v34
    v_and_b32 v35, 0x7fff7fff, v35
    v_and_b32 v36, 0x7fff7fff, v36
    v_and_b32 v37, 0x7fff7fff, v37
    v_and_b32 v38, 0x7fff7fff, v38
    v_and_b32 v39, 0x7fff7fff, v39
    v_and_b32 v40, 0x7fff7fff, v40
    v_and_b32 v41, 0x7fff7fff, v41
    v_and_b32 v42, 0x7fff7fff, v42
    v_and_b32 v43, 0x7fff7fff, v43
    v_and_b32 v44, 0x7fff7fff, v44
    v_and_b32 v45, 0x7fff7fff, v45
    v_and_b32 v46, 0x7fff7fff, v46
    v_and_b32 v47, 0x7fff7fff, v47
    v_and_b32 v48, 0x7fff7fff, v48
    v_and_b32 v49, 0x7fff7fff, v49
    v_and_b32 v50, 0x7fff7fff, v50
    v_and_b32 v51, 0x7fff7fff, v51
    v_mov_b32 v120, 0
    v_mov_b32 v121, 0
    v_mov_b32 v122, 0
    v_mov_b32 v123, 0
    s_waitcnt lgkmcnt(0)
    s_nop 0
    v_mfma_f32_16x16x32_bf16 v[120:123], v[32:35], v[96:99], v[120:123]
    v_mfma_f32_16x16x32_bf16 v[120:123], v[36:39], v[100:103], v[120:123]
    v_mfma_f32_16x16x32_bf16 v[120:123], v[40:43], v[104:107], v[120:123]
    v_mfma_f32_16x16x32_bf16 v[120:123], v[44:47], v[108:111], v[120:123]
    v_mfma_f32_16x16x32_bf16 v[120:123], v[48:51], v[112:115], v[120:123]
    s_nop 7
    s_nop 1
    v_cmp_gt_u32 vcc, 2, v117
    s_and_saveexec_b64 s[20:21], vcc
    ds_write_b32 v29, v120 offset:0
    ds_write_b32 v29, v121 offset:64
    ds_write_b32 v29, v122 offset:128
    ds_write_b32 v29, v123 offset:192
    s_mov_b64 exec, s[20:21]
    s_waitcnt lgkmcnt(0)
    s_barrier
    s_cmp_eq_u32 s4, 0
    s_cbranch_scc0 K4B_next
    v_cmp_gt_u32 vcc, 32, v0
    s_and_saveexec_b64 s[20:21], vcc
    ds_read_b128 v[32:35], v30 offset:0
    ds_read_b128 v[36:39], v30 offset:512
    ds_read_b128 v[40:43], v30 offset:1024
    ds_read_b128 v[44:47], v30 offset:1536
    s_waitcnt lgkmcnt(0)
    v_add_f32 v32, v32, v36
    v_add_f32 v40, v40, v44
    v_add_f32 v32, v32, v40
    v_cvt_pk_bf16_f32 v32, v32, v32
    v_lshlrev_b32 v32, 16, v32
    v_or_b32 v32, 23130, v32
    v_add_f32 v33, v33, v37
    v_add_f32 v41, v41, v45
    v_add_f32 v33, v33, v41
    v_cvt_pk_bf16_f32 v33, v33, v33
    v_lshlrev_b32 v33, 16, v33
    v_or_b32 v33, 23130, v33
    v_add_f32 v34, v34, v38
    v_add_f32 v42, v42, v46
    v_add_f32 v34, v34, v42
    v_cvt_pk_bf16_f32 v34, v34, v34
    v_lshlrev_b32 v34, 16, v34
    v_or_b32 v34, 23130, v34
    v_add_f32 v35, v35, v39
    v_add_f32 v43, v43, v47
    v_add_f32 v35, v35, v43
    v_cvt_pk_bf16_f32 v35, v35, v35
    v_lshlrev_b32 v35, 16, v35
    v_or_b32 v35, 23130, v35
    buffer_store_dwordx4 v[32:35], v31, s[8:11], s16 offen sc1
    s_mov_b64 exec, s[20:21]
K4B_next:
    s_add_u32 s30, s30, 14336
    s_add_u32 s16, s16, 14336
    s_add_u32 s31, s31, 458752
    s_add_u32 s7, s7, 114688
    s_add_u32 s32, s32, 10240
    s_add_u32 s33, s33, 1
    s_cmp_lt_u32 s33, 64
    s_cbranch_scc1 K4B_loop
K4_done:
    s_endpgm
K3_entry:
    s_sub_u32 s2, s2, 44
    s_cmp_ge_u32 s2, 189
    s_cbranch_scc1 K3_done
    s_load_dwordx2 s[12:13], s[0:1], 72
    s_mov_b32 s14, 3584
    s_mov_b32 s15, 0x00020000
    s_mov_b32 s5, 68174085
    s_mul_hi_u32 s5, s2, s5
    s_mul_i32 s6, s5, 63
    s_sub_u32 s6, s2, s6
K3_mt:
    s_lshl_b32 s7, s5, 7
    s_lshl_b32 s16, s4, 5
    s_add_u32 s7, s7, s16
    s_mul_i32 s7, s7, 896
    v_lshlrev_b32 v1, 4, v0
    s_mul_i32 s16, s16, 912
    v_add_u32 v2, s16, v1
    s_waitcnt lgkmcnt(0)
    v_cmp_gt_u32 vcc, 56, v0
    s_and_saveexec_b64 s[20:21], vcc
    buffer_load_dwordx4 v[8:11], v1, s[8:11], s7 offen
    s_add_u32 s7, s7, 896
    buffer_load_dwordx4 v[12:15], v1, s[8:11], s7 offen
    s_add_u32 s7, s7, 896
    buffer_load_dwordx4 v[16:19], v1, s[8:11], s7 offen
    s_add_u32 s7, s7, 896
    buffer_load_dwordx4 v[20:23], v1, s[8:11], s7 offen
    s_add_u32 s7, s7, 896
    buffer_load_dwordx4 v[24:27], v1, s[8:11], s7 offen
    s_add_u32 s7, s7, 896
    buffer_load_dwordx4 v[28:31], v1, s[8:11], s7 offen
    s_add_u32 s7, s7, 896
    buffer_load_dwordx4 v[32:35], v1, s[8:11], s7 offen
    s_add_u32 s7, s7, 896
    buffer_load_dwordx4 v[36:39], v1, s[8:11], s7 offen
    s_add_u32 s7, s7, 896
    buffer_load_dwordx4 v[40:43], v1, s[8:11], s7 offen
    s_add_u32 s7, s7, 896
    buffer_load_dwordx4 v[44:47], v1, s[8:11], s7 offen
    s_add_u32 s7, s7, 896
    buffer_load_dwordx4 v[48:51], v1, s[8:11], s7 offen
    s_add_u32 s7, s7, 896
    buffer_load_dwordx4 v[52:55], v1, s[8:11], s7 offen
    s_add_u32 s7, s7, 896
    buffer_load_dwordx4 v[56:59], v1, s[8:11], s7 offen
    s_add_u32 s7, s7, 896
    buffer_load_dwordx4 v[60:63], v1, s[8:11], s7 offen
    s_add_u32 s7, s7, 896
    buffer_load_dwordx4 v[64:67], v1, s[8:11], s7 offen
    s_add_u32 s7, s7, 896
    buffer_load_dwordx4 v[68:71], v1, s[8:11], s7 offen
    s_add_u32 s7, s7, 896
    buffer_load_dwordx4 v[72:75], v1, s[8:11], s7 offen
    s_add_u32 s7, s7, 896
    buffer_load_dwordx4 v[76:79], v1, s[8:11], s7 offen
    s_add_u32 s7, s7, 896
    buffer_load_dwordx4 v[80:83], v1, s[8:11], s7 offen
    s_add_u32 s7, s7, 896
    buffer_load_dwordx4 v[84:87], v1, s[8:11], s7 offen
    s_add_u32 s7, s7, 896
    buffer_load_dwordx4 v[88:91], v1, s[8:11], s7 offen
    s_add_u32 s7, s7, 896
    buffer_load_dwordx4 v[92:95], v1, s[8:11], s7 offen
    s_add_u32 s7, s7, 896
    buffer_load_dwordx4 v[96:99], v1, s[8:11], s7 offen
    s_add_u32 s7, s7, 896
    buffer_load_dwordx4 v[100:103], v1, s[8:11], s7 offen
    s_add_u32 s7, s7, 896
    buffer_load_dwordx4 v[104:107], v1, s[8:11], s7 offen
    s_add_u32 s7, s7, 896
    buffer_load_dwordx4 v[108:111], v1, s[8:11], s7 offen
    s_add_u32 s7, s7, 896
    buffer_load_dwordx4 v[112:115], v1, s[8:11], s7 offen
    s_add_u32 s7, s7, 896
    buffer_load_dwordx4 v[116:119], v1, s[8:11], s7 offen
    s_add_u32 s7, s7, 896
    buffer_load_dwordx4 v[120:123], v1, s[8:11], s7 offen
    s_add_u32 s7, s7, 896
    buffer_load_dwordx4 v[124:127], v1, s[8:11], s7 offen
    s_add_u32 s7, s7, 896
    buffer_load_dwordx4 v[128:131], v1, s[8:11], s7 offen
    s_add_u32 s7, s7, 896
    buffer_load_dwordx4 v[132:135], v1, s[8:11], s7 offen
    s_add_u32 s7, s7, 896
    s_waitcnt vmcnt(31)
    ds_write_b128 v2, v[8:11] offset:0
    s_waitcnt vmcnt(30)
    ds_write_b128 v2, v[12:15] offset:912
    s_waitcnt vmcnt(29)
    ds_write_b128 v2, v[16:19] offset:1824
    s_waitcnt vmcnt(28)
    ds_write_b128 v2, v[20:23] offset:2736
    s_waitcnt vmcnt(27)
    ds_write_b128 v2, v[24:27] offset:3648
    s_waitcnt vmcnt(26)
    ds_write_b128 v2, v[28:31] offset:4560
    s_waitcnt vmcnt(25)
    ds_write_b128 v2, v[32:35] offset:5472
    s_waitcnt vmcnt(24)
    ds_write_b128 v2, v[36:39] offset:6384
    s_waitcnt vmcnt(23)
    ds_write_b128 v2, v[40:43] offset:7296
    s_waitcnt vmcnt(22)
    ds_write_b128 v2, v[44:47] offset:8208
    s_waitcnt vmcnt(21)
    ds_write_b128 v2, v[48:51] offset:9120
    s_waitcnt vmcnt(20)
    ds_write_b128 v2, v[52:55] offset:10032
    s_waitcnt vmcnt(19)
    ds_write_b128 v2, v[56:59] offset:10944
    s_waitcnt vmcnt(18)
    ds_write_b128 v2, v[60:63] offset:11856
    s_waitcnt vmcnt(17)
    ds_write_b128 v2, v[64:67] offset:12768
    s_waitcnt vmcnt(16)
    ds_write_b128 v2, v[68:71] offset:13680
    s_waitcnt vmcnt(15)
    ds_write_b128 v2, v[72:75] offset:14592
    s_waitcnt vmcnt(14)
    ds_write_b128 v2, v[76:79] offset:15504
    s_waitcnt vmcnt(13)
    ds_write_b128 v2, v[80:83] offset:16416
    s_waitcnt vmcnt(12)
    ds_write_b128 v2, v[84:87] offset:17328
    s_waitcnt vmcnt(11)
    ds_write_b128 v2, v[88:91] offset:18240
    s_waitcnt vmcnt(10)
    ds_write_b128 v2, v[92:95] offset:19152
    s_waitcnt vmcnt(9)
    ds_write_b128 v2, v[96:99] offset:20064
    s_waitcnt vmcnt(8)
    ds_write_b128 v2, v[100:103] offset:20976
    s_waitcnt vmcnt(7)
    ds_write_b128 v2, v[104:107] offset:21888
    s_waitcnt vmcnt(6)
    ds_write_b128 v2, v[108:111] offset:22800
    s_waitcnt vmcnt(5)
    ds_write_b128 v2, v[112:115] offset:23712
    s_waitcnt vmcnt(4)
    ds_write_b128 v2, v[116:119] offset:24624
    s_waitcnt vmcnt(3)
    ds_write_b128 v2, v[120:123] offset:25536
    s_waitcnt vmcnt(2)
    ds_write_b128 v2, v[124:127] offset:26448
    s_waitcnt vmcnt(1)
    ds_write_b128 v2, v[128:131] offset:27360
    s_waitcnt vmcnt(0)
    ds_write_b128 v2, v[132:135] offset:28272
    s_mov_b64 exec, s[20:21]
    s_waitcnt lgkmcnt(0)
    s_barrier
    v_and_b32 v1, 15, v0
    v_lshrrev_b32 v2, 4, v0
    v_mul_u32_u24 v3, 912, v1
    v_lshl_add_u32 v3, v2, 4, v3
    v_add_u32 v137, 58368, v3
    s_mov_b32 s7, s6
K3_pass:
    s_lshl_b32 s16, s7, 8
    s_lshl_b32 s17, s4, 6
    s_add_u32 s16, s16, s17
    v_add_u32 v4, s16, v1
    v_mul_u32_u24 v4, 896, v4
    v_lshl_add_u32 v4, v2, 4, v4
    v_add_u32 v4, 2097152, v4
    v_add_u32 v5, 14336, v4
    v_add_u32 v6, 28672, v4
    v_add_u32 v7, 43008, v4
    v_accvgpr_write_b32 a0, 0
    v_accvgpr_write_b32 a1, 0
    v_accvgpr_write_b32 a2, 0
    v_accvgpr_write_b32 a3, 0
    v_accvgpr_write_b32 a4, 0
    v_accvgpr_write_b32 a5, 0
    v_accvgpr_write_b32 a6, 0
    v_accvgpr_write_b32 a7, 0
    v_accvgpr_write_b32 a8, 0
    v_accvgpr_write_b32 a9, 0
    v_accvgpr_write_b32 a10, 0
    v_accvgpr_write_b32 a11, 0
    v_accvgpr_write_b32 a12, 0
    v_accvgpr_write_b32 a13, 0
    v_accvgpr_write_b32 a14, 0
    v_accvgpr_write_b32 a15, 0
    v_accvgpr_write_b32 a16, 0
    v_accvgpr_write_b32 a17, 0
    v_accvgpr_write_b32 a18, 0
    v_accvgpr_write_b32 a19, 0
    v_accvgpr_write_b32 a20, 0
    v_accvgpr_write_b32 a21, 0
    v_accvgpr_write_b32 a22, 0
    v_accvgpr_write_b32 a23, 0
    v_accvgpr_write_b32 a24, 0
    v_accvgpr_write_b32 a25, 0
    v_accvgpr_write_b32 a26, 0
    v_accvgpr_write_b32 a27, 0
    v_accvgpr_write_b32 a28, 0
    v_accvgpr_write_b32 a29, 0
    v_accvgpr_write_b32 a30, 0
    v_accvgpr_write_b32 a31, 0
    v_accvgpr_write_b32 a32, 0
    v_accvgpr_write_b32 a33, 0
    v_accvgpr_write_b32 a34, 0
    v_accvgpr_write_b32 a35, 0
    v_accvgpr_write_b32 a36, 0
    v_accvgpr_write_b32 a37, 0
    v_accvgpr_write_b32 a38, 0
    v_accvgpr_write_b32 a39, 0
    v_accvgpr_write_b32 a40, 0
    v_accvgpr_write_b32 a41, 0
    v_accvgpr_write_b32 a42, 0
    v_accvgpr_write_b32 a43, 0
    v_accvgpr_write_b32 a44, 0
    v_accvgpr_write_b32 a45, 0
    v_accvgpr_write_b32 a46, 0
    v_accvgpr_write_b32 a47, 0
    v_accvgpr_write_b32 a48, 0
    v_accvgpr_write_b32 a49, 0
    v_accvgpr_write_b32 a50, 0
    v_accvgpr_write_b32 a51, 0
    v_accvgpr_write_b32 a52, 0
    v_accvgpr_write_b32 a53, 0
    v_accvgpr_write_b32 a54, 0
    v_accvgpr_write_b32 a55, 0
    v_accvgpr_write_b32 a56, 0
    v_accvgpr_write_b32 a57, 0
    v_accvgpr_write_b32 a58, 0
    v_accvgpr_write_b32 a59, 0
    v_accvgpr_write_b32 a60, 0
    v_accvgpr_write_b32 a61, 0
    v_accvgpr_write_b32 a62, 0
    v_accvgpr_write_b32 a63, 0
    v_accvgpr_write_b32 a64, 0
    v_accvgpr_write_b32 a65, 0
    v_accvgpr_write_b32 a66, 0
    v_accvgpr_write_b32 a67, 0
    v_accvgpr_write_b32 a68, 0
    v_accvgpr_write_b32 a69, 0
    v_accvgpr_write_b32 a70, 0
    v_accvgpr_write_b32 a71, 0
    v_accvgpr_write_b32 a72, 0
    v_accvgpr_write_b32 a73, 0
    v_accvgpr_write_b32 a74, 0
    v_accvgpr_write_b32 a75, 0
    v_accvgpr_write_b32 a76, 0
    v_accvgpr_write_b32 a77, 0
    v_accvgpr_write_b32 a78, 0
    v_accvgpr_write_b32 a79, 0
    v_accvgpr_write_b32 a80, 0
    v_accvgpr_write_b32 a81, 0
    v_accvgpr_write_b32 a82, 0
    v_accvgpr_write_b32 a83, 0
    v_accvgpr_write_b32 a84, 0
    v_accvgpr_write_b32 a85, 0
    v_accvgpr_write_b32 a86, 0
    v_accvgpr_write_b32 a87, 0
    v_accvgpr_write_b32 a88, 0
    v_accvgpr_write_b32 a89, 0
    v_accvgpr_write_b32 a90, 0
    v_accvgpr_write_b32 a91, 0
    v_accvgpr_write_b32 a92, 0
    v_accvgpr_write_b32 a93, 0
    v_accvgpr_write_b32 a94, 0
    v_accvgpr_write_b32 a95, 0
    v_accvgpr_write_b32 a96, 0
    v_accvgpr_write_b32 a97, 0
    v_accvgpr_write_b32 a98, 0
    v_accvgpr_write_b32 a99, 0
    v_accvgpr_write_b32 a100, 0
    v_accvgpr_write_b32 a101, 0
    v_accvgpr_write_b32 a102, 0
    v_accvgpr_write_b32 a103, 0
    v_accvgpr_write_b32 a104, 0
    v_accvgpr_write_b32 a105, 0
    v_accvgpr_write_b32 a106, 0
    v_accvgpr_write_b32 a107, 0
    v_accvgpr_write_b32 a108, 0
    v_accvgpr_write_b32 a109, 0
    v_accvgpr_write_b32 a110, 0
    v_accvgpr_write_b32 a111, 0
    v_accvgpr_write_b32 a112, 0
    v_accvgpr_write_b32 a113, 0
    v_accvgpr_write_b32 a114, 0
    v_accvgpr_write_b32 a115, 0
    v_accvgpr_write_b32 a116, 0
    v_accvgpr_write_b32 a117, 0
    v_accvgpr_write_b32 a118, 0
    v_accvgpr_write_b32 a119, 0
    v_accvgpr_write_b32 a120, 0
    v_accvgpr_write_b32 a121, 0
    v_accvgpr_write_b32 a122, 0
    v_accvgpr_write_b32 a123, 0
    v_accvgpr_write_b32 a124, 0
    v_accvgpr_write_b32 a125, 0
    v_accvgpr_write_b32 a126, 0
    v_accvgpr_write_b32 a127, 0
    s_cmp_ge_u32 s7, 28
    s_cbranch_scc0 K3_sw
    s_cmp_ge_u32 s7, 56
    s_cbranch_scc0 K3_ns
K3_sw:
    buffer_load_dwordx4 v[8:11], v4, s[8:11], 0 offen offset:0
    buffer_load_dwordx4 v[12:15], v5, s[8:11], 0 offen offset:0
    buffer_load_dwordx4 v[16:19], v6, s[8:11], 0 offen offset:0
    buffer_load_dwordx4 v[20:23], v7, s[8:11], 0 offen offset:0
    ds_read_b128 v[40:43], v3 offset:0
    ds_read_b128 v[44:47], v3 offset:14592
    ds_read_b128 v[48:51], v3 offset:29184
    ds_read_b128 v[52:55], v3 offset:43776
    ds_read_b128 v[56:59], v137 offset:0
    ds_read_b128 v[60:63], v137 offset:14592
    ds_read_b128 v[64:67], v137 offset:29184
    ds_read_b128 v[68:71], v137 offset:43776
    buffer_load_dwordx4 v[24:27], v4, s[8:11], 0 offen offset:64
    buffer_load_dwordx4 v[28:31], v5, s[8:11], 0 offen offset:64
    buffer_load_dwordx4 v[32:35], v6, s[8:11], 0 offen offset:64
    buffer_load_dwordx4 v[36:39], v7, s[8:11], 0 offen offset:64
    ds_read_b128 v[72:75], v3 offset:64
    ds_read_b128 v[76:79], v3 offset:14656
    ds_read_b128 v[80:83], v3 offset:29248
    ds_read_b128 v[84:87], v3 offset:43840
    ds_read_b128 v[88:91], v137 offset:64
    ds_read_b128 v[92:95], v137 offset:14656
    ds_read_b128 v[96:99], v137 offset:29248
    ds_read_b128 v[100:103], v137 offset:43840
    s_waitcnt vmcnt(4) lgkmcnt(8)
    v_mfma_f32_16x16x32_bf16 a[0:3], v[8:11], v[40:43], a[0:3]
    v_mfma_f32_16x16x32_bf16 a[4:7], v[12:15], v[40:43], a[4:7]
    v_mfma_f32_16x16x32_bf16 a[8:11], v[16:19], v[40:43], a[8:11]
    v_mfma_f32_16x16x32_bf16 a[12:15], v[20:23], v[40:43], a[12:15]
    v_mfma_f32_16x16x32_bf16 a[16:19], v[8:11], v[44:47], a[16:19]
    v_mfma_f32_16x16x32_bf16 a[20:23], v[12:15], v[44:47], a[20:23]
    v_mfma_f32_16x16x32_bf16 a[24:27], v[16:19], v[44:47], a[24:27]
    v_mfma_f32_16x16x32_bf16 a[28:31], v[20:23], v[44:47], a[28:31]
    v_mfma_f32_16x16x32_bf16 a[32:35], v[8:11], v[48:51], a[32:35]
    v_mfma_f32_16x16x32_bf16 a[36:39], v[12:15], v[48:51], a[36:39]
    v_mfma_f32_16x16x32_bf16 a[40:43], v[16:19], v[48:51], a[40:43]
    v_mfma_f32_16x16x32_bf16 a[44:47], v[20:23], v[48:51], a[44:47]
    v_mfma_f32_16x16x32_bf16 a[48:51], v[8:11], v[52:55], a[48:51]
    v_mfma_f32_16x16x32_bf16 a[52:55], v[12:15], v[52:55], a[52:55]
    v_mfma_f32_16x16x32_bf16 a[56:59], v[16:19], v[52:55], a[56:59]
    v_mfma_f32_16x16x32_bf16 a[60:63], v[20:23], v[52:55], a[60:63]
    v_mfma_f32_16x16x32_bf16 a[64:67], v[8:11], v[56:59], a[64:67]
    v_mfma_f32_16x16x32_bf16 a[68:71], v[12:15], v[56:59], a[68:71]
    v_mfma_f32_16x16x32_bf16 a[72:75], v[16:19], v[56:59], a[72:75]
    v_mfma_f32_16x16x32_bf16 a[76:79], v[20:23], v[56:59], a[76:79]
    v_mfma_f32_16x16x32_bf16 a[80:83], v[8:11], v[60:63], a[80:83]
    v_mfma_f32_16x16x32_bf16 a[84:87], v[12:15], v[60:63], a[84:87]
    v_mfma_f32_16x16x32_bf16 a[88:91], v[16:19], v[60:63], a[88:91]
    v_mfma_f32_16x16x32_bf16 a[92:95], v[20:23], v[60:63], a[92:95]
    v_mfma_f32_16x16x32_bf16 a[96:99], v[8:11], v[64:67], a[96:99]
    v_mfma_f32_16x16x32_bf16 a[100:103], v[12:15], v[64:67], a[100:103]
    v_mfma_f32_16x16x32_bf16 a[104:107], v[16:19], v[64:67], a[104:107]
    v_mfma_f32_16x16x32_bf16 a[108:111], v[20:23], v[64:67], a[108:111]
    v_mfma_f32_16x16x32_bf16 a[112:115], v[8:11], v[68:71], a[112:115]
    v_mfma_f32_16x16x32_bf16 a[116:119], v[12:15], v[68:71], a[116:119]
    v_mfma_f32_16x16x32_bf16 a[120:123], v[16:19], v[68:71], a[120:123]
    v_mfma_f32_16x16x32_bf16 a[124:127], v[20:23], v[68:71], a[124:127]
    buffer_load_dwordx4 v[8:11], v4, s[8:11], 0 offen offset:128
    buffer_load_dwordx4 v[12:15], v5, s[8:11], 0 offen offset:128
    buffer_load_dwordx4 v[16:19], v6, s[8:11], 0 offen offset:128
    buffer_load_dwordx4 v[20:23], v7, s[8:11], 0 offen offset:128
    ds_read_b128 v[40:43], v3 offset:128
    ds_read_b128 v[44:47], v3 offset:14720
    ds_read_b128 v[48:51], v3 offset:29312
    ds_read_b128 v[52:55], v3 offset:43904
    ds_read_b128 v[56:59], v137 offset:128
    ds_read_b128 v[60:63], v137 offset:14720
    ds_read_b128 v[64:67], v137 offset:29312
    ds_read_b128 v[68:71], v137 offset:43904
    s_waitcnt vmcnt(4) lgkmcnt(8)
    v_mfma_f32_16x16x32_bf16 a[0:3], v[24:27], v[72:75], a[0:3]
    v_mfma_f32_16x16x32_bf16 a[4:7], v[28:31], v[72:75], a[4:7]
    v_mfma_f32_16x16x32_bf16 a[8:11], v[32:35], v[72:75], a[8:11]
    v_mfma_f32_16x16x32_bf16 a[12:15], v[36:39], v[72:75], a[12:15]
    v_mfma_f32_16x16x32_bf16 a[16:19], v[24:27], v[76:79], a[16:19]
    v_mfma_f32_16x16x32_bf16 a[20:23], v[28:31], v[76:79], a[20:23]
    v_mfma_f32_16x16x32_bf16 a[24:27], v[32:35], v[76:79], a[24:27]
    v_mfma_f32_16x16x32_bf16 a[28:31], v[36:39], v[76:79], a[28:31]
    v_mfma_f32_16x16x32_bf16 a[32:35], v[24:27], v[80:83], a[32:35]
    v_mfma_f32_16x16x32_bf16 a[36:39], v[28:31], v[80:83], a[36:39]
    v_mfma_f32_16x16x32_bf16 a[40:43], v[32:35], v[80:83], a[40:43]
    v_mfma_f32_16x16x32_bf16 a[44:47], v[36:39], v[80:83], a[44:47]
    v_mfma_f32_16x16x32_bf16 a[48:51], v[24:27], v[84:87], a[48:51]
    v_mfma_f32_16x16x32_bf16 a[52:55], v[28:31], v[84:87], a[52:55]
    v_mfma_f32_16x16x32_bf16 a[56:59], v[32:35], v[84:87], a[56:59]
    v_mfma_f32_16x16x32_bf16 a[60:63], v[36:39], v[84:87], a[60:63]
    v_mfma_f32_16x16x32_bf16 a[64:67], v[24:27], v[88:91], a[64:67]
    v_mfma_f32_16x16x32_bf16 a[68:71], v[28:31], v[88:91], a[68:71]
    v_mfma_f32_16x16x32_bf16 a[72:75], v[32:35], v[88:91], a[72:75]
    v_mfma_f32_16x16x32_bf16 a[76:79], v[36:39], v[88:91], a[76:79]
    v_mfma_f32_16x16x32_bf16 a[80:83], v[24:27], v[92:95], a[80:83]
    v_mfma_f32_16x16x32_bf16 a[84:87], v[28:31], v[92:95], a[84:87]
    v_mfma_f32_16x16x32_bf16 a[88:91], v[32:35], v[92:95], a[88:91]
    v_mfma_f32_16x16x32_bf16 a[92:95], v[36:39], v[92:95], a[92:95]
    v_mfma_f32_16x16x32_bf16 a[96:99], v[24:27], v[96:99], a[96:99]
    v_mfma_f32_16x16x32_bf16 a[100:103], v[28:31], v[96:99], a[100:103]
    v_mfma_f32_16x16x32_bf16 a[104:107], v[32:35], v[96:99], a[104:107]
    v_mfma_f32_16x16x32_bf16 a[108:111], v[36:39], v[96:99], a[108:111]
    v_mfma_f32_16x16x32_bf16 a[112:115], v[24:27], v[100:103], a[112:115]
    v_mfma_f32_16x16x32_bf16 a[116:119], v[28:31], v[100:103], a[116:119]
    v_mfma_f32_16x16x32_bf16 a[120:123], v[32:35], v[100:103], a[120:123]
    v_mfma_f32_16x16x32_bf16 a[124:127], v[36:39], v[100:103], a[124:127]
    buffer_load_dwordx4 v[24:27], v4, s[8:11], 0 offen offset:192
    buffer_load_dwordx4 v[28:31], v5, s[8:11], 0 offen offset:192
    buffer_load_dwordx4 v[32:35], v6, s[8:11], 0 offen offset:192
    buffer_load_dwordx4 v[36:39], v7, s[8:11], 0 offen offset:192
    ds_read_b128 v[72:75], v3 offset:192
    ds_read_b128 v[76:79], v3 offset:14784
    ds_read_b128 v[80:83], v3 offset:29376
    ds_read_b128 v[84:87], v3 offset:43968
    ds_read_b128 v[88:91], v137 offset:192
    ds_read_b128 v[92:95], v137 offset:14784
    ds_read_b128 v[96:99], v137 offset:29376
    ds_read_b128 v[100:103], v137 offset:43968
    s_waitcnt vmcnt(4) lgkmcnt(8)
    v_mfma_f32_16x16x32_bf16 a[0:3], v[8:11], v[40:43], a[0:3]
    v_mfma_f32_16x16x32_bf16 a[4:7], v[12:15], v[40:43], a[4:7]
    v_mfma_f32_16x16x32_bf16 a[8:11], v[16:19], v[40:43], a[8:11]
    v_mfma_f32_16x16x32_bf16 a[12:15], v[20:23], v[40:43], a[12:15]
    v_mfma_f32_16x16x32_bf16 a[16:19], v[8:11], v[44:47], a[16:19]
    v_mfma_f32_16x16x32_bf16 a[20:23], v[12:15], v[44:47], a[20:23]
    v_mfma_f32_16x16x32_bf16 a[24:27], v[16:19], v[44:47], a[24:27]
    v_mfma_f32_16x16x32_bf16 a[28:31], v[20:23], v[44:47], a[28:31]
    v_mfma_f32_16x16x32_bf16 a[32:35], v[8:11], v[48:51], a[32:35]
    v_mfma_f32_16x16x32_bf16 a[36:39], v[12:15], v[48:51], a[36:39]
    v_mfma_f32_16x16x32_bf16 a[40:43], v[16:19], v[48:51], a[40:43]
    v_mfma_f32_16x16x32_bf16 a[44:47], v[20:23], v[48:51], a[44:47]
    v_mfma_f32_16x16x32_bf16 a[48:51], v[8:11], v[52:55], a[48:51]
    v_mfma_f32_16x16x32_bf16 a[52:55], v[12:15], v[52:55], a[52:55]
    v_mfma_f32_16x16x32_bf16 a[56:59], v[16:19], v[52:55], a[56:59]
    v_mfma_f32_16x16x32_bf16 a[60:63], v[20:23], v[52:55], a[60:63]
    v_mfma_f32_16x16x32_bf16 a[64:67], v[8:11], v[56:59], a[64:67]
    v_mfma_f32_16x16x32_bf16 a[68:71], v[12:15], v[56:59], a[68:71]
    v_mfma_f32_16x16x32_bf16 a[72:75], v[16:19], v[56:59], a[72:75]
    v_mfma_f32_16x16x32_bf16 a[76:79], v[20:23], v[56:59], a[76:79]
    v_mfma_f32_16x16x32_bf16 a[80:83], v[8:11], v[60:63], a[80:83]
    v_mfma_f32_16x16x32_bf16 a[84:87], v[12:15], v[60:63], a[84:87]
    v_mfma_f32_16x16x32_bf16 a[88:91], v[16:19], v[60:63], a[88:91]
    v_mfma_f32_16x16x32_bf16 a[92:95], v[20:23], v[60:63], a[92:95]
    v_mfma_f32_16x16x32_bf16 a[96:99], v[8:11], v[64:67], a[96:99]
    v_mfma_f32_16x16x32_bf16 a[100:103], v[12:15], v[64:67], a[100:103]
    v_mfma_f32_16x16x32_bf16 a[104:107], v[16:19], v[64:67], a[104:107]
    v_mfma_f32_16x16x32_bf16 a[108:111], v[20:23], v[64:67], a[108:111]
    v_mfma_f32_16x16x32_bf16 a[112:115], v[8:11], v[68:71], a[112:115]
    v_mfma_f32_16x16x32_bf16 a[116:119], v[12:15], v[68:71], a[116:119]
    v_mfma_f32_16x16x32_bf16 a[120:123], v[16:19], v[68:71], a[120:123]
    v_mfma_f32_16x16x32_bf16 a[124:127], v[20:23], v[68:71], a[124:127]
    buffer_load_dwordx4 v[8:11], v4, s[8:11], 0 offen offset:256
    buffer_load_dwordx4 v[12:15], v5, s[8:11], 0 offen offset:256
    buffer_load_dwordx4 v[16:19], v6, s[8:11], 0 offen offset:256
    buffer_load_dwordx4 v[20:23], v7, s[8:11], 0 offen offset:256
    ds_read_b128 v[40:43], v3 offset:256
    ds_read_b128 v[44:47], v3 offset:14848
    ds_read_b128 v[48:51], v3 offset:29440
    ds_read_b128 v[52:55], v3 offset:44032
    ds_read_b128 v[56:59], v137 offset:256
    ds_read_b128 v[60:63], v137 offset:14848
    ds_read_b128 v[64:67], v137 offset:29440
    ds_read_b128 v[68:71], v137 offset:44032
    s_waitcnt vmcnt(4) lgkmcnt(8)
    v_mfma_f32_16x16x32_bf16 a[0:3], v[24:27], v[72:75], a[0:3]
    v_mfma_f32_16x16x32_bf16 a[4:7], v[28:31], v[72:75], a[4:7]
    v_mfma_f32_16x16x32_bf16 a[8:11], v[32:35], v[72:75], a[8:11]
    v_mfma_f32_16x16x32_bf16 a[12:15], v[36:39], v[72:75], a[12:15]
    v_mfma_f32_16x16x32_bf16 a[16:19], v[24:27], v[76:79], a[16:19]
    v_mfma_f32_16x16x32_bf16 a[20:23], v[28:31], v[76:79], a[20:23]
    v_mfma_f32_16x16x32_bf16 a[24:27], v[32:35], v[76:79], a[24:27]
    v_mfma_f32_16x16x32_bf16 a[28:31], v[36:39], v[76:79], a[28:31]
    v_mfma_f32_16x16x32_bf16 a[32:35], v[24:27], v[80:83], a[32:35]
    v_mfma_f32_16x16x32_bf16 a[36:39], v[28:31], v[80:83], a[36:39]
    v_mfma_f32_16x16x32_bf16 a[40:43], v[32:35], v[80:83], a[40:43]
    v_mfma_f32_16x16x32_bf16 a[44:47], v[36:39], v[80:83], a[44:47]
    v_mfma_f32_16x16x32_bf16 a[48:51], v[24:27], v[84:87], a[48:51]
    v_mfma_f32_16x16x32_bf16 a[52:55], v[28:31], v[84:87], a[52:55]
    v_mfma_f32_16x16x32_bf16 a[56:59], v[32:35], v[84:87], a[56:59]
    v_mfma_f32_16x16x32_bf16 a[60:63], v[36:39], v[84:87], a[60:63]
    v_mfma_f32_16x16x32_bf16 a[64:67], v[24:27], v[88:91], a[64:67]
    v_mfma_f32_16x16x32_bf16 a[68:71], v[28:31], v[88:91], a[68:71]
    v_mfma_f32_16x16x32_bf16 a[72:75], v[32:35], v[88:91], a[72:75]
    v_mfma_f32_16x16x32_bf16 a[76:79], v[36:39], v[88:91], a[76:79]
    v_mfma_f32_16x16x32_bf16 a[80:83], v[24:27], v[92:95], a[80:83]
    v_mfma_f32_16x16x32_bf16 a[84:87], v[28:31], v[92:95], a[84:87]
    v_mfma_f32_16x16x32_bf16 a[88:91], v[32:35], v[92:95], a[88:91]
    v_mfma_f32_16x16x32_bf16 a[92:95], v[36:39], v[92:95], a[92:95]
    v_mfma_f32_16x16x32_bf16 a[96:99], v[24:27], v[96:99], a[96:99]
    v_mfma_f32_16x16x32_bf16 a[100:103], v[28:31], v[96:99], a[100:103]
    v_mfma_f32_16x16x32_bf16 a[104:107], v[32:35], v[96:99], a[104:107]
    v_mfma_f32_16x16x32_bf16 a[108:111], v[36:39], v[96:99], a[108:111]
    v_mfma_f32_16x16x32_bf16 a[112:115], v[24:27], v[100:103], a[112:115]
    v_mfma_f32_16x16x32_bf16 a[116:119], v[28:31], v[100:103], a[116:119]
    v_mfma_f32_16x16x32_bf16 a[120:123], v[32:35], v[100:103], a[120:123]
    v_mfma_f32_16x16x32_bf16 a[124:127], v[36:39], v[100:103], a[124:127]
    buffer_load_dwordx4 v[24:27], v4, s[8:11], 0 offen offset:320
    buffer_load_dwordx4 v[28:31], v5, s[8:11], 0 offen offset:320
    buffer_load_dwordx4 v[32:35], v6, s[8:11], 0 offen offset:320
    buffer_load_dwordx4 v[36:39], v7, s[8:11], 0 offen offset:320
    ds_read_b128 v[72:75], v3 offset:320
    ds_read_b128 v[76:79], v3 offset:14912
    ds_read_b128 v[80:83], v3 offset:29504
    ds_read_b128 v[84:87], v3 offset:44096
    ds_read_b128 v[88:91], v137 offset:320
    ds_read_b128 v[92:95], v137 offset:14912
    ds_read_b128 v[96:99], v137 offset:29504
    ds_read_b128 v[100:103], v137 offset:44096
    s_waitcnt vmcnt(4) lgkmcnt(8)
    v_mfma_f32_16x16x32_bf16 a[0:3], v[8:11], v[40:43], a[0:3]
    v_mfma_f32_16x16x32_bf16 a[4:7], v[12:15], v[40:43], a[4:7]
    v_mfma_f32_16x16x32_bf16 a[8:11], v[16:19], v[40:43], a[8:11]
    v_mfma_f32_16x16x32_bf16 a[12:15], v[20:23], v[40:43], a[12:15]
    v_mfma_f32_16x16x32_bf16 a[16:19], v[8:11], v[44:47], a[16:19]
    v_mfma_f32_16x16x32_bf16 a[20:23], v[12:15], v[44:47], a[20:23]
    v_mfma_f32_16x16x32_bf16 a[24:27], v[16:19], v[44:47], a[24:27]
    v_mfma_f32_16x16x32_bf16 a[28:31], v[20:23], v[44:47], a[28:31]
    v_mfma_f32_16x16x32_bf16 a[32:35], v[8:11], v[48:51], a[32:35]
    v_mfma_f32_16x16x32_bf16 a[36:39], v[12:15], v[48:51], a[36:39]
    v_mfma_f32_16x16x32_bf16 a[40:43], v[16:19], v[48:51], a[40:43]
    v_mfma_f32_16x16x32_bf16 a[44:47], v[20:23], v[48:51], a[44:47]
    v_mfma_f32_16x16x32_bf16 a[48:51], v[8:11], v[52:55], a[48:51]
    v_mfma_f32_16x16x32_bf16 a[52:55], v[12:15], v[52:55], a[52:55]
    v_mfma_f32_16x16x32_bf16 a[56:59], v[16:19], v[52:55], a[56:59]
    v_mfma_f32_16x16x32_bf16 a[60:63], v[20:23], v[52:55], a[60:63]
    v_mfma_f32_16x16x32_bf16 a[64:67], v[8:11], v[56:59], a[64:67]
    v_mfma_f32_16x16x32_bf16 a[68:71], v[12:15], v[56:59], a[68:71]
    v_mfma_f32_16x16x32_bf16 a[72:75], v[16:19], v[56:59], a[72:75]
    v_mfma_f32_16x16x32_bf16 a[76:79], v[20:23], v[56:59], a[76:79]
    v_mfma_f32_16x16x32_bf16 a[80:83], v[8:11], v[60:63], a[80:83]
    v_mfma_f32_16x16x32_bf16 a[84:87], v[12:15], v[60:63], a[84:87]
    v_mfma_f32_16x16x32_bf16 a[88:91], v[16:19], v[60:63], a[88:91]
    v_mfma_f32_16x16x32_bf16 a[92:95], v[20:23], v[60:63], a[92:95]
    v_mfma_f32_16x16x32_bf16 a[96:99], v[8:11], v[64:67], a[96:99]
    v_mfma_f32_16x16x32_bf16 a[100:103], v[12:15], v[64:67], a[100:103]
    v_mfma_f32_16x16x32_bf16 a[104:107], v[16:19], v[64:67], a[104:107]
    v_mfma_f32_16x16x32_bf16 a[108:111], v[20:23], v[64:67], a[108:111]
    v_mfma_f32_16x16x32_bf16 a[112:115], v[8:11], v[68:71], a[112:115]
    v_mfma_f32_16x16x32_bf16 a[116:119], v[12:15], v[68:71], a[116:119]
    v_mfma_f32_16x16x32_bf16 a[120:123], v[16:19], v[68:71], a[120:123]
    v_mfma_f32_16x16x32_bf16 a[124:127], v[20:23], v[68:71], a[124:127]
    buffer_load_dwordx4 v[8:11], v4, s[8:11], 0 offen offset:384
    buffer_load_dwordx4 v[12:15], v5, s[8:11], 0 offen offset:384
    buffer_load_dwordx4 v[16:19], v6, s[8:11], 0 offen offset:384
    buffer_load_dwordx4 v[20:23], v7, s[8:11], 0 offen offset:384
    ds_read_b128 v[40:43], v3 offset:384
    ds_read_b128 v[44:47], v3 offset:14976
    ds_read_b128 v[48:51], v3 offset:29568
    ds_read_b128 v[52:55], v3 offset:44160
    ds_read_b128 v[56:59], v137 offset:384
    ds_read_b128 v[60:63], v137 offset:14976
    ds_read_b128 v[64:67], v137 offset:29568
    ds_read_b128 v[68:71], v137 offset:44160
    s_waitcnt vmcnt(4) lgkmcnt(8)
    v_mfma_f32_16x16x32_bf16 a[0:3], v[24:27], v[72:75], a[0:3]
    v_mfma_f32_16x16x32_bf16 a[4:7], v[28:31], v[72:75], a[4:7]
    v_mfma_f32_16x16x32_bf16 a[8:11], v[32:35], v[72:75], a[8:11]
    v_mfma_f32_16x16x32_bf16 a[12:15], v[36:39], v[72:75], a[12:15]
    v_mfma_f32_16x16x32_bf16 a[16:19], v[24:27], v[76:79], a[16:19]
    v_mfma_f32_16x16x32_bf16 a[20:23], v[28:31], v[76:79], a[20:23]
    v_mfma_f32_16x16x32_bf16 a[24:27], v[32:35], v[76:79], a[24:27]
    v_mfma_f32_16x16x32_bf16 a[28:31], v[36:39], v[76:79], a[28:31]
    v_mfma_f32_16x16x32_bf16 a[32:35], v[24:27], v[80:83], a[32:35]
    v_mfma_f32_16x16x32_bf16 a[36:39], v[28:31], v[80:83], a[36:39]
    v_mfma_f32_16x16x32_bf16 a[40:43], v[32:35], v[80:83], a[40:43]
    v_mfma_f32_16x16x32_bf16 a[44:47], v[36:39], v[80:83], a[44:47]
    v_mfma_f32_16x16x32_bf16 a[48:51], v[24:27], v[84:87], a[48:51]
    v_mfma_f32_16x16x32_bf16 a[52:55], v[28:31], v[84:87], a[52:55]
    v_mfma_f32_16x16x32_bf16 a[56:59], v[32:35], v[84:87], a[56:59]
    v_mfma_f32_16x16x32_bf16 a[60:63], v[36:39], v[84:87], a[60:63]
    v_mfma_f32_16x16x32_bf16 a[64:67], v[24:27], v[88:91], a[64:67]
    v_mfma_f32_16x16x32_bf16 a[68:71], v[28:31], v[88:91], a[68:71]
    v_mfma_f32_16x16x32_bf16 a[72:75], v[32:35], v[88:91], a[72:75]
    v_mfma_f32_16x16x32_bf16 a[76:79], v[36:39], v[88:91], a[76:79]
    v_mfma_f32_16x16x32_bf16 a[80:83], v[24:27], v[92:95], a[80:83]
    v_mfma_f32_16x16x32_bf16 a[84:87], v[28:31], v[92:95], a[84:87]
    v_mfma_f32_16x16x32_bf16 a[88:91], v[32:35], v[92:95], a[88:91]
    v_mfma_f32_16x16x32_bf16 a[92:95], v[36:39], v[92:95], a[92:95]
    v_mfma_f32_16x16x32_bf16 a[96:99], v[24:27], v[96:99], a[96:99]
    v_mfma_f32_16x16x32_bf16 a[100:103], v[28:31], v[96:99], a[100:103]
    v_mfma_f32_16x16x32_bf16 a[104:107], v[32:35], v[96:99], a[104:107]
    v_mfma_f32_16x16x32_bf16 a[108:111], v[36:39], v[96:99], a[108:111]
    v_mfma_f32_16x16x32_bf16 a[112:115], v[24:27], v[100:103], a[112:115]
    v_mfma_f32_16x16x32_bf16 a[116:119], v[28:31], v[100:103], a[116:119]
    v_mfma_f32_16x16x32_bf16 a[120:123], v[32:35], v[100:103], a[120:123]
    v_mfma_f32_16x16x32_bf16 a[124:127], v[36:39], v[100:103], a[124:127]
    buffer_load_dwordx4 v[24:27], v4, s[8:11], 0 offen offset:448
    buffer_load_dwordx4 v[28:31], v5, s[8:11], 0 offen offset:448
    buffer_load_dwordx4 v[32:35], v6, s[8:11], 0 offen offset:448
    buffer_load_dwordx4 v[36:39], v7, s[8:11], 0 offen offset:448
    ds_read_b128 v[72:75], v3 offset:448
    ds_read_b128 v[76:79], v3 offset:15040
    ds_read_b128 v[80:83], v3 offset:29632
    ds_read_b128 v[84:87], v3 offset:44224
    ds_read_b128 v[88:91], v137 offset:448
    ds_read_b128 v[92:95], v137 offset:15040
    ds_read_b128 v[96:99], v137 offset:29632
    ds_read_b128 v[100:103], v137 offset:44224
    s_waitcnt vmcnt(4) lgkmcnt(8)
    v_mfma_f32_16x16x32_bf16 a[0:3], v[8:11], v[40:43], a[0:3]
    v_mfma_f32_16x16x32_bf16 a[4:7], v[12:15], v[40:43], a[4:7]
    v_mfma_f32_16x16x32_bf16 a[8:11], v[16:19], v[40:43], a[8:11]
    v_mfma_f32_16x16x32_bf16 a[12:15], v[20:23], v[40:43], a[12:15]
    v_mfma_f32_16x16x32_bf16 a[16:19], v[8:11], v[44:47], a[16:19]
    v_mfma_f32_16x16x32_bf16 a[20:23], v[12:15], v[44:47], a[20:23]
    v_mfma_f32_16x16x32_bf16 a[24:27], v[16:19], v[44:47], a[24:27]
    v_mfma_f32_16x16x32_bf16 a[28:31], v[20:23], v[44:47], a[28:31]
    v_mfma_f32_16x16x32_bf16 a[32:35], v[8:11], v[48:51], a[32:35]
    v_mfma_f32_16x16x32_bf16 a[36:39], v[12:15], v[48:51], a[36:39]
    v_mfma_f32_16x16x32_bf16 a[40:43], v[16:19], v[48:51], a[40:43]
    v_mfma_f32_16x16x32_bf16 a[44:47], v[20:23], v[48:51], a[44:47]
    v_mfma_f32_16x16x32_bf16 a[48:51], v[8:11], v[52:55], a[48:51]
    v_mfma_f32_16x16x32_bf16 a[52:55], v[12:15], v[52:55], a[52:55]
    v_mfma_f32_16x16x32_bf16 a[56:59], v[16:19], v[52:55], a[56:59]
    v_mfma_f32_16x16x32_bf16 a[60:63], v[20:23], v[52:55], a[60:63]
    v_mfma_f32_16x16x32_bf16 a[64:67], v[8:11], v[56:59], a[64:67]
    v_mfma_f32_16x16x32_bf16 a[68:71], v[12:15], v[56:59], a[68:71]
    v_mfma_f32_16x16x32_bf16 a[72:75], v[16:19], v[56:59], a[72:75]
    v_mfma_f32_16x16x32_bf16 a[76:79], v[20:23], v[56:59], a[76:79]
    v_mfma_f32_16x16x32_bf16 a[80:83], v[8:11], v[60:63], a[80:83]
    v_mfma_f32_16x16x32_bf16 a[84:87], v[12:15], v[60:63], a[84:87]
    v_mfma_f32_16x16x32_bf16 a[88:91], v[16:19], v[60:63], a[88:91]
    v_mfma_f32_16x16x32_bf16 a[92:95], v[20:23], v[60:63], a[92:95]
    v_mfma_f32_16x16x32_bf16 a[96:99], v[8:11], v[64:67], a[96:99]
    v_mfma_f32_16x16x32_bf16 a[100:103], v[12:15], v[64:67], a[100:103]
    v_mfma_f32_16x16x32_bf16 a[104:107], v[16:19], v[64:67], a[104:107]
    v_mfma_f32_16x16x32_bf16 a[108:111], v[20:23], v[64:67], a[108:111]
    v_mfma_f32_16x16x32_bf16 a[112:115], v[8:11], v[68:71], a[112:115]
    v_mfma_f32_16x16x32_bf16 a[116:119], v[12:15], v[68:71], a[116:119]
    v_mfma_f32_16x16x32_bf16 a[120:123], v[16:19], v[68:71], a[120:123]
    v_mfma_f32_16x16x32_bf16 a[124:127], v[20:23], v[68:71], a[124:127]
    buffer_load_dwordx4 v[8:11], v4, s[8:11], 0 offen offset:512
    buffer_load_dwordx4 v[12:15], v5, s[8:11], 0 offen offset:512
    buffer_load_dwordx4 v[16:19], v6, s[8:11], 0 offen offset:512
    buffer_load_dwordx4 v[20:23], v7, s[8:11], 0 offen offset:512
    ds_read_b128 v[40:43], v3 offset:512
    ds_read_b128 v[44:47], v3 offset:15104
    ds_read_b128 v[48:51], v3 offset:29696
    ds_read_b128 v[52:55], v3 offset:44288
    ds_read_b128 v[56:59], v137 offset:512
    ds_read_b128 v[60:63], v137 offset:15104
    ds_read_b128 v[64:67], v137 offset:29696
    ds_read_b128 v[68:71], v137 offset:44288
    s_waitcnt vmcnt(4) lgkmcnt(8)
    v_mfma_f32_16x16x32_bf16 a[0:3], v[24:27], v[72:75], a[0:3]
    v_mfma_f32_16x16x32_bf16 a[4:7], v[28:31], v[72:75], a[4:7]
    v_mfma_f32_16x16x32_bf16 a[8:11], v[32:35], v[72:75], a[8:11]
    v_mfma_f32_16x16x32_bf16 a[12:15], v[36:39], v[72:75], a[12:15]
    v_mfma_f32_16x16x32_bf16 a[16:19], v[24:27], v[76:79], a[16:19]
    v_mfma_f32_16x16x32_bf16 a[20:23], v[28:31], v[76:79], a[20:23]
    v_mfma_f32_16x16x32_bf16 a[24:27], v[32:35], v[76:79], a[24:27]
    v_mfma_f32_16x16x32_bf16 a[28:31], v[36:39], v[76:79], a[28:31]
    v_mfma_f32_16x16x32_bf16 a[32:35], v[24:27], v[80:83], a[32:35]
    v_mfma_f32_16x16x32_bf16 a[36:39], v[28:31], v[80:83], a[36:39]
    v_mfma_f32_16x16x32_bf16 a[40:43], v[32:35], v[80:83], a[40:43]
    v_mfma_f32_16x16x32_bf16 a[44:47], v[36:39], v[80:83], a[44:47]
    v_mfma_f32_16x16x32_bf16 a[48:51], v[24:27], v[84:87], a[48:51]
    v_mfma_f32_16x16x32_bf16 a[52:55], v[28:31], v[84:87], a[52:55]
    v_mfma_f32_16x16x32_bf16 a[56:59], v[32:35], v[84:87], a[56:59]
    v_mfma_f32_16x16x32_bf16 a[60:63], v[36:39], v[84:87], a[60:63]
    v_mfma_f32_16x16x32_bf16 a[64:67], v[24:27], v[88:91], a[64:67]
    v_mfma_f32_16x16x32_bf16 a[68:71], v[28:31], v[88:91], a[68:71]
    v_mfma_f32_16x16x32_bf16 a[72:75], v[32:35], v[88:91], a[72:75]
    v_mfma_f32_16x16x32_bf16 a[76:79], v[36:39], v[88:91], a[76:79]
    v_mfma_f32_16x16x32_bf16 a[80:83], v[24:27], v[92:95], a[80:83]
    v_mfma_f32_16x16x32_bf16 a[84:87], v[28:31], v[92:95], a[84:87]
    v_mfma_f32_16x16x32_bf16 a[88:91], v[32:35], v[92:95], a[88:91]
    v_mfma_f32_16x16x32_bf16 a[92:95], v[36:39], v[92:95], a[92:95]
    v_mfma_f32_16x16x32_bf16 a[96:99], v[24:27], v[96:99], a[96:99]
    v_mfma_f32_16x16x32_bf16 a[100:103], v[28:31], v[96:99], a[100:103]
    v_mfma_f32_16x16x32_bf16 a[104:107], v[32:35], v[96:99], a[104:107]
    v_mfma_f32_16x16x32_bf16 a[108:111], v[36:39], v[96:99], a[108:111]
    v_mfma_f32_16x16x32_bf16 a[112:115], v[24:27], v[100:103], a[112:115]
    v_mfma_f32_16x16x32_bf16 a[116:119], v[28:31], v[100:103], a[116:119]
    v_mfma_f32_16x16x32_bf16 a[120:123], v[32:35], v[100:103], a[120:123]
    v_mfma_f32_16x16x32_bf16 a[124:127], v[36:39], v[100:103], a[124:127]
    buffer_load_dwordx4 v[24:27], v4, s[8:11], 0 offen offset:576
    buffer_load_dwordx4 v[28:31], v5, s[8:11], 0 offen offset:576
    buffer_load_dwordx4 v[32:35], v6, s[8:11], 0 offen offset:576
    buffer_load_dwordx4 v[36:39], v7, s[8:11], 0 offen offset:576
    ds_read_b128 v[72:75], v3 offset:576
    ds_read_b128 v[76:79], v3 offset:15168
    ds_read_b128 v[80:83], v3 offset:29760
    ds_read_b128 v[84:87], v3 offset:44352
    ds_read_b128 v[88:91], v137 offset:576
    ds_read_b128 v[92:95], v137 offset:15168
    ds_read_b128 v[96:99], v137 offset:29760
    ds_read_b128 v[100:103], v137 offset:44352
    s_waitcnt vmcnt(4) lgkmcnt(8)
    v_mfma_f32_16x16x32_bf16 a[0:3], v[8:11], v[40:43], a[0:3]
    v_mfma_f32_16x16x32_bf16 a[4:7], v[12:15], v[40:43], a[4:7]
    v_mfma_f32_16x16x32_bf16 a[8:11], v[16:19], v[40:43], a[8:11]
    v_mfma_f32_16x16x32_bf16 a[12:15], v[20:23], v[40:43], a[12:15]
    v_mfma_f32_16x16x32_bf16 a[16:19], v[8:11], v[44:47], a[16:19]
    v_mfma_f32_16x16x32_bf16 a[20:23], v[12:15], v[44:47], a[20:23]
    v_mfma_f32_16x16x32_bf16 a[24:27], v[16:19], v[44:47], a[24:27]
    v_mfma_f32_16x16x32_bf16 a[28:31], v[20:23], v[44:47], a[28:31]
    v_mfma_f32_16x16x32_bf16 a[32:35], v[8:11], v[48:51], a[32:35]
    v_mfma_f32_16x16x32_bf16 a[36:39], v[12:15], v[48:51], a[36:39]
    v_mfma_f32_16x16x32_bf16 a[40:43], v[16:19], v[48:51], a[40:43]
    v_mfma_f32_16x16x32_bf16 a[44:47], v[20:23], v[48:51], a[44:47]
    v_mfma_f32_16x16x32_bf16 a[48:51], v[8:11], v[52:55], a[48:51]
    v_mfma_f32_16x16x32_bf16 a[52:55], v[12:15], v[52:55], a[52:55]
    v_mfma_f32_16x16x32_bf16 a[56:59], v[16:19], v[52:55], a[56:59]
    v_mfma_f32_16x16x32_bf16 a[60:63], v[20:23], v[52:55], a[60:63]
    v_mfma_f32_16x16x32_bf16 a[64:67], v[8:11], v[56:59], a[64:67]
    v_mfma_f32_16x16x32_bf16 a[68:71], v[12:15], v[56:59], a[68:71]
    v_mfma_f32_16x16x32_bf16 a[72:75], v[16:19], v[56:59], a[72:75]
    v_mfma_f32_16x16x32_bf16 a[76:79], v[20:23], v[56:59], a[76:79]
    v_mfma_f32_16x16x32_bf16 a[80:83], v[8:11], v[60:63], a[80:83]
    v_mfma_f32_16x16x32_bf16 a[84:87], v[12:15], v[60:63], a[84:87]
    v_mfma_f32_16x16x32_bf16 a[88:91], v[16:19], v[60:63], a[88:91]
    v_mfma_f32_16x16x32_bf16 a[92:95], v[20:23], v[60:63], a[92:95]
    v_mfma_f32_16x16x32_bf16 a[96:99], v[8:11], v[64:67], a[96:99]
    v_mfma_f32_16x16x32_bf16 a[100:103], v[12:15], v[64:67], a[100:103]
    v_mfma_f32_16x16x32_bf16 a[104:107], v[16:19], v[64:67], a[104:107]
    v_mfma_f32_16x16x32_bf16 a[108:111], v[20:23], v[64:67], a[108:111]
    v_mfma_f32_16x16x32_bf16 a[112:115], v[8:11], v[68:71], a[112:115]
    v_mfma_f32_16x16x32_bf16 a[116:119], v[12:15], v[68:71], a[116:119]
    v_mfma_f32_16x16x32_bf16 a[120:123], v[16:19], v[68:71], a[120:123]
    v_mfma_f32_16x16x32_bf16 a[124:127], v[20:23], v[68:71], a[124:127]
    buffer_load_dwordx4 v[8:11], v4, s[8:11], 0 offen offset:640
    buffer_load_dwordx4 v[12:15], v5, s[8:11], 0 offen offset:640
    buffer_load_dwordx4 v[16:19], v6, s[8:11], 0 offen offset:640
    buffer_load_dwordx4 v[20:23], v7, s[8:11], 0 offen offset:640
    ds_read_b128 v[40:43], v3 offset:640
    ds_read_b128 v[44:47], v3 offset:15232
    ds_read_b128 v[48:51], v3 offset:29824
    ds_read_b128 v[52:55], v3 offset:44416
    ds_read_b128 v[56:59], v137 offset:640
    ds_read_b128 v[60:63], v137 offset:15232
    ds_read_b128 v[64:67], v137 offset:29824
    ds_read_b128 v[68:71], v137 offset:44416
    s_waitcnt vmcnt(4) lgkmcnt(8)
    v_mfma_f32_16x16x32_bf16 a[0:3], v[24:27], v[72:75], a[0:3]
    v_mfma_f32_16x16x32_bf16 a[4:7], v[28:31], v[72:75], a[4:7]
    v_mfma_f32_16x16x32_bf16 a[8:11], v[32:35], v[72:75], a[8:11]
    v_mfma_f32_16x16x32_bf16 a[12:15], v[36:39], v[72:75], a[12:15]
    v_mfma_f32_16x16x32_bf16 a[16:19], v[24:27], v[76:79], a[16:19]
    v_mfma_f32_16x16x32_bf16 a[20:23], v[28:31], v[76:79], a[20:23]
    v_mfma_f32_16x16x32_bf16 a[24:27], v[32:35], v[76:79], a[24:27]
    v_mfma_f32_16x16x32_bf16 a[28:31], v[36:39], v[76:79], a[28:31]
    v_mfma_f32_16x16x32_bf16 a[32:35], v[24:27], v[80:83], a[32:35]
    v_mfma_f32_16x16x32_bf16 a[36:39], v[28:31], v[80:83], a[36:39]
    v_mfma_f32_16x16x32_bf16 a[40:43], v[32:35], v[80:83], a[40:43]
    v_mfma_f32_16x16x32_bf16 a[44:47], v[36:39], v[80:83], a[44:47]
    v_mfma_f32_16x16x32_bf16 a[48:51], v[24:27], v[84:87], a[48:51]
    v_mfma_f32_16x16x32_bf16 a[52:55], v[28:31], v[84:87], a[52:55]
    v_mfma_f32_16x16x32_bf16 a[56:59], v[32:35], v[84:87], a[56:59]
    v_mfma_f32_16x16x32_bf16 a[60:63], v[36:39], v[84:87], a[60:63]
    v_mfma_f32_16x16x32_bf16 a[64:67], v[24:27], v[88:91], a[64:67]
    v_mfma_f32_16x16x32_bf16 a[68:71], v[28:31], v[88:91], a[68:71]
    v_mfma_f32_16x16x32_bf16 a[72:75], v[32:35], v[88:91], a[72:75]
    v_mfma_f32_16x16x32_bf16 a[76:79], v[36:39], v[88:91], a[76:79]
    v_mfma_f32_16x16x32_bf16 a[80:83], v[24:27], v[92:95], a[80:83]
    v_mfma_f32_16x16x32_bf16 a[84:87], v[28:31], v[92:95], a[84:87]
    v_mfma_f32_16x16x32_bf16 a[88:91], v[32:35], v[92:95], a[88:91]
    v_mfma_f32_16x16x32_bf16 a[92:95], v[36:39], v[92:95], a[92:95]
    v_mfma_f32_16x16x32_bf16 a[96:99], v[24:27], v[96:99], a[96:99]
    v_mfma_f32_16x16x32_bf16 a[100:103], v[28:31], v[96:99], a[100:103]
    v_mfma_f32_16x16x32_bf16 a[104:107], v[32:35], v[96:99], a[104:107]
    v_mfma_f32_16x16x32_bf16 a[108:111], v[36:39], v[96:99], a[108:111]
    v_mfma_f32_16x16x32_bf16 a[112:115], v[24:27], v[100:103], a[112:115]
    v_mfma_f32_16x16x32_bf16 a[116:119], v[28:31], v[100:103], a[116:119]
    v_mfma_f32_16x16x32_bf16 a[120:123], v[32:35], v[100:103], a[120:123]
    v_mfma_f32_16x16x32_bf16 a[124:127], v[36:39], v[100:103], a[124:127]
    buffer_load_dwordx4 v[24:27], v4, s[8:11], 0 offen offset:704
    buffer_load_dwordx4 v[28:31], v5, s[8:11], 0 offen offset:704
    buffer_load_dwordx4 v[32:35], v6, s[8:11], 0 offen offset:704
    buffer_load_dwordx4 v[36:39], v7, s[8:11], 0 offen offset:704
    ds_read_b128 v[72:75], v3 offset:704
    ds_read_b128 v[76:79], v3 offset:15296
    ds_read_b128 v[80:83], v3 offset:29888
    ds_read_b128 v[84:87], v3 offset:44480
    ds_read_b128 v[88:91], v137 offset:704
    ds_read_b128 v[92:95], v137 offset:15296
    ds_read_b128 v[96:99], v137 offset:29888
    ds_read_b128 v[100:103], v137 offset:44480
    s_waitcnt vmcnt(4) lgkmcnt(8)
    v_mfma_f32_16x16x32_bf16 a[0:3], v[8:11], v[40:43], a[0:3]
    v_mfma_f32_16x16x32_bf16 a[4:7], v[12:15], v[40:43], a[4:7]
    v_mfma_f32_16x16x32_bf16 a[8:11], v[16:19], v[40:43], a[8:11]
    v_mfma_f32_16x16x32_bf16 a[12:15], v[20:23], v[40:43], a[12:15]
    v_mfma_f32_16x16x32_bf16 a[16:19], v[8:11], v[44:47], a[16:19]
    v_mfma_f32_16x16x32_bf16 a[20:23], v[12:15], v[44:47], a[20:23]
    v_mfma_f32_16x16x32_bf16 a[24:27], v[16:19], v[44:47], a[24:27]
    v_mfma_f32_16x16x32_bf16 a[28:31], v[20:23], v[44:47], a[28:31]
    v_mfma_f32_16x16x32_bf16 a[32:35], v[8:11], v[48:51], a[32:35]
    v_mfma_f32_16x16x32_bf16 a[36:39], v[12:15], v[48:51], a[36:39]
    v_mfma_f32_16x16x32_bf16 a[40:43], v[16:19], v[48:51], a[40:43]
    v_mfma_f32_16x16x32_bf16 a[44:47], v[20:23], v[48:51], a[44:47]
    v_mfma_f32_16x16x32_bf16 a[48:51], v[8:11], v[52:55], a[48:51]
    v_mfma_f32_16x16x32_bf16 a[52:55], v[12:15], v[52:55], a[52:55]
    v_mfma_f32_16x16x32_bf16 a[56:59], v[16:19], v[52:55], a[56:59]
    v_mfma_f32_16x16x32_bf16 a[60:63], v[20:23], v[52:55], a[60:63]
    v_mfma_f32_16x16x32_bf16 a[64:67], v[8:11], v[56:59], a[64:67]
    v_mfma_f32_16x16x32_bf16 a[68:71], v[12:15], v[56:59], a[68:71]
    v_mfma_f32_16x16x32_bf16 a[72:75], v[16:19], v[56:59], a[72:75]
    v_mfma_f32_16x16x32_bf16 a[76:79], v[20:23], v[56:59], a[76:79]
    v_mfma_f32_16x16x32_bf16 a[80:83], v[8:11], v[60:63], a[80:83]
    v_mfma_f32_16x16x32_bf16 a[84:87], v[12:15], v[60:63], a[84:87]
    v_mfma_f32_16x16x32_bf16 a[88:91], v[16:19], v[60:63], a[88:91]
    v_mfma_f32_16x16x32_bf16 a[92:95], v[20:23], v[60:63], a[92:95]
    v_mfma_f32_16x16x32_bf16 a[96:99], v[8:11], v[64:67], a[96:99]
    v_mfma_f32_16x16x32_bf16 a[100:103], v[12:15], v[64:67], a[100:103]
    v_mfma_f32_16x16x32_bf16 a[104:107], v[16:19], v[64:67], a[104:107]
    v_mfma_f32_16x16x32_bf16 a[108:111], v[20:23], v[64:67], a[108:111]
    v_mfma_f32_16x16x32_bf16 a[112:115], v[8:11], v[68:71], a[112:115]
    v_mfma_f32_16x16x32_bf16 a[116:119], v[12:15], v[68:71], a[116:119]
    v_mfma_f32_16x16x32_bf16 a[120:123], v[16:19], v[68:71], a[120:123]
    v_mfma_f32_16x16x32_bf16 a[124:127], v[20:23], v[68:71], a[124:127]
    buffer_load_dwordx4 v[8:11], v4, s[8:11], 0 offen offset:768
    buffer_load_dwordx4 v[12:15], v5, s[8:11], 0 offen offset:768
    buffer_load_dwordx4 v[16:19], v6, s[8:11], 0 offen offset:768
    buffer_load_dwordx4 v[20:23], v7, s[8:11], 0 offen offset:768
    ds_read_b128 v[40:43], v3 offset:768
    ds_read_b128 v[44:47], v3 offset:15360
    ds_read_b128 v[48:51], v3 offset:29952
    ds_read_b128 v[52:55], v3 offset:44544
    ds_read_b128 v[56:59], v137 offset:768
    ds_read_b128 v[60:63], v137 offset:15360
    ds_read_b128 v[64:67], v137 offset:29952
    ds_read_b128 v[68:71], v137 offset:44544
    s_waitcnt vmcnt(4) lgkmcnt(8)
    v_mfma_f32_16x16x32_bf16 a[0:3], v[24:27], v[72:75], a[0:3]
    v_mfma_f32_16x16x32_bf16 a[4:7], v[28:31], v[72:75], a[4:7]
    v_mfma_f32_16x16x32_bf16 a[8:11], v[32:35], v[72:75], a[8:11]
    v_mfma_f32_16x16x32_bf16 a[12:15], v[36:39], v[72:75], a[12:15]
    v_mfma_f32_16x16x32_bf16 a[16:19], v[24:27], v[76:79], a[16:19]
    v_mfma_f32_16x16x32_bf16 a[20:23], v[28:31], v[76:79], a[20:23]
    v_mfma_f32_16x16x32_bf16 a[24:27], v[32:35], v[76:79], a[24:27]
    v_mfma_f32_16x16x32_bf16 a[28:31], v[36:39], v[76:79], a[28:31]
    v_mfma_f32_16x16x32_bf16 a[32:35], v[24:27], v[80:83], a[32:35]
    v_mfma_f32_16x16x32_bf16 a[36:39], v[28:31], v[80:83], a[36:39]
    v_mfma_f32_16x16x32_bf16 a[40:43], v[32:35], v[80:83], a[40:43]
    v_mfma_f32_16x16x32_bf16 a[44:47], v[36:39], v[80:83], a[44:47]
    v_mfma_f32_16x16x32_bf16 a[48:51], v[24:27], v[84:87], a[48:51]
    v_mfma_f32_16x16x32_bf16 a[52:55], v[28:31], v[84:87], a[52:55]
    v_mfma_f32_16x16x32_bf16 a[56:59], v[32:35], v[84:87], a[56:59]
    v_mfma_f32_16x16x32_bf16 a[60:63], v[36:39], v[84:87], a[60:63]
    v_mfma_f32_16x16x32_bf16 a[64:67], v[24:27], v[88:91], a[64:67]
    v_mfma_f32_16x16x32_bf16 a[68:71], v[28:31], v[88:91], a[68:71]
    v_mfma_f32_16x16x32_bf16 a[72:75], v[32:35], v[88:91], a[72:75]
    v_mfma_f32_16x16x32_bf16 a[76:79], v[36:39], v[88:91], a[76:79]
    v_mfma_f32_16x16x32_bf16 a[80:83], v[24:27], v[92:95], a[80:83]
    v_mfma_f32_16x16x32_bf16 a[84:87], v[28:31], v[92:95], a[84:87]
    v_mfma_f32_16x16x32_bf16 a[88:91], v[32:35], v[92:95], a[88:91]
    v_mfma_f32_16x16x32_bf16 a[92:95], v[36:39], v[92:95], a[92:95]
    v_mfma_f32_16x16x32_bf16 a[96:99], v[24:27], v[96:99], a[96:99]
    v_mfma_f32_16x16x32_bf16 a[100:103], v[28:31], v[96:99], a[100:103]
    v_mfma_f32_16x16x32_bf16 a[104:107], v[32:35], v[96:99], a[104:107]
    v_mfma_f32_16x16x32_bf16 a[108:111], v[36:39], v[96:99], a[108:111]
    v_mfma_f32_16x16x32_bf16 a[112:115], v[24:27], v[100:103], a[112:115]
    v_mfma_f32_16x16x32_bf16 a[116:119], v[28:31], v[100:103], a[116:119]
    v_mfma_f32_16x16x32_bf16 a[120:123], v[32:35], v[100:103], a[120:123]
    v_mfma_f32_16x16x32_bf16 a[124:127], v[36:39], v[100:103], a[124:127]
    buffer_load_dwordx4 v[24:27], v4, s[8:11], 0 offen offset:832
    buffer_load_dwordx4 v[28:31], v5, s[8:11], 0 offen offset:832
    buffer_load_dwordx4 v[32:35], v6, s[8:11], 0 offen offset:832
    buffer_load_dwordx4 v[36:39], v7, s[8:11], 0 offen offset:832
    ds_read_b128 v[72:75], v3 offset:832
    ds_read_b128 v[76:79], v3 offset:15424
    ds_read_b128 v[80:83], v3 offset:30016
    ds_read_b128 v[84:87], v3 offset:44608
    ds_read_b128 v[88:91], v137 offset:832
    ds_read_b128 v[92:95], v137 offset:15424
    ds_read_b128 v[96:99], v137 offset:30016
    ds_read_b128 v[100:103], v137 offset:44608
    s_waitcnt vmcnt(4) lgkmcnt(8)
    v_mfma_f32_16x16x32_bf16 a[0:3], v[8:11], v[40:43], a[0:3]
    v_mfma_f32_16x16x32_bf16 a[4:7], v[12:15], v[40:43], a[4:7]
    v_mfma_f32_16x16x32_bf16 a[8:11], v[16:19], v[40:43], a[8:11]
    v_mfma_f32_16x16x32_bf16 a[12:15], v[20:23], v[40:43], a[12:15]
    v_mfma_f32_16x16x32_bf16 a[16:19], v[8:11], v[44:47], a[16:19]
    v_mfma_f32_16x16x32_bf16 a[20:23], v[12:15], v[44:47], a[20:23]
    v_mfma_f32_16x16x32_bf16 a[24:27], v[16:19], v[44:47], a[24:27]
    v_mfma_f32_16x16x32_bf16 a[28:31], v[20:23], v[44:47], a[28:31]
    v_mfma_f32_16x16x32_bf16 a[32:35], v[8:11], v[48:51], a[32:35]
    v_mfma_f32_16x16x32_bf16 a[36:39], v[12:15], v[48:51], a[36:39]
    v_mfma_f32_16x16x32_bf16 a[40:43], v[16:19], v[48:51], a[40:43]
    v_mfma_f32_16x16x32_bf16 a[44:47], v[20:23], v[48:51], a[44:47]
    v_mfma_f32_16x16x32_bf16 a[48:51], v[8:11], v[52:55], a[48:51]
    v_mfma_f32_16x16x32_bf16 a[52:55], v[12:15], v[52:55], a[52:55]
    v_mfma_f32_16x16x32_bf16 a[56:59], v[16:19], v[52:55], a[56:59]
    v_mfma_f32_16x16x32_bf16 a[60:63], v[20:23], v[52:55], a[60:63]
    v_mfma_f32_16x16x32_bf16 a[64:67], v[8:11], v[56:59], a[64:67]
    v_mfma_f32_16x16x32_bf16 a[68:71], v[12:15], v[56:59], a[68:71]
    v_mfma_f32_16x16x32_bf16 a[72:75], v[16:19], v[56:59], a[72:75]
    v_mfma_f32_16x16x32_bf16 a[76:79], v[20:23], v[56:59], a[76:79]
    v_mfma_f32_16x16x32_bf16 a[80:83], v[8:11], v[60:63], a[80:83]
    v_mfma_f32_16x16x32_bf16 a[84:87], v[12:15], v[60:63], a[84:87]
    v_mfma_f32_16x16x32_bf16 a[88:91], v[16:19], v[60:63], a[88:91]
    v_mfma_f32_16x16x32_bf16 a[92:95], v[20:23], v[60:63], a[92:95]
    v_mfma_f32_16x16x32_bf16 a[96:99], v[8:11], v[64:67], a[96:99]
    v_mfma_f32_16x16x32_bf16 a[100:103], v[12:15], v[64:67], a[100:103]
    v_mfma_f32_16x16x32_bf16 a[104:107], v[16:19], v[64:67], a[104:107]
    v_mfma_f32_16x16x32_bf16 a[108:111], v[20:23], v[64:67], a[108:111]
    v_mfma_f32_16x16x32_bf16 a[112:115], v[8:11], v[68:71], a[112:115]
    v_mfma_f32_16x16x32_bf16 a[116:119], v[12:15], v[68:71], a[116:119]
    v_mfma_f32_16x16x32_bf16 a[120:123], v[16:19], v[68:71], a[120:123]
    v_mfma_f32_16x16x32_bf16 a[124:127], v[20:23], v[68:71], a[124:127]
    s_waitcnt vmcnt(0) lgkmcnt(0)
    v_mfma_f32_16x16x32_bf16 a[0:3], v[24:27], v[72:75], a[0:3]
    v_mfma_f32_16x16x32_bf16 a[4:7], v[28:31], v[72:75], a[4:7]
    v_mfma_f32_16x16x32_bf16 a[8:11], v[32:35], v[72:75], a[8:11]
    v_mfma_f32_16x16x32_bf16 a[12:15], v[36:39], v[72:75], a[12:15]
    v_mfma_f32_16x16x32_bf16 a[16:19], v[24:27], v[76:79], a[16:19]
    v_mfma_f32_16x16x32_bf16 a[20:23], v[28:31], v[76:79], a[20:23]
    v_mfma_f32_16x16x32_bf16 a[24:27], v[32:35], v[76:79], a[24:27]
    v_mfma_f32_16x16x32_bf16 a[28:31], v[36:39], v[76:79], a[28:31]
    v_mfma_f32_16x16x32_bf16 a[32:35], v[24:27], v[80:83], a[32:35]
    v_mfma_f32_16x16x32_bf16 a[36:39], v[28:31], v[80:83], a[36:39]
    v_mfma_f32_16x16x32_bf16 a[40:43], v[32:35], v[80:83], a[40:43]
    v_mfma_f32_16x16x32_bf16 a[44:47], v[36:39], v[80:83], a[44:47]
    v_mfma_f32_16x16x32_bf16 a[48:51], v[24:27], v[84:87], a[48:51]
    v_mfma_f32_16x16x32_bf16 a[52:55], v[28:31], v[84:87], a[52:55]
    v_mfma_f32_16x16x32_bf16 a[56:59], v[32:35], v[84:87], a[56:59]
    v_mfma_f32_16x16x32_bf16 a[60:63], v[36:39], v[84:87], a[60:63]
    v_mfma_f32_16x16x32_bf16 a[64:67], v[24:27], v[88:91], a[64:67]
    v_mfma_f32_16x16x32_bf16 a[68:71], v[28:31], v[88:91], a[68:71]
    v_mfma_f32_16x16x32_bf16 a[72:75], v[32:35], v[88:91], a[72:75]
    v_mfma_f32_16x16x32_bf16 a[76:79], v[36:39], v[88:91], a[76:79]
    v_mfma_f32_16x16x32_bf16 a[80:83], v[24:27], v[92:95], a[80:83]
    v_mfma_f32_16x16x32_bf16 a[84:87], v[28:31], v[92:95], a[84:87]
    v_mfma_f32_16x16x32_bf16 a[88:91], v[32:35], v[92:95], a[88:91]
    v_mfma_f32_16x16x32_bf16 a[92:95], v[36:39], v[92:95], a[92:95]
    v_mfma_f32_16x16x32_bf16 a[96:99], v[24:27], v[96:99], a[96:99]
    v_mfma_f32_16x16x32_bf16 a[100:103], v[28:31], v[96:99], a[100:103]
    v_mfma_f32_16x16x32_bf16 a[104:107], v[32:35], v[96:99], a[104:107]
    v_mfma_f32_16x16x32_bf16 a[108:111], v[36:39], v[96:99], a[108:111]
    v_mfma_f32_16x16x32_bf16 a[112:115], v[24:27], v[100:103], a[112:115]
    v_mfma_f32_16x16x32_bf16 a[116:119], v[28:31], v[100:103], a[116:119]
    v_mfma_f32_16x16x32_bf16 a[120:123], v[32:35], v[100:103], a[120:123]
    v_mfma_f32_16x16x32_bf16 a[124:127], v[36:39], v[100:103], a[124:127]
    s_nop 7
    s_nop 7
    s_lshl_b32 s17, s5, 7
    v_add_u32 v104, s17, v1
    s_cmp_ge_u32 s7, 56
    s_cbranch_scc1 K3_epG
    v_mul_u32_u24 v104, 14336, v104
    v_lshl_add_u32 v104, v2, 3, v104
    s_lshl_b32 s17, s16, 1
    s_add_u32 s17, s17, 23068672
    v_add_u32 v104, s17, v104
    v_accvgpr_read_b32 v106, a0
    v_accvgpr_read_b32 v107, a1
    v_accvgpr_read_b32 v108, a2
    v_accvgpr_read_b32 v109, a3
    v_cvt_pk_bf16_f32 v110, v106, v107
    v_cvt_pk_bf16_f32 v111, v108, v109
    buffer_store_dwordx2 v[110:111], v104, s[8:11], 0 offen offset:0 sc1
    s_nop 1
    v_accvgpr_read_b32 v106, a4
    v_accvgpr_read_b32 v107, a5
    v_accvgpr_read_b32 v108, a6
    v_accvgpr_read_b32 v109, a7
    v_cvt_pk_bf16_f32 v110, v106, v107
    v_cvt_pk_bf16_f32 v111, v108, v109
    buffer_store_dwordx2 v[110:111], v104, s[8:11], 0 offen offset:32 sc1
    s_nop 1
    v_accvgpr_read_b32 v106, a8
    v_accvgpr_read_b32 v107, a9
    v_accvgpr_read_b32 v108, a10
    v_accvgpr_read_b32 v109, a11
    v_cvt_pk_bf16_f32 v110, v106, v107
    v_cvt_pk_bf16_f32 v111, v108, v109
    buffer_store_dwordx2 v[110:111], v104, s[8:11], 0 offen offset:64 sc1
    s_nop 1
    v_accvgpr_read_b32 v106, a12
    v_accvgpr_read_b32 v107, a13
    v_accvgpr_read_b32 v108, a14
    v_accvgpr_read_b32 v109, a15
    v_cvt_pk_bf16_f32 v110, v106, v107
    v_cvt_pk_bf16_f32 v111, v108, v109
    buffer_store_dwordx2 v[110:111], v104, s[8:11], 0 offen offset:96 sc1
    s_nop 1
    v_add_u32 v104, 229376, v104
    v_accvgpr_read_b32 v106, a16
    v_accvgpr_read_b32 v107, a17
    v_accvgpr_read_b32 v108, a18
    v_accvgpr_read_b32 v109, a19
    v_cvt_pk_bf16_f32 v110, v106, v107
    v_cvt_pk_bf16_f32 v111, v108, v109
    buffer_store_dwordx2 v[110:111], v104, s[8:11], 0 offen offset:0 sc1
    s_nop 1
    v_accvgpr_read_b32 v106, a20
    v_accvgpr_read_b32 v107, a21
    v_accvgpr_read_b32 v108, a22
    v_accvgpr_read_b32 v109, a23
    v_cvt_pk_bf16_f32 v110, v106, v107
    v_cvt_pk_bf16_f32 v111, v108, v109
    buffer_store_dwordx2 v[110:111], v104, s[8:11], 0 offen offset:32 sc1
    s_nop 1
    v_accvgpr_read_b32 v106, a24
    v_accvgpr_read_b32 v107, a25
    v_accvgpr_read_b32 v108, a26
    v_accvgpr_read_b32 v109, a27
    v_cvt_pk_bf16_f32 v110, v106, v107
    v_cvt_pk_bf16_f32 v111, v108, v109
    buffer_store_dwordx2 v[110:111], v104, s[8:11], 0 offen offset:64 sc1
    s_nop 1
    v_accvgpr_read_b32 v106, a28
    v_accvgpr_read_b32 v107, a29
    v_accvgpr_read_b32 v108, a30
    v_accvgpr_read_b32 v109, a31
    v_cvt_pk_bf16_f32 v110, v106, v107
    v_cvt_pk_bf16_f32 v111, v108, v109
    buffer_store_dwordx2 v[110:111], v104, s[8:11], 0 offen offset:96 sc1
    s_nop 1
    v_add_u32 v104, 229376, v104
    v_accvgpr_read_b32 v106, a32
    v_accvgpr_read_b32 v107, a33
    v_accvgpr_read_b32 v108, a34
    v_accvgpr_read_b32 v109, a35
    v_cvt_pk_bf16_f32 v110, v106, v107
    v_cvt_pk_bf16_f32 v111, v108, v109
    buffer_store_dwordx2 v[110:111], v104, s[8:11], 0 offen offset:0 sc1
    s_nop 1
    v_accvgpr_read_b32 v106, a36
    v_accvgpr_read_b32 v107, a37
    v_accvgpr_read_b32 v108, a38
    v_accvgpr_read_b32 v109, a39
    v_cvt_pk_bf16_f32 v110, v106, v107
    v_cvt_pk_bf16_f32 v111, v108, v109
    buffer_store_dwordx2 v[110:111], v104, s[8:11], 0 offen offset:32 sc1
    s_nop 1
    v_accvgpr_read_b32 v106, a40
    v_accvgpr_read_b32 v107, a41
    v_accvgpr_read_b32 v108, a42
    v_accvgpr_read_b32 v109, a43
    v_cvt_pk_bf16_f32 v110, v106, v107
    v_cvt_pk_bf16_f32 v111, v108, v109
    buffer_store_dwordx2 v[110:111], v104, s[8:11], 0 offen offset:64 sc1
    s_nop 1
    v_accvgpr_read_b32 v106, a44
    v_accvgpr_read_b32 v107, a45
    v_accvgpr_read_b32 v108, a46
    v_accvgpr_read_b32 v109, a47
    v_cvt_pk_bf16_f32 v110, v106, v107
    v_cvt_pk_bf16_f32 v111, v108, v109
    buffer_store_dwordx2 v[110:111], v104, s[8:11], 0 offen offset:96 sc1
    s_nop 1
    v_add_u32 v104, 229376, v104
    v_accvgpr_read_b32 v106, a48
    v_accvgpr_read_b32 v107, a49
    v_accvgpr_read_b32 v108, a50
    v_accvgpr_read_b32 v109, a51
    v_cvt_pk_bf16_f32 v110, v106, v107
    v_cvt_pk_bf16_f32 v111, v108, v109
    buffer_store_dwordx2 v[110:111], v104, s[8:11], 0 offen offset:0 sc1
    s_nop 1
    v_accvgpr_read_b32 v106, a52
    v_accvgpr_read_b32 v107, a53
    v_accvgpr_read_b32 v108, a54
    v_accvgpr_read_b32 v109, a55
    v_cvt_pk_bf16_f32 v110, v106, v107
    v_cvt_pk_bf16_f32 v111, v108, v109
    buffer_store_dwordx2 v[110:111], v104, s[8:11], 0 offen offset:32 sc1
    s_nop 1
    v_accvgpr_read_b32 v106, a56
    v_accvgpr_read_b32 v107, a57
    v_accvgpr_read_b32 v108, a58
    v_accvgpr_read_b32 v109, a59
    v_cvt_pk_bf16_f32 v110, v106, v107
    v_cvt_pk_bf16_f32 v111, v108, v109
    buffer_store_dwordx2 v[110:111], v104, s[8:11], 0 offen offset:64 sc1
    s_nop 1
    v_accvgpr_read_b32 v106, a60
    v_accvgpr_read_b32 v107, a61
    v_accvgpr_read_b32 v108, a62
    v_accvgpr_read_b32 v109, a63
    v_cvt_pk_bf16_f32 v110, v106, v107
    v_cvt_pk_bf16_f32 v111, v108, v109
    buffer_store_dwordx2 v[110:111], v104, s[8:11], 0 offen offset:96 sc1
    s_nop 1
    v_add_u32 v104, 229376, v104
    v_accvgpr_read_b32 v106, a64
    v_accvgpr_read_b32 v107, a65
    v_accvgpr_read_b32 v108, a66
    v_accvgpr_read_b32 v109, a67
    v_cvt_pk_bf16_f32 v110, v106, v107
    v_cvt_pk_bf16_f32 v111, v108, v109
    buffer_store_dwordx2 v[110:111], v104, s[8:11], 0 offen offset:0 sc1
    s_nop 1
    v_accvgpr_read_b32 v106, a68
    v_accvgpr_read_b32 v107, a69
    v_accvgpr_read_b32 v108, a70
    v_accvgpr_read_b32 v109, a71
    v_cvt_pk_bf16_f32 v110, v106, v107
    v_cvt_pk_bf16_f32 v111, v108, v109
    buffer_store_dwordx2 v[110:111], v104, s[8:11], 0 offen offset:32 sc1
    s_nop 1
    v_accvgpr_read_b32 v106, a72
    v_accvgpr_read_b32 v107, a73
    v_accvgpr_read_b32 v108, a74
    v_accvgpr_read_b32 v109, a75
    v_cvt_pk_bf16_f32 v110, v106, v107
    v_cvt_pk_bf16_f32 v111, v108, v109
    buffer_store_dwordx2 v[110:111], v104, s[8:11], 0 offen offset:64 sc1
    s_nop 1
    v_accvgpr_read_b32 v106, a76
    v_accvgpr_read_b32 v107, a77
    v_accvgpr_read_b32 v108, a78
    v_accvgpr_read_b32 v109, a79
    v_cvt_pk_bf16_f32 v110, v106, v107
    v_cvt_pk_bf16_f32 v111, v108, v109
    buffer_store_dwordx2 v[110:111], v104, s[8:11], 0 offen offset:96 sc1
    s_nop 1
    v_add_u32 v104, 229376, v104
    v_accvgpr_read_b32 v106, a80
    v_accvgpr_read_b32 v107, a81
    v_accvgpr_read_b32 v108, a82
    v_accvgpr_read_b32 v109, a83
    v_cvt_pk_bf16_f32 v110, v106, v107
    v_cvt_pk_bf16_f32 v111, v108, v109
    buffer_store_dwordx2 v[110:111], v104, s[8:11], 0 offen offset:0 sc1
    s_nop 1
    v_accvgpr_read_b32 v106, a84
    v_accvgpr_read_b32 v107, a85
    v_accvgpr_read_b32 v108, a86
    v_accvgpr_read_b32 v109, a87
    v_cvt_pk_bf16_f32 v110, v106, v107
    v_cvt_pk_bf16_f32 v111, v108, v109
    buffer_store_dwordx2 v[110:111], v104, s[8:11], 0 offen offset:32 sc1
    s_nop 1
    v_accvgpr_read_b32 v106, a88
    v_accvgpr_read_b32 v107, a89
    v_accvgpr_read_b32 v108, a90
    v_accvgpr_read_b32 v109, a91
    v_cvt_pk_bf16_f32 v110, v106, v107
    v_cvt_pk_bf16_f32 v111, v108, v109
    buffer_store_dwordx2 v[110:111], v104, s[8:11], 0 offen offset:64 sc1
    s_nop 1
    v_accvgpr_read_b32 v106, a92
    v_accvgpr_read_b32 v107, a93
    v_accvgpr_read_b32 v108, a94
    v_accvgpr_read_b32 v109, a95
    v_cvt_pk_bf16_f32 v110, v106, v107
    v_cvt_pk_bf16_f32 v111, v108, v109
    buffer_store_dwordx2 v[110:111], v104, s[8:11], 0 offen offset:96 sc1
    s_nop 1
    v_add_u32 v104, 229376, v104
    v_accvgpr_read_b32 v106, a96
    v_accvgpr_read_b32 v107, a97
    v_accvgpr_read_b32 v108, a98
    v_accvgpr_read_b32 v109, a99
    v_cvt_pk_bf16_f32 v110, v106, v107
    v_cvt_pk_bf16_f32 v111, v108, v109
    buffer_store_dwordx2 v[110:111], v104, s[8:11], 0 offen offset:0 sc1
    s_nop 1
    v_accvgpr_read_b32 v106, a100
    v_accvgpr_read_b32 v107, a101
    v_accvgpr_read_b32 v108, a102
    v_accvgpr_read_b32 v109, a103
    v_cvt_pk_bf16_f32 v110, v106, v107
    v_cvt_pk_bf16_f32 v111, v108, v109
    buffer_store_dwordx2 v[110:111], v104, s[8:11], 0 offen offset:32 sc1
    s_nop 1
    v_accvgpr_read_b32 v106, a104
    v_accvgpr_read_b32 v107, a105
    v_accvgpr_read_b32 v108, a106
    v_accvgpr_read_b32 v109, a107
    v_cvt_pk_bf16_f32 v110, v106, v107
    v_cvt_pk_bf16_f32 v111, v108, v109
    buffer_store_dwordx2 v[110:111], v104, s[8:11], 0 offen offset:64 sc1
    s_nop 1
    v_accvgpr_read_b32 v106, a108
    v_accvgpr_read_b32 v107, a109
    v_accvgpr_read_b32 v108, a110
    v_accvgpr_read_b32 v109, a111
    v_cvt_pk_bf16_f32 v110, v106, v107
    v_cvt_pk_bf16_f32 v111, v108, v109
    buffer_store_dwordx2 v[110:111], v104, s[8:11], 0 offen offset:96 sc1
    s_nop 1
    v_add_u32 v104, 229376, v104
    v_accvgpr_read_b32 v106, a112
    v_accvgpr_read_b32 v107, a113
    v_accvgpr_read_b32 v108, a114
    v_accvgpr_read_b32 v109, a115
    v_cvt_pk_bf16_f32 v110, v106, v107
    v_cvt_pk_bf16_f32 v111, v108, v109
    buffer_store_dwordx2 v[110:111], v104, s[8:11], 0 offen offset:0 sc1
    s_nop 1
    v_accvgpr_read_b32 v106, a116
    v_accvgpr_read_b32 v107, a117
    v_accvgpr_read_b32 v108, a118
    v_accvgpr_read_b32 v109, a119
    v_cvt_pk_bf16_f32 v110, v106, v107
    v_cvt_pk_bf16_f32 v111, v108, v109
    buffer_store_dwordx2 v[110:111], v104, s[8:11], 0 offen offset:32 sc1
    s_nop 1
    v_accvgpr_read_b32 v106, a120
    v_accvgpr_read_b32 v107, a121
    v_accvgpr_read_b32 v108, a122
    v_accvgpr_read_b32 v109, a123
    v_cvt_pk_bf16_f32 v110, v106, v107
    v_cvt_pk_bf16_f32 v111, v108, v109
    buffer_store_dwordx2 v[110:111], v104, s[8:11], 0 offen offset:64 sc1
    s_nop 1
    v_accvgpr_read_b32 v106, a124
    v_accvgpr_read_b32 v107, a125
    v_accvgpr_read_b32 v108, a126
    v_accvgpr_read_b32 v109, a127
    v_cvt_pk_bf16_f32 v110, v106, v107
    v_cvt_pk_bf16_f32 v111, v108, v109
    buffer_store_dwordx2 v[110:111], v104, s[8:11], 0 offen offset:96 sc1
    s_nop 1
    v_add_u32 v104, 229376, v104
    s_branch K3_next
K3_epG:
    s_sub_u32 s16, s16, 14336
    v_mul_u32_u24 v104, 3584, v104
    v_lshl_add_u32 v104, v2, 3, v104
    s_lshl_b32 s17, s16, 1
    s_add_u32 s18, s17, 81788928
    v_add_u32 v104, s18, v104
    v_lshlrev_b32 v105, 3, v2
    buffer_load_dwordx2 v[112:113], v105, s[12:15], s17 offen offset:0
    buffer_load_dwordx2 v[114:115], v105, s[12:15], s17 offen offset:32
    buffer_load_dwordx2 v[116:117], v105, s[12:15], s17 offen offset:64
    buffer_load_dwordx2 v[118:119], v105, s[12:15], s17 offen offset:96
    s_waitcnt vmcnt(0)
    v_lshlrev_b32 v120, 16, v112
    v_and_b32 v121, 0xffff0000, v112
    v_lshlrev_b32 v122, 16, v113
    v_and_b32 v123, 0xffff0000, v113
    v_lshlrev_b32 v124, 16, v114
    v_and_b32 v125, 0xffff0000, v114
    v_lshlrev_b32 v126, 16, v115
    v_and_b32 v127, 0xffff0000, v115
    v_lshlrev_b32 v128, 16, v116
    v_and_b32 v129, 0xffff0000, v116
    v_lshlrev_b32 v130, 16, v117
    v_and_b32 v131, 0xffff0000, v117
    v_lshlrev_b32 v132, 16, v118
    v_and_b32 v133, 0xffff0000, v118
    v_lshlrev_b32 v134, 16, v119
    v_and_b32 v135, 0xffff0000, v119
    v_accvgpr_read_b32 v106, a0
    v_cvt_pk_bf16_f32 v106, v106, v106
    v_lshlrev_b32 v106, 16, v106
    v_add_f32 v106, v106, v120
    v_cvt_pk_bf16_f32 v106, v106, v106
    v_lshlrev_b32 v106, 16, v106
    v_mul_f32 v136, v106, v106
    v_mul_f32 v136, 0x3d372713, v136
    v_add_f32 v136, 1.0, v136
    v_mul_f32 v136, v136, v106
    v_mul_f32 v136, 0xc0135761, v136
    v_exp_f32 v136, v136
    s_nop 0
    v_add_f32 v136, 1.0, v136
    v_rcp_f32 v136, v136
    s_nop 0
    v_mul_f32 v106, v106, v136
    v_accvgpr_read_b32 v107, a1
    v_cvt_pk_bf16_f32 v107, v107, v107
    v_lshlrev_b32 v107, 16, v107
    v_add_f32 v107, v107, v121
    v_cvt_pk_bf16_f32 v107, v107, v107
    v_lshlrev_b32 v107, 16, v107
    v_mul_f32 v136, v107, v107
    v_mul_f32 v136, 0x3d372713, v136
    v_add_f32 v136, 1.0, v136
    v_mul_f32 v136, v136, v107
    v_mul_f32 v136, 0xc0135761, v136
    v_exp_f32 v136, v136
    s_nop 0
    v_add_f32 v136, 1.0, v136
    v_rcp_f32 v136, v136
    s_nop 0
    v_mul_f32 v107, v107, v136
    v_accvgpr_read_b32 v108, a2
    v_cvt_pk_bf16_f32 v108, v108, v108
    v_lshlrev_b32 v108, 16, v108
    v_add_f32 v108, v108, v122
    v_cvt_pk_bf16_f32 v108, v108, v108
    v_lshlrev_b32 v108, 16, v108
    v_mul_f32 v136, v108, v108
    v_mul_f32 v136, 0x3d372713, v136
    v_add_f32 v136, 1.0, v136
    v_mul_f32 v136, v136, v108
    v_mul_f32 v136, 0xc0135761, v136
    v_exp_f32 v136, v136
    s_nop 0
    v_add_f32 v136, 1.0, v136
    v_rcp_f32 v136, v136
    s_nop 0
    v_mul_f32 v108, v108, v136
    v_accvgpr_read_b32 v109, a3
    v_cvt_pk_bf16_f32 v109, v109, v109
    v_lshlrev_b32 v109, 16, v109
    v_add_f32 v109, v109, v123
    v_cvt_pk_bf16_f32 v109, v109, v109
    v_lshlrev_b32 v109, 16, v109
    v_mul_f32 v136, v109, v109
    v_mul_f32 v136, 0x3d372713, v136
    v_add_f32 v136, 1.0, v136
    v_mul_f32 v136, v136, v109
    v_mul_f32 v136, 0xc0135761, v136
    v_exp_f32 v136, v136
    s_nop 0
    v_add_f32 v136, 1.0, v136
    v_rcp_f32 v136, v136
    s_nop 0
    v_mul_f32 v109, v109, v136
    v_cvt_pk_bf16_f32 v110, v106, v107
    v_cvt_pk_bf16_f32 v111, v108, v109
    buffer_store_dwordx2 v[110:111], v104, s[8:11], 0 offen offset:0 sc1
    s_nop 1
    v_accvgpr_read_b32 v106, a4
    v_cvt_pk_bf16_f32 v106, v106, v106
    v_lshlrev_b32 v106, 16, v106
    v_add_f32 v106, v106, v124
    v_cvt_pk_bf16_f32 v106, v106, v106
    v_lshlrev_b32 v106, 16, v106
    v_mul_f32 v136, v106, v106
    v_mul_f32 v136, 0x3d372713, v136
    v_add_f32 v136, 1.0, v136
    v_mul_f32 v136, v136, v106
    v_mul_f32 v136, 0xc0135761, v136
    v_exp_f32 v136, v136
    s_nop 0
    v_add_f32 v136, 1.0, v136
    v_rcp_f32 v136, v136
    s_nop 0
    v_mul_f32 v106, v106, v136
    v_accvgpr_read_b32 v107, a5
    v_cvt_pk_bf16_f32 v107, v107, v107
    v_lshlrev_b32 v107, 16, v107
    v_add_f32 v107, v107, v125
    v_cvt_pk_bf16_f32 v107, v107, v107
    v_lshlrev_b32 v107, 16, v107
    v_mul_f32 v136, v107, v107
    v_mul_f32 v136, 0x3d372713, v136
    v_add_f32 v136, 1.0, v136
    v_mul_f32 v136, v136, v107
    v_mul_f32 v136, 0xc0135761, v136
    v_exp_f32 v136, v136
    s_nop 0
    v_add_f32 v136, 1.0, v136
    v_rcp_f32 v136, v136
    s_nop 0
    v_mul_f32 v107, v107, v136
    v_accvgpr_read_b32 v108, a6
    v_cvt_pk_bf16_f32 v108, v108, v108
    v_lshlrev_b32 v108, 16, v108
    v_add_f32 v108, v108, v126
    v_cvt_pk_bf16_f32 v108, v108, v108
    v_lshlrev_b32 v108, 16, v108
    v_mul_f32 v136, v108, v108
    v_mul_f32 v136, 0x3d372713, v136
    v_add_f32 v136, 1.0, v136
    v_mul_f32 v136, v136, v108
    v_mul_f32 v136, 0xc0135761, v136
    v_exp_f32 v136, v136
    s_nop 0
    v_add_f32 v136, 1.0, v136
    v_rcp_f32 v136, v136
    s_nop 0
    v_mul_f32 v108, v108, v136
    v_accvgpr_read_b32 v109, a7
    v_cvt_pk_bf16_f32 v109, v109, v109
    v_lshlrev_b32 v109, 16, v109
    v_add_f32 v109, v109, v127
    v_cvt_pk_bf16_f32 v109, v109, v109
    v_lshlrev_b32 v109, 16, v109
    v_mul_f32 v136, v109, v109
    v_mul_f32 v136, 0x3d372713, v136
    v_add_f32 v136, 1.0, v136
    v_mul_f32 v136, v136, v109
    v_mul_f32 v136, 0xc0135761, v136
    v_exp_f32 v136, v136
    s_nop 0
    v_add_f32 v136, 1.0, v136
    v_rcp_f32 v136, v136
    s_nop 0
    v_mul_f32 v109, v109, v136
    v_cvt_pk_bf16_f32 v110, v106, v107
    v_cvt_pk_bf16_f32 v111, v108, v109
    buffer_store_dwordx2 v[110:111], v104, s[8:11], 0 offen offset:32 sc1
    s_nop 1
    v_accvgpr_read_b32 v106, a8
    v_cvt_pk_bf16_f32 v106, v106, v106
    v_lshlrev_b32 v106, 16, v106
    v_add_f32 v106, v106, v128
    v_cvt_pk_bf16_f32 v106, v106, v106
    v_lshlrev_b32 v106, 16, v106
    v_mul_f32 v136, v106, v106
    v_mul_f32 v136, 0x3d372713, v136
    v_add_f32 v136, 1.0, v136
    v_mul_f32 v136, v136, v106
    v_mul_f32 v136, 0xc0135761, v136
    v_exp_f32 v136, v136
    s_nop 0
    v_add_f32 v136, 1.0, v136
    v_rcp_f32 v136, v136
    s_nop 0
    v_mul_f32 v106, v106, v136
    v_accvgpr_read_b32 v107, a9
    v_cvt_pk_bf16_f32 v107, v107, v107
    v_lshlrev_b32 v107, 16, v107
    v_add_f32 v107, v107, v129
    v_cvt_pk_bf16_f32 v107, v107, v107
    v_lshlrev_b32 v107, 16, v107
    v_mul_f32 v136, v107, v107
    v_mul_f32 v136, 0x3d372713, v136
    v_add_f32 v136, 1.0, v136
    v_mul_f32 v136, v136, v107
    v_mul_f32 v136, 0xc0135761, v136
    v_exp_f32 v136, v136
    s_nop 0
    v_add_f32 v136, 1.0, v136
    v_rcp_f32 v136, v136
    s_nop 0
    v_mul_f32 v107, v107, v136
    v_accvgpr_read_b32 v108, a10
    v_cvt_pk_bf16_f32 v108, v108, v108
    v_lshlrev_b32 v108, 16, v108
    v_add_f32 v108, v108, v130
    v_cvt_pk_bf16_f32 v108, v108, v108
    v_lshlrev_b32 v108, 16, v108
    v_mul_f32 v136, v108, v108
    v_mul_f32 v136, 0x3d372713, v136
    v_add_f32 v136, 1.0, v136
    v_mul_f32 v136, v136, v108
    v_mul_f32 v136, 0xc0135761, v136
    v_exp_f32 v136, v136
    s_nop 0
    v_add_f32 v136, 1.0, v136
    v_rcp_f32 v136, v136
    s_nop 0
    v_mul_f32 v108, v108, v136
    v_accvgpr_read_b32 v109, a11
    v_cvt_pk_bf16_f32 v109, v109, v109
    v_lshlrev_b32 v109, 16, v109
    v_add_f32 v109, v109, v131
    v_cvt_pk_bf16_f32 v109, v109, v109
    v_lshlrev_b32 v109, 16, v109
    v_mul_f32 v136, v109, v109
    v_mul_f32 v136, 0x3d372713, v136
    v_add_f32 v136, 1.0, v136
    v_mul_f32 v136, v136, v109
    v_mul_f32 v136, 0xc0135761, v136
    v_exp_f32 v136, v136
    s_nop 0
    v_add_f32 v136, 1.0, v136
    v_rcp_f32 v136, v136
    s_nop 0
    v_mul_f32 v109, v109, v136
    v_cvt_pk_bf16_f32 v110, v106, v107
    v_cvt_pk_bf16_f32 v111, v108, v109
    buffer_store_dwordx2 v[110:111], v104, s[8:11], 0 offen offset:64 sc1
    s_nop 1
    v_accvgpr_read_b32 v106, a12
    v_cvt_pk_bf16_f32 v106, v106, v106
    v_lshlrev_b32 v106, 16, v106
    v_add_f32 v106, v106, v132
    v_cvt_pk_bf16_f32 v106, v106, v106
    v_lshlrev_b32 v106, 16, v106
    v_mul_f32 v136, v106, v106
    v_mul_f32 v136, 0x3d372713, v136
    v_add_f32 v136, 1.0, v136
    v_mul_f32 v136, v136, v106
    v_mul_f32 v136, 0xc0135761, v136
    v_exp_f32 v136, v136
    s_nop 0
    v_add_f32 v136, 1.0, v136
    v_rcp_f32 v136, v136
    s_nop 0
    v_mul_f32 v106, v106, v136
    v_accvgpr_read_b32 v107, a13
    v_cvt_pk_bf16_f32 v107, v107, v107
    v_lshlrev_b32 v107, 16, v107
    v_add_f32 v107, v107, v133
    v_cvt_pk_bf16_f32 v107, v107, v107
    v_lshlrev_b32 v107, 16, v107
    v_mul_f32 v136, v107, v107
    v_mul_f32 v136, 0x3d372713, v136
    v_add_f32 v136, 1.0, v136
    v_mul_f32 v136, v136, v107
    v_mul_f32 v136, 0xc0135761, v136
    v_exp_f32 v136, v136
    s_nop 0
    v_add_f32 v136, 1.0, v136
    v_rcp_f32 v136, v136
    s_nop 0
    v_mul_f32 v107, v107, v136
    v_accvgpr_read_b32 v108, a14
    v_cvt_pk_bf16_f32 v108, v108, v108
    v_lshlrev_b32 v108, 16, v108
    v_add_f32 v108, v108, v134
    v_cvt_pk_bf16_f32 v108, v108, v108
    v_lshlrev_b32 v108, 16, v108
    v_mul_f32 v136, v108, v108
    v_mul_f32 v136, 0x3d372713, v136
    v_add_f32 v136, 1.0, v136
    v_mul_f32 v136, v136, v108
    v_mul_f32 v136, 0xc0135761, v136
    v_exp_f32 v136, v136
    s_nop 0
    v_add_f32 v136, 1.0, v136
    v_rcp_f32 v136, v136
    s_nop 0
    v_mul_f32 v108, v108, v136
    v_accvgpr_read_b32 v109, a15
    v_cvt_pk_bf16_f32 v109, v109, v109
    v_lshlrev_b32 v109, 16, v109
    v_add_f32 v109, v109, v135
    v_cvt_pk_bf16_f32 v109, v109, v109
    v_lshlrev_b32 v109, 16, v109
    v_mul_f32 v136, v109, v109
    v_mul_f32 v136, 0x3d372713, v136
    v_add_f32 v136, 1.0, v136
    v_mul_f32 v136, v136, v109
    v_mul_f32 v136, 0xc0135761, v136
    v_exp_f32 v136, v136
    s_nop 0
    v_add_f32 v136, 1.0, v136
    v_rcp_f32 v136, v136
    s_nop 0
    v_mul_f32 v109, v109, v136
    v_cvt_pk_bf16_f32 v110, v106, v107
    v_cvt_pk_bf16_f32 v111, v108, v109
    buffer_store_dwordx2 v[110:111], v104, s[8:11], 0 offen offset:96 sc1
    s_nop 1
    v_add_u32 v104, 57344, v104
    v_accvgpr_read_b32 v106, a16
    v_cvt_pk_bf16_f32 v106, v106, v106
    v_lshlrev_b32 v106, 16, v106
    v_add_f32 v106, v106, v120
    v_cvt_pk_bf16_f32 v106, v106, v106
    v_lshlrev_b32 v106, 16, v106
    v_mul_f32 v136, v106, v106
    v_mul_f32 v136, 0x3d372713, v136
    v_add_f32 v136, 1.0, v136
    v_mul_f32 v136, v136, v106
    v_mul_f32 v136, 0xc0135761, v136
    v_exp_f32 v136, v136
    s_nop 0
    v_add_f32 v136, 1.0, v136
    v_rcp_f32 v136, v136
    s_nop 0
    v_mul_f32 v106, v106, v136
    v_accvgpr_read_b32 v107, a17
    v_cvt_pk_bf16_f32 v107, v107, v107
    v_lshlrev_b32 v107, 16, v107
    v_add_f32 v107, v107, v121
    v_cvt_pk_bf16_f32 v107, v107, v107
    v_lshlrev_b32 v107, 16, v107
    v_mul_f32 v136, v107, v107
    v_mul_f32 v136, 0x3d372713, v136
    v_add_f32 v136, 1.0, v136
    v_mul_f32 v136, v136, v107
    v_mul_f32 v136, 0xc0135761, v136
    v_exp_f32 v136, v136
    s_nop 0
    v_add_f32 v136, 1.0, v136
    v_rcp_f32 v136, v136
    s_nop 0
    v_mul_f32 v107, v107, v136
    v_accvgpr_read_b32 v108, a18
    v_cvt_pk_bf16_f32 v108, v108, v108
    v_lshlrev_b32 v108, 16, v108
    v_add_f32 v108, v108, v122
    v_cvt_pk_bf16_f32 v108, v108, v108
    v_lshlrev_b32 v108, 16, v108
    v_mul_f32 v136, v108, v108
    v_mul_f32 v136, 0x3d372713, v136
    v_add_f32 v136, 1.0, v136
    v_mul_f32 v136, v136, v108
    v_mul_f32 v136, 0xc0135761, v136
    v_exp_f32 v136, v136
    s_nop 0
    v_add_f32 v136, 1.0, v136
    v_rcp_f32 v136, v136
    s_nop 0
    v_mul_f32 v108, v108, v136
    v_accvgpr_read_b32 v109, a19
    v_cvt_pk_bf16_f32 v109, v109, v109
    v_lshlrev_b32 v109, 16, v109
    v_add_f32 v109, v109, v123
    v_cvt_pk_bf16_f32 v109, v109, v109
    v_lshlrev_b32 v109, 16, v109
    v_mul_f32 v136, v109, v109
    v_mul_f32 v136, 0x3d372713, v136
    v_add_f32 v136, 1.0, v136
    v_mul_f32 v136, v136, v109
    v_mul_f32 v136, 0xc0135761, v136
    v_exp_f32 v136, v136
    s_nop 0
    v_add_f32 v136, 1.0, v136
    v_rcp_f32 v136, v136
    s_nop 0
    v_mul_f32 v109, v109, v136
    v_cvt_pk_bf16_f32 v110, v106, v107
    v_cvt_pk_bf16_f32 v111, v108, v109
    buffer_store_dwordx2 v[110:111], v104, s[8:11], 0 offen offset:0 sc1
    s_nop 1
    v_accvgpr_read_b32 v106, a20
    v_cvt_pk_bf16_f32 v106, v106, v106
    v_lshlrev_b32 v106, 16, v106
    v_add_f32 v106, v106, v124
    v_cvt_pk_bf16_f32 v106, v106, v106
    v_lshlrev_b32 v106, 16, v106
    v_mul_f32 v136, v106, v106
    v_mul_f32 v136, 0x3d372713, v136
    v_add_f32 v136, 1.0, v136
    v_mul_f32 v136, v136, v106
    v_mul_f32 v136, 0xc0135761, v136
    v_exp_f32 v136, v136
    s_nop 0
    v_add_f32 v136, 1.0, v136
    v_rcp_f32 v136, v136
    s_nop 0
    v_mul_f32 v106, v106, v136
    v_accvgpr_read_b32 v107, a21
    v_cvt_pk_bf16_f32 v107, v107, v107
    v_lshlrev_b32 v107, 16, v107
    v_add_f32 v107, v107, v125
    v_cvt_pk_bf16_f32 v107, v107, v107
    v_lshlrev_b32 v107, 16, v107
    v_mul_f32 v136, v107, v107
    v_mul_f32 v136, 0x3d372713, v136
    v_add_f32 v136, 1.0, v136
    v_mul_f32 v136, v136, v107
    v_mul_f32 v136, 0xc0135761, v136
    v_exp_f32 v136, v136
    s_nop 0
    v_add_f32 v136, 1.0, v136
    v_rcp_f32 v136, v136
    s_nop 0
    v_mul_f32 v107, v107, v136
    v_accvgpr_read_b32 v108, a22
    v_cvt_pk_bf16_f32 v108, v108, v108
    v_lshlrev_b32 v108, 16, v108
    v_add_f32 v108, v108, v126
    v_cvt_pk_bf16_f32 v108, v108, v108
    v_lshlrev_b32 v108, 16, v108
    v_mul_f32 v136, v108, v108
    v_mul_f32 v136, 0x3d372713, v136
    v_add_f32 v136, 1.0, v136
    v_mul_f32 v136, v136, v108
    v_mul_f32 v136, 0xc0135761, v136
    v_exp_f32 v136, v136
    s_nop 0
    v_add_f32 v136, 1.0, v136
    v_rcp_f32 v136, v136
    s_nop 0
    v_mul_f32 v108, v108, v136
    v_accvgpr_read_b32 v109, a23
    v_cvt_pk_bf16_f32 v109, v109, v109
    v_lshlrev_b32 v109, 16, v109
    v_add_f32 v109, v109, v127
    v_cvt_pk_bf16_f32 v109, v109, v109
    v_lshlrev_b32 v109, 16, v109
    v_mul_f32 v136, v109, v109
    v_mul_f32 v136, 0x3d372713, v136
    v_add_f32 v136, 1.0, v136
    v_mul_f32 v136, v136, v109
    v_mul_f32 v136, 0xc0135761, v136
    v_exp_f32 v136, v136
    s_nop 0
    v_add_f32 v136, 1.0, v136
    v_rcp_f32 v136, v136
    s_nop 0
    v_mul_f32 v109, v109, v136
    v_cvt_pk_bf16_f32 v110, v106, v107
    v_cvt_pk_bf16_f32 v111, v108, v109
    buffer_store_dwordx2 v[110:111], v104, s[8:11], 0 offen offset:32 sc1
    s_nop 1
    v_accvgpr_read_b32 v106, a24
    v_cvt_pk_bf16_f32 v106, v106, v106
    v_lshlrev_b32 v106, 16, v106
    v_add_f32 v106, v106, v128
    v_cvt_pk_bf16_f32 v106, v106, v106
    v_lshlrev_b32 v106, 16, v106
    v_mul_f32 v136, v106, v106
    v_mul_f32 v136, 0x3d372713, v136
    v_add_f32 v136, 1.0, v136
    v_mul_f32 v136, v136, v106
    v_mul_f32 v136, 0xc0135761, v136
    v_exp_f32 v136, v136
    s_nop 0
    v_add_f32 v136, 1.0, v136
    v_rcp_f32 v136, v136
    s_nop 0
    v_mul_f32 v106, v106, v136
    v_accvgpr_read_b32 v107, a25
    v_cvt_pk_bf16_f32 v107, v107, v107
    v_lshlrev_b32 v107, 16, v107
    v_add_f32 v107, v107, v129
    v_cvt_pk_bf16_f32 v107, v107, v107
    v_lshlrev_b32 v107, 16, v107
    v_mul_f32 v136, v107, v107
    v_mul_f32 v136, 0x3d372713, v136
    v_add_f32 v136, 1.0, v136
    v_mul_f32 v136, v136, v107
    v_mul_f32 v136, 0xc0135761, v136
    v_exp_f32 v136, v136
    s_nop 0
    v_add_f32 v136, 1.0, v136
    v_rcp_f32 v136, v136
    s_nop 0
    v_mul_f32 v107, v107, v136
    v_accvgpr_read_b32 v108, a26
    v_cvt_pk_bf16_f32 v108, v108, v108
    v_lshlrev_b32 v108, 16, v108
    v_add_f32 v108, v108, v130
    v_cvt_pk_bf16_f32 v108, v108, v108
    v_lshlrev_b32 v108, 16, v108
    v_mul_f32 v136, v108, v108
    v_mul_f32 v136, 0x3d372713, v136
    v_add_f32 v136, 1.0, v136
    v_mul_f32 v136, v136, v108
    v_mul_f32 v136, 0xc0135761, v136
    v_exp_f32 v136, v136
    s_nop 0
    v_add_f32 v136, 1.0, v136
    v_rcp_f32 v136, v136
    s_nop 0
    v_mul_f32 v108, v108, v136
    v_accvgpr_read_b32 v109, a27
    v_cvt_pk_bf16_f32 v109, v109, v109
    v_lshlrev_b32 v109, 16, v109
    v_add_f32 v109, v109, v131
    v_cvt_pk_bf16_f32 v109, v109, v109
    v_lshlrev_b32 v109, 16, v109
    v_mul_f32 v136, v109, v109
    v_mul_f32 v136, 0x3d372713, v136
    v_add_f32 v136, 1.0, v136
    v_mul_f32 v136, v136, v109
    v_mul_f32 v136, 0xc0135761, v136
    v_exp_f32 v136, v136
    s_nop 0
    v_add_f32 v136, 1.0, v136
    v_rcp_f32 v136, v136
    s_nop 0
    v_mul_f32 v109, v109, v136
    v_cvt_pk_bf16_f32 v110, v106, v107
    v_cvt_pk_bf16_f32 v111, v108, v109
    buffer_store_dwordx2 v[110:111], v104, s[8:11], 0 offen offset:64 sc1
    s_nop 1
    v_accvgpr_read_b32 v106, a28
    v_cvt_pk_bf16_f32 v106, v106, v106
    v_lshlrev_b32 v106, 16, v106
    v_add_f32 v106, v106, v132
    v_cvt_pk_bf16_f32 v106, v106, v106
    v_lshlrev_b32 v106, 16, v106
    v_mul_f32 v136, v106, v106
    v_mul_f32 v136, 0x3d372713, v136
    v_add_f32 v136, 1.0, v136
    v_mul_f32 v136, v136, v106
    v_mul_f32 v136, 0xc0135761, v136
    v_exp_f32 v136, v136
    s_nop 0
    v_add_f32 v136, 1.0, v136
    v_rcp_f32 v136, v136
    s_nop 0
    v_mul_f32 v106, v106, v136
    v_accvgpr_read_b32 v107, a29
    v_cvt_pk_bf16_f32 v107, v107, v107
    v_lshlrev_b32 v107, 16, v107
    v_add_f32 v107, v107, v133
    v_cvt_pk_bf16_f32 v107, v107, v107
    v_lshlrev_b32 v107, 16, v107
    v_mul_f32 v136, v107, v107
    v_mul_f32 v136, 0x3d372713, v136
    v_add_f32 v136, 1.0, v136
    v_mul_f32 v136, v136, v107
    v_mul_f32 v136, 0xc0135761, v136
    v_exp_f32 v136, v136
    s_nop 0
    v_add_f32 v136, 1.0, v136
    v_rcp_f32 v136, v136
    s_nop 0
    v_mul_f32 v107, v107, v136
    v_accvgpr_read_b32 v108, a30
    v_cvt_pk_bf16_f32 v108, v108, v108
    v_lshlrev_b32 v108, 16, v108
    v_add_f32 v108, v108, v134
    v_cvt_pk_bf16_f32 v108, v108, v108
    v_lshlrev_b32 v108, 16, v108
    v_mul_f32 v136, v108, v108
    v_mul_f32 v136, 0x3d372713, v136
    v_add_f32 v136, 1.0, v136
    v_mul_f32 v136, v136, v108
    v_mul_f32 v136, 0xc0135761, v136
    v_exp_f32 v136, v136
    s_nop 0
    v_add_f32 v136, 1.0, v136
    v_rcp_f32 v136, v136
    s_nop 0
    v_mul_f32 v108, v108, v136
    v_accvgpr_read_b32 v109, a31
    v_cvt_pk_bf16_f32 v109, v109, v109
    v_lshlrev_b32 v109, 16, v109
    v_add_f32 v109, v109, v135
    v_cvt_pk_bf16_f32 v109, v109, v109
    v_lshlrev_b32 v109, 16, v109
    v_mul_f32 v136, v109, v109
    v_mul_f32 v136, 0x3d372713, v136
    v_add_f32 v136, 1.0, v136
    v_mul_f32 v136, v136, v109
    v_mul_f32 v136, 0xc0135761, v136
    v_exp_f32 v136, v136
    s_nop 0
    v_add_f32 v136, 1.0, v136
    v_rcp_f32 v136, v136
    s_nop 0
    v_mul_f32 v109, v109, v136
    v_cvt_pk_bf16_f32 v110, v106, v107
    v_cvt_pk_bf16_f32 v111, v108, v109
    buffer_store_dwordx2 v[110:111], v104, s[8:11], 0 offen offset:96 sc1
    s_nop 1
    v_add_u32 v104, 57344, v104
    v_accvgpr_read_b32 v106, a32
    v_cvt_pk_bf16_f32 v106, v106, v106
    v_lshlrev_b32 v106, 16, v106
    v_add_f32 v106, v106, v120
    v_cvt_pk_bf16_f32 v106, v106, v106
    v_lshlrev_b32 v106, 16, v106
    v_mul_f32 v136, v106, v106
    v_mul_f32 v136, 0x3d372713, v136
    v_add_f32 v136, 1.0, v136
    v_mul_f32 v136, v136, v106
    v_mul_f32 v136, 0xc0135761, v136
    v_exp_f32 v136, v136
    s_nop 0
    v_add_f32 v136, 1.0, v136
    v_rcp_f32 v136, v136
    s_nop 0
    v_mul_f32 v106, v106, v136
    v_accvgpr_read_b32 v107, a33
    v_cvt_pk_bf16_f32 v107, v107, v107
    v_lshlrev_b32 v107, 16, v107
    v_add_f32 v107, v107, v121
    v_cvt_pk_bf16_f32 v107, v107, v107
    v_lshlrev_b32 v107, 16, v107
    v_mul_f32 v136, v107, v107
    v_mul_f32 v136, 0x3d372713, v136
    v_add_f32 v136, 1.0, v136
    v_mul_f32 v136, v136, v107
    v_mul_f32 v136, 0xc0135761, v136
    v_exp_f32 v136, v136
    s_nop 0
    v_add_f32 v136, 1.0, v136
    v_rcp_f32 v136, v136
    s_nop 0
    v_mul_f32 v107, v107, v136
    v_accvgpr_read_b32 v108, a34
    v_cvt_pk_bf16_f32 v108, v108, v108
    v_lshlrev_b32 v108, 16, v108
    v_add_f32 v108, v108, v122
    v_cvt_pk_bf16_f32 v108, v108, v108
    v_lshlrev_b32 v108, 16, v108
    v_mul_f32 v136, v108, v108
    v_mul_f32 v136, 0x3d372713, v136
    v_add_f32 v136, 1.0, v136
    v_mul_f32 v136, v136, v108
    v_mul_f32 v136, 0xc0135761, v136
    v_exp_f32 v136, v136
    s_nop 0
    v_add_f32 v136, 1.0, v136
    v_rcp_f32 v136, v136
    s_nop 0
    v_mul_f32 v108, v108, v136
    v_accvgpr_read_b32 v109, a35
    v_cvt_pk_bf16_f32 v109, v109, v109
    v_lshlrev_b32 v109, 16, v109
    v_add_f32 v109, v109, v123
    v_cvt_pk_bf16_f32 v109, v109, v109
    v_lshlrev_b32 v109, 16, v109
    v_mul_f32 v136, v109, v109
    v_mul_f32 v136, 0x3d372713, v136
    v_add_f32 v136, 1.0, v136
    v_mul_f32 v136, v136, v109
    v_mul_f32 v136, 0xc0135761, v136
    v_exp_f32 v136, v136
    s_nop 0
    v_add_f32 v136, 1.0, v136
    v_rcp_f32 v136, v136
    s_nop 0
    v_mul_f32 v109, v109, v136
    v_cvt_pk_bf16_f32 v110, v106, v107
    v_cvt_pk_bf16_f32 v111, v108, v109
    buffer_store_dwordx2 v[110:111], v104, s[8:11], 0 offen offset:0 sc1
    s_nop 1
    v_accvgpr_read_b32 v106, a36
    v_cvt_pk_bf16_f32 v106, v106, v106
    v_lshlrev_b32 v106, 16, v106
    v_add_f32 v106, v106, v124
    v_cvt_pk_bf16_f32 v106, v106, v106
    v_lshlrev_b32 v106, 16, v106
    v_mul_f32 v136, v106, v106
    v_mul_f32 v136, 0x3d372713, v136
    v_add_f32 v136, 1.0, v136
    v_mul_f32 v136, v136, v106
    v_mul_f32 v136, 0xc0135761, v136
    v_exp_f32 v136, v136
    s_nop 0
    v_add_f32 v136, 1.0, v136
    v_rcp_f32 v136, v136
    s_nop 0
    v_mul_f32 v106, v106, v136
    v_accvgpr_read_b32 v107, a37
    v_cvt_pk_bf16_f32 v107, v107, v107
    v_lshlrev_b32 v107, 16, v107
    v_add_f32 v107, v107, v125
    v_cvt_pk_bf16_f32 v107, v107, v107
    v_lshlrev_b32 v107, 16, v107
    v_mul_f32 v136, v107, v107
    v_mul_f32 v136, 0x3d372713, v136
    v_add_f32 v136, 1.0, v136
    v_mul_f32 v136, v136, v107
    v_mul_f32 v136, 0xc0135761, v136
    v_exp_f32 v136, v136
    s_nop 0
    v_add_f32 v136, 1.0, v136
    v_rcp_f32 v136, v136
    s_nop 0
    v_mul_f32 v107, v107, v136
    v_accvgpr_read_b32 v108, a38
    v_cvt_pk_bf16_f32 v108, v108, v108
    v_lshlrev_b32 v108, 16, v108
    v_add_f32 v108, v108, v126
    v_cvt_pk_bf16_f32 v108, v108, v108
    v_lshlrev_b32 v108, 16, v108
    v_mul_f32 v136, v108, v108
    v_mul_f32 v136, 0x3d372713, v136
    v_add_f32 v136, 1.0, v136
    v_mul_f32 v136, v136, v108
    v_mul_f32 v136, 0xc0135761, v136
    v_exp_f32 v136, v136
    s_nop 0
    v_add_f32 v136, 1.0, v136
    v_rcp_f32 v136, v136
    s_nop 0
    v_mul_f32 v108, v108, v136
    v_accvgpr_read_b32 v109, a39
    v_cvt_pk_bf16_f32 v109, v109, v109
    v_lshlrev_b32 v109, 16, v109
    v_add_f32 v109, v109, v127
    v_cvt_pk_bf16_f32 v109, v109, v109
    v_lshlrev_b32 v109, 16, v109
    v_mul_f32 v136, v109, v109
    v_mul_f32 v136, 0x3d372713, v136
    v_add_f32 v136, 1.0, v136
    v_mul_f32 v136, v136, v109
    v_mul_f32 v136, 0xc0135761, v136
    v_exp_f32 v136, v136
    s_nop 0
    v_add_f32 v136, 1.0, v136
    v_rcp_f32 v136, v136
    s_nop 0
    v_mul_f32 v109, v109, v136
    v_cvt_pk_bf16_f32 v110, v106, v107
    v_cvt_pk_bf16_f32 v111, v108, v109
    buffer_store_dwordx2 v[110:111], v104, s[8:11], 0 offen offset:32 sc1
    s_nop 1
    v_accvgpr_read_b32 v106, a40
    v_cvt_pk_bf16_f32 v106, v106, v106
    v_lshlrev_b32 v106, 16, v106
    v_add_f32 v106, v106, v128
    v_cvt_pk_bf16_f32 v106, v106, v106
    v_lshlrev_b32 v106, 16, v106
    v_mul_f32 v136, v106, v106
    v_mul_f32 v136, 0x3d372713, v136
    v_add_f32 v136, 1.0, v136
    v_mul_f32 v136, v136, v106
    v_mul_f32 v136, 0xc0135761, v136
    v_exp_f32 v136, v136
    s_nop 0
    v_add_f32 v136, 1.0, v136
    v_rcp_f32 v136, v136
    s_nop 0
    v_mul_f32 v106, v106, v136
    v_accvgpr_read_b32 v107, a41
    v_cvt_pk_bf16_f32 v107, v107, v107
    v_lshlrev_b32 v107, 16, v107
    v_add_f32 v107, v107, v129
    v_cvt_pk_bf16_f32 v107, v107, v107
    v_lshlrev_b32 v107, 16, v107
    v_mul_f32 v136, v107, v107
    v_mul_f32 v136, 0x3d372713, v136
    v_add_f32 v136, 1.0, v136
    v_mul_f32 v136, v136, v107
    v_mul_f32 v136, 0xc0135761, v136
    v_exp_f32 v136, v136
    s_nop 0
    v_add_f32 v136, 1.0, v136
    v_rcp_f32 v136, v136
    s_nop 0
    v_mul_f32 v107, v107, v136
    v_accvgpr_read_b32 v108, a42
    v_cvt_pk_bf16_f32 v108, v108, v108
    v_lshlrev_b32 v108, 16, v108
    v_add_f32 v108, v108, v130
    v_cvt_pk_bf16_f32 v108, v108, v108
    v_lshlrev_b32 v108, 16, v108
    v_mul_f32 v136, v108, v108
    v_mul_f32 v136, 0x3d372713, v136
    v_add_f32 v136, 1.0, v136
    v_mul_f32 v136, v136, v108
    v_mul_f32 v136, 0xc0135761, v136
    v_exp_f32 v136, v136
    s_nop 0
    v_add_f32 v136, 1.0, v136
    v_rcp_f32 v136, v136
    s_nop 0
    v_mul_f32 v108, v108, v136
    v_accvgpr_read_b32 v109, a43
    v_cvt_pk_bf16_f32 v109, v109, v109
    v_lshlrev_b32 v109, 16, v109
    v_add_f32 v109, v109, v131
    v_cvt_pk_bf16_f32 v109, v109, v109
    v_lshlrev_b32 v109, 16, v109
    v_mul_f32 v136, v109, v109
    v_mul_f32 v136, 0x3d372713, v136
    v_add_f32 v136, 1.0, v136
    v_mul_f32 v136, v136, v109
    v_mul_f32 v136, 0xc0135761, v136
    v_exp_f32 v136, v136
    s_nop 0
    v_add_f32 v136, 1.0, v136
    v_rcp_f32 v136, v136
    s_nop 0
    v_mul_f32 v109, v109, v136
    v_cvt_pk_bf16_f32 v110, v106, v107
    v_cvt_pk_bf16_f32 v111, v108, v109
    buffer_store_dwordx2 v[110:111], v104, s[8:11], 0 offen offset:64 sc1
    s_nop 1
    v_accvgpr_read_b32 v106, a44
    v_cvt_pk_bf16_f32 v106, v106, v106
    v_lshlrev_b32 v106, 16, v106
    v_add_f32 v106, v106, v132
    v_cvt_pk_bf16_f32 v106, v106, v106
    v_lshlrev_b32 v106, 16, v106
    v_mul_f32 v136, v106, v106
    v_mul_f32 v136, 0x3d372713, v136
    v_add_f32 v136, 1.0, v136
    v_mul_f32 v136, v136, v106
    v_mul_f32 v136, 0xc0135761, v136
    v_exp_f32 v136, v136
    s_nop 0
    v_add_f32 v136, 1.0, v136
    v_rcp_f32 v136, v136
    s_nop 0
    v_mul_f32 v106, v106, v136
    v_accvgpr_read_b32 v107, a45
    v_cvt_pk_bf16_f32 v107, v107, v107
    v_lshlrev_b32 v107, 16, v107
    v_add_f32 v107, v107, v133
    v_cvt_pk_bf16_f32 v107, v107, v107
    v_lshlrev_b32 v107, 16, v107
    v_mul_f32 v136, v107, v107
    v_mul_f32 v136, 0x3d372713, v136
    v_add_f32 v136, 1.0, v136
    v_mul_f32 v136, v136, v107
    v_mul_f32 v136, 0xc0135761, v136
    v_exp_f32 v136, v136
    s_nop 0
    v_add_f32 v136, 1.0, v136
    v_rcp_f32 v136, v136
    s_nop 0
    v_mul_f32 v107, v107, v136
    v_accvgpr_read_b32 v108, a46
    v_cvt_pk_bf16_f32 v108, v108, v108
    v_lshlrev_b32 v108, 16, v108
    v_add_f32 v108, v108, v134
    v_cvt_pk_bf16_f32 v108, v108, v108
    v_lshlrev_b32 v108, 16, v108
    v_mul_f32 v136, v108, v108
    v_mul_f32 v136, 0x3d372713, v136
    v_add_f32 v136, 1.0, v136
    v_mul_f32 v136, v136, v108
    v_mul_f32 v136, 0xc0135761, v136
    v_exp_f32 v136, v136
    s_nop 0
    v_add_f32 v136, 1.0, v136
    v_rcp_f32 v136, v136
    s_nop 0
    v_mul_f32 v108, v108, v136
    v_accvgpr_read_b32 v109, a47
    v_cvt_pk_bf16_f32 v109, v109, v109
    v_lshlrev_b32 v109, 16, v109
    v_add_f32 v109, v109, v135
    v_cvt_pk_bf16_f32 v109, v109, v109
    v_lshlrev_b32 v109, 16, v109
    v_mul_f32 v136, v109, v109
    v_mul_f32 v136, 0x3d372713, v136
    v_add_f32 v136, 1.0, v136
    v_mul_f32 v136, v136, v109
    v_mul_f32 v136, 0xc0135761, v136
    v_exp_f32 v136, v136
    s_nop 0
    v_add_f32 v136, 1.0, v136
    v_rcp_f32 v136, v136
    s_nop 0
    v_mul_f32 v109, v109, v136
    v_cvt_pk_bf16_f32 v110, v106, v107
    v_cvt_pk_bf16_f32 v111, v108, v109
    buffer_store_dwordx2 v[110:111], v104, s[8:11], 0 offen offset:96 sc1
    s_nop 1
    v_add_u32 v104, 57344, v104
    v_accvgpr_read_b32 v106, a48
    v_cvt_pk_bf16_f32 v106, v106, v106
    v_lshlrev_b32 v106, 16, v106
    v_add_f32 v106, v106, v120
    v_cvt_pk_bf16_f32 v106, v106, v106
    v_lshlrev_b32 v106, 16, v106
    v_mul_f32 v136, v106, v106
    v_mul_f32 v136, 0x3d372713, v136
    v_add_f32 v136, 1.0, v136
    v_mul_f32 v136, v136, v106
    v_mul_f32 v136, 0xc0135761, v136
    v_exp_f32 v136, v136
    s_nop 0
    v_add_f32 v136, 1.0, v136
    v_rcp_f32 v136, v136
    s_nop 0
    v_mul_f32 v106, v106, v136
    v_accvgpr_read_b32 v107, a49
    v_cvt_pk_bf16_f32 v107, v107, v107
    v_lshlrev_b32 v107, 16, v107
    v_add_f32 v107, v107, v121
    v_cvt_pk_bf16_f32 v107, v107, v107
    v_lshlrev_b32 v107, 16, v107
    v_mul_f32 v136, v107, v107
    v_mul_f32 v136, 0x3d372713, v136
    v_add_f32 v136, 1.0, v136
    v_mul_f32 v136, v136, v107
    v_mul_f32 v136, 0xc0135761, v136
    v_exp_f32 v136, v136
    s_nop 0
    v_add_f32 v136, 1.0, v136
    v_rcp_f32 v136, v136
    s_nop 0
    v_mul_f32 v107, v107, v136
    v_accvgpr_read_b32 v108, a50
    v_cvt_pk_bf16_f32 v108, v108, v108
    v_lshlrev_b32 v108, 16, v108
    v_add_f32 v108, v108, v122
    v_cvt_pk_bf16_f32 v108, v108, v108
    v_lshlrev_b32 v108, 16, v108
    v_mul_f32 v136, v108, v108
    v_mul_f32 v136, 0x3d372713, v136
    v_add_f32 v136, 1.0, v136
    v_mul_f32 v136, v136, v108
    v_mul_f32 v136, 0xc0135761, v136
    v_exp_f32 v136, v136
    s_nop 0
    v_add_f32 v136, 1.0, v136
    v_rcp_f32 v136, v136
    s_nop 0
    v_mul_f32 v108, v108, v136
    v_accvgpr_read_b32 v109, a51
    v_cvt_pk_bf16_f32 v109, v109, v109
    v_lshlrev_b32 v109, 16, v109
    v_add_f32 v109, v109, v123
    v_cvt_pk_bf16_f32 v109, v109, v109
    v_lshlrev_b32 v109, 16, v109
    v_mul_f32 v136, v109, v109
    v_mul_f32 v136, 0x3d372713, v136
    v_add_f32 v136, 1.0, v136
    v_mul_f32 v136, v136, v109
    v_mul_f32 v136, 0xc0135761, v136
    v_exp_f32 v136, v136
    s_nop 0
    v_add_f32 v136, 1.0, v136
    v_rcp_f32 v136, v136
    s_nop 0
    v_mul_f32 v109, v109, v136
    v_cvt_pk_bf16_f32 v110, v106, v107
    v_cvt_pk_bf16_f32 v111, v108, v109
    buffer_store_dwordx2 v[110:111], v104, s[8:11], 0 offen offset:0 sc1
    s_nop 1
    v_accvgpr_read_b32 v106, a52
    v_cvt_pk_bf16_f32 v106, v106, v106
    v_lshlrev_b32 v106, 16, v106
    v_add_f32 v106, v106, v124
    v_cvt_pk_bf16_f32 v106, v106, v106
    v_lshlrev_b32 v106, 16, v106
    v_mul_f32 v136, v106, v106
    v_mul_f32 v136, 0x3d372713, v136
    v_add_f32 v136, 1.0, v136
    v_mul_f32 v136, v136, v106
    v_mul_f32 v136, 0xc0135761, v136
    v_exp_f32 v136, v136
    s_nop 0
    v_add_f32 v136, 1.0, v136
    v_rcp_f32 v136, v136
    s_nop 0
    v_mul_f32 v106, v106, v136
    v_accvgpr_read_b32 v107, a53
    v_cvt_pk_bf16_f32 v107, v107, v107
    v_lshlrev_b32 v107, 16, v107
    v_add_f32 v107, v107, v125
    v_cvt_pk_bf16_f32 v107, v107, v107
    v_lshlrev_b32 v107, 16, v107
    v_mul_f32 v136, v107, v107
    v_mul_f32 v136, 0x3d372713, v136
    v_add_f32 v136, 1.0, v136
    v_mul_f32 v136, v136, v107
    v_mul_f32 v136, 0xc0135761, v136
    v_exp_f32 v136, v136
    s_nop 0
    v_add_f32 v136, 1.0, v136
    v_rcp_f32 v136, v136
    s_nop 0
    v_mul_f32 v107, v107, v136
    v_accvgpr_read_b32 v108, a54
    v_cvt_pk_bf16_f32 v108, v108, v108
    v_lshlrev_b32 v108, 16, v108
    v_add_f32 v108, v108, v126
    v_cvt_pk_bf16_f32 v108, v108, v108
    v_lshlrev_b32 v108, 16, v108
    v_mul_f32 v136, v108, v108
    v_mul_f32 v136, 0x3d372713, v136
    v_add_f32 v136, 1.0, v136
    v_mul_f32 v136, v136, v108
    v_mul_f32 v136, 0xc0135761, v136
    v_exp_f32 v136, v136
    s_nop 0
    v_add_f32 v136, 1.0, v136
    v_rcp_f32 v136, v136
    s_nop 0
    v_mul_f32 v108, v108, v136
    v_accvgpr_read_b32 v109, a55
    v_cvt_pk_bf16_f32 v109, v109, v109
    v_lshlrev_b32 v109, 16, v109
    v_add_f32 v109, v109, v127
    v_cvt_pk_bf16_f32 v109, v109, v109
    v_lshlrev_b32 v109, 16, v109
    v_mul_f32 v136, v109, v109
    v_mul_f32 v136, 0x3d372713, v136
    v_add_f32 v136, 1.0, v136
    v_mul_f32 v136, v136, v109
    v_mul_f32 v136, 0xc0135761, v136
    v_exp_f32 v136, v136
    s_nop 0
    v_add_f32 v136, 1.0, v136
    v_rcp_f32 v136, v136
    s_nop 0
    v_mul_f32 v109, v109, v136
    v_cvt_pk_bf16_f32 v110, v106, v107
    v_cvt_pk_bf16_f32 v111, v108, v109
    buffer_store_dwordx2 v[110:111], v104, s[8:11], 0 offen offset:32 sc1
    s_nop 1
    v_accvgpr_read_b32 v106, a56
    v_cvt_pk_bf16_f32 v106, v106, v106
    v_lshlrev_b32 v106, 16, v106
    v_add_f32 v106, v106, v128
    v_cvt_pk_bf16_f32 v106, v106, v106
    v_lshlrev_b32 v106, 16, v106
    v_mul_f32 v136, v106, v106
    v_mul_f32 v136, 0x3d372713, v136
    v_add_f32 v136, 1.0, v136
    v_mul_f32 v136, v136, v106
    v_mul_f32 v136, 0xc0135761, v136
    v_exp_f32 v136, v136
    s_nop 0
    v_add_f32 v136, 1.0, v136
    v_rcp_f32 v136, v136
    s_nop 0
    v_mul_f32 v106, v106, v136
    v_accvgpr_read_b32 v107, a57
    v_cvt_pk_bf16_f32 v107, v107, v107
    v_lshlrev_b32 v107, 16, v107
    v_add_f32 v107, v107, v129
    v_cvt_pk_bf16_f32 v107, v107, v107
    v_lshlrev_b32 v107, 16, v107
    v_mul_f32 v136, v107, v107
    v_mul_f32 v136, 0x3d372713, v136
    v_add_f32 v136, 1.0, v136
    v_mul_f32 v136, v136, v107
    v_mul_f32 v136, 0xc0135761, v136
    v_exp_f32 v136, v136
    s_nop 0
    v_add_f32 v136, 1.0, v136
    v_rcp_f32 v136, v136
    s_nop 0
    v_mul_f32 v107, v107, v136
    v_accvgpr_read_b32 v108, a58
    v_cvt_pk_bf16_f32 v108, v108, v108
    v_lshlrev_b32 v108, 16, v108
    v_add_f32 v108, v108, v130
    v_cvt_pk_bf16_f32 v108, v108, v108
    v_lshlrev_b32 v108, 16, v108
    v_mul_f32 v136, v108, v108
    v_mul_f32 v136, 0x3d372713, v136
    v_add_f32 v136, 1.0, v136
    v_mul_f32 v136, v136, v108
    v_mul_f32 v136, 0xc0135761, v136
    v_exp_f32 v136, v136
    s_nop 0
    v_add_f32 v136, 1.0, v136
    v_rcp_f32 v136, v136
    s_nop 0
    v_mul_f32 v108, v108, v136
    v_accvgpr_read_b32 v109, a59
    v_cvt_pk_bf16_f32 v109, v109, v109
    v_lshlrev_b32 v109, 16, v109
    v_add_f32 v109, v109, v131
    v_cvt_pk_bf16_f32 v109, v109, v109
    v_lshlrev_b32 v109, 16, v109
    v_mul_f32 v136, v109, v109
    v_mul_f32 v136, 0x3d372713, v136
    v_add_f32 v136, 1.0, v136
    v_mul_f32 v136, v136, v109
    v_mul_f32 v136, 0xc0135761, v136
    v_exp_f32 v136, v136
    s_nop 0
    v_add_f32 v136, 1.0, v136
    v_rcp_f32 v136, v136
    s_nop 0
    v_mul_f32 v109, v109, v136
    v_cvt_pk_bf16_f32 v110, v106, v107
    v_cvt_pk_bf16_f32 v111, v108, v109
    buffer_store_dwordx2 v[110:111], v104, s[8:11], 0 offen offset:64 sc1
    s_nop 1
    v_accvgpr_read_b32 v106, a60
    v_cvt_pk_bf16_f32 v106, v106, v106
    v_lshlrev_b32 v106, 16, v106
    v_add_f32 v106, v106, v132
    v_cvt_pk_bf16_f32 v106, v106, v106
    v_lshlrev_b32 v106, 16, v106
    v_mul_f32 v136, v106, v106
    v_mul_f32 v136, 0x3d372713, v136
    v_add_f32 v136, 1.0, v136
    v_mul_f32 v136, v136, v106
    v_mul_f32 v136, 0xc0135761, v136
    v_exp_f32 v136, v136
    s_nop 0
    v_add_f32 v136, 1.0, v136
    v_rcp_f32 v136, v136
    s_nop 0
    v_mul_f32 v106, v106, v136
    v_accvgpr_read_b32 v107, a61
    v_cvt_pk_bf16_f32 v107, v107, v107
    v_lshlrev_b32 v107, 16, v107
    v_add_f32 v107, v107, v133
    v_cvt_pk_bf16_f32 v107, v107, v107
    v_lshlrev_b32 v107, 16, v107
    v_mul_f32 v136, v107, v107
    v_mul_f32 v136, 0x3d372713, v136
    v_add_f32 v136, 1.0, v136
    v_mul_f32 v136, v136, v107
    v_mul_f32 v136, 0xc0135761, v136
    v_exp_f32 v136, v136
    s_nop 0
    v_add_f32 v136, 1.0, v136
    v_rcp_f32 v136, v136
    s_nop 0
    v_mul_f32 v107, v107, v136
    v_accvgpr_read_b32 v108, a62
    v_cvt_pk_bf16_f32 v108, v108, v108
    v_lshlrev_b32 v108, 16, v108
    v_add_f32 v108, v108, v134
    v_cvt_pk_bf16_f32 v108, v108, v108
    v_lshlrev_b32 v108, 16, v108
    v_mul_f32 v136, v108, v108
    v_mul_f32 v136, 0x3d372713, v136
    v_add_f32 v136, 1.0, v136
    v_mul_f32 v136, v136, v108
    v_mul_f32 v136, 0xc0135761, v136
    v_exp_f32 v136, v136
    s_nop 0
    v_add_f32 v136, 1.0, v136
    v_rcp_f32 v136, v136
    s_nop 0
    v_mul_f32 v108, v108, v136
    v_accvgpr_read_b32 v109, a63
    v_cvt_pk_bf16_f32 v109, v109, v109
    v_lshlrev_b32 v109, 16, v109
    v_add_f32 v109, v109, v135
    v_cvt_pk_bf16_f32 v109, v109, v109
    v_lshlrev_b32 v109, 16, v109
    v_mul_f32 v136, v109, v109
    v_mul_f32 v136, 0x3d372713, v136
    v_add_f32 v136, 1.0, v136
    v_mul_f32 v136, v136, v109
    v_mul_f32 v136, 0xc0135761, v136
    v_exp_f32 v136, v136
    s_nop 0
    v_add_f32 v136, 1.0, v136
    v_rcp_f32 v136, v136
    s_nop 0
    v_mul_f32 v109, v109, v136
    v_cvt_pk_bf16_f32 v110, v106, v107
    v_cvt_pk_bf16_f32 v111, v108, v109
    buffer_store_dwordx2 v[110:111], v104, s[8:11], 0 offen offset:96 sc1
    s_nop 1
    v_add_u32 v104, 57344, v104
    v_accvgpr_read_b32 v106, a64
    v_cvt_pk_bf16_f32 v106, v106, v106
    v_lshlrev_b32 v106, 16, v106
    v_add_f32 v106, v106, v120
    v_cvt_pk_bf16_f32 v106, v106, v106
    v_lshlrev_b32 v106, 16, v106
    v_mul_f32 v136, v106, v106
    v_mul_f32 v136, 0x3d372713, v136
    v_add_f32 v136, 1.0, v136
    v_mul_f32 v136, v136, v106
    v_mul_f32 v136, 0xc0135761, v136
    v_exp_f32 v136, v136
    s_nop 0
    v_add_f32 v136, 1.0, v136
    v_rcp_f32 v136, v136
    s_nop 0
    v_mul_f32 v106, v106, v136
    v_accvgpr_read_b32 v107, a65
    v_cvt_pk_bf16_f32 v107, v107, v107
    v_lshlrev_b32 v107, 16, v107
    v_add_f32 v107, v107, v121
    v_cvt_pk_bf16_f32 v107, v107, v107
    v_lshlrev_b32 v107, 16, v107
    v_mul_f32 v136, v107, v107
    v_mul_f32 v136, 0x3d372713, v136
    v_add_f32 v136, 1.0, v136
    v_mul_f32 v136, v136, v107
    v_mul_f32 v136, 0xc0135761, v136
    v_exp_f32 v136, v136
    s_nop 0
    v_add_f32 v136, 1.0, v136
    v_rcp_f32 v136, v136
    s_nop 0
    v_mul_f32 v107, v107, v136
    v_accvgpr_read_b32 v108, a66
    v_cvt_pk_bf16_f32 v108, v108, v108
    v_lshlrev_b32 v108, 16, v108
    v_add_f32 v108, v108, v122
    v_cvt_pk_bf16_f32 v108, v108, v108
    v_lshlrev_b32 v108, 16, v108
    v_mul_f32 v136, v108, v108
    v_mul_f32 v136, 0x3d372713, v136
    v_add_f32 v136, 1.0, v136
    v_mul_f32 v136, v136, v108
    v_mul_f32 v136, 0xc0135761, v136
    v_exp_f32 v136, v136
    s_nop 0
    v_add_f32 v136, 1.0, v136
    v_rcp_f32 v136, v136
    s_nop 0
    v_mul_f32 v108, v108, v136
    v_accvgpr_read_b32 v109, a67
    v_cvt_pk_bf16_f32 v109, v109, v109
    v_lshlrev_b32 v109, 16, v109
    v_add_f32 v109, v109, v123
    v_cvt_pk_bf16_f32 v109, v109, v109
    v_lshlrev_b32 v109, 16, v109
    v_mul_f32 v136, v109, v109
    v_mul_f32 v136, 0x3d372713, v136
    v_add_f32 v136, 1.0, v136
    v_mul_f32 v136, v136, v109
    v_mul_f32 v136, 0xc0135761, v136
    v_exp_f32 v136, v136
    s_nop 0
    v_add_f32 v136, 1.0, v136
    v_rcp_f32 v136, v136
    s_nop 0
    v_mul_f32 v109, v109, v136
    v_cvt_pk_bf16_f32 v110, v106, v107
    v_cvt_pk_bf16_f32 v111, v108, v109
    buffer_store_dwordx2 v[110:111], v104, s[8:11], 0 offen offset:0 sc1
    s_nop 1
    v_accvgpr_read_b32 v106, a68
    v_cvt_pk_bf16_f32 v106, v106, v106
    v_lshlrev_b32 v106, 16, v106
    v_add_f32 v106, v106, v124
    v_cvt_pk_bf16_f32 v106, v106, v106
    v_lshlrev_b32 v106, 16, v106
    v_mul_f32 v136, v106, v106
    v_mul_f32 v136, 0x3d372713, v136
    v_add_f32 v136, 1.0, v136
    v_mul_f32 v136, v136, v106
    v_mul_f32 v136, 0xc0135761, v136
    v_exp_f32 v136, v136
    s_nop 0
    v_add_f32 v136, 1.0, v136
    v_rcp_f32 v136, v136
    s_nop 0
    v_mul_f32 v106, v106, v136
    v_accvgpr_read_b32 v107, a69
    v_cvt_pk_bf16_f32 v107, v107, v107
    v_lshlrev_b32 v107, 16, v107
    v_add_f32 v107, v107, v125
    v_cvt_pk_bf16_f32 v107, v107, v107
    v_lshlrev_b32 v107, 16, v107
    v_mul_f32 v136, v107, v107
    v_mul_f32 v136, 0x3d372713, v136
    v_add_f32 v136, 1.0, v136
    v_mul_f32 v136, v136, v107
    v_mul_f32 v136, 0xc0135761, v136
    v_exp_f32 v136, v136
    s_nop 0
    v_add_f32 v136, 1.0, v136
    v_rcp_f32 v136, v136
    s_nop 0
    v_mul_f32 v107, v107, v136
    v_accvgpr_read_b32 v108, a70
    v_cvt_pk_bf16_f32 v108, v108, v108
    v_lshlrev_b32 v108, 16, v108
    v_add_f32 v108, v108, v126
    v_cvt_pk_bf16_f32 v108, v108, v108
    v_lshlrev_b32 v108, 16, v108
    v_mul_f32 v136, v108, v108
    v_mul_f32 v136, 0x3d372713, v136
    v_add_f32 v136, 1.0, v136
    v_mul_f32 v136, v136, v108
    v_mul_f32 v136, 0xc0135761, v136
    v_exp_f32 v136, v136
    s_nop 0
    v_add_f32 v136, 1.0, v136
    v_rcp_f32 v136, v136
    s_nop 0
    v_mul_f32 v108, v108, v136
    v_accvgpr_read_b32 v109, a71
    v_cvt_pk_bf16_f32 v109, v109, v109
    v_lshlrev_b32 v109, 16, v109
    v_add_f32 v109, v109, v127
    v_cvt_pk_bf16_f32 v109, v109, v109
    v_lshlrev_b32 v109, 16, v109
    v_mul_f32 v136, v109, v109
    v_mul_f32 v136, 0x3d372713, v136
    v_add_f32 v136, 1.0, v136
    v_mul_f32 v136, v136, v109
    v_mul_f32 v136, 0xc0135761, v136
    v_exp_f32 v136, v136
    s_nop 0
    v_add_f32 v136, 1.0, v136
    v_rcp_f32 v136, v136
    s_nop 0
    v_mul_f32 v109, v109, v136
    v_cvt_pk_bf16_f32 v110, v106, v107
    v_cvt_pk_bf16_f32 v111, v108, v109
    buffer_store_dwordx2 v[110:111], v104, s[8:11], 0 offen offset:32 sc1
    s_nop 1
    v_accvgpr_read_b32 v106, a72
    v_cvt_pk_bf16_f32 v106, v106, v106
    v_lshlrev_b32 v106, 16, v106
    v_add_f32 v106, v106, v128
    v_cvt_pk_bf16_f32 v106, v106, v106
    v_lshlrev_b32 v106, 16, v106
    v_mul_f32 v136, v106, v106
    v_mul_f32 v136, 0x3d372713, v136
    v_add_f32 v136, 1.0, v136
    v_mul_f32 v136, v136, v106
    v_mul_f32 v136, 0xc0135761, v136
    v_exp_f32 v136, v136
    s_nop 0
    v_add_f32 v136, 1.0, v136
    v_rcp_f32 v136, v136
    s_nop 0
    v_mul_f32 v106, v106, v136
    v_accvgpr_read_b32 v107, a73
    v_cvt_pk_bf16_f32 v107, v107, v107
    v_lshlrev_b32 v107, 16, v107
    v_add_f32 v107, v107, v129
    v_cvt_pk_bf16_f32 v107, v107, v107
    v_lshlrev_b32 v107, 16, v107
    v_mul_f32 v136, v107, v107
    v_mul_f32 v136, 0x3d372713, v136
    v_add_f32 v136, 1.0, v136
    v_mul_f32 v136, v136, v107
    v_mul_f32 v136, 0xc0135761, v136
    v_exp_f32 v136, v136
    s_nop 0
    v_add_f32 v136, 1.0, v136
    v_rcp_f32 v136, v136
    s_nop 0
    v_mul_f32 v107, v107, v136
    v_accvgpr_read_b32 v108, a74
    v_cvt_pk_bf16_f32 v108, v108, v108
    v_lshlrev_b32 v108, 16, v108
    v_add_f32 v108, v108, v130
    v_cvt_pk_bf16_f32 v108, v108, v108
    v_lshlrev_b32 v108, 16, v108
    v_mul_f32 v136, v108, v108
    v_mul_f32 v136, 0x3d372713, v136
    v_add_f32 v136, 1.0, v136
    v_mul_f32 v136, v136, v108
    v_mul_f32 v136, 0xc0135761, v136
    v_exp_f32 v136, v136
    s_nop 0
    v_add_f32 v136, 1.0, v136
    v_rcp_f32 v136, v136
    s_nop 0
    v_mul_f32 v108, v108, v136
    v_accvgpr_read_b32 v109, a75
    v_cvt_pk_bf16_f32 v109, v109, v109
    v_lshlrev_b32 v109, 16, v109
    v_add_f32 v109, v109, v131
    v_cvt_pk_bf16_f32 v109, v109, v109
    v_lshlrev_b32 v109, 16, v109
    v_mul_f32 v136, v109, v109
    v_mul_f32 v136, 0x3d372713, v136
    v_add_f32 v136, 1.0, v136
    v_mul_f32 v136, v136, v109
    v_mul_f32 v136, 0xc0135761, v136
    v_exp_f32 v136, v136
    s_nop 0
    v_add_f32 v136, 1.0, v136
    v_rcp_f32 v136, v136
    s_nop 0
    v_mul_f32 v109, v109, v136
    v_cvt_pk_bf16_f32 v110, v106, v107
    v_cvt_pk_bf16_f32 v111, v108, v109
    buffer_store_dwordx2 v[110:111], v104, s[8:11], 0 offen offset:64 sc1
    s_nop 1
    v_accvgpr_read_b32 v106, a76
    v_cvt_pk_bf16_f32 v106, v106, v106
    v_lshlrev_b32 v106, 16, v106
    v_add_f32 v106, v106, v132
    v_cvt_pk_bf16_f32 v106, v106, v106
    v_lshlrev_b32 v106, 16, v106
    v_mul_f32 v136, v106, v106
    v_mul_f32 v136, 0x3d372713, v136
    v_add_f32 v136, 1.0, v136
    v_mul_f32 v136, v136, v106
    v_mul_f32 v136, 0xc0135761, v136
    v_exp_f32 v136, v136
    s_nop 0
    v_add_f32 v136, 1.0, v136
    v_rcp_f32 v136, v136
    s_nop 0
    v_mul_f32 v106, v106, v136
    v_accvgpr_read_b32 v107, a77
    v_cvt_pk_bf16_f32 v107, v107, v107
    v_lshlrev_b32 v107, 16, v107
    v_add_f32 v107, v107, v133
    v_cvt_pk_bf16_f32 v107, v107, v107
    v_lshlrev_b32 v107, 16, v107
    v_mul_f32 v136, v107, v107
    v_mul_f32 v136, 0x3d372713, v136
    v_add_f32 v136, 1.0, v136
    v_mul_f32 v136, v136, v107
    v_mul_f32 v136, 0xc0135761, v136
    v_exp_f32 v136, v136
    s_nop 0
    v_add_f32 v136, 1.0, v136
    v_rcp_f32 v136, v136
    s_nop 0
    v_mul_f32 v107, v107, v136
    v_accvgpr_read_b32 v108, a78
    v_cvt_pk_bf16_f32 v108, v108, v108
    v_lshlrev_b32 v108, 16, v108
    v_add_f32 v108, v108, v134
    v_cvt_pk_bf16_f32 v108, v108, v108
    v_lshlrev_b32 v108, 16, v108
    v_mul_f32 v136, v108, v108
    v_mul_f32 v136, 0x3d372713, v136
    v_add_f32 v136, 1.0, v136
    v_mul_f32 v136, v136, v108
    v_mul_f32 v136, 0xc0135761, v136
    v_exp_f32 v136, v136
    s_nop 0
    v_add_f32 v136, 1.0, v136
    v_rcp_f32 v136, v136
    s_nop 0
    v_mul_f32 v108, v108, v136
    v_accvgpr_read_b32 v109, a79
    v_cvt_pk_bf16_f32 v109, v109, v109
    v_lshlrev_b32 v109, 16, v109
    v_add_f32 v109, v109, v135
    v_cvt_pk_bf16_f32 v109, v109, v109
    v_lshlrev_b32 v109, 16, v109
    v_mul_f32 v136, v109, v109
    v_mul_f32 v136, 0x3d372713, v136
    v_add_f32 v136, 1.0, v136
    v_mul_f32 v136, v136, v109
    v_mul_f32 v136, 0xc0135761, v136
    v_exp_f32 v136, v136
    s_nop 0
    v_add_f32 v136, 1.0, v136
    v_rcp_f32 v136, v136
    s_nop 0
    v_mul_f32 v109, v109, v136
    v_cvt_pk_bf16_f32 v110, v106, v107
    v_cvt_pk_bf16_f32 v111, v108, v109
    buffer_store_dwordx2 v[110:111], v104, s[8:11], 0 offen offset:96 sc1
    s_nop 1
    v_add_u32 v104, 57344, v104
    v_accvgpr_read_b32 v106, a80
    v_cvt_pk_bf16_f32 v106, v106, v106
    v_lshlrev_b32 v106, 16, v106
    v_add_f32 v106, v106, v120
    v_cvt_pk_bf16_f32 v106, v106, v106
    v_lshlrev_b32 v106, 16, v106
    v_mul_f32 v136, v106, v106
    v_mul_f32 v136, 0x3d372713, v136
    v_add_f32 v136, 1.0, v136
    v_mul_f32 v136, v136, v106
    v_mul_f32 v136, 0xc0135761, v136
    v_exp_f32 v136, v136
    s_nop 0
    v_add_f32 v136, 1.0, v136
    v_rcp_f32 v136, v136
    s_nop 0
    v_mul_f32 v106, v106, v136
    v_accvgpr_read_b32 v107, a81
    v_cvt_pk_bf16_f32 v107, v107, v107
    v_lshlrev_b32 v107, 16, v107
    v_add_f32 v107, v107, v121
    v_cvt_pk_bf16_f32 v107, v107, v107
    v_lshlrev_b32 v107, 16, v107
    v_mul_f32 v136, v107, v107
    v_mul_f32 v136, 0x3d372713, v136
    v_add_f32 v136, 1.0, v136
    v_mul_f32 v136, v136, v107
    v_mul_f32 v136, 0xc0135761, v136
    v_exp_f32 v136, v136
    s_nop 0
    v_add_f32 v136, 1.0, v136
    v_rcp_f32 v136, v136
    s_nop 0
    v_mul_f32 v107, v107, v136
    v_accvgpr_read_b32 v108, a82
    v_cvt_pk_bf16_f32 v108, v108, v108
    v_lshlrev_b32 v108, 16, v108
    v_add_f32 v108, v108, v122
    v_cvt_pk_bf16_f32 v108, v108, v108
    v_lshlrev_b32 v108, 16, v108
    v_mul_f32 v136, v108, v108
    v_mul_f32 v136, 0x3d372713, v136
    v_add_f32 v136, 1.0, v136
    v_mul_f32 v136, v136, v108
    v_mul_f32 v136, 0xc0135761, v136
    v_exp_f32 v136, v136
    s_nop 0
    v_add_f32 v136, 1.0, v136
    v_rcp_f32 v136, v136
    s_nop 0
    v_mul_f32 v108, v108, v136
    v_accvgpr_read_b32 v109, a83
    v_cvt_pk_bf16_f32 v109, v109, v109
    v_lshlrev_b32 v109, 16, v109
    v_add_f32 v109, v109, v123
    v_cvt_pk_bf16_f32 v109, v109, v109
    v_lshlrev_b32 v109, 16, v109
    v_mul_f32 v136, v109, v109
    v_mul_f32 v136, 0x3d372713, v136
    v_add_f32 v136, 1.0, v136
    v_mul_f32 v136, v136, v109
    v_mul_f32 v136, 0xc0135761, v136
    v_exp_f32 v136, v136
    s_nop 0
    v_add_f32 v136, 1.0, v136
    v_rcp_f32 v136, v136
    s_nop 0
    v_mul_f32 v109, v109, v136
    v_cvt_pk_bf16_f32 v110, v106, v107
    v_cvt_pk_bf16_f32 v111, v108, v109
    buffer_store_dwordx2 v[110:111], v104, s[8:11], 0 offen offset:0 sc1
    s_nop 1
    v_accvgpr_read_b32 v106, a84
    v_cvt_pk_bf16_f32 v106, v106, v106
    v_lshlrev_b32 v106, 16, v106
    v_add_f32 v106, v106, v124
    v_cvt_pk_bf16_f32 v106, v106, v106
    v_lshlrev_b32 v106, 16, v106
    v_mul_f32 v136, v106, v106
    v_mul_f32 v136, 0x3d372713, v136
    v_add_f32 v136, 1.0, v136
    v_mul_f32 v136, v136, v106
    v_mul_f32 v136, 0xc0135761, v136
    v_exp_f32 v136, v136
    s_nop 0
    v_add_f32 v136, 1.0, v136
    v_rcp_f32 v136, v136
    s_nop 0
    v_mul_f32 v106, v106, v136
    v_accvgpr_read_b32 v107, a85
    v_cvt_pk_bf16_f32 v107, v107, v107
    v_lshlrev_b32 v107, 16, v107
    v_add_f32 v107, v107, v125
    v_cvt_pk_bf16_f32 v107, v107, v107
    v_lshlrev_b32 v107, 16, v107
    v_mul_f32 v136, v107, v107
    v_mul_f32 v136, 0x3d372713, v136
    v_add_f32 v136, 1.0, v136
    v_mul_f32 v136, v136, v107
    v_mul_f32 v136, 0xc0135761, v136
    v_exp_f32 v136, v136
    s_nop 0
    v_add_f32 v136, 1.0, v136
    v_rcp_f32 v136, v136
    s_nop 0
    v_mul_f32 v107, v107, v136
    v_accvgpr_read_b32 v108, a86
    v_cvt_pk_bf16_f32 v108, v108, v108
    v_lshlrev_b32 v108, 16, v108
    v_add_f32 v108, v108, v126
    v_cvt_pk_bf16_f32 v108, v108, v108
    v_lshlrev_b32 v108, 16, v108
    v_mul_f32 v136, v108, v108
    v_mul_f32 v136, 0x3d372713, v136
    v_add_f32 v136, 1.0, v136
    v_mul_f32 v136, v136, v108
    v_mul_f32 v136, 0xc0135761, v136
    v_exp_f32 v136, v136
    s_nop 0
    v_add_f32 v136, 1.0, v136
    v_rcp_f32 v136, v136
    s_nop 0
    v_mul_f32 v108, v108, v136
    v_accvgpr_read_b32 v109, a87
    v_cvt_pk_bf16_f32 v109, v109, v109
    v_lshlrev_b32 v109, 16, v109
    v_add_f32 v109, v109, v127
    v_cvt_pk_bf16_f32 v109, v109, v109
    v_lshlrev_b32 v109, 16, v109
    v_mul_f32 v136, v109, v109
    v_mul_f32 v136, 0x3d372713, v136
    v_add_f32 v136, 1.0, v136
    v_mul_f32 v136, v136, v109
    v_mul_f32 v136, 0xc0135761, v136
    v_exp_f32 v136, v136
    s_nop 0
    v_add_f32 v136, 1.0, v136
    v_rcp_f32 v136, v136
    s_nop 0
    v_mul_f32 v109, v109, v136
    v_cvt_pk_bf16_f32 v110, v106, v107
    v_cvt_pk_bf16_f32 v111, v108, v109
    buffer_store_dwordx2 v[110:111], v104, s[8:11], 0 offen offset:32 sc1
    s_nop 1
    v_accvgpr_read_b32 v106, a88
    v_cvt_pk_bf16_f32 v106, v106, v106
    v_lshlrev_b32 v106, 16, v106
    v_add_f32 v106, v106, v128
    v_cvt_pk_bf16_f32 v106, v106, v106
    v_lshlrev_b32 v106, 16, v106
    v_mul_f32 v136, v106, v106
    v_mul_f32 v136, 0x3d372713, v136
    v_add_f32 v136, 1.0, v136
    v_mul_f32 v136, v136, v106
    v_mul_f32 v136, 0xc0135761, v136
    v_exp_f32 v136, v136
    s_nop 0
    v_add_f32 v136, 1.0, v136
    v_rcp_f32 v136, v136
    s_nop 0
    v_mul_f32 v106, v106, v136
    v_accvgpr_read_b32 v107, a89
    v_cvt_pk_bf16_f32 v107, v107, v107
    v_lshlrev_b32 v107, 16, v107
    v_add_f32 v107, v107, v129
    v_cvt_pk_bf16_f32 v107, v107, v107
    v_lshlrev_b32 v107, 16, v107
    v_mul_f32 v136, v107, v107
    v_mul_f32 v136, 0x3d372713, v136
    v_add_f32 v136, 1.0, v136
    v_mul_f32 v136, v136, v107
    v_mul_f32 v136, 0xc0135761, v136
    v_exp_f32 v136, v136
    s_nop 0
    v_add_f32 v136, 1.0, v136
    v_rcp_f32 v136, v136
    s_nop 0
    v_mul_f32 v107, v107, v136
    v_accvgpr_read_b32 v108, a90
    v_cvt_pk_bf16_f32 v108, v108, v108
    v_lshlrev_b32 v108, 16, v108
    v_add_f32 v108, v108, v130
    v_cvt_pk_bf16_f32 v108, v108, v108
    v_lshlrev_b32 v108, 16, v108
    v_mul_f32 v136, v108, v108
    v_mul_f32 v136, 0x3d372713, v136
    v_add_f32 v136, 1.0, v136
    v_mul_f32 v136, v136, v108
    v_mul_f32 v136, 0xc0135761, v136
    v_exp_f32 v136, v136
    s_nop 0
    v_add_f32 v136, 1.0, v136
    v_rcp_f32 v136, v136
    s_nop 0
    v_mul_f32 v108, v108, v136
    v_accvgpr_read_b32 v109, a91
    v_cvt_pk_bf16_f32 v109, v109, v109
    v_lshlrev_b32 v109, 16, v109
    v_add_f32 v109, v109, v131
    v_cvt_pk_bf16_f32 v109, v109, v109
    v_lshlrev_b32 v109, 16, v109
    v_mul_f32 v136, v109, v109
    v_mul_f32 v136, 0x3d372713, v136
    v_add_f32 v136, 1.0, v136
    v_mul_f32 v136, v136, v109
    v_mul_f32 v136, 0xc0135761, v136
    v_exp_f32 v136, v136
    s_nop 0
    v_add_f32 v136, 1.0, v136
    v_rcp_f32 v136, v136
    s_nop 0
    v_mul_f32 v109, v109, v136
    v_cvt_pk_bf16_f32 v110, v106, v107
    v_cvt_pk_bf16_f32 v111, v108, v109
    buffer_store_dwordx2 v[110:111], v104, s[8:11], 0 offen offset:64 sc1
    s_nop 1
    v_accvgpr_read_b32 v106, a92
    v_cvt_pk_bf16_f32 v106, v106, v106
    v_lshlrev_b32 v106, 16, v106
    v_add_f32 v106, v106, v132
    v_cvt_pk_bf16_f32 v106, v106, v106
    v_lshlrev_b32 v106, 16, v106
    v_mul_f32 v136, v106, v106
    v_mul_f32 v136, 0x3d372713, v136
    v_add_f32 v136, 1.0, v136
    v_mul_f32 v136, v136, v106
    v_mul_f32 v136, 0xc0135761, v136
    v_exp_f32 v136, v136
    s_nop 0
    v_add_f32 v136, 1.0, v136
    v_rcp_f32 v136, v136
    s_nop 0
    v_mul_f32 v106, v106, v136
    v_accvgpr_read_b32 v107, a93
    v_cvt_pk_bf16_f32 v107, v107, v107
    v_lshlrev_b32 v107, 16, v107
    v_add_f32 v107, v107, v133
    v_cvt_pk_bf16_f32 v107, v107, v107
    v_lshlrev_b32 v107, 16, v107
    v_mul_f32 v136, v107, v107
    v_mul_f32 v136, 0x3d372713, v136
    v_add_f32 v136, 1.0, v136
    v_mul_f32 v136, v136, v107
    v_mul_f32 v136, 0xc0135761, v136
    v_exp_f32 v136, v136
    s_nop 0
    v_add_f32 v136, 1.0, v136
    v_rcp_f32 v136, v136
    s_nop 0
    v_mul_f32 v107, v107, v136
    v_accvgpr_read_b32 v108, a94
    v_cvt_pk_bf16_f32 v108, v108, v108
    v_lshlrev_b32 v108, 16, v108
    v_add_f32 v108, v108, v134
    v_cvt_pk_bf16_f32 v108, v108, v108
    v_lshlrev_b32 v108, 16, v108
    v_mul_f32 v136, v108, v108
    v_mul_f32 v136, 0x3d372713, v136
    v_add_f32 v136, 1.0, v136
    v_mul_f32 v136, v136, v108
    v_mul_f32 v136, 0xc0135761, v136
    v_exp_f32 v136, v136
    s_nop 0
    v_add_f32 v136, 1.0, v136
    v_rcp_f32 v136, v136
    s_nop 0
    v_mul_f32 v108, v108, v136
    v_accvgpr_read_b32 v109, a95
    v_cvt_pk_bf16_f32 v109, v109, v109
    v_lshlrev_b32 v109, 16, v109
    v_add_f32 v109, v109, v135
    v_cvt_pk_bf16_f32 v109, v109, v109
    v_lshlrev_b32 v109, 16, v109
    v_mul_f32 v136, v109, v109
    v_mul_f32 v136, 0x3d372713, v136
    v_add_f32 v136, 1.0, v136
    v_mul_f32 v136, v136, v109
    v_mul_f32 v136, 0xc0135761, v136
    v_exp_f32 v136, v136
    s_nop 0
    v_add_f32 v136, 1.0, v136
    v_rcp_f32 v136, v136
    s_nop 0
    v_mul_f32 v109, v109, v136
    v_cvt_pk_bf16_f32 v110, v106, v107
    v_cvt_pk_bf16_f32 v111, v108, v109
    buffer_store_dwordx2 v[110:111], v104, s[8:11], 0 offen offset:96 sc1
    s_nop 1
    v_add_u32 v104, 57344, v104
    v_accvgpr_read_b32 v106, a96
    v_cvt_pk_bf16_f32 v106, v106, v106
    v_lshlrev_b32 v106, 16, v106
    v_add_f32 v106, v106, v120
    v_cvt_pk_bf16_f32 v106, v106, v106
    v_lshlrev_b32 v106, 16, v106
    v_mul_f32 v136, v106, v106
    v_mul_f32 v136, 0x3d372713, v136
    v_add_f32 v136, 1.0, v136
    v_mul_f32 v136, v136, v106
    v_mul_f32 v136, 0xc0135761, v136
    v_exp_f32 v136, v136
    s_nop 0
    v_add_f32 v136, 1.0, v136
    v_rcp_f32 v136, v136
    s_nop 0
    v_mul_f32 v106, v106, v136
    v_accvgpr_read_b32 v107, a97
    v_cvt_pk_bf16_f32 v107, v107, v107
    v_lshlrev_b32 v107, 16, v107
    v_add_f32 v107, v107, v121
    v_cvt_pk_bf16_f32 v107, v107, v107
    v_lshlrev_b32 v107, 16, v107
    v_mul_f32 v136, v107, v107
    v_mul_f32 v136, 0x3d372713, v136
    v_add_f32 v136, 1.0, v136
    v_mul_f32 v136, v136, v107
    v_mul_f32 v136, 0xc0135761, v136
    v_exp_f32 v136, v136
    s_nop 0
    v_add_f32 v136, 1.0, v136
    v_rcp_f32 v136, v136
    s_nop 0
    v_mul_f32 v107, v107, v136
    v_accvgpr_read_b32 v108, a98
    v_cvt_pk_bf16_f32 v108, v108, v108
    v_lshlrev_b32 v108, 16, v108
    v_add_f32 v108, v108, v122
    v_cvt_pk_bf16_f32 v108, v108, v108
    v_lshlrev_b32 v108, 16, v108
    v_mul_f32 v136, v108, v108
    v_mul_f32 v136, 0x3d372713, v136
    v_add_f32 v136, 1.0, v136
    v_mul_f32 v136, v136, v108
    v_mul_f32 v136, 0xc0135761, v136
    v_exp_f32 v136, v136
    s_nop 0
    v_add_f32 v136, 1.0, v136
    v_rcp_f32 v136, v136
    s_nop 0
    v_mul_f32 v108, v108, v136
    v_accvgpr_read_b32 v109, a99
    v_cvt_pk_bf16_f32 v109, v109, v109
    v_lshlrev_b32 v109, 16, v109
    v_add_f32 v109, v109, v123
    v_cvt_pk_bf16_f32 v109, v109, v109
    v_lshlrev_b32 v109, 16, v109
    v_mul_f32 v136, v109, v109
    v_mul_f32 v136, 0x3d372713, v136
    v_add_f32 v136, 1.0, v136
    v_mul_f32 v136, v136, v109
    v_mul_f32 v136, 0xc0135761, v136
    v_exp_f32 v136, v136
    s_nop 0
    v_add_f32 v136, 1.0, v136
    v_rcp_f32 v136, v136
    s_nop 0
    v_mul_f32 v109, v109, v136
    v_cvt_pk_bf16_f32 v110, v106, v107
    v_cvt_pk_bf16_f32 v111, v108, v109
    buffer_store_dwordx2 v[110:111], v104, s[8:11], 0 offen offset:0 sc1
    s_nop 1
    v_accvgpr_read_b32 v106, a100
    v_cvt_pk_bf16_f32 v106, v106, v106
    v_lshlrev_b32 v106, 16, v106
    v_add_f32 v106, v106, v124
    v_cvt_pk_bf16_f32 v106, v106, v106
    v_lshlrev_b32 v106, 16, v106
    v_mul_f32 v136, v106, v106
    v_mul_f32 v136, 0x3d372713, v136
    v_add_f32 v136, 1.0, v136
    v_mul_f32 v136, v136, v106
    v_mul_f32 v136, 0xc0135761, v136
    v_exp_f32 v136, v136
    s_nop 0
    v_add_f32 v136, 1.0, v136
    v_rcp_f32 v136, v136
    s_nop 0
    v_mul_f32 v106, v106, v136
    v_accvgpr_read_b32 v107, a101
    v_cvt_pk_bf16_f32 v107, v107, v107
    v_lshlrev_b32 v107, 16, v107
    v_add_f32 v107, v107, v125
    v_cvt_pk_bf16_f32 v107, v107, v107
    v_lshlrev_b32 v107, 16, v107
    v_mul_f32 v136, v107, v107
    v_mul_f32 v136, 0x3d372713, v136
    v_add_f32 v136, 1.0, v136
    v_mul_f32 v136, v136, v107
    v_mul_f32 v136, 0xc0135761, v136
    v_exp_f32 v136, v136
    s_nop 0
    v_add_f32 v136, 1.0, v136
    v_rcp_f32 v136, v136
    s_nop 0
    v_mul_f32 v107, v107, v136
    v_accvgpr_read_b32 v108, a102
    v_cvt_pk_bf16_f32 v108, v108, v108
    v_lshlrev_b32 v108, 16, v108
    v_add_f32 v108, v108, v126
    v_cvt_pk_bf16_f32 v108, v108, v108
    v_lshlrev_b32 v108, 16, v108
    v_mul_f32 v136, v108, v108
    v_mul_f32 v136, 0x3d372713, v136
    v_add_f32 v136, 1.0, v136
    v_mul_f32 v136, v136, v108
    v_mul_f32 v136, 0xc0135761, v136
    v_exp_f32 v136, v136
    s_nop 0
    v_add_f32 v136, 1.0, v136
    v_rcp_f32 v136, v136
    s_nop 0
    v_mul_f32 v108, v108, v136
    v_accvgpr_read_b32 v109, a103
    v_cvt_pk_bf16_f32 v109, v109, v109
    v_lshlrev_b32 v109, 16, v109
    v_add_f32 v109, v109, v127
    v_cvt_pk_bf16_f32 v109, v109, v109
    v_lshlrev_b32 v109, 16, v109
    v_mul_f32 v136, v109, v109
    v_mul_f32 v136, 0x3d372713, v136
    v_add_f32 v136, 1.0, v136
    v_mul_f32 v136, v136, v109
    v_mul_f32 v136, 0xc0135761, v136
    v_exp_f32 v136, v136
    s_nop 0
    v_add_f32 v136, 1.0, v136
    v_rcp_f32 v136, v136
    s_nop 0
    v_mul_f32 v109, v109, v136
    v_cvt_pk_bf16_f32 v110, v106, v107
    v_cvt_pk_bf16_f32 v111, v108, v109
    buffer_store_dwordx2 v[110:111], v104, s[8:11], 0 offen offset:32 sc1
    s_nop 1
    v_accvgpr_read_b32 v106, a104
    v_cvt_pk_bf16_f32 v106, v106, v106
    v_lshlrev_b32 v106, 16, v106
    v_add_f32 v106, v106, v128
    v_cvt_pk_bf16_f32 v106, v106, v106
    v_lshlrev_b32 v106, 16, v106
    v_mul_f32 v136, v106, v106
    v_mul_f32 v136, 0x3d372713, v136
    v_add_f32 v136, 1.0, v136
    v_mul_f32 v136, v136, v106
    v_mul_f32 v136, 0xc0135761, v136
    v_exp_f32 v136, v136
    s_nop 0
    v_add_f32 v136, 1.0, v136
    v_rcp_f32 v136, v136
    s_nop 0
    v_mul_f32 v106, v106, v136
    v_accvgpr_read_b32 v107, a105
    v_cvt_pk_bf16_f32 v107, v107, v107
    v_lshlrev_b32 v107, 16, v107
    v_add_f32 v107, v107, v129
    v_cvt_pk_bf16_f32 v107, v107, v107
    v_lshlrev_b32 v107, 16, v107
    v_mul_f32 v136, v107, v107
    v_mul_f32 v136, 0x3d372713, v136
    v_add_f32 v136, 1.0, v136
    v_mul_f32 v136, v136, v107
    v_mul_f32 v136, 0xc0135761, v136
    v_exp_f32 v136, v136
    s_nop 0
    v_add_f32 v136, 1.0, v136
    v_rcp_f32 v136, v136
    s_nop 0
    v_mul_f32 v107, v107, v136
    v_accvgpr_read_b32 v108, a106
    v_cvt_pk_bf16_f32 v108, v108, v108
    v_lshlrev_b32 v108, 16, v108
    v_add_f32 v108, v108, v130
    v_cvt_pk_bf16_f32 v108, v108, v108
    v_lshlrev_b32 v108, 16, v108
    v_mul_f32 v136, v108, v108
    v_mul_f32 v136, 0x3d372713, v136
    v_add_f32 v136, 1.0, v136
    v_mul_f32 v136, v136, v108
    v_mul_f32 v136, 0xc0135761, v136
    v_exp_f32 v136, v136
    s_nop 0
    v_add_f32 v136, 1.0, v136
    v_rcp_f32 v136, v136
    s_nop 0
    v_mul_f32 v108, v108, v136
    v_accvgpr_read_b32 v109, a107
    v_cvt_pk_bf16_f32 v109, v109, v109
    v_lshlrev_b32 v109, 16, v109
    v_add_f32 v109, v109, v131
    v_cvt_pk_bf16_f32 v109, v109, v109
    v_lshlrev_b32 v109, 16, v109
    v_mul_f32 v136, v109, v109
    v_mul_f32 v136, 0x3d372713, v136
    v_add_f32 v136, 1.0, v136
    v_mul_f32 v136, v136, v109
    v_mul_f32 v136, 0xc0135761, v136
    v_exp_f32 v136, v136
    s_nop 0
    v_add_f32 v136, 1.0, v136
    v_rcp_f32 v136, v136
    s_nop 0
    v_mul_f32 v109, v109, v136
    v_cvt_pk_bf16_f32 v110, v106, v107
    v_cvt_pk_bf16_f32 v111, v108, v109
    buffer_store_dwordx2 v[110:111], v104, s[8:11], 0 offen offset:64 sc1
    s_nop 1
    v_accvgpr_read_b32 v106, a108
    v_cvt_pk_bf16_f32 v106, v106, v106
    v_lshlrev_b32 v106, 16, v106
    v_add_f32 v106, v106, v132
    v_cvt_pk_bf16_f32 v106, v106, v106
    v_lshlrev_b32 v106, 16, v106
    v_mul_f32 v136, v106, v106
    v_mul_f32 v136, 0x3d372713, v136
    v_add_f32 v136, 1.0, v136
    v_mul_f32 v136, v136, v106
    v_mul_f32 v136, 0xc0135761, v136
    v_exp_f32 v136, v136
    s_nop 0
    v_add_f32 v136, 1.0, v136
    v_rcp_f32 v136, v136
    s_nop 0
    v_mul_f32 v106, v106, v136
    v_accvgpr_read_b32 v107, a109
    v_cvt_pk_bf16_f32 v107, v107, v107
    v_lshlrev_b32 v107, 16, v107
    v_add_f32 v107, v107, v133
    v_cvt_pk_bf16_f32 v107, v107, v107
    v_lshlrev_b32 v107, 16, v107
    v_mul_f32 v136, v107, v107
    v_mul_f32 v136, 0x3d372713, v136
    v_add_f32 v136, 1.0, v136
    v_mul_f32 v136, v136, v107
    v_mul_f32 v136, 0xc0135761, v136
    v_exp_f32 v136, v136
    s_nop 0
    v_add_f32 v136, 1.0, v136
    v_rcp_f32 v136, v136
    s_nop 0
    v_mul_f32 v107, v107, v136
    v_accvgpr_read_b32 v108, a110
    v_cvt_pk_bf16_f32 v108, v108, v108
    v_lshlrev_b32 v108, 16, v108
    v_add_f32 v108, v108, v134
    v_cvt_pk_bf16_f32 v108, v108, v108
    v_lshlrev_b32 v108, 16, v108
    v_mul_f32 v136, v108, v108
    v_mul_f32 v136, 0x3d372713, v136
    v_add_f32 v136, 1.0, v136
    v_mul_f32 v136, v136, v108
    v_mul_f32 v136, 0xc0135761, v136
    v_exp_f32 v136, v136
    s_nop 0
    v_add_f32 v136, 1.0, v136
    v_rcp_f32 v136, v136
    s_nop 0
    v_mul_f32 v108, v108, v136
    v_accvgpr_read_b32 v109, a111
    v_cvt_pk_bf16_f32 v109, v109, v109
    v_lshlrev_b32 v109, 16, v109
    v_add_f32 v109, v109, v135
    v_cvt_pk_bf16_f32 v109, v109, v109
    v_lshlrev_b32 v109, 16, v109
    v_mul_f32 v136, v109, v109
    v_mul_f32 v136, 0x3d372713, v136
    v_add_f32 v136, 1.0, v136
    v_mul_f32 v136, v136, v109
    v_mul_f32 v136, 0xc0135761, v136
    v_exp_f32 v136, v136
    s_nop 0
    v_add_f32 v136, 1.0, v136
    v_rcp_f32 v136, v136
    s_nop 0
    v_mul_f32 v109, v109, v136
    v_cvt_pk_bf16_f32 v110, v106, v107
    v_cvt_pk_bf16_f32 v111, v108, v109
    buffer_store_dwordx2 v[110:111], v104, s[8:11], 0 offen offset:96 sc1
    s_nop 1
    v_add_u32 v104, 57344, v104
    v_accvgpr_read_b32 v106, a112
    v_cvt_pk_bf16_f32 v106, v106, v106
    v_lshlrev_b32 v106, 16, v106
    v_add_f32 v106, v106, v120
    v_cvt_pk_bf16_f32 v106, v106, v106
    v_lshlrev_b32 v106, 16, v106
    v_mul_f32 v136, v106, v106
    v_mul_f32 v136, 0x3d372713, v136
    v_add_f32 v136, 1.0, v136
    v_mul_f32 v136, v136, v106
    v_mul_f32 v136, 0xc0135761, v136
    v_exp_f32 v136, v136
    s_nop 0
    v_add_f32 v136, 1.0, v136
    v_rcp_f32 v136, v136
    s_nop 0
    v_mul_f32 v106, v106, v136
    v_accvgpr_read_b32 v107, a113
    v_cvt_pk_bf16_f32 v107, v107, v107
    v_lshlrev_b32 v107, 16, v107
    v_add_f32 v107, v107, v121
    v_cvt_pk_bf16_f32 v107, v107, v107
    v_lshlrev_b32 v107, 16, v107
    v_mul_f32 v136, v107, v107
    v_mul_f32 v136, 0x3d372713, v136
    v_add_f32 v136, 1.0, v136
    v_mul_f32 v136, v136, v107
    v_mul_f32 v136, 0xc0135761, v136
    v_exp_f32 v136, v136
    s_nop 0
    v_add_f32 v136, 1.0, v136
    v_rcp_f32 v136, v136
    s_nop 0
    v_mul_f32 v107, v107, v136
    v_accvgpr_read_b32 v108, a114
    v_cvt_pk_bf16_f32 v108, v108, v108
    v_lshlrev_b32 v108, 16, v108
    v_add_f32 v108, v108, v122
    v_cvt_pk_bf16_f32 v108, v108, v108
    v_lshlrev_b32 v108, 16, v108
    v_mul_f32 v136, v108, v108
    v_mul_f32 v136, 0x3d372713, v136
    v_add_f32 v136, 1.0, v136
    v_mul_f32 v136, v136, v108
    v_mul_f32 v136, 0xc0135761, v136
    v_exp_f32 v136, v136
    s_nop 0
    v_add_f32 v136, 1.0, v136
    v_rcp_f32 v136, v136
    s_nop 0
    v_mul_f32 v108, v108, v136
    v_accvgpr_read_b32 v109, a115
    v_cvt_pk_bf16_f32 v109, v109, v109
    v_lshlrev_b32 v109, 16, v109
    v_add_f32 v109, v109, v123
    v_cvt_pk_bf16_f32 v109, v109, v109
    v_lshlrev_b32 v109, 16, v109
    v_mul_f32 v136, v109, v109
    v_mul_f32 v136, 0x3d372713, v136
    v_add_f32 v136, 1.0, v136
    v_mul_f32 v136, v136, v109
    v_mul_f32 v136, 0xc0135761, v136
    v_exp_f32 v136, v136
    s_nop 0
    v_add_f32 v136, 1.0, v136
    v_rcp_f32 v136, v136
    s_nop 0
    v_mul_f32 v109, v109, v136
    v_cvt_pk_bf16_f32 v110, v106, v107
    v_cvt_pk_bf16_f32 v111, v108, v109
    buffer_store_dwordx2 v[110:111], v104, s[8:11], 0 offen offset:0 sc1
    s_nop 1
    v_accvgpr_read_b32 v106, a116
    v_cvt_pk_bf16_f32 v106, v106, v106
    v_lshlrev_b32 v106, 16, v106
    v_add_f32 v106, v106, v124
    v_cvt_pk_bf16_f32 v106, v106, v106
    v_lshlrev_b32 v106, 16, v106
    v_mul_f32 v136, v106, v106
    v_mul_f32 v136, 0x3d372713, v136
    v_add_f32 v136, 1.0, v136
    v_mul_f32 v136, v136, v106
    v_mul_f32 v136, 0xc0135761, v136
    v_exp_f32 v136, v136
    s_nop 0
    v_add_f32 v136, 1.0, v136
    v_rcp_f32 v136, v136
    s_nop 0
    v_mul_f32 v106, v106, v136
    v_accvgpr_read_b32 v107, a117
    v_cvt_pk_bf16_f32 v107, v107, v107
    v_lshlrev_b32 v107, 16, v107
    v_add_f32 v107, v107, v125
    v_cvt_pk_bf16_f32 v107, v107, v107
    v_lshlrev_b32 v107, 16, v107
    v_mul_f32 v136, v107, v107
    v_mul_f32 v136, 0x3d372713, v136
    v_add_f32 v136, 1.0, v136
    v_mul_f32 v136, v136, v107
    v_mul_f32 v136, 0xc0135761, v136
    v_exp_f32 v136, v136
    s_nop 0
    v_add_f32 v136, 1.0, v136
    v_rcp_f32 v136, v136
    s_nop 0
    v_mul_f32 v107, v107, v136
    v_accvgpr_read_b32 v108, a118
    v_cvt_pk_bf16_f32 v108, v108, v108
    v_lshlrev_b32 v108, 16, v108
    v_add_f32 v108, v108, v126
    v_cvt_pk_bf16_f32 v108, v108, v108
    v_lshlrev_b32 v108, 16, v108
    v_mul_f32 v136, v108, v108
    v_mul_f32 v136, 0x3d372713, v136
    v_add_f32 v136, 1.0, v136
    v_mul_f32 v136, v136, v108
    v_mul_f32 v136, 0xc0135761, v136
    v_exp_f32 v136, v136
    s_nop 0
    v_add_f32 v136, 1.0, v136
    v_rcp_f32 v136, v136
    s_nop 0
    v_mul_f32 v108, v108, v136
    v_accvgpr_read_b32 v109, a119
    v_cvt_pk_bf16_f32 v109, v109, v109
    v_lshlrev_b32 v109, 16, v109
    v_add_f32 v109, v109, v127
    v_cvt_pk_bf16_f32 v109, v109, v109
    v_lshlrev_b32 v109, 16, v109
    v_mul_f32 v136, v109, v109
    v_mul_f32 v136, 0x3d372713, v136
    v_add_f32 v136, 1.0, v136
    v_mul_f32 v136, v136, v109
    v_mul_f32 v136, 0xc0135761, v136
    v_exp_f32 v136, v136
    s_nop 0
    v_add_f32 v136, 1.0, v136
    v_rcp_f32 v136, v136
    s_nop 0
    v_mul_f32 v109, v109, v136
    v_cvt_pk_bf16_f32 v110, v106, v107
    v_cvt_pk_bf16_f32 v111, v108, v109
    buffer_store_dwordx2 v[110:111], v104, s[8:11], 0 offen offset:32 sc1
    s_nop 1
    v_accvgpr_read_b32 v106, a120
    v_cvt_pk_bf16_f32 v106, v106, v106
    v_lshlrev_b32 v106, 16, v106
    v_add_f32 v106, v106, v128
    v_cvt_pk_bf16_f32 v106, v106, v106
    v_lshlrev_b32 v106, 16, v106
    v_mul_f32 v136, v106, v106
    v_mul_f32 v136, 0x3d372713, v136
    v_add_f32 v136, 1.0, v136
    v_mul_f32 v136, v136, v106
    v_mul_f32 v136, 0xc0135761, v136
    v_exp_f32 v136, v136
    s_nop 0
    v_add_f32 v136, 1.0, v136
    v_rcp_f32 v136, v136
    s_nop 0
    v_mul_f32 v106, v106, v136
    v_accvgpr_read_b32 v107, a121
    v_cvt_pk_bf16_f32 v107, v107, v107
    v_lshlrev_b32 v107, 16, v107
    v_add_f32 v107, v107, v129
    v_cvt_pk_bf16_f32 v107, v107, v107
    v_lshlrev_b32 v107, 16, v107
    v_mul_f32 v136, v107, v107
    v_mul_f32 v136, 0x3d372713, v136
    v_add_f32 v136, 1.0, v136
    v_mul_f32 v136, v136, v107
    v_mul_f32 v136, 0xc0135761, v136
    v_exp_f32 v136, v136
    s_nop 0
    v_add_f32 v136, 1.0, v136
    v_rcp_f32 v136, v136
    s_nop 0
    v_mul_f32 v107, v107, v136
    v_accvgpr_read_b32 v108, a122
    v_cvt_pk_bf16_f32 v108, v108, v108
    v_lshlrev_b32 v108, 16, v108
    v_add_f32 v108, v108, v130
    v_cvt_pk_bf16_f32 v108, v108, v108
    v_lshlrev_b32 v108, 16, v108
    v_mul_f32 v136, v108, v108
    v_mul_f32 v136, 0x3d372713, v136
    v_add_f32 v136, 1.0, v136
    v_mul_f32 v136, v136, v108
    v_mul_f32 v136, 0xc0135761, v136
    v_exp_f32 v136, v136
    s_nop 0
    v_add_f32 v136, 1.0, v136
    v_rcp_f32 v136, v136
    s_nop 0
    v_mul_f32 v108, v108, v136
    v_accvgpr_read_b32 v109, a123
    v_cvt_pk_bf16_f32 v109, v109, v109
    v_lshlrev_b32 v109, 16, v109
    v_add_f32 v109, v109, v131
    v_cvt_pk_bf16_f32 v109, v109, v109
    v_lshlrev_b32 v109, 16, v109
    v_mul_f32 v136, v109, v109
    v_mul_f32 v136, 0x3d372713, v136
    v_add_f32 v136, 1.0, v136
    v_mul_f32 v136, v136, v109
    v_mul_f32 v136, 0xc0135761, v136
    v_exp_f32 v136, v136
    s_nop 0
    v_add_f32 v136, 1.0, v136
    v_rcp_f32 v136, v136
    s_nop 0
    v_mul_f32 v109, v109, v136
    v_cvt_pk_bf16_f32 v110, v106, v107
    v_cvt_pk_bf16_f32 v111, v108, v109
    buffer_store_dwordx2 v[110:111], v104, s[8:11], 0 offen offset:64 sc1
    s_nop 1
    v_accvgpr_read_b32 v106, a124
    v_cvt_pk_bf16_f32 v106, v106, v106
    v_lshlrev_b32 v106, 16, v106
    v_add_f32 v106, v106, v132
    v_cvt_pk_bf16_f32 v106, v106, v106
    v_lshlrev_b32 v106, 16, v106
    v_mul_f32 v136, v106, v106
    v_mul_f32 v136, 0x3d372713, v136
    v_add_f32 v136, 1.0, v136
    v_mul_f32 v136, v136, v106
    v_mul_f32 v136, 0xc0135761, v136
    v_exp_f32 v136, v136
    s_nop 0
    v_add_f32 v136, 1.0, v136
    v_rcp_f32 v136, v136
    s_nop 0
    v_mul_f32 v106, v106, v136
    v_accvgpr_read_b32 v107, a125
    v_cvt_pk_bf16_f32 v107, v107, v107
    v_lshlrev_b32 v107, 16, v107
    v_add_f32 v107, v107, v133
    v_cvt_pk_bf16_f32 v107, v107, v107
    v_lshlrev_b32 v107, 16, v107
    v_mul_f32 v136, v107, v107
    v_mul_f32 v136, 0x3d372713, v136
    v_add_f32 v136, 1.0, v136
    v_mul_f32 v136, v136, v107
    v_mul_f32 v136, 0xc0135761, v136
    v_exp_f32 v136, v136
    s_nop 0
    v_add_f32 v136, 1.0, v136
    v_rcp_f32 v136, v136
    s_nop 0
    v_mul_f32 v107, v107, v136
    v_accvgpr_read_b32 v108, a126
    v_cvt_pk_bf16_f32 v108, v108, v108
    v_lshlrev_b32 v108, 16, v108
    v_add_f32 v108, v108, v134
    v_cvt_pk_bf16_f32 v108, v108, v108
    v_lshlrev_b32 v108, 16, v108
    v_mul_f32 v136, v108, v108
    v_mul_f32 v136, 0x3d372713, v136
    v_add_f32 v136, 1.0, v136
    v_mul_f32 v136, v136, v108
    v_mul_f32 v136, 0xc0135761, v136
    v_exp_f32 v136, v136
    s_nop 0
    v_add_f32 v136, 1.0, v136
    v_rcp_f32 v136, v136
    s_nop 0
    v_mul_f32 v108, v108, v136
    v_accvgpr_read_b32 v109, a127
    v_cvt_pk_bf16_f32 v109, v109, v109
    v_lshlrev_b32 v109, 16, v109
    v_add_f32 v109, v109, v135
    v_cvt_pk_bf16_f32 v109, v109, v109
    v_lshlrev_b32 v109, 16, v109
    v_mul_f32 v136, v109, v109
    v_mul_f32 v136, 0x3d372713, v136
    v_add_f32 v136, 1.0, v136
    v_mul_f32 v136, v136, v109
    v_mul_f32 v136, 0xc0135761, v136
    v_exp_f32 v136, v136
    s_nop 0
    v_add_f32 v136, 1.0, v136
    v_rcp_f32 v136, v136
    s_nop 0
    v_mul_f32 v109, v109, v136
    v_cvt_pk_bf16_f32 v110, v106, v107
    v_cvt_pk_bf16_f32 v111, v108, v109
    buffer_store_dwordx2 v[110:111], v104, s[8:11], 0 offen offset:96 sc1
    s_nop 1
    v_add_u32 v104, 57344, v104
    s_branch K3_next
K3_ns:
    buffer_load_dwordx4 v[8:11], v4, s[8:11], 0 offen offset:0
    buffer_load_dwordx4 v[12:15], v5, s[8:11], 0 offen offset:0
    buffer_load_dwordx4 v[16:19], v6, s[8:11], 0 offen offset:0
    buffer_load_dwordx4 v[20:23], v7, s[8:11], 0 offen offset:0
    ds_read_b128 v[40:43], v3 offset:0
    ds_read_b128 v[44:47], v3 offset:14592
    ds_read_b128 v[48:51], v3 offset:29184
    ds_read_b128 v[52:55], v3 offset:43776
    ds_read_b128 v[56:59], v137 offset:0
    ds_read_b128 v[60:63], v137 offset:14592
    ds_read_b128 v[64:67], v137 offset:29184
    ds_read_b128 v[68:71], v137 offset:43776
    buffer_load_dwordx4 v[24:27], v4, s[8:11], 0 offen offset:64
    buffer_load_dwordx4 v[28:31], v5, s[8:11], 0 offen offset:64
    buffer_load_dwordx4 v[32:35], v6, s[8:11], 0 offen offset:64
    buffer_load_dwordx4 v[36:39], v7, s[8:11], 0 offen offset:64
    ds_read_b128 v[72:75], v3 offset:64
    ds_read_b128 v[76:79], v3 offset:14656
    ds_read_b128 v[80:83], v3 offset:29248
    ds_read_b128 v[84:87], v3 offset:43840
    ds_read_b128 v[88:91], v137 offset:64
    ds_read_b128 v[92:95], v137 offset:14656
    ds_read_b128 v[96:99], v137 offset:29248
    ds_read_b128 v[100:103], v137 offset:43840
    s_waitcnt vmcnt(4) lgkmcnt(8)
    v_mfma_f32_16x16x32_bf16 a[0:3], v[40:43], v[8:11], a[0:3]
    v_mfma_f32_16x16x32_bf16 a[4:7], v[40:43], v[12:15], a[4:7]
    v_mfma_f32_16x16x32_bf16 a[8:11], v[40:43], v[16:19], a[8:11]
    v_mfma_f32_16x16x32_bf16 a[12:15], v[40:43], v[20:23], a[12:15]
    v_mfma_f32_16x16x32_bf16 a[16:19], v[44:47], v[8:11], a[16:19]
    v_mfma_f32_16x16x32_bf16 a[20:23], v[44:47], v[12:15], a[20:23]
    v_mfma_f32_16x16x32_bf16 a[24:27], v[44:47], v[16:19], a[24:27]
    v_mfma_f32_16x16x32_bf16 a[28:31], v[44:47], v[20:23], a[28:31]
    v_mfma_f32_16x16x32_bf16 a[32:35], v[48:51], v[8:11], a[32:35]
    v_mfma_f32_16x16x32_bf16 a[36:39], v[48:51], v[12:15], a[36:39]
    v_mfma_f32_16x16x32_bf16 a[40:43], v[48:51], v[16:19], a[40:43]
    v_mfma_f32_16x16x32_bf16 a[44:47], v[48:51], v[20:23], a[44:47]
    v_mfma_f32_16x16x32_bf16 a[48:51], v[52:55], v[8:11], a[48:51]
    v_mfma_f32_16x16x32_bf16 a[52:55], v[52:55], v[12:15], a[52:55]
    v_mfma_f32_16x16x32_bf16 a[56:59], v[52:55], v[16:19], a[56:59]
    v_mfma_f32_16x16x32_bf16 a[60:63], v[52:55], v[20:23], a[60:63]
    v_mfma_f32_16x16x32_bf16 a[64:67], v[56:59], v[8:11], a[64:67]
    v_mfma_f32_16x16x32_bf16 a[68:71], v[56:59], v[12:15], a[68:71]
    v_mfma_f32_16x16x32_bf16 a[72:75], v[56:59], v[16:19], a[72:75]
    v_mfma_f32_16x16x32_bf16 a[76:79], v[56:59], v[20:23], a[76:79]
    v_mfma_f32_16x16x32_bf16 a[80:83], v[60:63], v[8:11], a[80:83]
    v_mfma_f32_16x16x32_bf16 a[84:87], v[60:63], v[12:15], a[84:87]
    v_mfma_f32_16x16x32_bf16 a[88:91], v[60:63], v[16:19], a[88:91]
    v_mfma_f32_16x16x32_bf16 a[92:95], v[60:63], v[20:23], a[92:95]
    v_mfma_f32_16x16x32_bf16 a[96:99], v[64:67], v[8:11], a[96:99]
    v_mfma_f32_16x16x32_bf16 a[100:103], v[64:67], v[12:15], a[100:103]
    v_mfma_f32_16x16x32_bf16 a[104:107], v[64:67], v[16:19], a[104:107]
    v_mfma_f32_16x16x32_bf16 a[108:111], v[64:67], v[20:23], a[108:111]
    v_mfma_f32_16x16x32_bf16 a[112:115], v[68:71], v[8:11], a[112:115]
    v_mfma_f32_16x16x32_bf16 a[116:119], v[68:71], v[12:15], a[116:119]
    v_mfma_f32_16x16x32_bf16 a[120:123], v[68:71], v[16:19], a[120:123]
    v_mfma_f32_16x16x32_bf16 a[124:127], v[68:71], v[20:23], a[124:127]
    buffer_load_dwordx4 v[8:11], v4, s[8:11], 0 offen offset:128
    buffer_load_dwordx4 v[12:15], v5, s[8:11], 0 offen offset:128
    buffer_load_dwordx4 v[16:19], v6, s[8:11], 0 offen offset:128
    buffer_load_dwordx4 v[20:23], v7, s[8:11], 0 offen offset:128
    ds_read_b128 v[40:43], v3 offset:128
    ds_read_b128 v[44:47], v3 offset:14720
    ds_read_b128 v[48:51], v3 offset:29312
    ds_read_b128 v[52:55], v3 offset:43904
    ds_read_b128 v[56:59], v137 offset:128
    ds_read_b128 v[60:63], v137 offset:14720
    ds_read_b128 v[64:67], v137 offset:29312
    ds_read_b128 v[68:71], v137 offset:43904
    s_waitcnt vmcnt(4) lgkmcnt(8)
    v_mfma_f32_16x16x32_bf16 a[0:3], v[72:75], v[24:27], a[0:3]
    v_mfma_f32_16x16x32_bf16 a[4:7], v[72:75], v[28:31], a[4:7]
    v_mfma_f32_16x16x32_bf16 a[8:11], v[72:75], v[32:35], a[8:11]
    v_mfma_f32_16x16x32_bf16 a[12:15], v[72:75], v[36:39], a[12:15]
    v_mfma_f32_16x16x32_bf16 a[16:19], v[76:79], v[24:27], a[16:19]
    v_mfma_f32_16x16x32_bf16 a[20:23], v[76:79], v[28:31], a[20:23]
    v_mfma_f32_16x16x32_bf16 a[24:27], v[76:79], v[32:35], a[24:27]
    v_mfma_f32_16x16x32_bf16 a[28:31], v[76:79], v[36:39], a[28:31]
    v_mfma_f32_16x16x32_bf16 a[32:35], v[80:83], v[24:27], a[32:35]
    v_mfma_f32_16x16x32_bf16 a[36:39], v[80:83], v[28:31], a[36:39]
    v_mfma_f32_16x16x32_bf16 a[40:43], v[80:83], v[32:35], a[40:43]
    v_mfma_f32_16x16x32_bf16 a[44:47], v[80:83], v[36:39], a[44:47]
    v_mfma_f32_16x16x32_bf16 a[48:51], v[84:87], v[24:27], a[48:51]
    v_mfma_f32_16x16x32_bf16 a[52:55], v[84:87], v[28:31], a[52:55]
    v_mfma_f32_16x16x32_bf16 a[56:59], v[84:87], v[32:35], a[56:59]
    v_mfma_f32_16x16x32_bf16 a[60:63], v[84:87], v[36:39], a[60:63]
    v_mfma_f32_16x16x32_bf16 a[64:67], v[88:91], v[24:27], a[64:67]
    v_mfma_f32_16x16x32_bf16 a[68:71], v[88:91], v[28:31], a[68:71]
    v_mfma_f32_16x16x32_bf16 a[72:75], v[88:91], v[32:35], a[72:75]
    v_mfma_f32_16x16x32_bf16 a[76:79], v[88:91], v[36:39], a[76:79]
    v_mfma_f32_16x16x32_bf16 a[80:83], v[92:95], v[24:27], a[80:83]
    v_mfma_f32_16x16x32_bf16 a[84:87], v[92:95], v[28:31], a[84:87]
    v_mfma_f32_16x16x32_bf16 a[88:91], v[92:95], v[32:35], a[88:91]
    v_mfma_f32_16x16x32_bf16 a[92:95], v[92:95], v[36:39], a[92:95]
    v_mfma_f32_16x16x32_bf16 a[96:99], v[96:99], v[24:27], a[96:99]
    v_mfma_f32_16x16x32_bf16 a[100:103], v[96:99], v[28:31], a[100:103]
    v_mfma_f32_16x16x32_bf16 a[104:107], v[96:99], v[32:35], a[104:107]
    v_mfma_f32_16x16x32_bf16 a[108:111], v[96:99], v[36:39], a[108:111]
    v_mfma_f32_16x16x32_bf16 a[112:115], v[100:103], v[24:27], a[112:115]
    v_mfma_f32_16x16x32_bf16 a[116:119], v[100:103], v[28:31], a[116:119]
    v_mfma_f32_16x16x32_bf16 a[120:123], v[100:103], v[32:35], a[120:123]
    v_mfma_f32_16x16x32_bf16 a[124:127], v[100:103], v[36:39], a[124:127]
    buffer_load_dwordx4 v[24:27], v4, s[8:11], 0 offen offset:192
    buffer_load_dwordx4 v[28:31], v5, s[8:11], 0 offen offset:192
    buffer_load_dwordx4 v[32:35], v6, s[8:11], 0 offen offset:192
    buffer_load_dwordx4 v[36:39], v7, s[8:11], 0 offen offset:192
    ds_read_b128 v[72:75], v3 offset:192
    ds_read_b128 v[76:79], v3 offset:14784
    ds_read_b128 v[80:83], v3 offset:29376
    ds_read_b128 v[84:87], v3 offset:43968
    ds_read_b128 v[88:91], v137 offset:192
    ds_read_b128 v[92:95], v137 offset:14784
    ds_read_b128 v[96:99], v137 offset:29376
    ds_read_b128 v[100:103], v137 offset:43968
    s_waitcnt vmcnt(4) lgkmcnt(8)
    v_mfma_f32_16x16x32_bf16 a[0:3], v[40:43], v[8:11], a[0:3]
    v_mfma_f32_16x16x32_bf16 a[4:7], v[40:43], v[12:15], a[4:7]
    v_mfma_f32_16x16x32_bf16 a[8:11], v[40:43], v[16:19], a[8:11]
    v_mfma_f32_16x16x32_bf16 a[12:15], v[40:43], v[20:23], a[12:15]
    v_mfma_f32_16x16x32_bf16 a[16:19], v[44:47], v[8:11], a[16:19]
    v_mfma_f32_16x16x32_bf16 a[20:23], v[44:47], v[12:15], a[20:23]
    v_mfma_f32_16x16x32_bf16 a[24:27], v[44:47], v[16:19], a[24:27]
    v_mfma_f32_16x16x32_bf16 a[28:31], v[44:47], v[20:23], a[28:31]
    v_mfma_f32_16x16x32_bf16 a[32:35], v[48:51], v[8:11], a[32:35]
    v_mfma_f32_16x16x32_bf16 a[36:39], v[48:51], v[12:15], a[36:39]
    v_mfma_f32_16x16x32_bf16 a[40:43], v[48:51], v[16:19], a[40:43]
    v_mfma_f32_16x16x32_bf16 a[44:47], v[48:51], v[20:23], a[44:47]
    v_mfma_f32_16x16x32_bf16 a[48:51], v[52:55], v[8:11], a[48:51]
    v_mfma_f32_16x16x32_bf16 a[52:55], v[52:55], v[12:15], a[52:55]
    v_mfma_f32_16x16x32_bf16 a[56:59], v[52:55], v[16:19], a[56:59]
    v_mfma_f32_16x16x32_bf16 a[60:63], v[52:55], v[20:23], a[60:63]
    v_mfma_f32_16x16x32_bf16 a[64:67], v[56:59], v[8:11], a[64:67]
    v_mfma_f32_16x16x32_bf16 a[68:71], v[56:59], v[12:15], a[68:71]
    v_mfma_f32_16x16x32_bf16 a[72:75], v[56:59], v[16:19], a[72:75]
    v_mfma_f32_16x16x32_bf16 a[76:79], v[56:59], v[20:23], a[76:79]
    v_mfma_f32_16x16x32_bf16 a[80:83], v[60:63], v[8:11], a[80:83]
    v_mfma_f32_16x16x32_bf16 a[84:87], v[60:63], v[12:15], a[84:87]
    v_mfma_f32_16x16x32_bf16 a[88:91], v[60:63], v[16:19], a[88:91]
    v_mfma_f32_16x16x32_bf16 a[92:95], v[60:63], v[20:23], a[92:95]
    v_mfma_f32_16x16x32_bf16 a[96:99], v[64:67], v[8:11], a[96:99]
    v_mfma_f32_16x16x32_bf16 a[100:103], v[64:67], v[12:15], a[100:103]
    v_mfma_f32_16x16x32_bf16 a[104:107], v[64:67], v[16:19], a[104:107]
    v_mfma_f32_16x16x32_bf16 a[108:111], v[64:67], v[20:23], a[108:111]
    v_mfma_f32_16x16x32_bf16 a[112:115], v[68:71], v[8:11], a[112:115]
    v_mfma_f32_16x16x32_bf16 a[116:119], v[68:71], v[12:15], a[116:119]
    v_mfma_f32_16x16x32_bf16 a[120:123], v[68:71], v[16:19], a[120:123]
    v_mfma_f32_16x16x32_bf16 a[124:127], v[68:71], v[20:23], a[124:127]
    buffer_load_dwordx4 v[8:11], v4, s[8:11], 0 offen offset:256
    buffer_load_dwordx4 v[12:15], v5, s[8:11], 0 offen offset:256
    buffer_load_dwordx4 v[16:19], v6, s[8:11], 0 offen offset:256
    buffer_load_dwordx4 v[20:23], v7, s[8:11], 0 offen offset:256
    ds_read_b128 v[40:43], v3 offset:256
    ds_read_b128 v[44:47], v3 offset:14848
    ds_read_b128 v[48:51], v3 offset:29440
    ds_read_b128 v[52:55], v3 offset:44032
    ds_read_b128 v[56:59], v137 offset:256
    ds_read_b128 v[60:63], v137 offset:14848
    ds_read_b128 v[64:67], v137 offset:29440
    ds_read_b128 v[68:71], v137 offset:44032
    s_waitcnt vmcnt(4) lgkmcnt(8)
    v_mfma_f32_16x16x32_bf16 a[0:3], v[72:75], v[24:27], a[0:3]
    v_mfma_f32_16x16x32_bf16 a[4:7], v[72:75], v[28:31], a[4:7]
    v_mfma_f32_16x16x32_bf16 a[8:11], v[72:75], v[32:35], a[8:11]
    v_mfma_f32_16x16x32_bf16 a[12:15], v[72:75], v[36:39], a[12:15]
    v_mfma_f32_16x16x32_bf16 a[16:19], v[76:79], v[24:27], a[16:19]
    v_mfma_f32_16x16x32_bf16 a[20:23], v[76:79], v[28:31], a[20:23]
    v_mfma_f32_16x16x32_bf16 a[24:27], v[76:79], v[32:35], a[24:27]
    v_mfma_f32_16x16x32_bf16 a[28:31], v[76:79], v[36:39], a[28:31]
    v_mfma_f32_16x16x32_bf16 a[32:35], v[80:83], v[24:27], a[32:35]
    v_mfma_f32_16x16x32_bf16 a[36:39], v[80:83], v[28:31], a[36:39]
    v_mfma_f32_16x16x32_bf16 a[40:43], v[80:83], v[32:35], a[40:43]
    v_mfma_f32_16x16x32_bf16 a[44:47], v[80:83], v[36:39], a[44:47]
    v_mfma_f32_16x16x32_bf16 a[48:51], v[84:87], v[24:27], a[48:51]
    v_mfma_f32_16x16x32_bf16 a[52:55], v[84:87], v[28:31], a[52:55]
    v_mfma_f32_16x16x32_bf16 a[56:59], v[84:87], v[32:35], a[56:59]
    v_mfma_f32_16x16x32_bf16 a[60:63], v[84:87], v[36:39], a[60:63]
    v_mfma_f32_16x16x32_bf16 a[64:67], v[88:91], v[24:27], a[64:67]
    v_mfma_f32_16x16x32_bf16 a[68:71], v[88:91], v[28:31], a[68:71]
    v_mfma_f32_16x16x32_bf16 a[72:75], v[88:91], v[32:35], a[72:75]
    v_mfma_f32_16x16x32_bf16 a[76:79], v[88:91], v[36:39], a[76:79]
    v_mfma_f32_16x16x32_bf16 a[80:83], v[92:95], v[24:27], a[80:83]
    v_mfma_f32_16x16x32_bf16 a[84:87], v[92:95], v[28:31], a[84:87]
    v_mfma_f32_16x16x32_bf16 a[88:91], v[92:95], v[32:35], a[88:91]
    v_mfma_f32_16x16x32_bf16 a[92:95], v[92:95], v[36:39], a[92:95]
    v_mfma_f32_16x16x32_bf16 a[96:99], v[96:99], v[24:27], a[96:99]
    v_mfma_f32_16x16x32_bf16 a[100:103], v[96:99], v[28:31], a[100:103]
    v_mfma_f32_16x16x32_bf16 a[104:107], v[96:99], v[32:35], a[104:107]
    v_mfma_f32_16x16x32_bf16 a[108:111], v[96:99], v[36:39], a[108:111]
    v_mfma_f32_16x16x32_bf16 a[112:115], v[100:103], v[24:27], a[112:115]
    v_mfma_f32_16x16x32_bf16 a[116:119], v[100:103], v[28:31], a[116:119]
    v_mfma_f32_16x16x32_bf16 a[120:123], v[100:103], v[32:35], a[120:123]
    v_mfma_f32_16x16x32_bf16 a[124:127], v[100:103], v[36:39], a[124:127]
    buffer_load_dwordx4 v[24:27], v4, s[8:11], 0 offen offset:320
    buffer_load_dwordx4 v[28:31], v5, s[8:11], 0 offen offset:320
    buffer_load_dwordx4 v[32:35], v6, s[8:11], 0 offen offset:320
    buffer_load_dwordx4 v[36:39], v7, s[8:11], 0 offen offset:320
    ds_read_b128 v[72:75], v3 offset:320
    ds_read_b128 v[76:79], v3 offset:14912
    ds_read_b128 v[80:83], v3 offset:29504
    ds_read_b128 v[84:87], v3 offset:44096
    ds_read_b128 v[88:91], v137 offset:320
    ds_read_b128 v[92:95], v137 offset:14912
    ds_read_b128 v[96:99], v137 offset:29504
    ds_read_b128 v[100:103], v137 offset:44096
    s_waitcnt vmcnt(4) lgkmcnt(8)
    v_mfma_f32_16x16x32_bf16 a[0:3], v[40:43], v[8:11], a[0:3]
    v_mfma_f32_16x16x32_bf16 a[4:7], v[40:43], v[12:15], a[4:7]
    v_mfma_f32_16x16x32_bf16 a[8:11], v[40:43], v[16:19], a[8:11]
    v_mfma_f32_16x16x32_bf16 a[12:15], v[40:43], v[20:23], a[12:15]
    v_mfma_f32_16x16x32_bf16 a[16:19], v[44:47], v[8:11], a[16:19]
    v_mfma_f32_16x16x32_bf16 a[20:23], v[44:47], v[12:15], a[20:23]
    v_mfma_f32_16x16x32_bf16 a[24:27], v[44:47], v[16:19], a[24:27]
    v_mfma_f32_16x16x32_bf16 a[28:31], v[44:47], v[20:23], a[28:31]
    v_mfma_f32_16x16x32_bf16 a[32:35], v[48:51], v[8:11], a[32:35]
    v_mfma_f32_16x16x32_bf16 a[36:39], v[48:51], v[12:15], a[36:39]
    v_mfma_f32_16x16x32_bf16 a[40:43], v[48:51], v[16:19], a[40:43]
    v_mfma_f32_16x16x32_bf16 a[44:47], v[48:51], v[20:23], a[44:47]
    v_mfma_f32_16x16x32_bf16 a[48:51], v[52:55], v[8:11], a[48:51]
    v_mfma_f32_16x16x32_bf16 a[52:55], v[52:55], v[12:15], a[52:55]
    v_mfma_f32_16x16x32_bf16 a[56:59], v[52:55], v[16:19], a[56:59]
    v_mfma_f32_16x16x32_bf16 a[60:63], v[52:55], v[20:23], a[60:63]
    v_mfma_f32_16x16x32_bf16 a[64:67], v[56:59], v[8:11], a[64:67]
    v_mfma_f32_16x16x32_bf16 a[68:71], v[56:59], v[12:15], a[68:71]
    v_mfma_f32_16x16x32_bf16 a[72:75], v[56:59], v[16:19], a[72:75]
    v_mfma_f32_16x16x32_bf16 a[76:79], v[56:59], v[20:23], a[76:79]
    v_mfma_f32_16x16x32_bf16 a[80:83], v[60:63], v[8:11], a[80:83]
    v_mfma_f32_16x16x32_bf16 a[84:87], v[60:63], v[12:15], a[84:87]
    v_mfma_f32_16x16x32_bf16 a[88:91], v[60:63], v[16:19], a[88:91]
    v_mfma_f32_16x16x32_bf16 a[92:95], v[60:63], v[20:23], a[92:95]
    v_mfma_f32_16x16x32_bf16 a[96:99], v[64:67], v[8:11], a[96:99]
    v_mfma_f32_16x16x32_bf16 a[100:103], v[64:67], v[12:15], a[100:103]
    v_mfma_f32_16x16x32_bf16 a[104:107], v[64:67], v[16:19], a[104:107]
    v_mfma_f32_16x16x32_bf16 a[108:111], v[64:67], v[20:23], a[108:111]
    v_mfma_f32_16x16x32_bf16 a[112:115], v[68:71], v[8:11], a[112:115]
    v_mfma_f32_16x16x32_bf16 a[116:119], v[68:71], v[12:15], a[116:119]
    v_mfma_f32_16x16x32_bf16 a[120:123], v[68:71], v[16:19], a[120:123]
    v_mfma_f32_16x16x32_bf16 a[124:127], v[68:71], v[20:23], a[124:127]
    buffer_load_dwordx4 v[8:11], v4, s[8:11], 0 offen offset:384
    buffer_load_dwordx4 v[12:15], v5, s[8:11], 0 offen offset:384
    buffer_load_dwordx4 v[16:19], v6, s[8:11], 0 offen offset:384
    buffer_load_dwordx4 v[20:23], v7, s[8:11], 0 offen offset:384
    ds_read_b128 v[40:43], v3 offset:384
    ds_read_b128 v[44:47], v3 offset:14976
    ds_read_b128 v[48:51], v3 offset:29568
    ds_read_b128 v[52:55], v3 offset:44160
    ds_read_b128 v[56:59], v137 offset:384
    ds_read_b128 v[60:63], v137 offset:14976
    ds_read_b128 v[64:67], v137 offset:29568
    ds_read_b128 v[68:71], v137 offset:44160
    s_waitcnt vmcnt(4) lgkmcnt(8)
    v_mfma_f32_16x16x32_bf16 a[0:3], v[72:75], v[24:27], a[0:3]
    v_mfma_f32_16x16x32_bf16 a[4:7], v[72:75], v[28:31], a[4:7]
    v_mfma_f32_16x16x32_bf16 a[8:11], v[72:75], v[32:35], a[8:11]
    v_mfma_f32_16x16x32_bf16 a[12:15], v[72:75], v[36:39], a[12:15]
    v_mfma_f32_16x16x32_bf16 a[16:19], v[76:79], v[24:27], a[16:19]
    v_mfma_f32_16x16x32_bf16 a[20:23], v[76:79], v[28:31], a[20:23]
    v_mfma_f32_16x16x32_bf16 a[24:27], v[76:79], v[32:35], a[24:27]
    v_mfma_f32_16x16x32_bf16 a[28:31], v[76:79], v[36:39], a[28:31]
    v_mfma_f32_16x16x32_bf16 a[32:35], v[80:83], v[24:27], a[32:35]
    v_mfma_f32_16x16x32_bf16 a[36:39], v[80:83], v[28:31], a[36:39]
    v_mfma_f32_16x16x32_bf16 a[40:43], v[80:83], v[32:35], a[40:43]
    v_mfma_f32_16x16x32_bf16 a[44:47], v[80:83], v[36:39], a[44:47]
    v_mfma_f32_16x16x32_bf16 a[48:51], v[84:87], v[24:27], a[48:51]
    v_mfma_f32_16x16x32_bf16 a[52:55], v[84:87], v[28:31], a[52:55]
    v_mfma_f32_16x16x32_bf16 a[56:59], v[84:87], v[32:35], a[56:59]
    v_mfma_f32_16x16x32_bf16 a[60:63], v[84:87], v[36:39], a[60:63]
    v_mfma_f32_16x16x32_bf16 a[64:67], v[88:91], v[24:27], a[64:67]
    v_mfma_f32_16x16x32_bf16 a[68:71], v[88:91], v[28:31], a[68:71]
    v_mfma_f32_16x16x32_bf16 a[72:75], v[88:91], v[32:35], a[72:75]
    v_mfma_f32_16x16x32_bf16 a[76:79], v[88:91], v[36:39], a[76:79]
    v_mfma_f32_16x16x32_bf16 a[80:83], v[92:95], v[24:27], a[80:83]
    v_mfma_f32_16x16x32_bf16 a[84:87], v[92:95], v[28:31], a[84:87]
    v_mfma_f32_16x16x32_bf16 a[88:91], v[92:95], v[32:35], a[88:91]
    v_mfma_f32_16x16x32_bf16 a[92:95], v[92:95], v[36:39], a[92:95]
    v_mfma_f32_16x16x32_bf16 a[96:99], v[96:99], v[24:27], a[96:99]
    v_mfma_f32_16x16x32_bf16 a[100:103], v[96:99], v[28:31], a[100:103]
    v_mfma_f32_16x16x32_bf16 a[104:107], v[96:99], v[32:35], a[104:107]
    v_mfma_f32_16x16x32_bf16 a[108:111], v[96:99], v[36:39], a[108:111]
    v_mfma_f32_16x16x32_bf16 a[112:115], v[100:103], v[24:27], a[112:115]
    v_mfma_f32_16x16x32_bf16 a[116:119], v[100:103], v[28:31], a[116:119]
    v_mfma_f32_16x16x32_bf16 a[120:123], v[100:103], v[32:35], a[120:123]
    v_mfma_f32_16x16x32_bf16 a[124:127], v[100:103], v[36:39], a[124:127]
    buffer_load_dwordx4 v[24:27], v4, s[8:11], 0 offen offset:448
    buffer_load_dwordx4 v[28:31], v5, s[8:11], 0 offen offset:448
    buffer_load_dwordx4 v[32:35], v6, s[8:11], 0 offen offset:448
    buffer_load_dwordx4 v[36:39], v7, s[8:11], 0 offen offset:448
    ds_read_b128 v[72:75], v3 offset:448
    ds_read_b128 v[76:79], v3 offset:15040
    ds_read_b128 v[80:83], v3 offset:29632
    ds_read_b128 v[84:87], v3 offset:44224
    ds_read_b128 v[88:91], v137 offset:448
    ds_read_b128 v[92:95], v137 offset:15040
    ds_read_b128 v[96:99], v137 offset:29632
    ds_read_b128 v[100:103], v137 offset:44224
    s_waitcnt vmcnt(4) lgkmcnt(8)
    v_mfma_f32_16x16x32_bf16 a[0:3], v[40:43], v[8:11], a[0:3]
    v_mfma_f32_16x16x32_bf16 a[4:7], v[40:43], v[12:15], a[4:7]
    v_mfma_f32_16x16x32_bf16 a[8:11], v[40:43], v[16:19], a[8:11]
    v_mfma_f32_16x16x32_bf16 a[12:15], v[40:43], v[20:23], a[12:15]
    v_mfma_f32_16x16x32_bf16 a[16:19], v[44:47], v[8:11], a[16:19]
    v_mfma_f32_16x16x32_bf16 a[20:23], v[44:47], v[12:15], a[20:23]
    v_mfma_f32_16x16x32_bf16 a[24:27], v[44:47], v[16:19], a[24:27]
    v_mfma_f32_16x16x32_bf16 a[28:31], v[44:47], v[20:23], a[28:31]
    v_mfma_f32_16x16x32_bf16 a[32:35], v[48:51], v[8:11], a[32:35]
    v_mfma_f32_16x16x32_bf16 a[36:39], v[48:51], v[12:15], a[36:39]
    v_mfma_f32_16x16x32_bf16 a[40:43], v[48:51], v[16:19], a[40:43]
    v_mfma_f32_16x16x32_bf16 a[44:47], v[48:51], v[20:23], a[44:47]
    v_mfma_f32_16x16x32_bf16 a[48:51], v[52:55], v[8:11], a[48:51]
    v_mfma_f32_16x16x32_bf16 a[52:55], v[52:55], v[12:15], a[52:55]
    v_mfma_f32_16x16x32_bf16 a[56:59], v[52:55], v[16:19], a[56:59]
    v_mfma_f32_16x16x32_bf16 a[60:63], v[52:55], v[20:23], a[60:63]
    v_mfma_f32_16x16x32_bf16 a[64:67], v[56:59], v[8:11], a[64:67]
    v_mfma_f32_16x16x32_bf16 a[68:71], v[56:59], v[12:15], a[68:71]
    v_mfma_f32_16x16x32_bf16 a[72:75], v[56:59], v[16:19], a[72:75]
    v_mfma_f32_16x16x32_bf16 a[76:79], v[56:59], v[20:23], a[76:79]
    v_mfma_f32_16x16x32_bf16 a[80:83], v[60:63], v[8:11], a[80:83]
    v_mfma_f32_16x16x32_bf16 a[84:87], v[60:63], v[12:15], a[84:87]
    v_mfma_f32_16x16x32_bf16 a[88:91], v[60:63], v[16:19], a[88:91]
    v_mfma_f32_16x16x32_bf16 a[92:95], v[60:63], v[20:23], a[92:95]
    v_mfma_f32_16x16x32_bf16 a[96:99], v[64:67], v[8:11], a[96:99]
    v_mfma_f32_16x16x32_bf16 a[100:103], v[64:67], v[12:15], a[100:103]
    v_mfma_f32_16x16x32_bf16 a[104:107], v[64:67], v[16:19], a[104:107]
    v_mfma_f32_16x16x32_bf16 a[108:111], v[64:67], v[20:23], a[108:111]
    v_mfma_f32_16x16x32_bf16 a[112:115], v[68:71], v[8:11], a[112:115]
    v_mfma_f32_16x16x32_bf16 a[116:119], v[68:71], v[12:15], a[116:119]
    v_mfma_f32_16x16x32_bf16 a[120:123], v[68:71], v[16:19], a[120:123]
    v_mfma_f32_16x16x32_bf16 a[124:127], v[68:71], v[20:23], a[124:127]
    buffer_load_dwordx4 v[8:11], v4, s[8:11], 0 offen offset:512
    buffer_load_dwordx4 v[12:15], v5, s[8:11], 0 offen offset:512
    buffer_load_dwordx4 v[16:19], v6, s[8:11], 0 offen offset:512
    buffer_load_dwordx4 v[20:23], v7, s[8:11], 0 offen offset:512
    ds_read_b128 v[40:43], v3 offset:512
    ds_read_b128 v[44:47], v3 offset:15104
    ds_read_b128 v[48:51], v3 offset:29696
    ds_read_b128 v[52:55], v3 offset:44288
    ds_read_b128 v[56:59], v137 offset:512
    ds_read_b128 v[60:63], v137 offset:15104
    ds_read_b128 v[64:67], v137 offset:29696
    ds_read_b128 v[68:71], v137 offset:44288
    s_waitcnt vmcnt(4) lgkmcnt(8)
    v_mfma_f32_16x16x32_bf16 a[0:3], v[72:75], v[24:27], a[0:3]
    v_mfma_f32_16x16x32_bf16 a[4:7], v[72:75], v[28:31], a[4:7]
    v_mfma_f32_16x16x32_bf16 a[8:11], v[72:75], v[32:35], a[8:11]
    v_mfma_f32_16x16x32_bf16 a[12:15], v[72:75], v[36:39], a[12:15]
    v_mfma_f32_16x16x32_bf16 a[16:19], v[76:79], v[24:27], a[16:19]
    v_mfma_f32_16x16x32_bf16 a[20:23], v[76:79], v[28:31], a[20:23]
    v_mfma_f32_16x16x32_bf16 a[24:27], v[76:79], v[32:35], a[24:27]
    v_mfma_f32_16x16x32_bf16 a[28:31], v[76:79], v[36:39], a[28:31]
    v_mfma_f32_16x16x32_bf16 a[32:35], v[80:83], v[24:27], a[32:35]
    v_mfma_f32_16x16x32_bf16 a[36:39], v[80:83], v[28:31], a[36:39]
    v_mfma_f32_16x16x32_bf16 a[40:43], v[80:83], v[32:35], a[40:43]
    v_mfma_f32_16x16x32_bf16 a[44:47], v[80:83], v[36:39], a[44:47]
    v_mfma_f32_16x16x32_bf16 a[48:51], v[84:87], v[24:27], a[48:51]
    v_mfma_f32_16x16x32_bf16 a[52:55], v[84:87], v[28:31], a[52:55]
    v_mfma_f32_16x16x32_bf16 a[56:59], v[84:87], v[32:35], a[56:59]
    v_mfma_f32_16x16x32_bf16 a[60:63], v[84:87], v[36:39], a[60:63]
    v_mfma_f32_16x16x32_bf16 a[64:67], v[88:91], v[24:27], a[64:67]
    v_mfma_f32_16x16x32_bf16 a[68:71], v[88:91], v[28:31], a[68:71]
    v_mfma_f32_16x16x32_bf16 a[72:75], v[88:91], v[32:35], a[72:75]
    v_mfma_f32_16x16x32_bf16 a[76:79], v[88:91], v[36:39], a[76:79]
    v_mfma_f32_16x16x32_bf16 a[80:83], v[92:95], v[24:27], a[80:83]
    v_mfma_f32_16x16x32_bf16 a[84:87], v[92:95], v[28:31], a[84:87]
    v_mfma_f32_16x16x32_bf16 a[88:91], v[92:95], v[32:35], a[88:91]
    v_mfma_f32_16x16x32_bf16 a[92:95], v[92:95], v[36:39], a[92:95]
    v_mfma_f32_16x16x32_bf16 a[96:99], v[96:99], v[24:27], a[96:99]
    v_mfma_f32_16x16x32_bf16 a[100:103], v[96:99], v[28:31], a[100:103]
    v_mfma_f32_16x16x32_bf16 a[104:107], v[96:99], v[32:35], a[104:107]
    v_mfma_f32_16x16x32_bf16 a[108:111], v[96:99], v[36:39], a[108:111]
    v_mfma_f32_16x16x32_bf16 a[112:115], v[100:103], v[24:27], a[112:115]
    v_mfma_f32_16x16x32_bf16 a[116:119], v[100:103], v[28:31], a[116:119]
    v_mfma_f32_16x16x32_bf16 a[120:123], v[100:103], v[32:35], a[120:123]
    v_mfma_f32_16x16x32_bf16 a[124:127], v[100:103], v[36:39], a[124:127]
    buffer_load_dwordx4 v[24:27], v4, s[8:11], 0 offen offset:576
    buffer_load_dwordx4 v[28:31], v5, s[8:11], 0 offen offset:576
    buffer_load_dwordx4 v[32:35], v6, s[8:11], 0 offen offset:576
    buffer_load_dwordx4 v[36:39], v7, s[8:11], 0 offen offset:576
    ds_read_b128 v[72:75], v3 offset:576
    ds_read_b128 v[76:79], v3 offset:15168
    ds_read_b128 v[80:83], v3 offset:29760
    ds_read_b128 v[84:87], v3 offset:44352
    ds_read_b128 v[88:91], v137 offset:576
    ds_read_b128 v[92:95], v137 offset:15168
    ds_read_b128 v[96:99], v137 offset:29760
    ds_read_b128 v[100:103], v137 offset:44352
    s_waitcnt vmcnt(4) lgkmcnt(8)
    v_mfma_f32_16x16x32_bf16 a[0:3], v[40:43], v[8:11], a[0:3]
    v_mfma_f32_16x16x32_bf16 a[4:7], v[40:43], v[12:15], a[4:7]
    v_mfma_f32_16x16x32_bf16 a[8:11], v[40:43], v[16:19], a[8:11]
    v_mfma_f32_16x16x32_bf16 a[12:15], v[40:43], v[20:23], a[12:15]
    v_mfma_f32_16x16x32_bf16 a[16:19], v[44:47], v[8:11], a[16:19]
    v_mfma_f32_16x16x32_bf16 a[20:23], v[44:47], v[12:15], a[20:23]
    v_mfma_f32_16x16x32_bf16 a[24:27], v[44:47], v[16:19], a[24:27]
    v_mfma_f32_16x16x32_bf16 a[28:31], v[44:47], v[20:23], a[28:31]
    v_mfma_f32_16x16x32_bf16 a[32:35], v[48:51], v[8:11], a[32:35]
    v_mfma_f32_16x16x32_bf16 a[36:39], v[48:51], v[12:15], a[36:39]
    v_mfma_f32_16x16x32_bf16 a[40:43], v[48:51], v[16:19], a[40:43]
    v_mfma_f32_16x16x32_bf16 a[44:47], v[48:51], v[20:23], a[44:47]
    v_mfma_f32_16x16x32_bf16 a[48:51], v[52:55], v[8:11], a[48:51]
    v_mfma_f32_16x16x32_bf16 a[52:55], v[52:55], v[12:15], a[52:55]
    v_mfma_f32_16x16x32_bf16 a[56:59], v[52:55], v[16:19], a[56:59]
    v_mfma_f32_16x16x32_bf16 a[60:63], v[52:55], v[20:23], a[60:63]
    v_mfma_f32_16x16x32_bf16 a[64:67], v[56:59], v[8:11], a[64:67]
    v_mfma_f32_16x16x32_bf16 a[68:71], v[56:59], v[12:15], a[68:71]
    v_mfma_f32_16x16x32_bf16 a[72:75], v[56:59], v[16:19], a[72:75]
    v_mfma_f32_16x16x32_bf16 a[76:79], v[56:59], v[20:23], a[76:79]
    v_mfma_f32_16x16x32_bf16 a[80:83], v[60:63], v[8:11], a[80:83]
    v_mfma_f32_16x16x32_bf16 a[84:87], v[60:63], v[12:15], a[84:87]
    v_mfma_f32_16x16x32_bf16 a[88:91], v[60:63], v[16:19], a[88:91]
    v_mfma_f32_16x16x32_bf16 a[92:95], v[60:63], v[20:23], a[92:95]
    v_mfma_f32_16x16x32_bf16 a[96:99], v[64:67], v[8:11], a[96:99]
    v_mfma_f32_16x16x32_bf16 a[100:103], v[64:67], v[12:15], a[100:103]
    v_mfma_f32_16x16x32_bf16 a[104:107], v[64:67], v[16:19], a[104:107]
    v_mfma_f32_16x16x32_bf16 a[108:111], v[64:67], v[20:23], a[108:111]
    v_mfma_f32_16x16x32_bf16 a[112:115], v[68:71], v[8:11], a[112:115]
    v_mfma_f32_16x16x32_bf16 a[116:119], v[68:71], v[12:15], a[116:119]
    v_mfma_f32_16x16x32_bf16 a[120:123], v[68:71], v[16:19], a[120:123]
    v_mfma_f32_16x16x32_bf16 a[124:127], v[68:71], v[20:23], a[124:127]
    buffer_load_dwordx4 v[8:11], v4, s[8:11], 0 offen offset:640
    buffer_load_dwordx4 v[12:15], v5, s[8:11], 0 offen offset:640
    buffer_load_dwordx4 v[16:19], v6, s[8:11], 0 offen offset:640
    buffer_load_dwordx4 v[20:23], v7, s[8:11], 0 offen offset:640
    ds_read_b128 v[40:43], v3 offset:640
    ds_read_b128 v[44:47], v3 offset:15232
    ds_read_b128 v[48:51], v3 offset:29824
    ds_read_b128 v[52:55], v3 offset:44416
    ds_read_b128 v[56:59], v137 offset:640
    ds_read_b128 v[60:63], v137 offset:15232
    ds_read_b128 v[64:67], v137 offset:29824
    ds_read_b128 v[68:71], v137 offset:44416
    s_waitcnt vmcnt(4) lgkmcnt(8)
    v_mfma_f32_16x16x32_bf16 a[0:3], v[72:75], v[24:27], a[0:3]
    v_mfma_f32_16x16x32_bf16 a[4:7], v[72:75], v[28:31], a[4:7]
    v_mfma_f32_16x16x32_bf16 a[8:11], v[72:75], v[32:35], a[8:11]
    v_mfma_f32_16x16x32_bf16 a[12:15], v[72:75], v[36:39], a[12:15]
    v_mfma_f32_16x16x32_bf16 a[16:19], v[76:79], v[24:27], a[16:19]
    v_mfma_f32_16x16x32_bf16 a[20:23], v[76:79], v[28:31], a[20:23]
    v_mfma_f32_16x16x32_bf16 a[24:27], v[76:79], v[32:35], a[24:27]
    v_mfma_f32_16x16x32_bf16 a[28:31], v[76:79], v[36:39], a[28:31]
    v_mfma_f32_16x16x32_bf16 a[32:35], v[80:83], v[24:27], a[32:35]
    v_mfma_f32_16x16x32_bf16 a[36:39], v[80:83], v[28:31], a[36:39]
    v_mfma_f32_16x16x32_bf16 a[40:43], v[80:83], v[32:35], a[40:43]
    v_mfma_f32_16x16x32_bf16 a[44:47], v[80:83], v[36:39], a[44:47]
    v_mfma_f32_16x16x32_bf16 a[48:51], v[84:87], v[24:27], a[48:51]
    v_mfma_f32_16x16x32_bf16 a[52:55], v[84:87], v[28:31], a[52:55]
    v_mfma_f32_16x16x32_bf16 a[56:59], v[84:87], v[32:35], a[56:59]
    v_mfma_f32_16x16x32_bf16 a[60:63], v[84:87], v[36:39], a[60:63]
    v_mfma_f32_16x16x32_bf16 a[64:67], v[88:91], v[24:27], a[64:67]
    v_mfma_f32_16x16x32_bf16 a[68:71], v[88:91], v[28:31], a[68:71]
    v_mfma_f32_16x16x32_bf16 a[72:75], v[88:91], v[32:35], a[72:75]
    v_mfma_f32_16x16x32_bf16 a[76:79], v[88:91], v[36:39], a[76:79]
    v_mfma_f32_16x16x32_bf16 a[80:83], v[92:95], v[24:27], a[80:83]
    v_mfma_f32_16x16x32_bf16 a[84:87], v[92:95], v[28:31], a[84:87]
    v_mfma_f32_16x16x32_bf16 a[88:91], v[92:95], v[32:35], a[88:91]
    v_mfma_f32_16x16x32_bf16 a[92:95], v[92:95], v[36:39], a[92:95]
    v_mfma_f32_16x16x32_bf16 a[96:99], v[96:99], v[24:27], a[96:99]
    v_mfma_f32_16x16x32_bf16 a[100:103], v[96:99], v[28:31], a[100:103]
    v_mfma_f32_16x16x32_bf16 a[104:107], v[96:99], v[32:35], a[104:107]
    v_mfma_f32_16x16x32_bf16 a[108:111], v[96:99], v[36:39], a[108:111]
    v_mfma_f32_16x16x32_bf16 a[112:115], v[100:103], v[24:27], a[112:115]
    v_mfma_f32_16x16x32_bf16 a[116:119], v[100:103], v[28:31], a[116:119]
    v_mfma_f32_16x16x32_bf16 a[120:123], v[100:103], v[32:35], a[120:123]
    v_mfma_f32_16x16x32_bf16 a[124:127], v[100:103], v[36:39], a[124:127]
    buffer_load_dwordx4 v[24:27], v4, s[8:11], 0 offen offset:704
    buffer_load_dwordx4 v[28:31], v5, s[8:11], 0 offen offset:704
    buffer_load_dwordx4 v[32:35], v6, s[8:11], 0 offen offset:704
    buffer_load_dwordx4 v[36:39], v7, s[8:11], 0 offen offset:704
    ds_read_b128 v[72:75], v3 offset:704
    ds_read_b128 v[76:79], v3 offset:15296
    ds_read_b128 v[80:83], v3 offset:29888
    ds_read_b128 v[84:87], v3 offset:44480
    ds_read_b128 v[88:91], v137 offset:704
    ds_read_b128 v[92:95], v137 offset:15296
    ds_read_b128 v[96:99], v137 offset:29888
    ds_read_b128 v[100:103], v137 offset:44480
    s_waitcnt vmcnt(4) lgkmcnt(8)
    v_mfma_f32_16x16x32_bf16 a[0:3], v[40:43], v[8:11], a[0:3]
    v_mfma_f32_16x16x32_bf16 a[4:7], v[40:43], v[12:15], a[4:7]
    v_mfma_f32_16x16x32_bf16 a[8:11], v[40:43], v[16:19], a[8:11]
    v_mfma_f32_16x16x32_bf16 a[12:15], v[40:43], v[20:23], a[12:15]
    v_mfma_f32_16x16x32_bf16 a[16:19], v[44:47], v[8:11], a[16:19]
    v_mfma_f32_16x16x32_bf16 a[20:23], v[44:47], v[12:15], a[20:23]
    v_mfma_f32_16x16x32_bf16 a[24:27], v[44:47], v[16:19], a[24:27]
    v_mfma_f32_16x16x32_bf16 a[28:31], v[44:47], v[20:23], a[28:31]
    v_mfma_f32_16x16x32_bf16 a[32:35], v[48:51], v[8:11], a[32:35]
    v_mfma_f32_16x16x32_bf16 a[36:39], v[48:51], v[12:15], a[36:39]
    v_mfma_f32_16x16x32_bf16 a[40:43], v[48:51], v[16:19], a[40:43]
    v_mfma_f32_16x16x32_bf16 a[44:47], v[48:51], v[20:23], a[44:47]
    v_mfma_f32_16x16x32_bf16 a[48:51], v[52:55], v[8:11], a[48:51]
    v_mfma_f32_16x16x32_bf16 a[52:55], v[52:55], v[12:15], a[52:55]
    v_mfma_f32_16x16x32_bf16 a[56:59], v[52:55], v[16:19], a[56:59]
    v_mfma_f32_16x16x32_bf16 a[60:63], v[52:55], v[20:23], a[60:63]
    v_mfma_f32_16x16x32_bf16 a[64:67], v[56:59], v[8:11], a[64:67]
    v_mfma_f32_16x16x32_bf16 a[68:71], v[56:59], v[12:15], a[68:71]
    v_mfma_f32_16x16x32_bf16 a[72:75], v[56:59], v[16:19], a[72:75]
    v_mfma_f32_16x16x32_bf16 a[76:79], v[56:59], v[20:23], a[76:79]
    v_mfma_f32_16x16x32_bf16 a[80:83], v[60:63], v[8:11], a[80:83]
    v_mfma_f32_16x16x32_bf16 a[84:87], v[60:63], v[12:15], a[84:87]
    v_mfma_f32_16x16x32_bf16 a[88:91], v[60:63], v[16:19], a[88:91]
    v_mfma_f32_16x16x32_bf16 a[92:95], v[60:63], v[20:23], a[92:95]
    v_mfma_f32_16x16x32_bf16 a[96:99], v[64:67], v[8:11], a[96:99]
    v_mfma_f32_16x16x32_bf16 a[100:103], v[64:67], v[12:15], a[100:103]
    v_mfma_f32_16x16x32_bf16 a[104:107], v[64:67], v[16:19], a[104:107]
    v_mfma_f32_16x16x32_bf16 a[108:111], v[64:67], v[20:23], a[108:111]
    v_mfma_f32_16x16x32_bf16 a[112:115], v[68:71], v[8:11], a[112:115]
    v_mfma_f32_16x16x32_bf16 a[116:119], v[68:71], v[12:15], a[116:119]
    v_mfma_f32_16x16x32_bf16 a[120:123], v[68:71], v[16:19], a[120:123]
    v_mfma_f32_16x16x32_bf16 a[124:127], v[68:71], v[20:23], a[124:127]
    buffer_load_dwordx4 v[8:11], v4, s[8:11], 0 offen offset:768
    buffer_load_dwordx4 v[12:15], v5, s[8:11], 0 offen offset:768
    buffer_load_dwordx4 v[16:19], v6, s[8:11], 0 offen offset:768
    buffer_load_dwordx4 v[20:23], v7, s[8:11], 0 offen offset:768
    ds_read_b128 v[40:43], v3 offset:768
    ds_read_b128 v[44:47], v3 offset:15360
    ds_read_b128 v[48:51], v3 offset:29952
    ds_read_b128 v[52:55], v3 offset:44544
    ds_read_b128 v[56:59], v137 offset:768
    ds_read_b128 v[60:63], v137 offset:15360
    ds_read_b128 v[64:67], v137 offset:29952
    ds_read_b128 v[68:71], v137 offset:44544
    s_waitcnt vmcnt(4) lgkmcnt(8)
    v_mfma_f32_16x16x32_bf16 a[0:3], v[72:75], v[24:27], a[0:3]
    v_mfma_f32_16x16x32_bf16 a[4:7], v[72:75], v[28:31], a[4:7]
    v_mfma_f32_16x16x32_bf16 a[8:11], v[72:75], v[32:35], a[8:11]
    v_mfma_f32_16x16x32_bf16 a[12:15], v[72:75], v[36:39], a[12:15]
    v_mfma_f32_16x16x32_bf16 a[16:19], v[76:79], v[24:27], a[16:19]
    v_mfma_f32_16x16x32_bf16 a[20:23], v[76:79], v[28:31], a[20:23]
    v_mfma_f32_16x16x32_bf16 a[24:27], v[76:79], v[32:35], a[24:27]
    v_mfma_f32_16x16x32_bf16 a[28:31], v[76:79], v[36:39], a[28:31]
    v_mfma_f32_16x16x32_bf16 a[32:35], v[80:83], v[24:27], a[32:35]
    v_mfma_f32_16x16x32_bf16 a[36:39], v[80:83], v[28:31], a[36:39]
    v_mfma_f32_16x16x32_bf16 a[40:43], v[80:83], v[32:35], a[40:43]
    v_mfma_f32_16x16x32_bf16 a[44:47], v[80:83], v[36:39], a[44:47]
    v_mfma_f32_16x16x32_bf16 a[48:51], v[84:87], v[24:27], a[48:51]
    v_mfma_f32_16x16x32_bf16 a[52:55], v[84:87], v[28:31], a[52:55]
    v_mfma_f32_16x16x32_bf16 a[56:59], v[84:87], v[32:35], a[56:59]
    v_mfma_f32_16x16x32_bf16 a[60:63], v[84:87], v[36:39], a[60:63]
    v_mfma_f32_16x16x32_bf16 a[64:67], v[88:91], v[24:27], a[64:67]
    v_mfma_f32_16x16x32_bf16 a[68:71], v[88:91], v[28:31], a[68:71]
    v_mfma_f32_16x16x32_bf16 a[72:75], v[88:91], v[32:35], a[72:75]
    v_mfma_f32_16x16x32_bf16 a[76:79], v[88:91], v[36:39], a[76:79]
    v_mfma_f32_16x16x32_bf16 a[80:83], v[92:95], v[24:27], a[80:83]
    v_mfma_f32_16x16x32_bf16 a[84:87], v[92:95], v[28:31], a[84:87]
    v_mfma_f32_16x16x32_bf16 a[88:91], v[92:95], v[32:35], a[88:91]
    v_mfma_f32_16x16x32_bf16 a[92:95], v[92:95], v[36:39], a[92:95]
    v_mfma_f32_16x16x32_bf16 a[96:99], v[96:99], v[24:27], a[96:99]
    v_mfma_f32_16x16x32_bf16 a[100:103], v[96:99], v[28:31], a[100:103]
    v_mfma_f32_16x16x32_bf16 a[104:107], v[96:99], v[32:35], a[104:107]
    v_mfma_f32_16x16x32_bf16 a[108:111], v[96:99], v[36:39], a[108:111]
    v_mfma_f32_16x16x32_bf16 a[112:115], v[100:103], v[24:27], a[112:115]
    v_mfma_f32_16x16x32_bf16 a[116:119], v[100:103], v[28:31], a[116:119]
    v_mfma_f32_16x16x32_bf16 a[120:123], v[100:103], v[32:35], a[120:123]
    v_mfma_f32_16x16x32_bf16 a[124:127], v[100:103], v[36:39], a[124:127]
    buffer_load_dwordx4 v[24:27], v4, s[8:11], 0 offen offset:832
    buffer_load_dwordx4 v[28:31], v5, s[8:11], 0 offen offset:832
    buffer_load_dwordx4 v[32:35], v6, s[8:11], 0 offen offset:832
    buffer_load_dwordx4 v[36:39], v7, s[8:11], 0 offen offset:832
    ds_read_b128 v[72:75], v3 offset:832
    ds_read_b128 v[76:79], v3 offset:15424
    ds_read_b128 v[80:83], v3 offset:30016
    ds_read_b128 v[84:87], v3 offset:44608
    ds_read_b128 v[88:91], v137 offset:832
    ds_read_b128 v[92:95], v137 offset:15424
    ds_read_b128 v[96:99], v137 offset:30016
    ds_read_b128 v[100:103], v137 offset:44608
    s_waitcnt vmcnt(4) lgkmcnt(8)
    v_mfma_f32_16x16x32_bf16 a[0:3], v[40:43], v[8:11], a[0:3]
    v_mfma_f32_16x16x32_bf16 a[4:7], v[40:43], v[12:15], a[4:7]
    v_mfma_f32_16x16x32_bf16 a[8:11], v[40:43], v[16:19], a[8:11]
    v_mfma_f32_16x16x32_bf16 a[12:15], v[40:43], v[20:23], a[12:15]
    v_mfma_f32_16x16x32_bf16 a[16:19], v[44:47], v[8:11], a[16:19]
    v_mfma_f32_16x16x32_bf16 a[20:23], v[44:47], v[12:15], a[20:23]
    v_mfma_f32_16x16x32_bf16 a[24:27], v[44:47], v[16:19], a[24:27]
    v_mfma_f32_16x16x32_bf16 a[28:31], v[44:47], v[20:23], a[28:31]
    v_mfma_f32_16x16x32_bf16 a[32:35], v[48:51], v[8:11], a[32:35]
    v_mfma_f32_16x16x32_bf16 a[36:39], v[48:51], v[12:15], a[36:39]
    v_mfma_f32_16x16x32_bf16 a[40:43], v[48:51], v[16:19], a[40:43]
    v_mfma_f32_16x16x32_bf16 a[44:47], v[48:51], v[20:23], a[44:47]
    v_mfma_f32_16x16x32_bf16 a[48:51], v[52:55], v[8:11], a[48:51]
    v_mfma_f32_16x16x32_bf16 a[52:55], v[52:55], v[12:15], a[52:55]
    v_mfma_f32_16x16x32_bf16 a[56:59], v[52:55], v[16:19], a[56:59]
    v_mfma_f32_16x16x32_bf16 a[60:63], v[52:55], v[20:23], a[60:63]
    v_mfma_f32_16x16x32_bf16 a[64:67], v[56:59], v[8:11], a[64:67]
    v_mfma_f32_16x16x32_bf16 a[68:71], v[56:59], v[12:15], a[68:71]
    v_mfma_f32_16x16x32_bf16 a[72:75], v[56:59], v[16:19], a[72:75]
    v_mfma_f32_16x16x32_bf16 a[76:79], v[56:59], v[20:23], a[76:79]
    v_mfma_f32_16x16x32_bf16 a[80:83], v[60:63], v[8:11], a[80:83]
    v_mfma_f32_16x16x32_bf16 a[84:87], v[60:63], v[12:15], a[84:87]
    v_mfma_f32_16x16x32_bf16 a[88:91], v[60:63], v[16:19], a[88:91]
    v_mfma_f32_16x16x32_bf16 a[92:95], v[60:63], v[20:23], a[92:95]
    v_mfma_f32_16x16x32_bf16 a[96:99], v[64:67], v[8:11], a[96:99]
    v_mfma_f32_16x16x32_bf16 a[100:103], v[64:67], v[12:15], a[100:103]
    v_mfma_f32_16x16x32_bf16 a[104:107], v[64:67], v[16:19], a[104:107]
    v_mfma_f32_16x16x32_bf16 a[108:111], v[64:67], v[20:23], a[108:111]
    v_mfma_f32_16x16x32_bf16 a[112:115], v[68:71], v[8:11], a[112:115]
    v_mfma_f32_16x16x32_bf16 a[116:119], v[68:71], v[12:15], a[116:119]
    v_mfma_f32_16x16x32_bf16 a[120:123], v[68:71], v[16:19], a[120:123]
    v_mfma_f32_16x16x32_bf16 a[124:127], v[68:71], v[20:23], a[124:127]
    s_waitcnt vmcnt(0) lgkmcnt(0)
    v_mfma_f32_16x16x32_bf16 a[0:3], v[72:75], v[24:27], a[0:3]
    v_mfma_f32_16x16x32_bf16 a[4:7], v[72:75], v[28:31], a[4:7]
    v_mfma_f32_16x16x32_bf16 a[8:11], v[72:75], v[32:35], a[8:11]
    v_mfma_f32_16x16x32_bf16 a[12:15], v[72:75], v[36:39], a[12:15]
    v_mfma_f32_16x16x32_bf16 a[16:19], v[76:79], v[24:27], a[16:19]
    v_mfma_f32_16x16x32_bf16 a[20:23], v[76:79], v[28:31], a[20:23]
    v_mfma_f32_16x16x32_bf16 a[24:27], v[76:79], v[32:35], a[24:27]
    v_mfma_f32_16x16x32_bf16 a[28:31], v[76:79], v[36:39], a[28:31]
    v_mfma_f32_16x16x32_bf16 a[32:35], v[80:83], v[24:27], a[32:35]
    v_mfma_f32_16x16x32_bf16 a[36:39], v[80:83], v[28:31], a[36:39]
    v_mfma_f32_16x16x32_bf16 a[40:43], v[80:83], v[32:35], a[40:43]
    v_mfma_f32_16x16x32_bf16 a[44:47], v[80:83], v[36:39], a[44:47]
    v_mfma_f32_16x16x32_bf16 a[48:51], v[84:87], v[24:27], a[48:51]
    v_mfma_f32_16x16x32_bf16 a[52:55], v[84:87], v[28:31], a[52:55]
    v_mfma_f32_16x16x32_bf16 a[56:59], v[84:87], v[32:35], a[56:59]
    v_mfma_f32_16x16x32_bf16 a[60:63], v[84:87], v[36:39], a[60:63]
    v_mfma_f32_16x16x32_bf16 a[64:67], v[88:91], v[24:27], a[64:67]
    v_mfma_f32_16x16x32_bf16 a[68:71], v[88:91], v[28:31], a[68:71]
    v_mfma_f32_16x16x32_bf16 a[72:75], v[88:91], v[32:35], a[72:75]
    v_mfma_f32_16x16x32_bf16 a[76:79], v[88:91], v[36:39], a[76:79]
    v_mfma_f32_16x16x32_bf16 a[80:83], v[92:95], v[24:27], a[80:83]
    v_mfma_f32_16x16x32_bf16 a[84:87], v[92:95], v[28:31], a[84:87]
    v_mfma_f32_16x16x32_bf16 a[88:91], v[92:95], v[32:35], a[88:91]
    v_mfma_f32_16x16x32_bf16 a[92:95], v[92:95], v[36:39], a[92:95]
    v_mfma_f32_16x16x32_bf16 a[96:99], v[96:99], v[24:27], a[96:99]
    v_mfma_f32_16x16x32_bf16 a[100:103], v[96:99], v[28:31], a[100:103]
    v_mfma_f32_16x16x32_bf16 a[104:107], v[96:99], v[32:35], a[104:107]
    v_mfma_f32_16x16x32_bf16 a[108:111], v[96:99], v[36:39], a[108:111]
    v_mfma_f32_16x16x32_bf16 a[112:115], v[100:103], v[24:27], a[112:115]
    v_mfma_f32_16x16x32_bf16 a[116:119], v[100:103], v[28:31], a[116:119]
    v_mfma_f32_16x16x32_bf16 a[120:123], v[100:103], v[32:35], a[120:123]
    v_mfma_f32_16x16x32_bf16 a[124:127], v[100:103], v[36:39], a[124:127]
    s_nop 7
    s_nop 7
    s_sub_u32 s16, s16, 7168
    s_lshr_b32 s16, s16, 6
    s_mov_b32 s18, 613566757
    s_mul_hi_u32 s17, s16, s18
    s_mul_i32 s18, s17, 7
    s_sub_u32 s18, s16, s18
    s_lshl_b32 s18, s18, 2
    s_lshl_b32 s19, s5, 2
    s_mul_i32 s19, s19, 28
    s_add_u32 s19, s19, s18
    s_lshl_b32 s19, s19, 4
    s_add_u32 s19, s19, s17
    s_lshl_b32 s19, s19, 10
    s_add_u32 s19, s19, 52428800
    v_lshlrev_b32 v104, 6, v1
    v_lshl_add_u32 v104, v2, 3, v104
    s_add_u32 s22, s19, 0
    v_accvgpr_read_b32 v106, a0
    v_accvgpr_read_b32 v107, a1
    v_accvgpr_read_b32 v108, a2
    v_accvgpr_read_b32 v109, a3
    v_cvt_pk_bf16_f32 v110, v106, v107
    v_cvt_pk_bf16_f32 v111, v108, v109
    buffer_store_dwordx2 v[110:111], v104, s[8:11], s22 offen sc1
    s_nop 1
    s_add_u32 s22, s19, 16384
    v_accvgpr_read_b32 v106, a4
    v_accvgpr_read_b32 v107, a5
    v_accvgpr_read_b32 v108, a6
    v_accvgpr_read_b32 v109, a7
    v_cvt_pk_bf16_f32 v110, v106, v107
    v_cvt_pk_bf16_f32 v111, v108, v109
    buffer_store_dwordx2 v[110:111], v104, s[8:11], s22 offen sc1
    s_nop 1
    s_add_u32 s22, s19, 32768
    v_accvgpr_read_b32 v106, a8
    v_accvgpr_read_b32 v107, a9
    v_accvgpr_read_b32 v108, a10
    v_accvgpr_read_b32 v109, a11
    v_cvt_pk_bf16_f32 v110, v106, v107
    v_cvt_pk_bf16_f32 v111, v108, v109
    buffer_store_dwordx2 v[110:111], v104, s[8:11], s22 offen sc1
    s_nop 1
    s_add_u32 s22, s19, 49152
    v_accvgpr_read_b32 v106, a12
    v_accvgpr_read_b32 v107, a13
    v_accvgpr_read_b32 v108, a14
    v_accvgpr_read_b32 v109, a15
    v_cvt_pk_bf16_f32 v110, v106, v107
    v_cvt_pk_bf16_f32 v111, v108, v109
    buffer_store_dwordx2 v[110:111], v104, s[8:11], s22 offen sc1
    s_nop 1
    s_add_u32 s22, s19, 32
    v_accvgpr_read_b32 v106, a16
    v_accvgpr_read_b32 v107, a17
    v_accvgpr_read_b32 v108, a18
    v_accvgpr_read_b32 v109, a19
    v_cvt_pk_bf16_f32 v110, v106, v107
    v_cvt_pk_bf16_f32 v111, v108, v109
    buffer_store_dwordx2 v[110:111], v104, s[8:11], s22 offen sc1
    s_nop 1
    s_add_u32 s22, s19, 16416
    v_accvgpr_read_b32 v106, a20
    v_accvgpr_read_b32 v107, a21
    v_accvgpr_read_b32 v108, a22
    v_accvgpr_read_b32 v109, a23
    v_cvt_pk_bf16_f32 v110, v106, v107
    v_cvt_pk_bf16_f32 v111, v108, v109
    buffer_store_dwordx2 v[110:111], v104, s[8:11], s22 offen sc1
    s_nop 1
    s_add_u32 s22, s19, 32800
    v_accvgpr_read_b32 v106, a24
    v_accvgpr_read_b32 v107, a25
    v_accvgpr_read_b32 v108, a26
    v_accvgpr_read_b32 v109, a27
    v_cvt_pk_bf16_f32 v110, v106, v107
    v_cvt_pk_bf16_f32 v111, v108, v109
    buffer_store_dwordx2 v[110:111], v104, s[8:11], s22 offen sc1
    s_nop 1
    s_add_u32 s22, s19, 49184
    v_accvgpr_read_b32 v106, a28
    v_accvgpr_read_b32 v107, a29
    v_accvgpr_read_b32 v108, a30
    v_accvgpr_read_b32 v109, a31
    v_cvt_pk_bf16_f32 v110, v106, v107
    v_cvt_pk_bf16_f32 v111, v108, v109
    buffer_store_dwordx2 v[110:111], v104, s[8:11], s22 offen sc1
    s_nop 1
    s_add_u32 s22, s19, 458752
    v_accvgpr_read_b32 v106, a32
    v_accvgpr_read_b32 v107, a33
    v_accvgpr_read_b32 v108, a34
    v_accvgpr_read_b32 v109, a35
    v_cvt_pk_bf16_f32 v110, v106, v107
    v_cvt_pk_bf16_f32 v111, v108, v109
    buffer_store_dwordx2 v[110:111], v104, s[8:11], s22 offen sc1
    s_nop 1
    s_add_u32 s22, s19, 475136
    v_accvgpr_read_b32 v106, a36
    v_accvgpr_read_b32 v107, a37
    v_accvgpr_read_b32 v108, a38
    v_accvgpr_read_b32 v109, a39
    v_cvt_pk_bf16_f32 v110, v106, v107
    v_cvt_pk_bf16_f32 v111, v108, v109
    buffer_store_dwordx2 v[110:111], v104, s[8:11], s22 offen sc1
    s_nop 1
    s_add_u32 s22, s19, 491520
    v_accvgpr_read_b32 v106, a40
    v_accvgpr_read_b32 v107, a41
    v_accvgpr_read_b32 v108, a42
    v_accvgpr_read_b32 v109, a43
    v_cvt_pk_bf16_f32 v110, v106, v107
    v_cvt_pk_bf16_f32 v111, v108, v109
    buffer_store_dwordx2 v[110:111], v104, s[8:11], s22 offen sc1
    s_nop 1
    s_add_u32 s22, s19, 507904
    v_accvgpr_read_b32 v106, a44
    v_accvgpr_read_b32 v107, a45
    v_accvgpr_read_b32 v108, a46
    v_accvgpr_read_b32 v109, a47
    v_cvt_pk_bf16_f32 v110, v106, v107
    v_cvt_pk_bf16_f32 v111, v108, v109
    buffer_store_dwordx2 v[110:111], v104, s[8:11], s22 offen sc1
    s_nop 1
    s_add_u32 s22, s19, 458784
    v_accvgpr_read_b32 v106, a48
    v_accvgpr_read_b32 v107, a49
    v_accvgpr_read_b32 v108, a50
    v_accvgpr_read_b32 v109, a51
    v_cvt_pk_bf16_f32 v110, v106, v107
    v_cvt_pk_bf16_f32 v111, v108, v109
    buffer_store_dwordx2 v[110:111], v104, s[8:11], s22 offen sc1
    s_nop 1
    s_add_u32 s22, s19, 475168
    v_accvgpr_read_b32 v106, a52
    v_accvgpr_read_b32 v107, a53
    v_accvgpr_read_b32 v108, a54
    v_accvgpr_read_b32 v109, a55
    v_cvt_pk_bf16_f32 v110, v106, v107
    v_cvt_pk_bf16_f32 v111, v108, v109
    buffer_store_dwordx2 v[110:111], v104, s[8:11], s22 offen sc1
    s_nop 1
    s_add_u32 s22, s19, 491552
    v_accvgpr_read_b32 v106, a56
    v_accvgpr_read_b32 v107, a57
    v_accvgpr_read_b32 v108, a58
    v_accvgpr_read_b32 v109, a59
    v_cvt_pk_bf16_f32 v110, v106, v107
    v_cvt_pk_bf16_f32 v111, v108, v109
    buffer_store_dwordx2 v[110:111], v104, s[8:11], s22 offen sc1
    s_nop 1
    s_add_u32 s22, s19, 507936
    v_accvgpr_read_b32 v106, a60
    v_accvgpr_read_b32 v107, a61
    v_accvgpr_read_b32 v108, a62
    v_accvgpr_read_b32 v109, a63
    v_cvt_pk_bf16_f32 v110, v106, v107
    v_cvt_pk_bf16_f32 v111, v108, v109
    buffer_store_dwordx2 v[110:111], v104, s[8:11], s22 offen sc1
    s_nop 1
    s_add_u32 s22, s19, 917504
    v_accvgpr_read_b32 v106, a64
    v_accvgpr_read_b32 v107, a65
    v_accvgpr_read_b32 v108, a66
    v_accvgpr_read_b32 v109, a67
    v_cvt_pk_bf16_f32 v110, v106, v107
    v_cvt_pk_bf16_f32 v111, v108, v109
    buffer_store_dwordx2 v[110:111], v104, s[8:11], s22 offen sc1
    s_nop 1
    s_add_u32 s22, s19, 933888
    v_accvgpr_read_b32 v106, a68
    v_accvgpr_read_b32 v107, a69
    v_accvgpr_read_b32 v108, a70
    v_accvgpr_read_b32 v109, a71
    v_cvt_pk_bf16_f32 v110, v106, v107
    v_cvt_pk_bf16_f32 v111, v108, v109
    buffer_store_dwordx2 v[110:111], v104, s[8:11], s22 offen sc1
    s_nop 1
    s_add_u32 s22, s19, 950272
    v_accvgpr_read_b32 v106, a72
    v_accvgpr_read_b32 v107, a73
    v_accvgpr_read_b32 v108, a74
    v_accvgpr_read_b32 v109, a75
    v_cvt_pk_bf16_f32 v110, v106, v107
    v_cvt_pk_bf16_f32 v111, v108, v109
    buffer_store_dwordx2 v[110:111], v104, s[8:11], s22 offen sc1
    s_nop 1
    s_add_u32 s22, s19, 966656
    v_accvgpr_read_b32 v106, a76
    v_accvgpr_read_b32 v107, a77
    v_accvgpr_read_b32 v108, a78
    v_accvgpr_read_b32 v109, a79
    v_cvt_pk_bf16_f32 v110, v106, v107
    v_cvt_pk_bf16_f32 v111, v108, v109
    buffer_store_dwordx2 v[110:111], v104, s[8:11], s22 offen sc1
    s_nop 1
    s_add_u32 s22, s19, 917536
    v_accvgpr_read_b32 v106, a80
    v_accvgpr_read_b32 v107, a81
    v_accvgpr_read_b32 v108, a82
    v_accvgpr_read_b32 v109, a83
    v_cvt_pk_bf16_f32 v110, v106, v107
    v_cvt_pk_bf16_f32 v111, v108, v109
    buffer_store_dwordx2 v[110:111], v104, s[8:11], s22 offen sc1
    s_nop 1
    s_add_u32 s22, s19, 933920
    v_accvgpr_read_b32 v106, a84
    v_accvgpr_read_b32 v107, a85
    v_accvgpr_read_b32 v108, a86
    v_accvgpr_read_b32 v109, a87
    v_cvt_pk_bf16_f32 v110, v106, v107
    v_cvt_pk_bf16_f32 v111, v108, v109
    buffer_store_dwordx2 v[110:111], v104, s[8:11], s22 offen sc1
    s_nop 1
    s_add_u32 s22, s19, 950304
    v_accvgpr_read_b32 v106, a88
    v_accvgpr_read_b32 v107, a89
    v_accvgpr_read_b32 v108, a90
    v_accvgpr_read_b32 v109, a91
    v_cvt_pk_bf16_f32 v110, v106, v107
    v_cvt_pk_bf16_f32 v111, v108, v109
    buffer_store_dwordx2 v[110:111], v104, s[8:11], s22 offen sc1
    s_nop 1
    s_add_u32 s22, s19, 966688
    v_accvgpr_read_b32 v106, a92
    v_accvgpr_read_b32 v107, a93
    v_accvgpr_read_b32 v108, a94
    v_accvgpr_read_b32 v109, a95
    v_cvt_pk_bf16_f32 v110, v106, v107
    v_cvt_pk_bf16_f32 v111, v108, v109
    buffer_store_dwordx2 v[110:111], v104, s[8:11], s22 offen sc1
    s_nop 1
    s_add_u32 s22, s19, 1376256
    v_accvgpr_read_b32 v106, a96
    v_accvgpr_read_b32 v107, a97
    v_accvgpr_read_b32 v108, a98
    v_accvgpr_read_b32 v109, a99
    v_cvt_pk_bf16_f32 v110, v106, v107
    v_cvt_pk_bf16_f32 v111, v108, v109
    buffer_store_dwordx2 v[110:111], v104, s[8:11], s22 offen sc1
    s_nop 1
    s_add_u32 s22, s19, 1392640
    v_accvgpr_read_b32 v106, a100
    v_accvgpr_read_b32 v107, a101
    v_accvgpr_read_b32 v108, a102
    v_accvgpr_read_b32 v109, a103
    v_cvt_pk_bf16_f32 v110, v106, v107
    v_cvt_pk_bf16_f32 v111, v108, v109
    buffer_store_dwordx2 v[110:111], v104, s[8:11], s22 offen sc1
    s_nop 1
    s_add_u32 s22, s19, 1409024
    v_accvgpr_read_b32 v106, a104
    v_accvgpr_read_b32 v107, a105
    v_accvgpr_read_b32 v108, a106
    v_accvgpr_read_b32 v109, a107
    v_cvt_pk_bf16_f32 v110, v106, v107
    v_cvt_pk_bf16_f32 v111, v108, v109
    buffer_store_dwordx2 v[110:111], v104, s[8:11], s22 offen sc1
    s_nop 1
    s_add_u32 s22, s19, 1425408
    v_accvgpr_read_b32 v106, a108
    v_accvgpr_read_b32 v107, a109
    v_accvgpr_read_b32 v108, a110
    v_accvgpr_read_b32 v109, a111
    v_cvt_pk_bf16_f32 v110, v106, v107
    v_cvt_pk_bf16_f32 v111, v108, v109
    buffer_store_dwordx2 v[110:111], v104, s[8:11], s22 offen sc1
    s_nop 1
    s_add_u32 s22, s19, 1376288
    v_accvgpr_read_b32 v106, a112
    v_accvgpr_read_b32 v107, a113
    v_accvgpr_read_b32 v108, a114
    v_accvgpr_read_b32 v109, a115
    v_cvt_pk_bf16_f32 v110, v106, v107
    v_cvt_pk_bf16_f32 v111, v108, v109
    buffer_store_dwordx2 v[110:111], v104, s[8:11], s22 offen sc1
    s_nop 1
    s_add_u32 s22, s19, 1392672
    v_accvgpr_read_b32 v106, a116
    v_accvgpr_read_b32 v107, a117
    v_accvgpr_read_b32 v108, a118
    v_accvgpr_read_b32 v109, a119
    v_cvt_pk_bf16_f32 v110, v106, v107
    v_cvt_pk_bf16_f32 v111, v108, v109
    buffer_store_dwordx2 v[110:111], v104, s[8:11], s22 offen sc1
    s_nop 1
    s_add_u32 s22, s19, 1409056
    v_accvgpr_read_b32 v106, a120
    v_accvgpr_read_b32 v107, a121
    v_accvgpr_read_b32 v108, a122
    v_accvgpr_read_b32 v109, a123
    v_cvt_pk_bf16_f32 v110, v106, v107
    v_cvt_pk_bf16_f32 v111, v108, v109
    buffer_store_dwordx2 v[110:111], v104, s[8:11], s22 offen sc1
    s_nop 1
    s_add_u32 s22, s19, 1425440
    v_accvgpr_read_b32 v106, a124
    v_accvgpr_read_b32 v107, a125
    v_accvgpr_read_b32 v108, a126
    v_accvgpr_read_b32 v109, a127
    v_cvt_pk_bf16_f32 v110, v106, v107
    v_cvt_pk_bf16_f32 v111, v108, v109
    buffer_store_dwordx2 v[110:111], v104, s[8:11], s22 offen sc1
    s_nop 1
K3_next:
    s_waitcnt vmcnt(0)
    s_barrier
    s_cmp_eq_u32 s4, 0
    s_cbranch_scc0 K3_nosig
    v_cmp_eq_u32 vcc, 0, v0
    s_and_saveexec_b64 s[20:21], vcc
    s_lshl_b32 s16, s5, 6
    s_add_u32 s16, s16, 90832896
    v_mov_b32 v104, 1
    v_mov_b32 v105, 0
    buffer_atomic_add v104, v105, s[8:11], s16 offen sc1
    s_mov_b64 exec, s[20:21]
K3_nosig:
    s_add_u32 s5, s5, 3
    s_cmp_lt_u32 s5, 16
    s_cbranch_scc1 K3_mt
K3_done:
    s_cmp_ge_u32 s2, 64
    s_cbranch_scc1 K5_done
    s_load_dwordx2 s[12:13], s[0:1], 0
    s_mov_b32 s14, 1835008
    s_mov_b32 s15, 0x00020000
    s_load_dwordx2 s[16:17], s[0:1], 88
    s_mov_b32 s18, 896
    s_mov_b32 s19, 0x00020000
    s_load_dwordx2 s[24:25], s[0:1], 96
    s_mov_b32 s26, 1835008
    s_mov_b32 s27, 0x00020000
    v_lshlrev_b32 v2, 4, v0
    v_lshrrev_b32 v3, 3, v0
    v_mul_u32_u24 v3, 912, v3
    v_and_b32 v1, 7, v0
    v_lshl_add_u32 v3, v1, 3, v3
    s_add_u32 s38, s4, 0
    s_lshl_b32 s34, s38, 10
    s_lshl_b32 s38, s38, 6
    s_add_u32 s39, s4, 4
    s_lshl_b32 s35, s39, 10
    s_lshl_b32 s39, s39, 6
    s_add_u32 s40, s4, 8
    s_lshl_b32 s36, s40, 10
    s_lshl_b32 s40, s40, 6
    s_add_u32 s41, s4, 12
    s_min_u32 s41, s41, 13
    s_lshl_b32 s37, s41, 10
    s_lshl_b32 s41, s41, 6
    s_mov_b32 s29, 0x07060302
    s_mov_b32 s42, 0
    v_and_b32 v116, 15, v0
    v_lshrrev_b32 v117, 4, v0
    s_waitcnt lgkmcnt(0)
    s_mul_i32 s31, s2, 28
    s_mul_i32 s6, s4, 7
    s_add_u32 s31, s31, s6
    s_lshl_b32 s32, s31, 12
    s_lshl_b32 s31, s31, 14
    s_add_u32 s31, s31, 52428800
    s_add_u32 s32, s32, 91226112
    v_lshlrev_b32 v26, 6, v116
    v_lshl_add_u32 v26, v117, 4, v26
    v_lshlrev_b32 v27, 4, v116
    v_lshl_add_u32 v27, v117, 8, v27
    s_mul_i32 s6, s4, 112
    v_add_u32 v28, s6, v116
    v_mul_u32_u24 v28, 3584, v28
    v_lshl_add_u32 v28, v117, 4, v28
    v_add_u32 v28, 20971520, v28
    s_lshl_b32 s6, s2, 5
    v_add_u32 v29, s6, v116
    v_mul_u32_u24 v29, 3584, v29
    v_lshl_add_u32 v29, v117, 4, v29
    v_add_u32 v29, 81788928, v29
    v_mul_u32_u24 v30, 96, v116
    v_add_u32 v31, 45056, v30
    v_lshl_add_u32 v30, v117, 4, v30
    v_add_u32 v30, 45072, v30
    v_mul_u32_u24 v20, 3072, v117
    v_add_u32 v31, v31, v20
    v_accvgpr_write_b32 a168, 0
    v_accvgpr_write_b32 a169, 0
    v_accvgpr_write_b32 a170, 0
    v_accvgpr_write_b32 a171, 0
    v_accvgpr_write_b32 a172, 0
    v_accvgpr_write_b32 a173, 0
    v_accvgpr_write_b32 a174, 0
    v_accvgpr_write_b32 a175, 0
    v_accvgpr_write_b32 a176, 0
    v_accvgpr_write_b32 a177, 0
    v_accvgpr_write_b32 a178, 0
    v_accvgpr_write_b32 a179, 0
    v_accvgpr_write_b32 a180, 0
    v_accvgpr_write_b32 a181, 0
    v_accvgpr_write_b32 a182, 0
    v_accvgpr_write_b32 a183, 0
    v_accvgpr_write_b32 a184, 0
    v_accvgpr_write_b32 a185, 0
    v_accvgpr_write_b32 a186, 0
    v_accvgpr_write_b32 a187, 0
    v_accvgpr_write_b32 a188, 0
    v_accvgpr_write_b32 a189, 0
    v_accvgpr_write_b32 a190, 0
    v_accvgpr_write_b32 a191, 0
    v_accvgpr_write_b32 a192, 0
    v_accvgpr_write_b32 a193, 0
    v_accvgpr_write_b32 a194, 0
    v_accvgpr_write_b32 a195, 0
    v_accvgpr_write_b32 a196, 0
    v_accvgpr_write_b32 a197, 0
    v_accvgpr_write_b32 a198, 0
    v_accvgpr_write_b32 a199, 0
    v_accvgpr_write_b32 a200, 0
    v_accvgpr_write_b32 a201, 0
    v_accvgpr_write_b32 a202, 0
    v_accvgpr_write_b32 a203, 0
    v_accvgpr_write_b32 a204, 0
    v_accvgpr_write_b32 a205, 0
    v_accvgpr_write_b32 a206, 0
    v_accvgpr_write_b32 a207, 0
    v_accvgpr_write_b32 a208, 0
    v_accvgpr_write_b32 a209, 0
    v_accvgpr_write_b32 a210, 0
    v_accvgpr_write_b32 a211, 0
    v_accvgpr_write_b32 a212, 0
    v_accvgpr_write_b32 a213, 0
    v_accvgpr_write_b32 a214, 0
    v_accvgpr_write_b32 a215, 0
    v_accvgpr_write_b32 a216, 0
    v_accvgpr_write_b32 a217, 0
    v_accvgpr_write_b32 a218, 0
    v_accvgpr_write_b32 a219, 0
    v_accvgpr_write_b32 a220, 0
    v_accvgpr_write_b32 a221, 0
    v_accvgpr_write_b32 a222, 0
    v_accvgpr_write_b32 a223, 0
    s_lshr_b32 s28, s2, 2
    s_lshl_b32 s28, s28, 6
    s_add_u32 s28, s28, 90832896
    v_mov_b32 v21, 0
K5c_cp:
    s_sleep 8
    buffer_load_dword v20, v21, s[8:11], s28 offen sc1
    s_waitcnt vmcnt(0)
    v_cmp_ne_u32 vcc, 63, v20
    s_add_u32 s42, s42, 1
    s_cmp_gt_u32 s42, 0x400000
    s_cbranch_scc1 K5c_cpo
    s_cbranch_vccnz K5c_cp
K5c_cpo:
    s_mov_b32 s6, 0
    buffer_load_dwordx4 v[32:35], v28, s[8:11], s6 offen sc1
    s_mov_b32 s6, 57344
    buffer_load_dwordx4 v[36:39], v28, s[8:11], s6 offen sc1
    s_mov_b32 s6, 114688
    buffer_load_dwordx4 v[40:43], v28, s[8:11], s6 offen sc1
    s_mov_b32 s6, 172032
    buffer_load_dwordx4 v[44:47], v28, s[8:11], s6 offen sc1
    s_mov_b32 s6, 229376
    buffer_load_dwordx4 v[48:51], v28, s[8:11], s6 offen sc1
    s_mov_b32 s6, 286720
    buffer_load_dwordx4 v[52:55], v28, s[8:11], s6 offen sc1
    s_mov_b32 s6, 344064
    buffer_load_dwordx4 v[56:59], v28, s[8:11], s6 offen sc1
    s_mov_b32 s6, 0
    buffer_load_dwordx4 v[60:63], v29, s[8:11], s6 offen sc1
    s_mov_b32 s6, 57344
    buffer_load_dwordx4 v[64:67], v29, s[8:11], s6 offen sc1
    s_mov_b32 s6, 64
    buffer_load_dwordx4 v[68:71], v28, s[8:11], s6 offen sc1
    s_mov_b32 s6, 57408
    buffer_load_dwordx4 v[72:75], v28, s[8:11], s6 offen sc1
    s_mov_b32 s6, 114752
    buffer_load_dwordx4 v[76:79], v28, s[8:11], s6 offen sc1
    s_mov_b32 s6, 172096
    buffer_load_dwordx4 v[80:83], v28, s[8:11], s6 offen sc1
    s_mov_b32 s6, 229440
    buffer_load_dwordx4 v[84:87], v28, s[8:11], s6 offen sc1
    s_mov_b32 s6, 286784
    buffer_load_dwordx4 v[88:91], v28, s[8:11], s6 offen sc1
    s_mov_b32 s6, 344128
    buffer_load_dwordx4 v[92:95], v28, s[8:11], s6 offen sc1
    s_mov_b32 s6, 64
    buffer_load_dwordx4 v[96:99], v29, s[8:11], s6 offen sc1
    s_mov_b32 s6, 57408
    buffer_load_dwordx4 v[100:103], v29, s[8:11], s6 offen sc1
    s_waitcnt vmcnt(9) lgkmcnt(0)
    v_mfma_f32_16x16x32_bf16 a[168:171], v[32:35], v[60:63], a[168:171]
    v_mfma_f32_16x16x32_bf16 a[172:175], v[32:35], v[64:67], a[172:175]
    v_mfma_f32_16x16x32_bf16 a[176:179], v[36:39], v[60:63], a[176:179]
    v_mfma_f32_16x16x32_bf16 a[180:183], v[36:39], v[64:67], a[180:183]
    v_mfma_f32_16x16x32_bf16 a[184:187], v[40:43], v[60:63], a[184:187]
    v_mfma_f32_16x16x32_bf16 a[188:191], v[40:43], v[64:67], a[188:191]
    v_mfma_f32_16x16x32_bf16 a[192:195], v[44:47], v[60:63], a[192:195]
    v_mfma_f32_16x16x32_bf16 a[196:199], v[44:47], v[64:67], a[196:199]
    v_mfma_f32_16x16x32_bf16 a[200:203], v[48:51], v[60:63], a[200:203]
    v_mfma_f32_16x16x32_bf16 a[204:207], v[48:51], v[64:67], a[204:207]
    v_mfma_f32_16x16x32_bf16 a[208:211], v[52:55], v[60:63], a[208:211]
    v_mfma_f32_16x16x32_bf16 a[212:215], v[52:55], v[64:67], a[212:215]
    v_mfma_f32_16x16x32_bf16 a[216:219], v[56:59], v[60:63], a[216:219]
    v_mfma_f32_16x16x32_bf16 a[220:223], v[56:59], v[64:67], a[220:223]
    s_mov_b32 s6, 128
    buffer_load_dwordx4 v[32:35], v28, s[8:11], s6 offen sc1
    s_mov_b32 s6, 57472
    buffer_load_dwordx4 v[36:39], v28, s[8:11], s6 offen sc1
    s_mov_b32 s6, 114816
    buffer_load_dwordx4 v[40:43], v28, s[8:11], s6 offen sc1
    s_mov_b32 s6, 172160
    buffer_load_dwordx4 v[44:47], v28, s[8:11], s6 offen sc1
    s_mov_b32 s6, 229504
    buffer_load_dwordx4 v[48:51], v28, s[8:11], s6 offen sc1
    s_mov_b32 s6, 286848
    buffer_load_dwordx4 v[52:55], v28, s[8:11], s6 offen sc1
    s_mov_b32 s6, 344192
    buffer_load_dwordx4 v[56:59], v28, s[8:11], s6 offen sc1
    s_mov_b32 s6, 128
    buffer_load_dwordx4 v[60:63], v29, s[8:11], s6 offen sc1
    s_mov_b32 s6, 57472
    buffer_load_dwordx4 v[64:67], v29, s[8:11], s6 offen sc1
    s_waitcnt vmcnt(9) lgkmcnt(0)
    v_mfma_f32_16x16x32_bf16 a[168:171], v[68:71], v[96:99], a[168:171]
    v_mfma_f32_16x16x32_bf16 a[172:175], v[68:71], v[100:103], a[172:175]
    v_mfma_f32_16x16x32_bf16 a[176:179], v[72:75], v[96:99], a[176:179]
    v_mfma_f32_16x16x32_bf16 a[180:183], v[72:75], v[100:103], a[180:183]
    v_mfma_f32_16x16x32_bf16 a[184:187], v[76:79], v[96:99], a[184:187]
    v_mfma_f32_16x16x32_bf16 a[188:191], v[76:79], v[100:103], a[188:191]
    v_mfma_f32_16x16x32_bf16 a[192:195], v[80:83], v[96:99], a[192:195]
    v_mfma_f32_16x16x32_bf16 a[196:199], v[80:83], v[100:103], a[196:199]
    v_mfma_f32_16x16x32_bf16 a[200:203], v[84:87], v[96:99], a[200:203]
    v_mfma_f32_16x16x32_bf16 a[204:207], v[84:87], v[100:103], a[204:207]
    v_mfma_f32_16x16x32_bf16 a[208:211], v[88:91], v[96:99], a[208:211]
    v_mfma_f32_16x16x32_bf16 a[212:215], v[88:91], v[100:103], a[212:215]
    v_mfma_f32_16x16x32_bf16 a[216:219], v[92:95], v[96:99], a[216:219]
    v_mfma_f32_16x16x32_bf16 a[220:223], v[92:95], v[100:103], a[220:223]
    s_mov_b32 s6, 192
    buffer_load_dwordx4 v[68:71], v28, s[8:11], s6 offen sc1
    s_mov_b32 s6, 57536
    buffer_load_dwordx4 v[72:75], v28, s[8:11], s6 offen sc1
    s_mov_b32 s6, 114880
    buffer_load_dwordx4 v[76:79], v28, s[8:11], s6 offen sc1
    s_mov_b32 s6, 172224
    buffer_load_dwordx4 v[80:83], v28, s[8:11], s6 offen sc1
    s_mov_b32 s6, 229568
    buffer_load_dwordx4 v[84:87], v28, s[8:11], s6 offen sc1
    s_mov_b32 s6, 286912
    buffer_load_dwordx4 v[88:91], v28, s[8:11], s6 offen sc1
    s_mov_b32 s6, 344256
    buffer_load_dwordx4 v[92:95], v28, s[8:11], s6 offen sc1
    s_mov_b32 s6, 192
    buffer_load_dwordx4 v[96:99], v29, s[8:11], s6 offen sc1
    s_mov_b32 s6, 57536
    buffer_load_dwordx4 v[100:103], v29, s[8:11], s6 offen sc1
    s_waitcnt vmcnt(9) lgkmcnt(0)
    v_mfma_f32_16x16x32_bf16 a[168:171], v[32:35], v[60:63], a[168:171]
    v_mfma_f32_16x16x32_bf16 a[172:175], v[32:35], v[64:67], a[172:175]
    v_mfma_f32_16x16x32_bf16 a[176:179], v[36:39], v[60:63], a[176:179]
    v_mfma_f32_16x16x32_bf16 a[180:183], v[36:39], v[64:67], a[180:183]
    v_mfma_f32_16x16x32_bf16 a[184:187], v[40:43], v[60:63], a[184:187]
    v_mfma_f32_16x16x32_bf16 a[188:191], v[40:43], v[64:67], a[188:191]
    v_mfma_f32_16x16x32_bf16 a[192:195], v[44:47], v[60:63], a[192:195]
    v_mfma_f32_16x16x32_bf16 a[196:199], v[44:47], v[64:67], a[196:199]
    v_mfma_f32_16x16x32_bf16 a[200:203], v[48:51], v[60:63], a[200:203]
    v_mfma_f32_16x16x32_bf16 a[204:207], v[48:51], v[64:67], a[204:207]
    v_mfma_f32_16x16x32_bf16 a[208:211], v[52:55], v[60:63], a[208:211]
    v_mfma_f32_16x16x32_bf16 a[212:215], v[52:55], v[64:67], a[212:215]
    v_mfma_f32_16x16x32_bf16 a[216:219], v[56:59], v[60:63], a[216:219]
    v_mfma_f32_16x16x32_bf16 a[220:223], v[56:59], v[64:67], a[220:223]
    s_mov_b32 s6, 256
    buffer_load_dwordx4 v[32:35], v28, s[8:11], s6 offen sc1
    s_mov_b32 s6, 57600
    buffer_load_dwordx4 v[36:39], v28, s[8:11], s6 offen sc1
    s_mov_b32 s6, 114944
    buffer_load_dwordx4 v[40:43], v28, s[8:11], s6 offen sc1
    s_mov_b32 s6, 172288
    buffer_load_dwordx4 v[44:47], v28, s[8:11], s6 offen sc1
    s_mov_b32 s6, 229632
    buffer_load_dwordx4 v[48:51], v28, s[8:11], s6 offen sc1
    s_mov_b32 s6, 286976
    buffer_load_dwordx4 v[52:55], v28, s[8:11], s6 offen sc1
    s_mov_b32 s6, 344320
    buffer_load_dwordx4 v[56:59], v28, s[8:11], s6 offen sc1
    s_mov_b32 s6, 256
    buffer_load_dwordx4 v[60:63], v29, s[8:11], s6 offen sc1
    s_mov_b32 s6, 57600
    buffer_load_dwordx4 v[64:67], v29, s[8:11], s6 offen sc1
    s_waitcnt vmcnt(9) lgkmcnt(0)
    v_mfma_f32_16x16x32_bf16 a[168:171], v[68:71], v[96:99], a[168:171]
    v_mfma_f32_16x16x32_bf16 a[172:175], v[68:71], v[100:103], a[172:175]
    v_mfma_f32_16x16x32_bf16 a[176:179], v[72:75], v[96:99], a[176:179]
    v_mfma_f32_16x16x32_bf16 a[180:183], v[72:75], v[100:103], a[180:183]
    v_mfma_f32_16x16x32_bf16 a[184:187], v[76:79], v[96:99], a[184:187]
    v_mfma_f32_16x16x32_bf16 a[188:191], v[76:79], v[100:103], a[188:191]
    v_mfma_f32_16x16x32_bf16 a[192:195], v[80:83], v[96:99], a[192:195]
    v_mfma_f32_16x16x32_bf16 a[196:199], v[80:83], v[100:103], a[196:199]
    v_mfma_f32_16x16x32_bf16 a[200:203], v[84:87], v[96:99], a[200:203]
    v_mfma_f32_16x16x32_bf16 a[204:207], v[84:87], v[100:103], a[204:207]
    v_mfma_f32_16x16x32_bf16 a[208:211], v[88:91], v[96:99], a[208:211]
    v_mfma_f32_16x16x32_bf16 a[212:215], v[88:91], v[100:103], a[212:215]
    v_mfma_f32_16x16x32_bf16 a[216:219], v[92:95], v[96:99], a[216:219]
    v_mfma_f32_16x16x32_bf16 a[220:223], v[92:95], v[100:103], a[220:223]
    s_mov_b32 s6, 320
    buffer_load_dwordx4 v[68:71], v28, s[8:11], s6 offen sc1
    s_mov_b32 s6, 57664
    buffer_load_dwordx4 v[72:75], v28, s[8:11], s6 offen sc1
    s_mov_b32 s6, 115008
    buffer_load_dwordx4 v[76:79], v28, s[8:11], s6 offen sc1
    s_mov_b32 s6, 172352
    buffer_load_dwordx4 v[80:83], v28, s[8:11], s6 offen sc1
    s_mov_b32 s6, 229696
    buffer_load_dwordx4 v[84:87], v28, s[8:11], s6 offen sc1
    s_mov_b32 s6, 287040
    buffer_load_dwordx4 v[88:91], v28, s[8:11], s6 offen sc1
    s_mov_b32 s6, 344384
    buffer_load_dwordx4 v[92:95], v28, s[8:11], s6 offen sc1
    s_mov_b32 s6, 320
    buffer_load_dwordx4 v[96:99], v29, s[8:11], s6 offen sc1
    s_mov_b32 s6, 57664
    buffer_load_dwordx4 v[100:103], v29, s[8:11], s6 offen sc1
    s_waitcnt vmcnt(9) lgkmcnt(0)
    v_mfma_f32_16x16x32_bf16 a[168:171], v[32:35], v[60:63], a[168:171]
    v_mfma_f32_16x16x32_bf16 a[172:175], v[32:35], v[64:67], a[172:175]
    v_mfma_f32_16x16x32_bf16 a[176:179], v[36:39], v[60:63], a[176:179]
    v_mfma_f32_16x16x32_bf16 a[180:183], v[36:39], v[64:67], a[180:183]
    v_mfma_f32_16x16x32_bf16 a[184:187], v[40:43], v[60:63], a[184:187]
    v_mfma_f32_16x16x32_bf16 a[188:191], v[40:43], v[64:67], a[188:191]
    v_mfma_f32_16x16x32_bf16 a[192:195], v[44:47], v[60:63], a[192:195]
    v_mfma_f32_16x16x32_bf16 a[196:199], v[44:47], v[64:67], a[196:199]
    v_mfma_f32_16x16x32_bf16 a[200:203], v[48:51], v[60:63], a[200:203]
    v_mfma_f32_16x16x32_bf16 a[204:207], v[48:51], v[64:67], a[204:207]
    v_mfma_f32_16x16x32_bf16 a[208:211], v[52:55], v[60:63], a[208:211]
    v_mfma_f32_16x16x32_bf16 a[212:215], v[52:55], v[64:67], a[212:215]
    v_mfma_f32_16x16x32_bf16 a[216:219], v[56:59], v[60:63], a[216:219]
    v_mfma_f32_16x16x32_bf16 a[220:223], v[56:59], v[64:67], a[220:223]
    s_mov_b32 s6, 384
    buffer_load_dwordx4 v[32:35], v28, s[8:11], s6 offen sc1
    s_mov_b32 s6, 57728
    buffer_load_dwordx4 v[36:39], v28, s[8:11], s6 offen sc1
    s_mov_b32 s6, 115072
    buffer_load_dwordx4 v[40:43], v28, s[8:11], s6 offen sc1
    s_mov_b32 s6, 172416
    buffer_load_dwordx4 v[44:47], v28, s[8:11], s6 offen sc1
    s_mov_b32 s6, 229760
    buffer_load_dwordx4 v[48:51], v28, s[8:11], s6 offen sc1
    s_mov_b32 s6, 287104
    buffer_load_dwordx4 v[52:55], v28, s[8:11], s6 offen sc1
    s_mov_b32 s6, 344448
    buffer_load_dwordx4 v[56:59], v28, s[8:11], s6 offen sc1
    s_mov_b32 s6, 384
    buffer_load_dwordx4 v[60:63], v29, s[8:11], s6 offen sc1
    s_mov_b32 s6, 57728
    buffer_load_dwordx4 v[64:67], v29, s[8:11], s6 offen sc1
    s_waitcnt vmcnt(9) lgkmcnt(0)
    v_mfma_f32_16x16x32_bf16 a[168:171], v[68:71], v[96:99], a[168:171]
    v_mfma_f32_16x16x32_bf16 a[172:175], v[68:71], v[100:103], a[172:175]
    v_mfma_f32_16x16x32_bf16 a[176:179], v[72:75], v[96:99], a[176:179]
    v_mfma_f32_16x16x32_bf16 a[180:183], v[72:75], v[100:103], a[180:183]
    v_mfma_f32_16x16x32_bf16 a[184:187], v[76:79], v[96:99], a[184:187]
    v_mfma_f32_16x16x32_bf16 a[188:191], v[76:79], v[100:103], a[188:191]
    v_mfma_f32_16x16x32_bf16 a[192:195], v[80:83], v[96:99], a[192:195]
    v_mfma_f32_16x16x32_bf16 a[196:199], v[80:83], v[100:103], a[196:199]
    v_mfma_f32_16x16x32_bf16 a[200:203], v[84:87], v[96:99], a[200:203]
    v_mfma_f32_16x16x32_bf16 a[204:207], v[84:87], v[100:103], a[204:207]
    v_mfma_f32_16x16x32_bf16 a[208:211], v[88:91], v[96:99], a[208:211]
    v_mfma_f32_16x16x32_bf16 a[212:215], v[88:91], v[100:103], a[212:215]
    v_mfma_f32_16x16x32_bf16 a[216:219], v[92:95], v[96:99], a[216:219]
    v_mfma_f32_16x16x32_bf16 a[220:223], v[92:95], v[100:103], a[220:223]
    s_mov_b32 s6, 448
    buffer_load_dwordx4 v[68:71], v28, s[8:11], s6 offen sc1
    s_mov_b32 s6, 57792
    buffer_load_dwordx4 v[72:75], v28, s[8:11], s6 offen sc1
    s_mov_b32 s6, 115136
    buffer_load_dwordx4 v[76:79], v28, s[8:11], s6 offen sc1
    s_mov_b32 s6, 172480
    buffer_load_dwordx4 v[80:83], v28, s[8:11], s6 offen sc1
    s_mov_b32 s6, 229824
    buffer_load_dwordx4 v[84:87], v28, s[8:11], s6 offen sc1
    s_mov_b32 s6, 287168
    buffer_load_dwordx4 v[88:91], v28, s[8:11], s6 offen sc1
    s_mov_b32 s6, 344512
    buffer_load_dwordx4 v[92:95], v28, s[8:11], s6 offen sc1
    s_mov_b32 s6, 448
    buffer_load_dwordx4 v[96:99], v29, s[8:11], s6 offen sc1
    s_mov_b32 s6, 57792
    buffer_load_dwordx4 v[100:103], v29, s[8:11], s6 offen sc1
    s_waitcnt vmcnt(9) lgkmcnt(0)
    v_mfma_f32_16x16x32_bf16 a[168:171], v[32:35], v[60:63], a[168:171]
    v_mfma_f32_16x16x32_bf16 a[172:175], v[32:35], v[64:67], a[172:175]
    v_mfma_f32_16x16x32_bf16 a[176:179], v[36:39], v[60:63], a[176:179]
    v_mfma_f32_16x16x32_bf16 a[180:183], v[36:39], v[64:67], a[180:183]
    v_mfma_f32_16x16x32_bf16 a[184:187], v[40:43], v[60:63], a[184:187]
    v_mfma_f32_16x16x32_bf16 a[188:191], v[40:43], v[64:67], a[188:191]
    v_mfma_f32_16x16x32_bf16 a[192:195], v[44:47], v[60:63], a[192:195]
    v_mfma_f32_16x16x32_bf16 a[196:199], v[44:47], v[64:67], a[196:199]
    v_mfma_f32_16x16x32_bf16 a[200:203], v[48:51], v[60:63], a[200:203]
    v_mfma_f32_16x16x32_bf16 a[204:207], v[48:51], v[64:67], a[204:207]
    v_mfma_f32_16x16x32_bf16 a[208:211], v[52:55], v[60:63], a[208:211]
    v_mfma_f32_16x16x32_bf16 a[212:215], v[52:55], v[64:67], a[212:215]
    v_mfma_f32_16x16x32_bf16 a[216:219], v[56:59], v[60:63], a[216:219]
    v_mfma_f32_16x16x32_bf16 a[220:223], v[56:59], v[64:67], a[220:223]
    s_mov_b32 s6, 512
    buffer_load_dwordx4 v[32:35], v28, s[8:11], s6 offen sc1
    s_mov_b32 s6, 57856
    buffer_load_dwordx4 v[36:39], v28, s[8:11], s6 offen sc1
    s_mov_b32 s6, 115200
    buffer_load_dwordx4 v[40:43], v28, s[8:11], s6 offen sc1
    s_mov_b32 s6, 172544
    buffer_load_dwordx4 v[44:47], v28, s[8:11], s6 offen sc1
    s_mov_b32 s6, 229888
    buffer_load_dwordx4 v[48:51], v28, s[8:11], s6 offen sc1
    s_mov_b32 s6, 287232
    buffer_load_dwordx4 v[52:55], v28, s[8:11], s6 offen sc1
    s_mov_b32 s6, 344576
    buffer_load_dwordx4 v[56:59], v28, s[8:11], s6 offen sc1
    s_mov_b32 s6, 512
    buffer_load_dwordx4 v[60:63], v29, s[8:11], s6 offen sc1
    s_mov_b32 s6, 57856
    buffer_load_dwordx4 v[64:67], v29, s[8:11], s6 offen sc1
    s_waitcnt vmcnt(9) lgkmcnt(0)
    v_mfma_f32_16x16x32_bf16 a[168:171], v[68:71], v[96:99], a[168:171]
    v_mfma_f32_16x16x32_bf16 a[172:175], v[68:71], v[100:103], a[172:175]
    v_mfma_f32_16x16x32_bf16 a[176:179], v[72:75], v[96:99], a[176:179]
    v_mfma_f32_16x16x32_bf16 a[180:183], v[72:75], v[100:103], a[180:183]
    v_mfma_f32_16x16x32_bf16 a[184:187], v[76:79], v[96:99], a[184:187]
    v_mfma_f32_16x16x32_bf16 a[188:191], v[76:79], v[100:103], a[188:191]
    v_mfma_f32_16x16x32_bf16 a[192:195], v[80:83], v[96:99], a[192:195]
    v_mfma_f32_16x16x32_bf16 a[196:199], v[80:83], v[100:103], a[196:199]
    v_mfma_f32_16x16x32_bf16 a[200:203], v[84:87], v[96:99], a[200:203]
    v_mfma_f32_16x16x32_bf16 a[204:207], v[84:87], v[100:103], a[204:207]
    v_mfma_f32_16x16x32_bf16 a[208:211], v[88:91], v[96:99], a[208:211]
    v_mfma_f32_16x16x32_bf16 a[212:215], v[88:91], v[100:103], a[212:215]
    v_mfma_f32_16x16x32_bf16 a[216:219], v[92:95], v[96:99], a[216:219]
    v_mfma_f32_16x16x32_bf16 a[220:223], v[92:95], v[100:103], a[220:223]
    s_mov_b32 s6, 576
    buffer_load_dwordx4 v[68:71], v28, s[8:11], s6 offen sc1
    s_mov_b32 s6, 57920
    buffer_load_dwordx4 v[72:75], v28, s[8:11], s6 offen sc1
    s_mov_b32 s6, 115264
    buffer_load_dwordx4 v[76:79], v28, s[8:11], s6 offen sc1
    s_mov_b32 s6, 172608
    buffer_load_dwordx4 v[80:83], v28, s[8:11], s6 offen sc1
    s_mov_b32 s6, 229952
    buffer_load_dwordx4 v[84:87], v28, s[8:11], s6 offen sc1
    s_mov_b32 s6, 287296
    buffer_load_dwordx4 v[88:91], v28, s[8:11], s6 offen sc1
    s_mov_b32 s6, 344640
    buffer_load_dwordx4 v[92:95], v28, s[8:11], s6 offen sc1
    s_mov_b32 s6, 576
    buffer_load_dwordx4 v[96:99], v29, s[8:11], s6 offen sc1
    s_mov_b32 s6, 57920
    buffer_load_dwordx4 v[100:103], v29, s[8:11], s6 offen sc1
    s_waitcnt vmcnt(9) lgkmcnt(0)
    v_mfma_f32_16x16x32_bf16 a[168:171], v[32:35], v[60:63], a[168:171]
    v_mfma_f32_16x16x32_bf16 a[172:175], v[32:35], v[64:67], a[172:175]
    v_mfma_f32_16x16x32_bf16 a[176:179], v[36:39], v[60:63], a[176:179]
    v_mfma_f32_16x16x32_bf16 a[180:183], v[36:39], v[64:67], a[180:183]
    v_mfma_f32_16x16x32_bf16 a[184:187], v[40:43], v[60:63], a[184:187]
    v_mfma_f32_16x16x32_bf16 a[188:191], v[40:43], v[64:67], a[188:191]
    v_mfma_f32_16x16x32_bf16 a[192:195], v[44:47], v[60:63], a[192:195]
    v_mfma_f32_16x16x32_bf16 a[196:199], v[44:47], v[64:67], a[196:199]
    v_mfma_f32_16x16x32_bf16 a[200:203], v[48:51], v[60:63], a[200:203]
    v_mfma_f32_16x16x32_bf16 a[204:207], v[48:51], v[64:67], a[204:207]
    v_mfma_f32_16x16x32_bf16 a[208:211], v[52:55], v[60:63], a[208:211]
    v_mfma_f32_16x16x32_bf16 a[212:215], v[52:55], v[64:67], a[212:215]
    v_mfma_f32_16x16x32_bf16 a[216:219], v[56:59], v[60:63], a[216:219]
    v_mfma_f32_16x16x32_bf16 a[220:223], v[56:59], v[64:67], a[220:223]
    s_mov_b32 s6, 640
    buffer_load_dwordx4 v[32:35], v28, s[8:11], s6 offen sc1
    s_mov_b32 s6, 57984
    buffer_load_dwordx4 v[36:39], v28, s[8:11], s6 offen sc1
    s_mov_b32 s6, 115328
    buffer_load_dwordx4 v[40:43], v28, s[8:11], s6 offen sc1
    s_mov_b32 s6, 172672
    buffer_load_dwordx4 v[44:47], v28, s[8:11], s6 offen sc1
    s_mov_b32 s6, 230016
    buffer_load_dwordx4 v[48:51], v28, s[8:11], s6 offen sc1
    s_mov_b32 s6, 287360
    buffer_load_dwordx4 v[52:55], v28, s[8:11], s6 offen sc1
    s_mov_b32 s6, 344704
    buffer_load_dwordx4 v[56:59], v28, s[8:11], s6 offen sc1
    s_mov_b32 s6, 640
    buffer_load_dwordx4 v[60:63], v29, s[8:11], s6 offen sc1
    s_mov_b32 s6, 57984
    buffer_load_dwordx4 v[64:67], v29, s[8:11], s6 offen sc1
    s_waitcnt vmcnt(9) lgkmcnt(0)
    v_mfma_f32_16x16x32_bf16 a[168:171], v[68:71], v[96:99], a[168:171]
    v_mfma_f32_16x16x32_bf16 a[172:175], v[68:71], v[100:103], a[172:175]
    v_mfma_f32_16x16x32_bf16 a[176:179], v[72:75], v[96:99], a[176:179]
    v_mfma_f32_16x16x32_bf16 a[180:183], v[72:75], v[100:103], a[180:183]
    v_mfma_f32_16x16x32_bf16 a[184:187], v[76:79], v[96:99], a[184:187]
    v_mfma_f32_16x16x32_bf16 a[188:191], v[76:79], v[100:103], a[188:191]
    v_mfma_f32_16x16x32_bf16 a[192:195], v[80:83], v[96:99], a[192:195]
    v_mfma_f32_16x16x32_bf16 a[196:199], v[80:83], v[100:103], a[196:199]
    v_mfma_f32_16x16x32_bf16 a[200:203], v[84:87], v[96:99], a[200:203]
    v_mfma_f32_16x16x32_bf16 a[204:207], v[84:87], v[100:103], a[204:207]
    v_mfma_f32_16x16x32_bf16 a[208:211], v[88:91], v[96:99], a[208:211]
    v_mfma_f32_16x16x32_bf16 a[212:215], v[88:91], v[100:103], a[212:215]
    v_mfma_f32_16x16x32_bf16 a[216:219], v[92:95], v[96:99], a[216:219]
    v_mfma_f32_16x16x32_bf16 a[220:223], v[92:95], v[100:103], a[220:223]
    s_mov_b32 s6, 704
    buffer_load_dwordx4 v[68:71], v28, s[8:11], s6 offen sc1
    s_mov_b32 s6, 58048
    buffer_load_dwordx4 v[72:75], v28, s[8:11], s6 offen sc1
    s_mov_b32 s6, 115392
    buffer_load_dwordx4 v[76:79], v28, s[8:11], s6 offen sc1
    s_mov_b32 s6, 172736
    buffer_load_dwordx4 v[80:83], v28, s[8:11], s6 offen sc1
    s_mov_b32 s6, 230080
    buffer_load_dwordx4 v[84:87], v28, s[8:11], s6 offen sc1
    s_mov_b32 s6, 287424
    buffer_load_dwordx4 v[88:91], v28, s[8:11], s6 offen sc1
    s_mov_b32 s6, 344768
    buffer_load_dwordx4 v[92:95], v28, s[8:11], s6 offen sc1
    s_mov_b32 s6, 704
    buffer_load_dwordx4 v[96:99], v29, s[8:11], s6 offen sc1
    s_mov_b32 s6, 58048
    buffer_load_dwordx4 v[100:103], v29, s[8:11], s6 offen sc1
    s_waitcnt vmcnt(9) lgkmcnt(0)
    v_mfma_f32_16x16x32_bf16 a[168:171], v[32:35], v[60:63], a[168:171]
    v_mfma_f32_16x16x32_bf16 a[172:175], v[32:35], v[64:67], a[172:175]
    v_mfma_f32_16x16x32_bf16 a[176:179], v[36:39], v[60:63], a[176:179]
    v_mfma_f32_16x16x32_bf16 a[180:183], v[36:39], v[64:67], a[180:183]
    v_mfma_f32_16x16x32_bf16 a[184:187], v[40:43], v[60:63], a[184:187]
    v_mfma_f32_16x16x32_bf16 a[188:191], v[40:43], v[64:67], a[188:191]
    v_mfma_f32_16x16x32_bf16 a[192:195], v[44:47], v[60:63], a[192:195]
    v_mfma_f32_16x16x32_bf16 a[196:199], v[44:47], v[64:67], a[196:199]
    v_mfma_f32_16x16x32_bf16 a[200:203], v[48:51], v[60:63], a[200:203]
    v_mfma_f32_16x16x32_bf16 a[204:207], v[48:51], v[64:67], a[204:207]
    v_mfma_f32_16x16x32_bf16 a[208:211], v[52:55], v[60:63], a[208:211]
    v_mfma_f32_16x16x32_bf16 a[212:215], v[52:55], v[64:67], a[212:215]
    v_mfma_f32_16x16x32_bf16 a[216:219], v[56:59], v[60:63], a[216:219]
    v_mfma_f32_16x16x32_bf16 a[220:223], v[56:59], v[64:67], a[220:223]
    s_mov_b32 s6, 768
    buffer_load_dwordx4 v[32:35], v28, s[8:11], s6 offen sc1
    s_mov_b32 s6, 58112
    buffer_load_dwordx4 v[36:39], v28, s[8:11], s6 offen sc1
    s_mov_b32 s6, 115456
    buffer_load_dwordx4 v[40:43], v28, s[8:11], s6 offen sc1
    s_mov_b32 s6, 172800
    buffer_load_dwordx4 v[44:47], v28, s[8:11], s6 offen sc1
    s_mov_b32 s6, 230144
    buffer_load_dwordx4 v[48:51], v28, s[8:11], s6 offen sc1
    s_mov_b32 s6, 287488
    buffer_load_dwordx4 v[52:55], v28, s[8:11], s6 offen sc1
    s_mov_b32 s6, 344832
    buffer_load_dwordx4 v[56:59], v28, s[8:11], s6 offen sc1
    s_mov_b32 s6, 768
    buffer_load_dwordx4 v[60:63], v29, s[8:11], s6 offen sc1
    s_mov_b32 s6, 58112
    buffer_load_dwordx4 v[64:67], v29, s[8:11], s6 offen sc1
    s_waitcnt vmcnt(9) lgkmcnt(0)
    v_mfma_f32_16x16x32_bf16 a[168:171], v[68:71], v[96:99], a[168:171]
    v_mfma_f32_16x16x32_bf16 a[172:175], v[68:71], v[100:103], a[172:175]
    v_mfma_f32_16x16x32_bf16 a[176:179], v[72:75], v[96:99], a[176:179]
    v_mfma_f32_16x16x32_bf16 a[180:183], v[72:75], v[100:103], a[180:183]
    v_mfma_f32_16x16x32_bf16 a[184:187], v[76:79], v[96:99], a[184:187]
    v_mfma_f32_16x16x32_bf16 a[188:191], v[76:79], v[100:103], a[188:191]
    v_mfma_f32_16x16x32_bf16 a[192:195], v[80:83], v[96:99], a[192:195]
    v_mfma_f32_16x16x32_bf16 a[196:199], v[80:83], v[100:103], a[196:199]
    v_mfma_f32_16x16x32_bf16 a[200:203], v[84:87], v[96:99], a[200:203]
    v_mfma_f32_16x16x32_bf16 a[204:207], v[84:87], v[100:103], a[204:207]
    v_mfma_f32_16x16x32_bf16 a[208:211], v[88:91], v[96:99], a[208:211]
    v_mfma_f32_16x16x32_bf16 a[212:215], v[88:91], v[100:103], a[212:215]
    v_mfma_f32_16x16x32_bf16 a[216:219], v[92:95], v[96:99], a[216:219]
    v_mfma_f32_16x16x32_bf16 a[220:223], v[92:95], v[100:103], a[220:223]
    s_mov_b32 s6, 832
    buffer_load_dwordx4 v[68:71], v28, s[8:11], s6 offen sc1
    s_mov_b32 s6, 58176
    buffer_load_dwordx4 v[72:75], v28, s[8:11], s6 offen sc1
    s_mov_b32 s6, 115520
    buffer_load_dwordx4 v[76:79], v28, s[8:11], s6 offen sc1
    s_mov_b32 s6, 172864
    buffer_load_dwordx4 v[80:83], v28, s[8:11], s6 offen sc1
    s_mov_b32 s6, 230208
    buffer_load_dwordx4 v[84:87], v28, s[8:11], s6 offen sc1
    s_mov_b32 s6, 287552
    buffer_load_dwordx4 v[88:91], v28, s[8:11], s6 offen sc1
    s_mov_b32 s6, 344896
    buffer_load_dwordx4 v[92:95], v28, s[8:11], s6 offen sc1
    s_mov_b32 s6, 832
    buffer_load_dwordx4 v[96:99], v29, s[8:11], s6 offen sc1
    s_mov_b32 s6, 58176
    buffer_load_dwordx4 v[100:103], v29, s[8:11], s6 offen sc1
    s_waitcnt vmcnt(9) lgkmcnt(0)
    v_mfma_f32_16x16x32_bf16 a[168:171], v[32:35], v[60:63], a[168:171]
    v_mfma_f32_16x16x32_bf16 a[172:175], v[32:35], v[64:67], a[172:175]
    v_mfma_f32_16x16x32_bf16 a[176:179], v[36:39], v[60:63], a[176:179]
    v_mfma_f32_16x16x32_bf16 a[180:183], v[36:39], v[64:67], a[180:183]
    v_mfma_f32_16x16x32_bf16 a[184:187], v[40:43], v[60:63], a[184:187]
    v_mfma_f32_16x16x32_bf16 a[188:191], v[40:43], v[64:67], a[188:191]
    v_mfma_f32_16x16x32_bf16 a[192:195], v[44:47], v[60:63], a[192:195]
    v_mfma_f32_16x16x32_bf16 a[196:199], v[44:47], v[64:67], a[196:199]
    v_mfma_f32_16x16x32_bf16 a[200:203], v[48:51], v[60:63], a[200:203]
    v_mfma_f32_16x16x32_bf16 a[204:207], v[48:51], v[64:67], a[204:207]
    v_mfma_f32_16x16x32_bf16 a[208:211], v[52:55], v[60:63], a[208:211]
    v_mfma_f32_16x16x32_bf16 a[212:215], v[52:55], v[64:67], a[212:215]
    v_mfma_f32_16x16x32_bf16 a[216:219], v[56:59], v[60:63], a[216:219]
    v_mfma_f32_16x16x32_bf16 a[220:223], v[56:59], v[64:67], a[220:223]
    s_mov_b32 s6, 896
    buffer_load_dwordx4 v[32:35], v28, s[8:11], s6 offen sc1
    s_mov_b32 s6, 58240
    buffer_load_dwordx4 v[36:39], v28, s[8:11], s6 offen sc1
    s_mov_b32 s6, 115584
    buffer_load_dwordx4 v[40:43], v28, s[8:11], s6 offen sc1
    s_mov_b32 s6, 172928
    buffer_load_dwordx4 v[44:47], v28, s[8:11], s6 offen sc1
    s_mov_b32 s6, 230272
    buffer_load_dwordx4 v[48:51], v28, s[8:11], s6 offen sc1
    s_mov_b32 s6, 287616
    buffer_load_dwordx4 v[52:55], v28, s[8:11], s6 offen sc1
    s_mov_b32 s6, 344960
    buffer_load_dwordx4 v[56:59], v28, s[8:11], s6 offen sc1
    s_mov_b32 s6, 896
    buffer_load_dwordx4 v[60:63], v29, s[8:11], s6 offen sc1
    s_mov_b32 s6, 58240
    buffer_load_dwordx4 v[64:67], v29, s[8:11], s6 offen sc1
    s_waitcnt vmcnt(9) lgkmcnt(0)
    v_mfma_f32_16x16x32_bf16 a[168:171], v[68:71], v[96:99], a[168:171]
    v_mfma_f32_16x16x32_bf16 a[172:175], v[68:71], v[100:103], a[172:175]
    v_mfma_f32_16x16x32_bf16 a[176:179], v[72:75], v[96:99], a[176:179]
    v_mfma_f32_16x16x32_bf16 a[180:183], v[72:75], v[100:103], a[180:183]
    v_mfma_f32_16x16x32_bf16 a[184:187], v[76:79], v[96:99], a[184:187]
    v_mfma_f32_16x16x32_bf16 a[188:191], v[76:79], v[100:103], a[188:191]
    v_mfma_f32_16x16x32_bf16 a[192:195], v[80:83], v[96:99], a[192:195]
    v_mfma_f32_16x16x32_bf16 a[196:199], v[80:83], v[100:103], a[196:199]
    v_mfma_f32_16x16x32_bf16 a[200:203], v[84:87], v[96:99], a[200:203]
    v_mfma_f32_16x16x32_bf16 a[204:207], v[84:87], v[100:103], a[204:207]
    v_mfma_f32_16x16x32_bf16 a[208:211], v[88:91], v[96:99], a[208:211]
    v_mfma_f32_16x16x32_bf16 a[212:215], v[88:91], v[100:103], a[212:215]
    v_mfma_f32_16x16x32_bf16 a[216:219], v[92:95], v[96:99], a[216:219]
    v_mfma_f32_16x16x32_bf16 a[220:223], v[92:95], v[100:103], a[220:223]
    s_mov_b32 s6, 960
    buffer_load_dwordx4 v[68:71], v28, s[8:11], s6 offen sc1
    s_mov_b32 s6, 58304
    buffer_load_dwordx4 v[72:75], v28, s[8:11], s6 offen sc1
    s_mov_b32 s6, 115648
    buffer_load_dwordx4 v[76:79], v28, s[8:11], s6 offen sc1
    s_mov_b32 s6, 172992
    buffer_load_dwordx4 v[80:83], v28, s[8:11], s6 offen sc1
    s_mov_b32 s6, 230336
    buffer_load_dwordx4 v[84:87], v28, s[8:11], s6 offen sc1
    s_mov_b32 s6, 287680
    buffer_load_dwordx4 v[88:91], v28, s[8:11], s6 offen sc1
    s_mov_b32 s6, 345024
    buffer_load_dwordx4 v[92:95], v28, s[8:11], s6 offen sc1
    s_mov_b32 s6, 960
    buffer_load_dwordx4 v[96:99], v29, s[8:11], s6 offen sc1
    s_mov_b32 s6, 58304
    buffer_load_dwordx4 v[100:103], v29, s[8:11], s6 offen sc1
    s_waitcnt vmcnt(9) lgkmcnt(0)
    v_mfma_f32_16x16x32_bf16 a[168:171], v[32:35], v[60:63], a[168:171]
    v_mfma_f32_16x16x32_bf16 a[172:175], v[32:35], v[64:67], a[172:175]
    v_mfma_f32_16x16x32_bf16 a[176:179], v[36:39], v[60:63], a[176:179]
    v_mfma_f32_16x16x32_bf16 a[180:183], v[36:39], v[64:67], a[180:183]
    v_mfma_f32_16x16x32_bf16 a[184:187], v[40:43], v[60:63], a[184:187]
    v_mfma_f32_16x16x32_bf16 a[188:191], v[40:43], v[64:67], a[188:191]
    v_mfma_f32_16x16x32_bf16 a[192:195], v[44:47], v[60:63], a[192:195]
    v_mfma_f32_16x16x32_bf16 a[196:199], v[44:47], v[64:67], a[196:199]
    v_mfma_f32_16x16x32_bf16 a[200:203], v[48:51], v[60:63], a[200:203]
    v_mfma_f32_16x16x32_bf16 a[204:207], v[48:51], v[64:67], a[204:207]
    v_mfma_f32_16x16x32_bf16 a[208:211], v[52:55], v[60:63], a[208:211]
    v_mfma_f32_16x16x32_bf16 a[212:215], v[52:55], v[64:67], a[212:215]
    v_mfma_f32_16x16x32_bf16 a[216:219], v[56:59], v[60:63], a[216:219]
    v_mfma_f32_16x16x32_bf16 a[220:223], v[56:59], v[64:67], a[220:223]
    s_mov_b32 s6, 1024
    buffer_load_dwordx4 v[32:35], v28, s[8:11], s6 offen sc1
    s_mov_b32 s6, 58368
    buffer_load_dwordx4 v[36:39], v28, s[8:11], s6 offen sc1
    s_mov_b32 s6, 115712
    buffer_load_dwordx4 v[40:43], v28, s[8:11], s6 offen sc1
    s_mov_b32 s6, 173056
    buffer_load_dwordx4 v[44:47], v28, s[8:11], s6 offen sc1
    s_mov_b32 s6, 230400
    buffer_load_dwordx4 v[48:51], v28, s[8:11], s6 offen sc1
    s_mov_b32 s6, 287744
    buffer_load_dwordx4 v[52:55], v28, s[8:11], s6 offen sc1
    s_mov_b32 s6, 345088
    buffer_load_dwordx4 v[56:59], v28, s[8:11], s6 offen sc1
    s_mov_b32 s6, 1024
    buffer_load_dwordx4 v[60:63], v29, s[8:11], s6 offen sc1
    s_mov_b32 s6, 58368
    buffer_load_dwordx4 v[64:67], v29, s[8:11], s6 offen sc1
    s_waitcnt vmcnt(9) lgkmcnt(0)
    v_mfma_f32_16x16x32_bf16 a[168:171], v[68:71], v[96:99], a[168:171]
    v_mfma_f32_16x16x32_bf16 a[172:175], v[68:71], v[100:103], a[172:175]
    v_mfma_f32_16x16x32_bf16 a[176:179], v[72:75], v[96:99], a[176:179]
    v_mfma_f32_16x16x32_bf16 a[180:183], v[72:75], v[100:103], a[180:183]
    v_mfma_f32_16x16x32_bf16 a[184:187], v[76:79], v[96:99], a[184:187]
    v_mfma_f32_16x16x32_bf16 a[188:191], v[76:79], v[100:103], a[188:191]
    v_mfma_f32_16x16x32_bf16 a[192:195], v[80:83], v[96:99], a[192:195]
    v_mfma_f32_16x16x32_bf16 a[196:199], v[80:83], v[100:103], a[196:199]
    v_mfma_f32_16x16x32_bf16 a[200:203], v[84:87], v[96:99], a[200:203]
    v_mfma_f32_16x16x32_bf16 a[204:207], v[84:87], v[100:103], a[204:207]
    v_mfma_f32_16x16x32_bf16 a[208:211], v[88:91], v[96:99], a[208:211]
    v_mfma_f32_16x16x32_bf16 a[212:215], v[88:91], v[100:103], a[212:215]
    v_mfma_f32_16x16x32_bf16 a[216:219], v[92:95], v[96:99], a[216:219]
    v_mfma_f32_16x16x32_bf16 a[220:223], v[92:95], v[100:103], a[220:223]
    s_mov_b32 s6, 1088
    buffer_load_dwordx4 v[68:71], v28, s[8:11], s6 offen sc1
    s_mov_b32 s6, 58432
    buffer_load_dwordx4 v[72:75], v28, s[8:11], s6 offen sc1
    s_mov_b32 s6, 115776
    buffer_load_dwordx4 v[76:79], v28, s[8:11], s6 offen sc1
    s_mov_b32 s6, 173120
    buffer_load_dwordx4 v[80:83], v28, s[8:11], s6 offen sc1
    s_mov_b32 s6, 230464
    buffer_load_dwordx4 v[84:87], v28, s[8:11], s6 offen sc1
    s_mov_b32 s6, 287808
    buffer_load_dwordx4 v[88:91], v28, s[8:11], s6 offen sc1
    s_mov_b32 s6, 345152
    buffer_load_dwordx4 v[92:95], v28, s[8:11], s6 offen sc1
    s_mov_b32 s6, 1088
    buffer_load_dwordx4 v[96:99], v29, s[8:11], s6 offen sc1
    s_mov_b32 s6, 58432
    buffer_load_dwordx4 v[100:103], v29, s[8:11], s6 offen sc1
    s_waitcnt vmcnt(9) lgkmcnt(0)
    v_mfma_f32_16x16x32_bf16 a[168:171], v[32:35], v[60:63], a[168:171]
    v_mfma_f32_16x16x32_bf16 a[172:175], v[32:35], v[64:67], a[172:175]
    v_mfma_f32_16x16x32_bf16 a[176:179], v[36:39], v[60:63], a[176:179]
    v_mfma_f32_16x16x32_bf16 a[180:183], v[36:39], v[64:67], a[180:183]
    v_mfma_f32_16x16x32_bf16 a[184:187], v[40:43], v[60:63], a[184:187]
    v_mfma_f32_16x16x32_bf16 a[188:191], v[40:43], v[64:67], a[188:191]
    v_mfma_f32_16x16x32_bf16 a[192:195], v[44:47], v[60:63], a[192:195]
    v_mfma_f32_16x16x32_bf16 a[196:199], v[44:47], v[64:67], a[196:199]
    v_mfma_f32_16x16x32_bf16 a[200:203], v[48:51], v[60:63], a[200:203]
    v_mfma_f32_16x16x32_bf16 a[204:207], v[48:51], v[64:67], a[204:207]
    v_mfma_f32_16x16x32_bf16 a[208:211], v[52:55], v[60:63], a[208:211]
    v_mfma_f32_16x16x32_bf16 a[212:215], v[52:55], v[64:67], a[212:215]
    v_mfma_f32_16x16x32_bf16 a[216:219], v[56:59], v[60:63], a[216:219]
    v_mfma_f32_16x16x32_bf16 a[220:223], v[56:59], v[64:67], a[220:223]
    s_mov_b32 s6, 1152
    buffer_load_dwordx4 v[32:35], v28, s[8:11], s6 offen sc1
    s_mov_b32 s6, 58496
    buffer_load_dwordx4 v[36:39], v28, s[8:11], s6 offen sc1
    s_mov_b32 s6, 115840
    buffer_load_dwordx4 v[40:43], v28, s[8:11], s6 offen sc1
    s_mov_b32 s6, 173184
    buffer_load_dwordx4 v[44:47], v28, s[8:11], s6 offen sc1
    s_mov_b32 s6, 230528
    buffer_load_dwordx4 v[48:51], v28, s[8:11], s6 offen sc1
    s_mov_b32 s6, 287872
    buffer_load_dwordx4 v[52:55], v28, s[8:11], s6 offen sc1
    s_mov_b32 s6, 345216
    buffer_load_dwordx4 v[56:59], v28, s[8:11], s6 offen sc1
    s_mov_b32 s6, 1152
    buffer_load_dwordx4 v[60:63], v29, s[8:11], s6 offen sc1
    s_mov_b32 s6, 58496
    buffer_load_dwordx4 v[64:67], v29, s[8:11], s6 offen sc1
    s_waitcnt vmcnt(9) lgkmcnt(0)
    v_mfma_f32_16x16x32_bf16 a[168:171], v[68:71], v[96:99], a[168:171]
    v_mfma_f32_16x16x32_bf16 a[172:175], v[68:71], v[100:103], a[172:175]
    v_mfma_f32_16x16x32_bf16 a[176:179], v[72:75], v[96:99], a[176:179]
    v_mfma_f32_16x16x32_bf16 a[180:183], v[72:75], v[100:103], a[180:183]
    v_mfma_f32_16x16x32_bf16 a[184:187], v[76:79], v[96:99], a[184:187]
    v_mfma_f32_16x16x32_bf16 a[188:191], v[76:79], v[100:103], a[188:191]
    v_mfma_f32_16x16x32_bf16 a[192:195], v[80:83], v[96:99], a[192:195]
    v_mfma_f32_16x16x32_bf16 a[196:199], v[80:83], v[100:103], a[196:199]
    v_mfma_f32_16x16x32_bf16 a[200:203], v[84:87], v[96:99], a[200:203]
    v_mfma_f32_16x16x32_bf16 a[204:207], v[84:87], v[100:103], a[204:207]
    v_mfma_f32_16x16x32_bf16 a[208:211], v[88:91], v[96:99], a[208:211]
    v_mfma_f32_16x16x32_bf16 a[212:215], v[88:91], v[100:103], a[212:215]
    v_mfma_f32_16x16x32_bf16 a[216:219], v[92:95], v[96:99], a[216:219]
    v_mfma_f32_16x16x32_bf16 a[220:223], v[92:95], v[100:103], a[220:223]
    s_mov_b32 s6, 1216
    buffer_load_dwordx4 v[68:71], v28, s[8:11], s6 offen sc1
    s_mov_b32 s6, 58560
    buffer_load_dwordx4 v[72:75], v28, s[8:11], s6 offen sc1
    s_mov_b32 s6, 115904
    buffer_load_dwordx4 v[76:79], v28, s[8:11], s6 offen sc1
    s_mov_b32 s6, 173248
    buffer_load_dwordx4 v[80:83], v28, s[8:11], s6 offen sc1
    s_mov_b32 s6, 230592
    buffer_load_dwordx4 v[84:87], v28, s[8:11], s6 offen sc1
    s_mov_b32 s6, 287936
    buffer_load_dwordx4 v[88:91], v28, s[8:11], s6 offen sc1
    s_mov_b32 s6, 345280
    buffer_load_dwordx4 v[92:95], v28, s[8:11], s6 offen sc1
    s_mov_b32 s6, 1216
    buffer_load_dwordx4 v[96:99], v29, s[8:11], s6 offen sc1
    s_mov_b32 s6, 58560
    buffer_load_dwordx4 v[100:103], v29, s[8:11], s6 offen sc1
    s_waitcnt vmcnt(9) lgkmcnt(0)
    v_mfma_f32_16x16x32_bf16 a[168:171], v[32:35], v[60:63], a[168:171]
    v_mfma_f32_16x16x32_bf16 a[172:175], v[32:35], v[64:67], a[172:175]
    v_mfma_f32_16x16x32_bf16 a[176:179], v[36:39], v[60:63], a[176:179]
    v_mfma_f32_16x16x32_bf16 a[180:183], v[36:39], v[64:67], a[180:183]
    v_mfma_f32_16x16x32_bf16 a[184:187], v[40:43], v[60:63], a[184:187]
    v_mfma_f32_16x16x32_bf16 a[188:191], v[40:43], v[64:67], a[188:191]
    v_mfma_f32_16x16x32_bf16 a[192:195], v[44:47], v[60:63], a[192:195]
    v_mfma_f32_16x16x32_bf16 a[196:199], v[44:47], v[64:67], a[196:199]
    v_mfma_f32_16x16x32_bf16 a[200:203], v[48:51], v[60:63], a[200:203]
    v_mfma_f32_16x16x32_bf16 a[204:207], v[48:51], v[64:67], a[204:207]
    v_mfma_f32_16x16x32_bf16 a[208:211], v[52:55], v[60:63], a[208:211]
    v_mfma_f32_16x16x32_bf16 a[212:215], v[52:55], v[64:67], a[212:215]
    v_mfma_f32_16x16x32_bf16 a[216:219], v[56:59], v[60:63], a[216:219]
    v_mfma_f32_16x16x32_bf16 a[220:223], v[56:59], v[64:67], a[220:223]
    s_mov_b32 s6, 1280
    buffer_load_dwordx4 v[32:35], v28, s[8:11], s6 offen sc1
    s_mov_b32 s6, 58624
    buffer_load_dwordx4 v[36:39], v28, s[8:11], s6 offen sc1
    s_mov_b32 s6, 115968
    buffer_load_dwordx4 v[40:43], v28, s[8:11], s6 offen sc1
    s_mov_b32 s6, 173312
    buffer_load_dwordx4 v[44:47], v28, s[8:11], s6 offen sc1
    s_mov_b32 s6, 230656
    buffer_load_dwordx4 v[48:51], v28, s[8:11], s6 offen sc1
    s_mov_b32 s6, 288000
    buffer_load_dwordx4 v[52:55], v28, s[8:11], s6 offen sc1
    s_mov_b32 s6, 345344
    buffer_load_dwordx4 v[56:59], v28, s[8:11], s6 offen sc1
    s_mov_b32 s6, 1280
    buffer_load_dwordx4 v[60:63], v29, s[8:11], s6 offen sc1
    s_mov_b32 s6, 58624
    buffer_load_dwordx4 v[64:67], v29, s[8:11], s6 offen sc1
    s_waitcnt vmcnt(9) lgkmcnt(0)
    v_mfma_f32_16x16x32_bf16 a[168:171], v[68:71], v[96:99], a[168:171]
    v_mfma_f32_16x16x32_bf16 a[172:175], v[68:71], v[100:103], a[172:175]
    v_mfma_f32_16x16x32_bf16 a[176:179], v[72:75], v[96:99], a[176:179]
    v_mfma_f32_16x16x32_bf16 a[180:183], v[72:75], v[100:103], a[180:183]
    v_mfma_f32_16x16x32_bf16 a[184:187], v[76:79], v[96:99], a[184:187]
    v_mfma_f32_16x16x32_bf16 a[188:191], v[76:79], v[100:103], a[188:191]
    v_mfma_f32_16x16x32_bf16 a[192:195], v[80:83], v[96:99], a[192:195]
    v_mfma_f32_16x16x32_bf16 a[196:199], v[80:83], v[100:103], a[196:199]
    v_mfma_f32_16x16x32_bf16 a[200:203], v[84:87], v[96:99], a[200:203]
    v_mfma_f32_16x16x32_bf16 a[204:207], v[84:87], v[100:103], a[204:207]
    v_mfma_f32_16x16x32_bf16 a[208:211], v[88:91], v[96:99], a[208:211]
    v_mfma_f32_16x16x32_bf16 a[212:215], v[88:91], v[100:103], a[212:215]
    v_mfma_f32_16x16x32_bf16 a[216:219], v[92:95], v[96:99], a[216:219]
    v_mfma_f32_16x16x32_bf16 a[220:223], v[92:95], v[100:103], a[220:223]
    s_mov_b32 s6, 1344
    buffer_load_dwordx4 v[68:71], v28, s[8:11], s6 offen sc1
    s_mov_b32 s6, 58688
    buffer_load_dwordx4 v[72:75], v28, s[8:11], s6 offen sc1
    s_mov_b32 s6, 116032
    buffer_load_dwordx4 v[76:79], v28, s[8:11], s6 offen sc1
    s_mov_b32 s6, 173376
    buffer_load_dwordx4 v[80:83], v28, s[8:11], s6 offen sc1
    s_mov_b32 s6, 230720
    buffer_load_dwordx4 v[84:87], v28, s[8:11], s6 offen sc1
    s_mov_b32 s6, 288064
    buffer_load_dwordx4 v[88:91], v28, s[8:11], s6 offen sc1
    s_mov_b32 s6, 345408
    buffer_load_dwordx4 v[92:95], v28, s[8:11], s6 offen sc1
    s_mov_b32 s6, 1344
    buffer_load_dwordx4 v[96:99], v29, s[8:11], s6 offen sc1
    s_mov_b32 s6, 58688
    buffer_load_dwordx4 v[100:103], v29, s[8:11], s6 offen sc1
    s_waitcnt vmcnt(9) lgkmcnt(0)
    v_mfma_f32_16x16x32_bf16 a[168:171], v[32:35], v[60:63], a[168:171]
    v_mfma_f32_16x16x32_bf16 a[172:175], v[32:35], v[64:67], a[172:175]
    v_mfma_f32_16x16x32_bf16 a[176:179], v[36:39], v[60:63], a[176:179]
    v_mfma_f32_16x16x32_bf16 a[180:183], v[36:39], v[64:67], a[180:183]
    v_mfma_f32_16x16x32_bf16 a[184:187], v[40:43], v[60:63], a[184:187]
    v_mfma_f32_16x16x32_bf16 a[188:191], v[40:43], v[64:67], a[188:191]
    v_mfma_f32_16x16x32_bf16 a[192:195], v[44:47], v[60:63], a[192:195]
    v_mfma_f32_16x16x32_bf16 a[196:199], v[44:47], v[64:67], a[196:199]
    v_mfma_f32_16x16x32_bf16 a[200:203], v[48:51], v[60:63], a[200:203]
    v_mfma_f32_16x16x32_bf16 a[204:207], v[48:51], v[64:67], a[204:207]
    v_mfma_f32_16x16x32_bf16 a[208:211], v[52:55], v[60:63], a[208:211]
    v_mfma_f32_16x16x32_bf16 a[212:215], v[52:55], v[64:67], a[212:215]
    v_mfma_f32_16x16x32_bf16 a[216:219], v[56:59], v[60:63], a[216:219]
    v_mfma_f32_16x16x32_bf16 a[220:223], v[56:59], v[64:67], a[220:223]
    s_mov_b32 s6, 1408
    buffer_load_dwordx4 v[32:35], v28, s[8:11], s6 offen sc1
    s_mov_b32 s6, 58752
    buffer_load_dwordx4 v[36:39], v28, s[8:11], s6 offen sc1
    s_mov_b32 s6, 116096
    buffer_load_dwordx4 v[40:43], v28, s[8:11], s6 offen sc1
    s_mov_b32 s6, 173440
    buffer_load_dwordx4 v[44:47], v28, s[8:11], s6 offen sc1
    s_mov_b32 s6, 230784
    buffer_load_dwordx4 v[48:51], v28, s[8:11], s6 offen sc1
    s_mov_b32 s6, 288128
    buffer_load_dwordx4 v[52:55], v28, s[8:11], s6 offen sc1
    s_mov_b32 s6, 345472
    buffer_load_dwordx4 v[56:59], v28, s[8:11], s6 offen sc1
    s_mov_b32 s6, 1408
    buffer_load_dwordx4 v[60:63], v29, s[8:11], s6 offen sc1
    s_mov_b32 s6, 58752
    buffer_load_dwordx4 v[64:67], v29, s[8:11], s6 offen sc1
    s_waitcnt vmcnt(9) lgkmcnt(0)
    v_mfma_f32_16x16x32_bf16 a[168:171], v[68:71], v[96:99], a[168:171]
    v_mfma_f32_16x16x32_bf16 a[172:175], v[68:71], v[100:103], a[172:175]
    v_mfma_f32_16x16x32_bf16 a[176:179], v[72:75], v[96:99], a[176:179]
    v_mfma_f32_16x16x32_bf16 a[180:183], v[72:75], v[100:103], a[180:183]
    v_mfma_f32_16x16x32_bf16 a[184:187], v[76:79], v[96:99], a[184:187]
    v_mfma_f32_16x16x32_bf16 a[188:191], v[76:79], v[100:103], a[188:191]
    v_mfma_f32_16x16x32_bf16 a[192:195], v[80:83], v[96:99], a[192:195]
    v_mfma_f32_16x16x32_bf16 a[196:199], v[80:83], v[100:103], a[196:199]
    v_mfma_f32_16x16x32_bf16 a[200:203], v[84:87], v[96:99], a[200:203]
    v_mfma_f32_16x16x32_bf16 a[204:207], v[84:87], v[100:103], a[204:207]
    v_mfma_f32_16x16x32_bf16 a[208:211], v[88:91], v[96:99], a[208:211]
    v_mfma_f32_16x16x32_bf16 a[212:215], v[88:91], v[100:103], a[212:215]
    v_mfma_f32_16x16x32_bf16 a[216:219], v[92:95], v[96:99], a[216:219]
    v_mfma_f32_16x16x32_bf16 a[220:223], v[92:95], v[100:103], a[220:223]
    s_mov_b32 s6, 1472
    buffer_load_dwordx4 v[68:71], v28, s[8:11], s6 offen sc1
    s_mov_b32 s6, 58816
    buffer_load_dwordx4 v[72:75], v28, s[8:11], s6 offen sc1
    s_mov_b32 s6, 116160
    buffer_load_dwordx4 v[76:79], v28, s[8:11], s6 offen sc1
    s_mov_b32 s6, 173504
    buffer_load_dwordx4 v[80:83], v28, s[8:11], s6 offen sc1
    s_mov_b32 s6, 230848
    buffer_load_dwordx4 v[84:87], v28, s[8:11], s6 offen sc1
    s_mov_b32 s6, 288192
    buffer_load_dwordx4 v[88:91], v28, s[8:11], s6 offen sc1
    s_mov_b32 s6, 345536
    buffer_load_dwordx4 v[92:95], v28, s[8:11], s6 offen sc1
    s_mov_b32 s6, 1472
    buffer_load_dwordx4 v[96:99], v29, s[8:11], s6 offen sc1
    s_mov_b32 s6, 58816
    buffer_load_dwordx4 v[100:103], v29, s[8:11], s6 offen sc1
    s_waitcnt vmcnt(9) lgkmcnt(0)
    v_mfma_f32_16x16x32_bf16 a[168:171], v[32:35], v[60:63], a[168:171]
    v_mfma_f32_16x16x32_bf16 a[172:175], v[32:35], v[64:67], a[172:175]
    v_mfma_f32_16x16x32_bf16 a[176:179], v[36:39], v[60:63], a[176:179]
    v_mfma_f32_16x16x32_bf16 a[180:183], v[36:39], v[64:67], a[180:183]
    v_mfma_f32_16x16x32_bf16 a[184:187], v[40:43], v[60:63], a[184:187]
    v_mfma_f32_16x16x32_bf16 a[188:191], v[40:43], v[64:67], a[188:191]
    v_mfma_f32_16x16x32_bf16 a[192:195], v[44:47], v[60:63], a[192:195]
    v_mfma_f32_16x16x32_bf16 a[196:199], v[44:47], v[64:67], a[196:199]
    v_mfma_f32_16x16x32_bf16 a[200:203], v[48:51], v[60:63], a[200:203]
    v_mfma_f32_16x16x32_bf16 a[204:207], v[48:51], v[64:67], a[204:207]
    v_mfma_f32_16x16x32_bf16 a[208:211], v[52:55], v[60:63], a[208:211]
    v_mfma_f32_16x16x32_bf16 a[212:215], v[52:55], v[64:67], a[212:215]
    v_mfma_f32_16x16x32_bf16 a[216:219], v[56:59], v[60:63], a[216:219]
    v_mfma_f32_16x16x32_bf16 a[220:223], v[56:59], v[64:67], a[220:223]
    s_mov_b32 s6, 1536
    buffer_load_dwordx4 v[32:35], v28, s[8:11], s6 offen sc1
    s_mov_b32 s6, 58880
    buffer_load_dwordx4 v[36:39], v28, s[8:11], s6 offen sc1
    s_mov_b32 s6, 116224
    buffer_load_dwordx4 v[40:43], v28, s[8:11], s6 offen sc1
    s_mov_b32 s6, 173568
    buffer_load_dwordx4 v[44:47], v28, s[8:11], s6 offen sc1
    s_mov_b32 s6, 230912
    buffer_load_dwordx4 v[48:51], v28, s[8:11], s6 offen sc1
    s_mov_b32 s6, 288256
    buffer_load_dwordx4 v[52:55], v28, s[8:11], s6 offen sc1
    s_mov_b32 s6, 345600
    buffer_load_dwordx4 v[56:59], v28, s[8:11], s6 offen sc1
    s_mov_b32 s6, 1536
    buffer_load_dwordx4 v[60:63], v29, s[8:11], s6 offen sc1
    s_mov_b32 s6, 58880
    buffer_load_dwordx4 v[64:67], v29, s[8:11], s6 offen sc1
    s_waitcnt vmcnt(9) lgkmcnt(0)
    v_mfma_f32_16x16x32_bf16 a[168:171], v[68:71], v[96:99], a[168:171]
    v_mfma_f32_16x16x32_bf16 a[172:175], v[68:71], v[100:103], a[172:175]
    v_mfma_f32_16x16x32_bf16 a[176:179], v[72:75], v[96:99], a[176:179]
    v_mfma_f32_16x16x32_bf16 a[180:183], v[72:75], v[100:103], a[180:183]
    v_mfma_f32_16x16x32_bf16 a[184:187], v[76:79], v[96:99], a[184:187]
    v_mfma_f32_16x16x32_bf16 a[188:191], v[76:79], v[100:103], a[188:191]
    v_mfma_f32_16x16x32_bf16 a[192:195], v[80:83], v[96:99], a[192:195]
    v_mfma_f32_16x16x32_bf16 a[196:199], v[80:83], v[100:103], a[196:199]
    v_mfma_f32_16x16x32_bf16 a[200:203], v[84:87], v[96:99], a[200:203]
    v_mfma_f32_16x16x32_bf16 a[204:207], v[84:87], v[100:103], a[204:207]
    v_mfma_f32_16x16x32_bf16 a[208:211], v[88:91], v[96:99], a[208:211]
    v_mfma_f32_16x16x32_bf16 a[212:215], v[88:91], v[100:103], a[212:215]
    v_mfma_f32_16x16x32_bf16 a[216:219], v[92:95], v[96:99], a[216:219]
    v_mfma_f32_16x16x32_bf16 a[220:223], v[92:95], v[100:103], a[220:223]
    s_mov_b32 s6, 1600
    buffer_load_dwordx4 v[68:71], v28, s[8:11], s6 offen sc1
    s_mov_b32 s6, 58944
    buffer_load_dwordx4 v[72:75], v28, s[8:11], s6 offen sc1
    s_mov_b32 s6, 116288
    buffer_load_dwordx4 v[76:79], v28, s[8:11], s6 offen sc1
    s_mov_b32 s6, 173632
    buffer_load_dwordx4 v[80:83], v28, s[8:11], s6 offen sc1
    s_mov_b32 s6, 230976
    buffer_load_dwordx4 v[84:87], v28, s[8:11], s6 offen sc1
    s_mov_b32 s6, 288320
    buffer_load_dwordx4 v[88:91], v28, s[8:11], s6 offen sc1
    s_mov_b32 s6, 345664
    buffer_load_dwordx4 v[92:95], v28, s[8:11], s6 offen sc1
    s_mov_b32 s6, 1600
    buffer_load_dwordx4 v[96:99], v29, s[8:11], s6 offen sc1
    s_mov_b32 s6, 58944
    buffer_load_dwordx4 v[100:103], v29, s[8:11], s6 offen sc1
    s_waitcnt vmcnt(9) lgkmcnt(0)
    v_mfma_f32_16x16x32_bf16 a[168:171], v[32:35], v[60:63], a[168:171]
    v_mfma_f32_16x16x32_bf16 a[172:175], v[32:35], v[64:67], a[172:175]
    v_mfma_f32_16x16x32_bf16 a[176:179], v[36:39], v[60:63], a[176:179]
    v_mfma_f32_16x16x32_bf16 a[180:183], v[36:39], v[64:67], a[180:183]
    v_mfma_f32_16x16x32_bf16 a[184:187], v[40:43], v[60:63], a[184:187]
    v_mfma_f32_16x16x32_bf16 a[188:191], v[40:43], v[64:67], a[188:191]
    v_mfma_f32_16x16x32_bf16 a[192:195], v[44:47], v[60:63], a[192:195]
    v_mfma_f32_16x16x32_bf16 a[196:199], v[44:47], v[64:67], a[196:199]
    v_mfma_f32_16x16x32_bf16 a[200:203], v[48:51], v[60:63], a[200:203]
    v_mfma_f32_16x16x32_bf16 a[204:207], v[48:51], v[64:67], a[204:207]
    v_mfma_f32_16x16x32_bf16 a[208:211], v[52:55], v[60:63], a[208:211]
    v_mfma_f32_16x16x32_bf16 a[212:215], v[52:55], v[64:67], a[212:215]
    v_mfma_f32_16x16x32_bf16 a[216:219], v[56:59], v[60:63], a[216:219]
    v_mfma_f32_16x16x32_bf16 a[220:223], v[56:59], v[64:67], a[220:223]
    s_mov_b32 s6, 1664
    buffer_load_dwordx4 v[32:35], v28, s[8:11], s6 offen sc1
    s_mov_b32 s6, 59008
    buffer_load_dwordx4 v[36:39], v28, s[8:11], s6 offen sc1
    s_mov_b32 s6, 116352
    buffer_load_dwordx4 v[40:43], v28, s[8:11], s6 offen sc1
    s_mov_b32 s6, 173696
    buffer_load_dwordx4 v[44:47], v28, s[8:11], s6 offen sc1
    s_mov_b32 s6, 231040
    buffer_load_dwordx4 v[48:51], v28, s[8:11], s6 offen sc1
    s_mov_b32 s6, 288384
    buffer_load_dwordx4 v[52:55], v28, s[8:11], s6 offen sc1
    s_mov_b32 s6, 345728
    buffer_load_dwordx4 v[56:59], v28, s[8:11], s6 offen sc1
    s_mov_b32 s6, 1664
    buffer_load_dwordx4 v[60:63], v29, s[8:11], s6 offen sc1
    s_mov_b32 s6, 59008
    buffer_load_dwordx4 v[64:67], v29, s[8:11], s6 offen sc1
    s_waitcnt vmcnt(9) lgkmcnt(0)
    v_mfma_f32_16x16x32_bf16 a[168:171], v[68:71], v[96:99], a[168:171]
    v_mfma_f32_16x16x32_bf16 a[172:175], v[68:71], v[100:103], a[172:175]
    v_mfma_f32_16x16x32_bf16 a[176:179], v[72:75], v[96:99], a[176:179]
    v_mfma_f32_16x16x32_bf16 a[180:183], v[72:75], v[100:103], a[180:183]
    v_mfma_f32_16x16x32_bf16 a[184:187], v[76:79], v[96:99], a[184:187]
    v_mfma_f32_16x16x32_bf16 a[188:191], v[76:79], v[100:103], a[188:191]
    v_mfma_f32_16x16x32_bf16 a[192:195], v[80:83], v[96:99], a[192:195]
    v_mfma_f32_16x16x32_bf16 a[196:199], v[80:83], v[100:103], a[196:199]
    v_mfma_f32_16x16x32_bf16 a[200:203], v[84:87], v[96:99], a[200:203]
    v_mfma_f32_16x16x32_bf16 a[204:207], v[84:87], v[100:103], a[204:207]
    v_mfma_f32_16x16x32_bf16 a[208:211], v[88:91], v[96:99], a[208:211]
    v_mfma_f32_16x16x32_bf16 a[212:215], v[88:91], v[100:103], a[212:215]
    v_mfma_f32_16x16x32_bf16 a[216:219], v[92:95], v[96:99], a[216:219]
    v_mfma_f32_16x16x32_bf16 a[220:223], v[92:95], v[100:103], a[220:223]
    s_mov_b32 s6, 1728
    buffer_load_dwordx4 v[68:71], v28, s[8:11], s6 offen sc1
    s_mov_b32 s6, 59072
    buffer_load_dwordx4 v[72:75], v28, s[8:11], s6 offen sc1
    s_mov_b32 s6, 116416
    buffer_load_dwordx4 v[76:79], v28, s[8:11], s6 offen sc1
    s_mov_b32 s6, 173760
    buffer_load_dwordx4 v[80:83], v28, s[8:11], s6 offen sc1
    s_mov_b32 s6, 231104
    buffer_load_dwordx4 v[84:87], v28, s[8:11], s6 offen sc1
    s_mov_b32 s6, 288448
    buffer_load_dwordx4 v[88:91], v28, s[8:11], s6 offen sc1
    s_mov_b32 s6, 345792
    buffer_load_dwordx4 v[92:95], v28, s[8:11], s6 offen sc1
    s_mov_b32 s6, 1728
    buffer_load_dwordx4 v[96:99], v29, s[8:11], s6 offen sc1
    s_mov_b32 s6, 59072
    buffer_load_dwordx4 v[100:103], v29, s[8:11], s6 offen sc1
    s_waitcnt vmcnt(9) lgkmcnt(0)
    v_mfma_f32_16x16x32_bf16 a[168:171], v[32:35], v[60:63], a[168:171]
    v_mfma_f32_16x16x32_bf16 a[172:175], v[32:35], v[64:67], a[172:175]
    v_mfma_f32_16x16x32_bf16 a[176:179], v[36:39], v[60:63], a[176:179]
    v_mfma_f32_16x16x32_bf16 a[180:183], v[36:39], v[64:67], a[180:183]
    v_mfma_f32_16x16x32_bf16 a[184:187], v[40:43], v[60:63], a[184:187]
    v_mfma_f32_16x16x32_bf16 a[188:191], v[40:43], v[64:67], a[188:191]
    v_mfma_f32_16x16x32_bf16 a[192:195], v[44:47], v[60:63], a[192:195]
    v_mfma_f32_16x16x32_bf16 a[196:199], v[44:47], v[64:67], a[196:199]
    v_mfma_f32_16x16x32_bf16 a[200:203], v[48:51], v[60:63], a[200:203]
    v_mfma_f32_16x16x32_bf16 a[204:207], v[48:51], v[64:67], a[204:207]
    v_mfma_f32_16x16x32_bf16 a[208:211], v[52:55], v[60:63], a[208:211]
    v_mfma_f32_16x16x32_bf16 a[212:215], v[52:55], v[64:67], a[212:215]
    v_mfma_f32_16x16x32_bf16 a[216:219], v[56:59], v[60:63], a[216:219]
    v_mfma_f32_16x16x32_bf16 a[220:223], v[56:59], v[64:67], a[220:223]
    s_mov_b32 s6, 1792
    buffer_load_dwordx4 v[32:35], v28, s[8:11], s6 offen sc1
    s_mov_b32 s6, 59136
    buffer_load_dwordx4 v[36:39], v28, s[8:11], s6 offen sc1
    s_mov_b32 s6, 116480
    buffer_load_dwordx4 v[40:43], v28, s[8:11], s6 offen sc1
    s_mov_b32 s6, 173824
    buffer_load_dwordx4 v[44:47], v28, s[8:11], s6 offen sc1
    s_mov_b32 s6, 231168
    buffer_load_dwordx4 v[48:51], v28, s[8:11], s6 offen sc1
    s_mov_b32 s6, 288512
    buffer_load_dwordx4 v[52:55], v28, s[8:11], s6 offen sc1
    s_mov_b32 s6, 345856
    buffer_load_dwordx4 v[56:59], v28, s[8:11], s6 offen sc1
    s_mov_b32 s6, 1792
    buffer_load_dwordx4 v[60:63], v29, s[8:11], s6 offen sc1
    s_mov_b32 s6, 59136
    buffer_load_dwordx4 v[64:67], v29, s[8:11], s6 offen sc1
    s_waitcnt vmcnt(9) lgkmcnt(0)
    v_mfma_f32_16x16x32_bf16 a[168:171], v[68:71], v[96:99], a[168:171]
    v_mfma_f32_16x16x32_bf16 a[172:175], v[68:71], v[100:103], a[172:175]
    v_mfma_f32_16x16x32_bf16 a[176:179], v[72:75], v[96:99], a[176:179]
    v_mfma_f32_16x16x32_bf16 a[180:183], v[72:75], v[100:103], a[180:183]
    v_mfma_f32_16x16x32_bf16 a[184:187], v[76:79], v[96:99], a[184:187]
    v_mfma_f32_16x16x32_bf16 a[188:191], v[76:79], v[100:103], a[188:191]
    v_mfma_f32_16x16x32_bf16 a[192:195], v[80:83], v[96:99], a[192:195]
    v_mfma_f32_16x16x32_bf16 a[196:199], v[80:83], v[100:103], a[196:199]
    v_mfma_f32_16x16x32_bf16 a[200:203], v[84:87], v[96:99], a[200:203]
    v_mfma_f32_16x16x32_bf16 a[204:207], v[84:87], v[100:103], a[204:207]
    v_mfma_f32_16x16x32_bf16 a[208:211], v[88:91], v[96:99], a[208:211]
    v_mfma_f32_16x16x32_bf16 a[212:215], v[88:91], v[100:103], a[212:215]
    v_mfma_f32_16x16x32_bf16 a[216:219], v[92:95], v[96:99], a[216:219]
    v_mfma_f32_16x16x32_bf16 a[220:223], v[92:95], v[100:103], a[220:223]
    s_mov_b32 s6, 1856
    buffer_load_dwordx4 v[68:71], v28, s[8:11], s6 offen sc1
    s_mov_b32 s6, 59200
    buffer_load_dwordx4 v[72:75], v28, s[8:11], s6 offen sc1
    s_mov_b32 s6, 116544
    buffer_load_dwordx4 v[76:79], v28, s[8:11], s6 offen sc1
    s_mov_b32 s6, 173888
    buffer_load_dwordx4 v[80:83], v28, s[8:11], s6 offen sc1
    s_mov_b32 s6, 231232
    buffer_load_dwordx4 v[84:87], v28, s[8:11], s6 offen sc1
    s_mov_b32 s6, 288576
    buffer_load_dwordx4 v[88:91], v28, s[8:11], s6 offen sc1
    s_mov_b32 s6, 345920
    buffer_load_dwordx4 v[92:95], v28, s[8:11], s6 offen sc1
    s_mov_b32 s6, 1856
    buffer_load_dwordx4 v[96:99], v29, s[8:11], s6 offen sc1
    s_mov_b32 s6, 59200
    buffer_load_dwordx4 v[100:103], v29, s[8:11], s6 offen sc1
    s_waitcnt vmcnt(9) lgkmcnt(0)
    v_mfma_f32_16x16x32_bf16 a[168:171], v[32:35], v[60:63], a[168:171]
    v_mfma_f32_16x16x32_bf16 a[172:175], v[32:35], v[64:67], a[172:175]
    v_mfma_f32_16x16x32_bf16 a[176:179], v[36:39], v[60:63], a[176:179]
    v_mfma_f32_16x16x32_bf16 a[180:183], v[36:39], v[64:67], a[180:183]
    v_mfma_f32_16x16x32_bf16 a[184:187], v[40:43], v[60:63], a[184:187]
    v_mfma_f32_16x16x32_bf16 a[188:191], v[40:43], v[64:67], a[188:191]
    v_mfma_f32_16x16x32_bf16 a[192:195], v[44:47], v[60:63], a[192:195]
    v_mfma_f32_16x16x32_bf16 a[196:199], v[44:47], v[64:67], a[196:199]
    v_mfma_f32_16x16x32_bf16 a[200:203], v[48:51], v[60:63], a[200:203]
    v_mfma_f32_16x16x32_bf16 a[204:207], v[48:51], v[64:67], a[204:207]
    v_mfma_f32_16x16x32_bf16 a[208:211], v[52:55], v[60:63], a[208:211]
    v_mfma_f32_16x16x32_bf16 a[212:215], v[52:55], v[64:67], a[212:215]
    v_mfma_f32_16x16x32_bf16 a[216:219], v[56:59], v[60:63], a[216:219]
    v_mfma_f32_16x16x32_bf16 a[220:223], v[56:59], v[64:67], a[220:223]
    s_mov_b32 s6, 1920
    buffer_load_dwordx4 v[32:35], v28, s[8:11], s6 offen sc1
    s_mov_b32 s6, 59264
    buffer_load_dwordx4 v[36:39], v28, s[8:11], s6 offen sc1
    s_mov_b32 s6, 116608
    buffer_load_dwordx4 v[40:43], v28, s[8:11], s6 offen sc1
    s_mov_b32 s6, 173952
    buffer_load_dwordx4 v[44:47], v28, s[8:11], s6 offen sc1
    s_mov_b32 s6, 231296
    buffer_load_dwordx4 v[48:51], v28, s[8:11], s6 offen sc1
    s_mov_b32 s6, 288640
    buffer_load_dwordx4 v[52:55], v28, s[8:11], s6 offen sc1
    s_mov_b32 s6, 345984
    buffer_load_dwordx4 v[56:59], v28, s[8:11], s6 offen sc1
    s_mov_b32 s6, 1920
    buffer_load_dwordx4 v[60:63], v29, s[8:11], s6 offen sc1
    s_mov_b32 s6, 59264
    buffer_load_dwordx4 v[64:67], v29, s[8:11], s6 offen sc1
    s_waitcnt vmcnt(9) lgkmcnt(0)
    v_mfma_f32_16x16x32_bf16 a[168:171], v[68:71], v[96:99], a[168:171]
    v_mfma_f32_16x16x32_bf16 a[172:175], v[68:71], v[100:103], a[172:175]
    v_mfma_f32_16x16x32_bf16 a[176:179], v[72:75], v[96:99], a[176:179]
    v_mfma_f32_16x16x32_bf16 a[180:183], v[72:75], v[100:103], a[180:183]
    v_mfma_f32_16x16x32_bf16 a[184:187], v[76:79], v[96:99], a[184:187]
    v_mfma_f32_16x16x32_bf16 a[188:191], v[76:79], v[100:103], a[188:191]
    v_mfma_f32_16x16x32_bf16 a[192:195], v[80:83], v[96:99], a[192:195]
    v_mfma_f32_16x16x32_bf16 a[196:199], v[80:83], v[100:103], a[196:199]
    v_mfma_f32_16x16x32_bf16 a[200:203], v[84:87], v[96:99], a[200:203]
    v_mfma_f32_16x16x32_bf16 a[204:207], v[84:87], v[100:103], a[204:207]
    v_mfma_f32_16x16x32_bf16 a[208:211], v[88:91], v[96:99], a[208:211]
    v_mfma_f32_16x16x32_bf16 a[212:215], v[88:91], v[100:103], a[212:215]
    v_mfma_f32_16x16x32_bf16 a[216:219], v[92:95], v[96:99], a[216:219]
    v_mfma_f32_16x16x32_bf16 a[220:223], v[92:95], v[100:103], a[220:223]
    s_mov_b32 s6, 1984
    buffer_load_dwordx4 v[68:71], v28, s[8:11], s6 offen sc1
    s_mov_b32 s6, 59328
    buffer_load_dwordx4 v[72:75], v28, s[8:11], s6 offen sc1
    s_mov_b32 s6, 116672
    buffer_load_dwordx4 v[76:79], v28, s[8:11], s6 offen sc1
    s_mov_b32 s6, 174016
    buffer_load_dwordx4 v[80:83], v28, s[8:11], s6 offen sc1
    s_mov_b32 s6, 231360
    buffer_load_dwordx4 v[84:87], v28, s[8:11], s6 offen sc1
    s_mov_b32 s6, 288704
    buffer_load_dwordx4 v[88:91], v28, s[8:11], s6 offen sc1
    s_mov_b32 s6, 346048
    buffer_load_dwordx4 v[92:95], v28, s[8:11], s6 offen sc1
    s_mov_b32 s6, 1984
    buffer_load_dwordx4 v[96:99], v29, s[8:11], s6 offen sc1
    s_mov_b32 s6, 59328
    buffer_load_dwordx4 v[100:103], v29, s[8:11], s6 offen sc1
    s_waitcnt vmcnt(9) lgkmcnt(0)
    v_mfma_f32_16x16x32_bf16 a[168:171], v[32:35], v[60:63], a[168:171]
    v_mfma_f32_16x16x32_bf16 a[172:175], v[32:35], v[64:67], a[172:175]
    v_mfma_f32_16x16x32_bf16 a[176:179], v[36:39], v[60:63], a[176:179]
    v_mfma_f32_16x16x32_bf16 a[180:183], v[36:39], v[64:67], a[180:183]
    v_mfma_f32_16x16x32_bf16 a[184:187], v[40:43], v[60:63], a[184:187]
    v_mfma_f32_16x16x32_bf16 a[188:191], v[40:43], v[64:67], a[188:191]
    v_mfma_f32_16x16x32_bf16 a[192:195], v[44:47], v[60:63], a[192:195]
    v_mfma_f32_16x16x32_bf16 a[196:199], v[44:47], v[64:67], a[196:199]
    v_mfma_f32_16x16x32_bf16 a[200:203], v[48:51], v[60:63], a[200:203]
    v_mfma_f32_16x16x32_bf16 a[204:207], v[48:51], v[64:67], a[204:207]
    v_mfma_f32_16x16x32_bf16 a[208:211], v[52:55], v[60:63], a[208:211]
    v_mfma_f32_16x16x32_bf16 a[212:215], v[52:55], v[64:67], a[212:215]
    v_mfma_f32_16x16x32_bf16 a[216:219], v[56:59], v[60:63], a[216:219]
    v_mfma_f32_16x16x32_bf16 a[220:223], v[56:59], v[64:67], a[220:223]
    s_mov_b32 s6, 2048
    buffer_load_dwordx4 v[32:35], v28, s[8:11], s6 offen sc1
    s_mov_b32 s6, 59392
    buffer_load_dwordx4 v[36:39], v28, s[8:11], s6 offen sc1
    s_mov_b32 s6, 116736
    buffer_load_dwordx4 v[40:43], v28, s[8:11], s6 offen sc1
    s_mov_b32 s6, 174080
    buffer_load_dwordx4 v[44:47], v28, s[8:11], s6 offen sc1
    s_mov_b32 s6, 231424
    buffer_load_dwordx4 v[48:51], v28, s[8:11], s6 offen sc1
    s_mov_b32 s6, 288768
    buffer_load_dwordx4 v[52:55], v28, s[8:11], s6 offen sc1
    s_mov_b32 s6, 346112
    buffer_load_dwordx4 v[56:59], v28, s[8:11], s6 offen sc1
    s_mov_b32 s6, 2048
    buffer_load_dwordx4 v[60:63], v29, s[8:11], s6 offen sc1
    s_mov_b32 s6, 59392
    buffer_load_dwordx4 v[64:67], v29, s[8:11], s6 offen sc1
    s_waitcnt vmcnt(9) lgkmcnt(0)
    v_mfma_f32_16x16x32_bf16 a[168:171], v[68:71], v[96:99], a[168:171]
    v_mfma_f32_16x16x32_bf16 a[172:175], v[68:71], v[100:103], a[172:175]
    v_mfma_f32_16x16x32_bf16 a[176:179], v[72:75], v[96:99], a[176:179]
    v_mfma_f32_16x16x32_bf16 a[180:183], v[72:75], v[100:103], a[180:183]
    v_mfma_f32_16x16x32_bf16 a[184:187], v[76:79], v[96:99], a[184:187]
    v_mfma_f32_16x16x32_bf16 a[188:191], v[76:79], v[100:103], a[188:191]
    v_mfma_f32_16x16x32_bf16 a[192:195], v[80:83], v[96:99], a[192:195]
    v_mfma_f32_16x16x32_bf16 a[196:199], v[80:83], v[100:103], a[196:199]
    v_mfma_f32_16x16x32_bf16 a[200:203], v[84:87], v[96:99], a[200:203]
    v_mfma_f32_16x16x32_bf16 a[204:207], v[84:87], v[100:103], a[204:207]
    v_mfma_f32_16x16x32_bf16 a[208:211], v[88:91], v[96:99], a[208:211]
    v_mfma_f32_16x16x32_bf16 a[212:215], v[88:91], v[100:103], a[212:215]
    v_mfma_f32_16x16x32_bf16 a[216:219], v[92:95], v[96:99], a[216:219]
    v_mfma_f32_16x16x32_bf16 a[220:223], v[92:95], v[100:103], a[220:223]
    s_mov_b32 s6, 2112
    buffer_load_dwordx4 v[68:71], v28, s[8:11], s6 offen sc1
    s_mov_b32 s6, 59456
    buffer_load_dwordx4 v[72:75], v28, s[8:11], s6 offen sc1
    s_mov_b32 s6, 116800
    buffer_load_dwordx4 v[76:79], v28, s[8:11], s6 offen sc1
    s_mov_b32 s6, 174144
    buffer_load_dwordx4 v[80:83], v28, s[8:11], s6 offen sc1
    s_mov_b32 s6, 231488
    buffer_load_dwordx4 v[84:87], v28, s[8:11], s6 offen sc1
    s_mov_b32 s6, 288832
    buffer_load_dwordx4 v[88:91], v28, s[8:11], s6 offen sc1
    s_mov_b32 s6, 346176
    buffer_load_dwordx4 v[92:95], v28, s[8:11], s6 offen sc1
    s_mov_b32 s6, 2112
    buffer_load_dwordx4 v[96:99], v29, s[8:11], s6 offen sc1
    s_mov_b32 s6, 59456
    buffer_load_dwordx4 v[100:103], v29, s[8:11], s6 offen sc1
    s_waitcnt vmcnt(9) lgkmcnt(0)
    v_mfma_f32_16x16x32_bf16 a[168:171], v[32:35], v[60:63], a[168:171]
    v_mfma_f32_16x16x32_bf16 a[172:175], v[32:35], v[64:67], a[172:175]
    v_mfma_f32_16x16x32_bf16 a[176:179], v[36:39], v[60:63], a[176:179]
    v_mfma_f32_16x16x32_bf16 a[180:183], v[36:39], v[64:67], a[180:183]
    v_mfma_f32_16x16x32_bf16 a[184:187], v[40:43], v[60:63], a[184:187]
    v_mfma_f32_16x16x32_bf16 a[188:191], v[40:43], v[64:67], a[188:191]
    v_mfma_f32_16x16x32_bf16 a[192:195], v[44:47], v[60:63], a[192:195]
    v_mfma_f32_16x16x32_bf16 a[196:199], v[44:47], v[64:67], a[196:199]
    v_mfma_f32_16x16x32_bf16 a[200:203], v[48:51], v[60:63], a[200:203]
    v_mfma_f32_16x16x32_bf16 a[204:207], v[48:51], v[64:67], a[204:207]
    v_mfma_f32_16x16x32_bf16 a[208:211], v[52:55], v[60:63], a[208:211]
    v_mfma_f32_16x16x32_bf16 a[212:215], v[52:55], v[64:67], a[212:215]
    v_mfma_f32_16x16x32_bf16 a[216:219], v[56:59], v[60:63], a[216:219]
    v_mfma_f32_16x16x32_bf16 a[220:223], v[56:59], v[64:67], a[220:223]
    s_mov_b32 s6, 2176
    buffer_load_dwordx4 v[32:35], v28, s[8:11], s6 offen sc1
    s_mov_b32 s6, 59520
    buffer_load_dwordx4 v[36:39], v28, s[8:11], s6 offen sc1
    s_mov_b32 s6, 116864
    buffer_load_dwordx4 v[40:43], v28, s[8:11], s6 offen sc1
    s_mov_b32 s6, 174208
    buffer_load_dwordx4 v[44:47], v28, s[8:11], s6 offen sc1
    s_mov_b32 s6, 231552
    buffer_load_dwordx4 v[48:51], v28, s[8:11], s6 offen sc1
    s_mov_b32 s6, 288896
    buffer_load_dwordx4 v[52:55], v28, s[8:11], s6 offen sc1
    s_mov_b32 s6, 346240
    buffer_load_dwordx4 v[56:59], v28, s[8:11], s6 offen sc1
    s_mov_b32 s6, 2176
    buffer_load_dwordx4 v[60:63], v29, s[8:11], s6 offen sc1
    s_mov_b32 s6, 59520
    buffer_load_dwordx4 v[64:67], v29, s[8:11], s6 offen sc1
    s_waitcnt vmcnt(9) lgkmcnt(0)
    v_mfma_f32_16x16x32_bf16 a[168:171], v[68:71], v[96:99], a[168:171]
    v_mfma_f32_16x16x32_bf16 a[172:175], v[68:71], v[100:103], a[172:175]
    v_mfma_f32_16x16x32_bf16 a[176:179], v[72:75], v[96:99], a[176:179]
    v_mfma_f32_16x16x32_bf16 a[180:183], v[72:75], v[100:103], a[180:183]
    v_mfma_f32_16x16x32_bf16 a[184:187], v[76:79], v[96:99], a[184:187]
    v_mfma_f32_16x16x32_bf16 a[188:191], v[76:79], v[100:103], a[188:191]
    v_mfma_f32_16x16x32_bf16 a[192:195], v[80:83], v[96:99], a[192:195]
    v_mfma_f32_16x16x32_bf16 a[196:199], v[80:83], v[100:103], a[196:199]
    v_mfma_f32_16x16x32_bf16 a[200:203], v[84:87], v[96:99], a[200:203]
    v_mfma_f32_16x16x32_bf16 a[204:207], v[84:87], v[100:103], a[204:207]
    v_mfma_f32_16x16x32_bf16 a[208:211], v[88:91], v[96:99], a[208:211]
    v_mfma_f32_16x16x32_bf16 a[212:215], v[88:91], v[100:103], a[212:215]
    v_mfma_f32_16x16x32_bf16 a[216:219], v[92:95], v[96:99], a[216:219]
    v_mfma_f32_16x16x32_bf16 a[220:223], v[92:95], v[100:103], a[220:223]
    s_mov_b32 s6, 2240
    buffer_load_dwordx4 v[68:71], v28, s[8:11], s6 offen sc1
    s_mov_b32 s6, 59584
    buffer_load_dwordx4 v[72:75], v28, s[8:11], s6 offen sc1
    s_mov_b32 s6, 116928
    buffer_load_dwordx4 v[76:79], v28, s[8:11], s6 offen sc1
    s_mov_b32 s6, 174272
    buffer_load_dwordx4 v[80:83], v28, s[8:11], s6 offen sc1
    s_mov_b32 s6, 231616
    buffer_load_dwordx4 v[84:87], v28, s[8:11], s6 offen sc1
    s_mov_b32 s6, 288960
    buffer_load_dwordx4 v[88:91], v28, s[8:11], s6 offen sc1
    s_mov_b32 s6, 346304
    buffer_load_dwordx4 v[92:95], v28, s[8:11], s6 offen sc1
    s_mov_b32 s6, 2240
    buffer_load_dwordx4 v[96:99], v29, s[8:11], s6 offen sc1
    s_mov_b32 s6, 59584
    buffer_load_dwordx4 v[100:103], v29, s[8:11], s6 offen sc1
    s_waitcnt vmcnt(9) lgkmcnt(0)
    v_mfma_f32_16x16x32_bf16 a[168:171], v[32:35], v[60:63], a[168:171]
    v_mfma_f32_16x16x32_bf16 a[172:175], v[32:35], v[64:67], a[172:175]
    v_mfma_f32_16x16x32_bf16 a[176:179], v[36:39], v[60:63], a[176:179]
    v_mfma_f32_16x16x32_bf16 a[180:183], v[36:39], v[64:67], a[180:183]
    v_mfma_f32_16x16x32_bf16 a[184:187], v[40:43], v[60:63], a[184:187]
    v_mfma_f32_16x16x32_bf16 a[188:191], v[40:43], v[64:67], a[188:191]
    v_mfma_f32_16x16x32_bf16 a[192:195], v[44:47], v[60:63], a[192:195]
    v_mfma_f32_16x16x32_bf16 a[196:199], v[44:47], v[64:67], a[196:199]
    v_mfma_f32_16x16x32_bf16 a[200:203], v[48:51], v[60:63], a[200:203]
    v_mfma_f32_16x16x32_bf16 a[204:207], v[48:51], v[64:67], a[204:207]
    v_mfma_f32_16x16x32_bf16 a[208:211], v[52:55], v[60:63], a[208:211]
    v_mfma_f32_16x16x32_bf16 a[212:215], v[52:55], v[64:67], a[212:215]
    v_mfma_f32_16x16x32_bf16 a[216:219], v[56:59], v[60:63], a[216:219]
    v_mfma_f32_16x16x32_bf16 a[220:223], v[56:59], v[64:67], a[220:223]
    s_mov_b32 s6, 2304
    buffer_load_dwordx4 v[32:35], v28, s[8:11], s6 offen sc1
    s_mov_b32 s6, 59648
    buffer_load_dwordx4 v[36:39], v28, s[8:11], s6 offen sc1
    s_mov_b32 s6, 116992
    buffer_load_dwordx4 v[40:43], v28, s[8:11], s6 offen sc1
    s_mov_b32 s6, 174336
    buffer_load_dwordx4 v[44:47], v28, s[8:11], s6 offen sc1
    s_mov_b32 s6, 231680
    buffer_load_dwordx4 v[48:51], v28, s[8:11], s6 offen sc1
    s_mov_b32 s6, 289024
    buffer_load_dwordx4 v[52:55], v28, s[8:11], s6 offen sc1
    s_mov_b32 s6, 346368
    buffer_load_dwordx4 v[56:59], v28, s[8:11], s6 offen sc1
    s_mov_b32 s6, 2304
    buffer_load_dwordx4 v[60:63], v29, s[8:11], s6 offen sc1
    s_mov_b32 s6, 59648
    buffer_load_dwordx4 v[64:67], v29, s[8:11], s6 offen sc1
    s_waitcnt vmcnt(9) lgkmcnt(0)
    v_mfma_f32_16x16x32_bf16 a[168:171], v[68:71], v[96:99], a[168:171]
    v_mfma_f32_16x16x32_bf16 a[172:175], v[68:71], v[100:103], a[172:175]
    v_mfma_f32_16x16x32_bf16 a[176:179], v[72:75], v[96:99], a[176:179]
    v_mfma_f32_16x16x32_bf16 a[180:183], v[72:75], v[100:103], a[180:183]
    v_mfma_f32_16x16x32_bf16 a[184:187], v[76:79], v[96:99], a[184:187]
    v_mfma_f32_16x16x32_bf16 a[188:191], v[76:79], v[100:103], a[188:191]
    v_mfma_f32_16x16x32_bf16 a[192:195], v[80:83], v[96:99], a[192:195]
    v_mfma_f32_16x16x32_bf16 a[196:199], v[80:83], v[100:103], a[196:199]
    v_mfma_f32_16x16x32_bf16 a[200:203], v[84:87], v[96:99], a[200:203]
    v_mfma_f32_16x16x32_bf16 a[204:207], v[84:87], v[100:103], a[204:207]
    v_mfma_f32_16x16x32_bf16 a[208:211], v[88:91], v[96:99], a[208:211]
    v_mfma_f32_16x16x32_bf16 a[212:215], v[88:91], v[100:103], a[212:215]
    v_mfma_f32_16x16x32_bf16 a[216:219], v[92:95], v[96:99], a[216:219]
    v_mfma_f32_16x16x32_bf16 a[220:223], v[92:95], v[100:103], a[220:223]
    s_mov_b32 s6, 2368
    buffer_load_dwordx4 v[68:71], v28, s[8:11], s6 offen sc1
    s_mov_b32 s6, 59712
    buffer_load_dwordx4 v[72:75], v28, s[8:11], s6 offen sc1
    s_mov_b32 s6, 117056
    buffer_load_dwordx4 v[76:79], v28, s[8:11], s6 offen sc1
    s_mov_b32 s6, 174400
    buffer_load_dwordx4 v[80:83], v28, s[8:11], s6 offen sc1
    s_mov_b32 s6, 231744
    buffer_load_dwordx4 v[84:87], v28, s[8:11], s6 offen sc1
    s_mov_b32 s6, 289088
    buffer_load_dwordx4 v[88:91], v28, s[8:11], s6 offen sc1
    s_mov_b32 s6, 346432
    buffer_load_dwordx4 v[92:95], v28, s[8:11], s6 offen sc1
    s_mov_b32 s6, 2368
    buffer_load_dwordx4 v[96:99], v29, s[8:11], s6 offen sc1
    s_mov_b32 s6, 59712
    buffer_load_dwordx4 v[100:103], v29, s[8:11], s6 offen sc1
    s_waitcnt vmcnt(9) lgkmcnt(0)
    v_mfma_f32_16x16x32_bf16 a[168:171], v[32:35], v[60:63], a[168:171]
    v_mfma_f32_16x16x32_bf16 a[172:175], v[32:35], v[64:67], a[172:175]
    v_mfma_f32_16x16x32_bf16 a[176:179], v[36:39], v[60:63], a[176:179]
    v_mfma_f32_16x16x32_bf16 a[180:183], v[36:39], v[64:67], a[180:183]
    v_mfma_f32_16x16x32_bf16 a[184:187], v[40:43], v[60:63], a[184:187]
    v_mfma_f32_16x16x32_bf16 a[188:191], v[40:43], v[64:67], a[188:191]
    v_mfma_f32_16x16x32_bf16 a[192:195], v[44:47], v[60:63], a[192:195]
    v_mfma_f32_16x16x32_bf16 a[196:199], v[44:47], v[64:67], a[196:199]
    v_mfma_f32_16x16x32_bf16 a[200:203], v[48:51], v[60:63], a[200:203]
    v_mfma_f32_16x16x32_bf16 a[204:207], v[48:51], v[64:67], a[204:207]
    v_mfma_f32_16x16x32_bf16 a[208:211], v[52:55], v[60:63], a[208:211]
    v_mfma_f32_16x16x32_bf16 a[212:215], v[52:55], v[64:67], a[212:215]
    v_mfma_f32_16x16x32_bf16 a[216:219], v[56:59], v[60:63], a[216:219]
    v_mfma_f32_16x16x32_bf16 a[220:223], v[56:59], v[64:67], a[220:223]
    s_mov_b32 s6, 2432
    buffer_load_dwordx4 v[32:35], v28, s[8:11], s6 offen sc1
    s_mov_b32 s6, 59776
    buffer_load_dwordx4 v[36:39], v28, s[8:11], s6 offen sc1
    s_mov_b32 s6, 117120
    buffer_load_dwordx4 v[40:43], v28, s[8:11], s6 offen sc1
    s_mov_b32 s6, 174464
    buffer_load_dwordx4 v[44:47], v28, s[8:11], s6 offen sc1
    s_mov_b32 s6, 231808
    buffer_load_dwordx4 v[48:51], v28, s[8:11], s6 offen sc1
    s_mov_b32 s6, 289152
    buffer_load_dwordx4 v[52:55], v28, s[8:11], s6 offen sc1
    s_mov_b32 s6, 346496
    buffer_load_dwordx4 v[56:59], v28, s[8:11], s6 offen sc1
    s_mov_b32 s6, 2432
    buffer_load_dwordx4 v[60:63], v29, s[8:11], s6 offen sc1
    s_mov_b32 s6, 59776
    buffer_load_dwordx4 v[64:67], v29, s[8:11], s6 offen sc1
    s_waitcnt vmcnt(9) lgkmcnt(0)
    v_mfma_f32_16x16x32_bf16 a[168:171], v[68:71], v[96:99], a[168:171]
    v_mfma_f32_16x16x32_bf16 a[172:175], v[68:71], v[100:103], a[172:175]
    v_mfma_f32_16x16x32_bf16 a[176:179], v[72:75], v[96:99], a[176:179]
    v_mfma_f32_16x16x32_bf16 a[180:183], v[72:75], v[100:103], a[180:183]
    v_mfma_f32_16x16x32_bf16 a[184:187], v[76:79], v[96:99], a[184:187]
    v_mfma_f32_16x16x32_bf16 a[188:191], v[76:79], v[100:103], a[188:191]
    v_mfma_f32_16x16x32_bf16 a[192:195], v[80:83], v[96:99], a[192:195]
    v_mfma_f32_16x16x32_bf16 a[196:199], v[80:83], v[100:103], a[196:199]
    v_mfma_f32_16x16x32_bf16 a[200:203], v[84:87], v[96:99], a[200:203]
    v_mfma_f32_16x16x32_bf16 a[204:207], v[84:87], v[100:103], a[204:207]
    v_mfma_f32_16x16x32_bf16 a[208:211], v[88:91], v[96:99], a[208:211]
    v_mfma_f32_16x16x32_bf16 a[212:215], v[88:91], v[100:103], a[212:215]
    v_mfma_f32_16x16x32_bf16 a[216:219], v[92:95], v[96:99], a[216:219]
    v_mfma_f32_16x16x32_bf16 a[220:223], v[92:95], v[100:103], a[220:223]
    s_mov_b32 s6, 2496
    buffer_load_dwordx4 v[68:71], v28, s[8:11], s6 offen sc1
    s_mov_b32 s6, 59840
    buffer_load_dwordx4 v[72:75], v28, s[8:11], s6 offen sc1
    s_mov_b32 s6, 117184
    buffer_load_dwordx4 v[76:79], v28, s[8:11], s6 offen sc1
    s_mov_b32 s6, 174528
    buffer_load_dwordx4 v[80:83], v28, s[8:11], s6 offen sc1
    s_mov_b32 s6, 231872
    buffer_load_dwordx4 v[84:87], v28, s[8:11], s6 offen sc1
    s_mov_b32 s6, 289216
    buffer_load_dwordx4 v[88:91], v28, s[8:11], s6 offen sc1
    s_mov_b32 s6, 346560
    buffer_load_dwordx4 v[92:95], v28, s[8:11], s6 offen sc1
    s_mov_b32 s6, 2496
    buffer_load_dwordx4 v[96:99], v29, s[8:11], s6 offen sc1
    s_mov_b32 s6, 59840
    buffer_load_dwordx4 v[100:103], v29, s[8:11], s6 offen sc1
    s_waitcnt vmcnt(9) lgkmcnt(0)
    v_mfma_f32_16x16x32_bf16 a[168:171], v[32:35], v[60:63], a[168:171]
    v_mfma_f32_16x16x32_bf16 a[172:175], v[32:35], v[64:67], a[172:175]
    v_mfma_f32_16x16x32_bf16 a[176:179], v[36:39], v[60:63], a[176:179]
    v_mfma_f32_16x16x32_bf16 a[180:183], v[36:39], v[64:67], a[180:183]
    v_mfma_f32_16x16x32_bf16 a[184:187], v[40:43], v[60:63], a[184:187]
    v_mfma_f32_16x16x32_bf16 a[188:191], v[40:43], v[64:67], a[188:191]
    v_mfma_f32_16x16x32_bf16 a[192:195], v[44:47], v[60:63], a[192:195]
    v_mfma_f32_16x16x32_bf16 a[196:199], v[44:47], v[64:67], a[196:199]
    v_mfma_f32_16x16x32_bf16 a[200:203], v[48:51], v[60:63], a[200:203]
    v_mfma_f32_16x16x32_bf16 a[204:207], v[48:51], v[64:67], a[204:207]
    v_mfma_f32_16x16x32_bf16 a[208:211], v[52:55], v[60:63], a[208:211]
    v_mfma_f32_16x16x32_bf16 a[212:215], v[52:55], v[64:67], a[212:215]
    v_mfma_f32_16x16x32_bf16 a[216:219], v[56:59], v[60:63], a[216:219]
    v_mfma_f32_16x16x32_bf16 a[220:223], v[56:59], v[64:67], a[220:223]
    s_mov_b32 s6, 2560
    buffer_load_dwordx4 v[32:35], v28, s[8:11], s6 offen sc1
    s_mov_b32 s6, 59904
    buffer_load_dwordx4 v[36:39], v28, s[8:11], s6 offen sc1
    s_mov_b32 s6, 117248
    buffer_load_dwordx4 v[40:43], v28, s[8:11], s6 offen sc1
    s_mov_b32 s6, 174592
    buffer_load_dwordx4 v[44:47], v28, s[8:11], s6 offen sc1
    s_mov_b32 s6, 231936
    buffer_load_dwordx4 v[48:51], v28, s[8:11], s6 offen sc1
    s_mov_b32 s6, 289280
    buffer_load_dwordx4 v[52:55], v28, s[8:11], s6 offen sc1
    s_mov_b32 s6, 346624
    buffer_load_dwordx4 v[56:59], v28, s[8:11], s6 offen sc1
    s_mov_b32 s6, 2560
    buffer_load_dwordx4 v[60:63], v29, s[8:11], s6 offen sc1
    s_mov_b32 s6, 59904
    buffer_load_dwordx4 v[64:67], v29, s[8:11], s6 offen sc1
    s_waitcnt vmcnt(9) lgkmcnt(0)
    v_mfma_f32_16x16x32_bf16 a[168:171], v[68:71], v[96:99], a[168:171]
    v_mfma_f32_16x16x32_bf16 a[172:175], v[68:71], v[100:103], a[172:175]
    v_mfma_f32_16x16x32_bf16 a[176:179], v[72:75], v[96:99], a[176:179]
    v_mfma_f32_16x16x32_bf16 a[180:183], v[72:75], v[100:103], a[180:183]
    v_mfma_f32_16x16x32_bf16 a[184:187], v[76:79], v[96:99], a[184:187]
    v_mfma_f32_16x16x32_bf16 a[188:191], v[76:79], v[100:103], a[188:191]
    v_mfma_f32_16x16x32_bf16 a[192:195], v[80:83], v[96:99], a[192:195]
    v_mfma_f32_16x16x32_bf16 a[196:199], v[80:83], v[100:103], a[196:199]
    v_mfma_f32_16x16x32_bf16 a[200:203], v[84:87], v[96:99], a[200:203]
    v_mfma_f32_16x16x32_bf16 a[204:207], v[84:87], v[100:103], a[204:207]
    v_mfma_f32_16x16x32_bf16 a[208:211], v[88:91], v[96:99], a[208:211]
    v_mfma_f32_16x16x32_bf16 a[212:215], v[88:91], v[100:103], a[212:215]
    v_mfma_f32_16x16x32_bf16 a[216:219], v[92:95], v[96:99], a[216:219]
    v_mfma_f32_16x16x32_bf16 a[220:223], v[92:95], v[100:103], a[220:223]
    s_mov_b32 s6, 2624
    buffer_load_dwordx4 v[68:71], v28, s[8:11], s6 offen sc1
    s_mov_b32 s6, 59968
    buffer_load_dwordx4 v[72:75], v28, s[8:11], s6 offen sc1
    s_mov_b32 s6, 117312
    buffer_load_dwordx4 v[76:79], v28, s[8:11], s6 offen sc1
    s_mov_b32 s6, 174656
    buffer_load_dwordx4 v[80:83], v28, s[8:11], s6 offen sc1
    s_mov_b32 s6, 232000
    buffer_load_dwordx4 v[84:87], v28, s[8:11], s6 offen sc1
    s_mov_b32 s6, 289344
    buffer_load_dwordx4 v[88:91], v28, s[8:11], s6 offen sc1
    s_mov_b32 s6, 346688
    buffer_load_dwordx4 v[92:95], v28, s[8:11], s6 offen sc1
    s_mov_b32 s6, 2624
    buffer_load_dwordx4 v[96:99], v29, s[8:11], s6 offen sc1
    s_mov_b32 s6, 59968
    buffer_load_dwordx4 v[100:103], v29, s[8:11], s6 offen sc1
    s_waitcnt vmcnt(9) lgkmcnt(0)
    v_mfma_f32_16x16x32_bf16 a[168:171], v[32:35], v[60:63], a[168:171]
    v_mfma_f32_16x16x32_bf16 a[172:175], v[32:35], v[64:67], a[172:175]
    v_mfma_f32_16x16x32_bf16 a[176:179], v[36:39], v[60:63], a[176:179]
    v_mfma_f32_16x16x32_bf16 a[180:183], v[36:39], v[64:67], a[180:183]
    v_mfma_f32_16x16x32_bf16 a[184:187], v[40:43], v[60:63], a[184:187]
    v_mfma_f32_16x16x32_bf16 a[188:191], v[40:43], v[64:67], a[188:191]
    v_mfma_f32_16x16x32_bf16 a[192:195], v[44:47], v[60:63], a[192:195]
    v_mfma_f32_16x16x32_bf16 a[196:199], v[44:47], v[64:67], a[196:199]
    v_mfma_f32_16x16x32_bf16 a[200:203], v[48:51], v[60:63], a[200:203]
    v_mfma_f32_16x16x32_bf16 a[204:207], v[48:51], v[64:67], a[204:207]
    v_mfma_f32_16x16x32_bf16 a[208:211], v[52:55], v[60:63], a[208:211]
    v_mfma_f32_16x16x32_bf16 a[212:215], v[52:55], v[64:67], a[212:215]
    v_mfma_f32_16x16x32_bf16 a[216:219], v[56:59], v[60:63], a[216:219]
    v_mfma_f32_16x16x32_bf16 a[220:223], v[56:59], v[64:67], a[220:223]
    s_mov_b32 s6, 2688
    buffer_load_dwordx4 v[32:35], v28, s[8:11], s6 offen sc1
    s_mov_b32 s6, 60032
    buffer_load_dwordx4 v[36:39], v28, s[8:11], s6 offen sc1
    s_mov_b32 s6, 117376
    buffer_load_dwordx4 v[40:43], v28, s[8:11], s6 offen sc1
    s_mov_b32 s6, 174720
    buffer_load_dwordx4 v[44:47], v28, s[8:11], s6 offen sc1
    s_mov_b32 s6, 232064
    buffer_load_dwordx4 v[48:51], v28, s[8:11], s6 offen sc1
    s_mov_b32 s6, 289408
    buffer_load_dwordx4 v[52:55], v28, s[8:11], s6 offen sc1
    s_mov_b32 s6, 346752
    buffer_load_dwordx4 v[56:59], v28, s[8:11], s6 offen sc1
    s_mov_b32 s6, 2688
    buffer_load_dwordx4 v[60:63], v29, s[8:11], s6 offen sc1
    s_mov_b32 s6, 60032
    buffer_load_dwordx4 v[64:67], v29, s[8:11], s6 offen sc1
    s_waitcnt vmcnt(9) lgkmcnt(0)
    v_mfma_f32_16x16x32_bf16 a[168:171], v[68:71], v[96:99], a[168:171]
    v_mfma_f32_16x16x32_bf16 a[172:175], v[68:71], v[100:103], a[172:175]
    v_mfma_f32_16x16x32_bf16 a[176:179], v[72:75], v[96:99], a[176:179]
    v_mfma_f32_16x16x32_bf16 a[180:183], v[72:75], v[100:103], a[180:183]
    v_mfma_f32_16x16x32_bf16 a[184:187], v[76:79], v[96:99], a[184:187]
    v_mfma_f32_16x16x32_bf16 a[188:191], v[76:79], v[100:103], a[188:191]
    v_mfma_f32_16x16x32_bf16 a[192:195], v[80:83], v[96:99], a[192:195]
    v_mfma_f32_16x16x32_bf16 a[196:199], v[80:83], v[100:103], a[196:199]
    v_mfma_f32_16x16x32_bf16 a[200:203], v[84:87], v[96:99], a[200:203]
    v_mfma_f32_16x16x32_bf16 a[204:207], v[84:87], v[100:103], a[204:207]
    v_mfma_f32_16x16x32_bf16 a[208:211], v[88:91], v[96:99], a[208:211]
    v_mfma_f32_16x16x32_bf16 a[212:215], v[88:91], v[100:103], a[212:215]
    v_mfma_f32_16x16x32_bf16 a[216:219], v[92:95], v[96:99], a[216:219]
    v_mfma_f32_16x16x32_bf16 a[220:223], v[92:95], v[100:103], a[220:223]
    s_mov_b32 s6, 2752
    buffer_load_dwordx4 v[68:71], v28, s[8:11], s6 offen sc1
    s_mov_b32 s6, 60096
    buffer_load_dwordx4 v[72:75], v28, s[8:11], s6 offen sc1
    s_mov_b32 s6, 117440
    buffer_load_dwordx4 v[76:79], v28, s[8:11], s6 offen sc1
    s_mov_b32 s6, 174784
    buffer_load_dwordx4 v[80:83], v28, s[8:11], s6 offen sc1
    s_mov_b32 s6, 232128
    buffer_load_dwordx4 v[84:87], v28, s[8:11], s6 offen sc1
    s_mov_b32 s6, 289472
    buffer_load_dwordx4 v[88:91], v28, s[8:11], s6 offen sc1
    s_mov_b32 s6, 346816
    buffer_load_dwordx4 v[92:95], v28, s[8:11], s6 offen sc1
    s_mov_b32 s6, 2752
    buffer_load_dwordx4 v[96:99], v29, s[8:11], s6 offen sc1
    s_mov_b32 s6, 60096
    buffer_load_dwordx4 v[100:103], v29, s[8:11], s6 offen sc1
    s_waitcnt vmcnt(9) lgkmcnt(0)
    v_mfma_f32_16x16x32_bf16 a[168:171], v[32:35], v[60:63], a[168:171]
    v_mfma_f32_16x16x32_bf16 a[172:175], v[32:35], v[64:67], a[172:175]
    v_mfma_f32_16x16x32_bf16 a[176:179], v[36:39], v[60:63], a[176:179]
    v_mfma_f32_16x16x32_bf16 a[180:183], v[36:39], v[64:67], a[180:183]
    v_mfma_f32_16x16x32_bf16 a[184:187], v[40:43], v[60:63], a[184:187]
    v_mfma_f32_16x16x32_bf16 a[188:191], v[40:43], v[64:67], a[188:191]
    v_mfma_f32_16x16x32_bf16 a[192:195], v[44:47], v[60:63], a[192:195]
    v_mfma_f32_16x16x32_bf16 a[196:199], v[44:47], v[64:67], a[196:199]
    v_mfma_f32_16x16x32_bf16 a[200:203], v[48:51], v[60:63], a[200:203]
    v_mfma_f32_16x16x32_bf16 a[204:207], v[48:51], v[64:67], a[204:207]
    v_mfma_f32_16x16x32_bf16 a[208:211], v[52:55], v[60:63], a[208:211]
    v_mfma_f32_16x16x32_bf16 a[212:215], v[52:55], v[64:67], a[212:215]
    v_mfma_f32_16x16x32_bf16 a[216:219], v[56:59], v[60:63], a[216:219]
    v_mfma_f32_16x16x32_bf16 a[220:223], v[56:59], v[64:67], a[220:223]
    s_mov_b32 s6, 2816
    buffer_load_dwordx4 v[32:35], v28, s[8:11], s6 offen sc1
    s_mov_b32 s6, 60160
    buffer_load_dwordx4 v[36:39], v28, s[8:11], s6 offen sc1
    s_mov_b32 s6, 117504
    buffer_load_dwordx4 v[40:43], v28, s[8:11], s6 offen sc1
    s_mov_b32 s6, 174848
    buffer_load_dwordx4 v[44:47], v28, s[8:11], s6 offen sc1
    s_mov_b32 s6, 232192
    buffer_load_dwordx4 v[48:51], v28, s[8:11], s6 offen sc1
    s_mov_b32 s6, 289536
    buffer_load_dwordx4 v[52:55], v28, s[8:11], s6 offen sc1
    s_mov_b32 s6, 346880
    buffer_load_dwordx4 v[56:59], v28, s[8:11], s6 offen sc1
    s_mov_b32 s6, 2816
    buffer_load_dwordx4 v[60:63], v29, s[8:11], s6 offen sc1
    s_mov_b32 s6, 60160
    buffer_load_dwordx4 v[64:67], v29, s[8:11], s6 offen sc1
    s_waitcnt vmcnt(9) lgkmcnt(0)
    v_mfma_f32_16x16x32_bf16 a[168:171], v[68:71], v[96:99], a[168:171]
    v_mfma_f32_16x16x32_bf16 a[172:175], v[68:71], v[100:103], a[172:175]
    v_mfma_f32_16x16x32_bf16 a[176:179], v[72:75], v[96:99], a[176:179]
    v_mfma_f32_16x16x32_bf16 a[180:183], v[72:75], v[100:103], a[180:183]
    v_mfma_f32_16x16x32_bf16 a[184:187], v[76:79], v[96:99], a[184:187]
    v_mfma_f32_16x16x32_bf16 a[188:191], v[76:79], v[100:103], a[188:191]
    v_mfma_f32_16x16x32_bf16 a[192:195], v[80:83], v[96:99], a[192:195]
    v_mfma_f32_16x16x32_bf16 a[196:199], v[80:83], v[100:103], a[196:199]
    v_mfma_f32_16x16x32_bf16 a[200:203], v[84:87], v[96:99], a[200:203]
    v_mfma_f32_16x16x32_bf16 a[204:207], v[84:87], v[100:103], a[204:207]
    v_mfma_f32_16x16x32_bf16 a[208:211], v[88:91], v[96:99], a[208:211]
    v_mfma_f32_16x16x32_bf16 a[212:215], v[88:91], v[100:103], a[212:215]
    v_mfma_f32_16x16x32_bf16 a[216:219], v[92:95], v[96:99], a[216:219]
    v_mfma_f32_16x16x32_bf16 a[220:223], v[92:95], v[100:103], a[220:223]
    s_mov_b32 s6, 2880
    buffer_load_dwordx4 v[68:71], v28, s[8:11], s6 offen sc1
    s_mov_b32 s6, 60224
    buffer_load_dwordx4 v[72:75], v28, s[8:11], s6 offen sc1
    s_mov_b32 s6, 117568
    buffer_load_dwordx4 v[76:79], v28, s[8:11], s6 offen sc1
    s_mov_b32 s6, 174912
    buffer_load_dwordx4 v[80:83], v28, s[8:11], s6 offen sc1
    s_mov_b32 s6, 232256
    buffer_load_dwordx4 v[84:87], v28, s[8:11], s6 offen sc1
    s_mov_b32 s6, 289600
    buffer_load_dwordx4 v[88:91], v28, s[8:11], s6 offen sc1
    s_mov_b32 s6, 346944
    buffer_load_dwordx4 v[92:95], v28, s[8:11], s6 offen sc1
    s_mov_b32 s6, 2880
    buffer_load_dwordx4 v[96:99], v29, s[8:11], s6 offen sc1
    s_mov_b32 s6, 60224
    buffer_load_dwordx4 v[100:103], v29, s[8:11], s6 offen sc1
    s_waitcnt vmcnt(9) lgkmcnt(0)
    v_mfma_f32_16x16x32_bf16 a[168:171], v[32:35], v[60:63], a[168:171]
    v_mfma_f32_16x16x32_bf16 a[172:175], v[32:35], v[64:67], a[172:175]
    v_mfma_f32_16x16x32_bf16 a[176:179], v[36:39], v[60:63], a[176:179]
    v_mfma_f32_16x16x32_bf16 a[180:183], v[36:39], v[64:67], a[180:183]
    v_mfma_f32_16x16x32_bf16 a[184:187], v[40:43], v[60:63], a[184:187]
    v_mfma_f32_16x16x32_bf16 a[188:191], v[40:43], v[64:67], a[188:191]
    v_mfma_f32_16x16x32_bf16 a[192:195], v[44:47], v[60:63], a[192:195]
    v_mfma_f32_16x16x32_bf16 a[196:199], v[44:47], v[64:67], a[196:199]
    v_mfma_f32_16x16x32_bf16 a[200:203], v[48:51], v[60:63], a[200:203]
    v_mfma_f32_16x16x32_bf16 a[204:207], v[48:51], v[64:67], a[204:207]
    v_mfma_f32_16x16x32_bf16 a[208:211], v[52:55], v[60:63], a[208:211]
    v_mfma_f32_16x16x32_bf16 a[212:215], v[52:55], v[64:67], a[212:215]
    v_mfma_f32_16x16x32_bf16 a[216:219], v[56:59], v[60:63], a[216:219]
    v_mfma_f32_16x16x32_bf16 a[220:223], v[56:59], v[64:67], a[220:223]
    s_mov_b32 s6, 2944
    buffer_load_dwordx4 v[32:35], v28, s[8:11], s6 offen sc1
    s_mov_b32 s6, 60288
    buffer_load_dwordx4 v[36:39], v28, s[8:11], s6 offen sc1
    s_mov_b32 s6, 117632
    buffer_load_dwordx4 v[40:43], v28, s[8:11], s6 offen sc1
    s_mov_b32 s6, 174976
    buffer_load_dwordx4 v[44:47], v28, s[8:11], s6 offen sc1
    s_mov_b32 s6, 232320
    buffer_load_dwordx4 v[48:51], v28, s[8:11], s6 offen sc1
    s_mov_b32 s6, 289664
    buffer_load_dwordx4 v[52:55], v28, s[8:11], s6 offen sc1
    s_mov_b32 s6, 347008
    buffer_load_dwordx4 v[56:59], v28, s[8:11], s6 offen sc1
    s_mov_b32 s6, 2944
    buffer_load_dwordx4 v[60:63], v29, s[8:11], s6 offen sc1
    s_mov_b32 s6, 60288
    buffer_load_dwordx4 v[64:67], v29, s[8:11], s6 offen sc1
    s_waitcnt vmcnt(9) lgkmcnt(0)
    v_mfma_f32_16x16x32_bf16 a[168:171], v[68:71], v[96:99], a[168:171]
    v_mfma_f32_16x16x32_bf16 a[172:175], v[68:71], v[100:103], a[172:175]
    v_mfma_f32_16x16x32_bf16 a[176:179], v[72:75], v[96:99], a[176:179]
    v_mfma_f32_16x16x32_bf16 a[180:183], v[72:75], v[100:103], a[180:183]
    v_mfma_f32_16x16x32_bf16 a[184:187], v[76:79], v[96:99], a[184:187]
    v_mfma_f32_16x16x32_bf16 a[188:191], v[76:79], v[100:103], a[188:191]
    v_mfma_f32_16x16x32_bf16 a[192:195], v[80:83], v[96:99], a[192:195]
    v_mfma_f32_16x16x32_bf16 a[196:199], v[80:83], v[100:103], a[196:199]
    v_mfma_f32_16x16x32_bf16 a[200:203], v[84:87], v[96:99], a[200:203]
    v_mfma_f32_16x16x32_bf16 a[204:207], v[84:87], v[100:103], a[204:207]
    v_mfma_f32_16x16x32_bf16 a[208:211], v[88:91], v[96:99], a[208:211]
    v_mfma_f32_16x16x32_bf16 a[212:215], v[88:91], v[100:103], a[212:215]
    v_mfma_f32_16x16x32_bf16 a[216:219], v[92:95], v[96:99], a[216:219]
    v_mfma_f32_16x16x32_bf16 a[220:223], v[92:95], v[100:103], a[220:223]
    s_mov_b32 s6, 3008
    buffer_load_dwordx4 v[68:71], v28, s[8:11], s6 offen sc1
    s_mov_b32 s6, 60352
    buffer_load_dwordx4 v[72:75], v28, s[8:11], s6 offen sc1
    s_mov_b32 s6, 117696
    buffer_load_dwordx4 v[76:79], v28, s[8:11], s6 offen sc1
    s_mov_b32 s6, 175040
    buffer_load_dwordx4 v[80:83], v28, s[8:11], s6 offen sc1
    s_mov_b32 s6, 232384
    buffer_load_dwordx4 v[84:87], v28, s[8:11], s6 offen sc1
    s_mov_b32 s6, 289728
    buffer_load_dwordx4 v[88:91], v28, s[8:11], s6 offen sc1
    s_mov_b32 s6, 347072
    buffer_load_dwordx4 v[92:95], v28, s[8:11], s6 offen sc1
    s_mov_b32 s6, 3008
    buffer_load_dwordx4 v[96:99], v29, s[8:11], s6 offen sc1
    s_mov_b32 s6, 60352
    buffer_load_dwordx4 v[100:103], v29, s[8:11], s6 offen sc1
    s_waitcnt vmcnt(9) lgkmcnt(0)
    v_mfma_f32_16x16x32_bf16 a[168:171], v[32:35], v[60:63], a[168:171]
    v_mfma_f32_16x16x32_bf16 a[172:175], v[32:35], v[64:67], a[172:175]
    v_mfma_f32_16x16x32_bf16 a[176:179], v[36:39], v[60:63], a[176:179]
    v_mfma_f32_16x16x32_bf16 a[180:183], v[36:39], v[64:67], a[180:183]
    v_mfma_f32_16x16x32_bf16 a[184:187], v[40:43], v[60:63], a[184:187]
    v_mfma_f32_16x16x32_bf16 a[188:191], v[40:43], v[64:67], a[188:191]
    v_mfma_f32_16x16x32_bf16 a[192:195], v[44:47], v[60:63], a[192:195]
    v_mfma_f32_16x16x32_bf16 a[196:199], v[44:47], v[64:67], a[196:199]
    v_mfma_f32_16x16x32_bf16 a[200:203], v[48:51], v[60:63], a[200:203]
    v_mfma_f32_16x16x32_bf16 a[204:207], v[48:51], v[64:67], a[204:207]
    v_mfma_f32_16x16x32_bf16 a[208:211], v[52:55], v[60:63], a[208:211]
    v_mfma_f32_16x16x32_bf16 a[212:215], v[52:55], v[64:67], a[212:215]
    v_mfma_f32_16x16x32_bf16 a[216:219], v[56:59], v[60:63], a[216:219]
    v_mfma_f32_16x16x32_bf16 a[220:223], v[56:59], v[64:67], a[220:223]
    s_mov_b32 s6, 3072
    buffer_load_dwordx4 v[32:35], v28, s[8:11], s6 offen sc1
    s_mov_b32 s6, 60416
    buffer_load_dwordx4 v[36:39], v28, s[8:11], s6 offen sc1
    s_mov_b32 s6, 117760
    buffer_load_dwordx4 v[40:43], v28, s[8:11], s6 offen sc1
    s_mov_b32 s6, 175104
    buffer_load_dwordx4 v[44:47], v28, s[8:11], s6 offen sc1
    s_mov_b32 s6, 232448
    buffer_load_dwordx4 v[48:51], v28, s[8:11], s6 offen sc1
    s_mov_b32 s6, 289792
    buffer_load_dwordx4 v[52:55], v28, s[8:11], s6 offen sc1
    s_mov_b32 s6, 347136
    buffer_load_dwordx4 v[56:59], v28, s[8:11], s6 offen sc1
    s_mov_b32 s6, 3072
    buffer_load_dwordx4 v[60:63], v29, s[8:11], s6 offen sc1
    s_mov_b32 s6, 60416
    buffer_load_dwordx4 v[64:67], v29, s[8:11], s6 offen sc1
    s_waitcnt vmcnt(9) lgkmcnt(0)
    v_mfma_f32_16x16x32_bf16 a[168:171], v[68:71], v[96:99], a[168:171]
    v_mfma_f32_16x16x32_bf16 a[172:175], v[68:71], v[100:103], a[172:175]
    v_mfma_f32_16x16x32_bf16 a[176:179], v[72:75], v[96:99], a[176:179]
    v_mfma_f32_16x16x32_bf16 a[180:183], v[72:75], v[100:103], a[180:183]
    v_mfma_f32_16x16x32_bf16 a[184:187], v[76:79], v[96:99], a[184:187]
    v_mfma_f32_16x16x32_bf16 a[188:191], v[76:79], v[100:103], a[188:191]
    v_mfma_f32_16x16x32_bf16 a[192:195], v[80:83], v[96:99], a[192:195]
    v_mfma_f32_16x16x32_bf16 a[196:199], v[80:83], v[100:103], a[196:199]
    v_mfma_f32_16x16x32_bf16 a[200:203], v[84:87], v[96:99], a[200:203]
    v_mfma_f32_16x16x32_bf16 a[204:207], v[84:87], v[100:103], a[204:207]
    v_mfma_f32_16x16x32_bf16 a[208:211], v[88:91], v[96:99], a[208:211]
    v_mfma_f32_16x16x32_bf16 a[212:215], v[88:91], v[100:103], a[212:215]
    v_mfma_f32_16x16x32_bf16 a[216:219], v[92:95], v[96:99], a[216:219]
    v_mfma_f32_16x16x32_bf16 a[220:223], v[92:95], v[100:103], a[220:223]
    s_mov_b32 s6, 3136
    buffer_load_dwordx4 v[68:71], v28, s[8:11], s6 offen sc1
    s_mov_b32 s6, 60480
    buffer_load_dwordx4 v[72:75], v28, s[8:11], s6 offen sc1
    s_mov_b32 s6, 117824
    buffer_load_dwordx4 v[76:79], v28, s[8:11], s6 offen sc1
    s_mov_b32 s6, 175168
    buffer_load_dwordx4 v[80:83], v28, s[8:11], s6 offen sc1
    s_mov_b32 s6, 232512
    buffer_load_dwordx4 v[84:87], v28, s[8:11], s6 offen sc1
    s_mov_b32 s6, 289856
    buffer_load_dwordx4 v[88:91], v28, s[8:11], s6 offen sc1
    s_mov_b32 s6, 347200
    buffer_load_dwordx4 v[92:95], v28, s[8:11], s6 offen sc1
    s_mov_b32 s6, 3136
    buffer_load_dwordx4 v[96:99], v29, s[8:11], s6 offen sc1
    s_mov_b32 s6, 60480
    buffer_load_dwordx4 v[100:103], v29, s[8:11], s6 offen sc1
    s_waitcnt vmcnt(9) lgkmcnt(0)
    v_mfma_f32_16x16x32_bf16 a[168:171], v[32:35], v[60:63], a[168:171]
    v_mfma_f32_16x16x32_bf16 a[172:175], v[32:35], v[64:67], a[172:175]
    v_mfma_f32_16x16x32_bf16 a[176:179], v[36:39], v[60:63], a[176:179]
    v_mfma_f32_16x16x32_bf16 a[180:183], v[36:39], v[64:67], a[180:183]
    v_mfma_f32_16x16x32_bf16 a[184:187], v[40:43], v[60:63], a[184:187]
    v_mfma_f32_16x16x32_bf16 a[188:191], v[40:43], v[64:67], a[188:191]
    v_mfma_f32_16x16x32_bf16 a[192:195], v[44:47], v[60:63], a[192:195]
    v_mfma_f32_16x16x32_bf16 a[196:199], v[44:47], v[64:67], a[196:199]
    v_mfma_f32_16x16x32_bf16 a[200:203], v[48:51], v[60:63], a[200:203]
    v_mfma_f32_16x16x32_bf16 a[204:207], v[48:51], v[64:67], a[204:207]
    v_mfma_f32_16x16x32_bf16 a[208:211], v[52:55], v[60:63], a[208:211]
    v_mfma_f32_16x16x32_bf16 a[212:215], v[52:55], v[64:67], a[212:215]
    v_mfma_f32_16x16x32_bf16 a[216:219], v[56:59], v[60:63], a[216:219]
    v_mfma_f32_16x16x32_bf16 a[220:223], v[56:59], v[64:67], a[220:223]
    s_mov_b32 s6, 3200
    buffer_load_dwordx4 v[32:35], v28, s[8:11], s6 offen sc1
    s_mov_b32 s6, 60544
    buffer_load_dwordx4 v[36:39], v28, s[8:11], s6 offen sc1
    s_mov_b32 s6, 117888
    buffer_load_dwordx4 v[40:43], v28, s[8:11], s6 offen sc1
    s_mov_b32 s6, 175232
    buffer_load_dwordx4 v[44:47], v28, s[8:11], s6 offen sc1
    s_mov_b32 s6, 232576
    buffer_load_dwordx4 v[48:51], v28, s[8:11], s6 offen sc1
    s_mov_b32 s6, 289920
    buffer_load_dwordx4 v[52:55], v28, s[8:11], s6 offen sc1
    s_mov_b32 s6, 347264
    buffer_load_dwordx4 v[56:59], v28, s[8:11], s6 offen sc1
    s_mov_b32 s6, 3200
    buffer_load_dwordx4 v[60:63], v29, s[8:11], s6 offen sc1
    s_mov_b32 s6, 60544
    buffer_load_dwordx4 v[64:67], v29, s[8:11], s6 offen sc1
    s_waitcnt vmcnt(9) lgkmcnt(0)
    v_mfma_f32_16x16x32_bf16 a[168:171], v[68:71], v[96:99], a[168:171]
    v_mfma_f32_16x16x32_bf16 a[172:175], v[68:71], v[100:103], a[172:175]
    v_mfma_f32_16x16x32_bf16 a[176:179], v[72:75], v[96:99], a[176:179]
    v_mfma_f32_16x16x32_bf16 a[180:183], v[72:75], v[100:103], a[180:183]
    v_mfma_f32_16x16x32_bf16 a[184:187], v[76:79], v[96:99], a[184:187]
    v_mfma_f32_16x16x32_bf16 a[188:191], v[76:79], v[100:103], a[188:191]
    v_mfma_f32_16x16x32_bf16 a[192:195], v[80:83], v[96:99], a[192:195]
    v_mfma_f32_16x16x32_bf16 a[196:199], v[80:83], v[100:103], a[196:199]
    v_mfma_f32_16x16x32_bf16 a[200:203], v[84:87], v[96:99], a[200:203]
    v_mfma_f32_16x16x32_bf16 a[204:207], v[84:87], v[100:103], a[204:207]
    v_mfma_f32_16x16x32_bf16 a[208:211], v[88:91], v[96:99], a[208:211]
    v_mfma_f32_16x16x32_bf16 a[212:215], v[88:91], v[100:103], a[212:215]
    v_mfma_f32_16x16x32_bf16 a[216:219], v[92:95], v[96:99], a[216:219]
    v_mfma_f32_16x16x32_bf16 a[220:223], v[92:95], v[100:103], a[220:223]
    s_mov_b32 s6, 3264
    buffer_load_dwordx4 v[68:71], v28, s[8:11], s6 offen sc1
    s_mov_b32 s6, 60608
    buffer_load_dwordx4 v[72:75], v28, s[8:11], s6 offen sc1
    s_mov_b32 s6, 117952
    buffer_load_dwordx4 v[76:79], v28, s[8:11], s6 offen sc1
    s_mov_b32 s6, 175296
    buffer_load_dwordx4 v[80:83], v28, s[8:11], s6 offen sc1
    s_mov_b32 s6, 232640
    buffer_load_dwordx4 v[84:87], v28, s[8:11], s6 offen sc1
    s_mov_b32 s6, 289984
    buffer_load_dwordx4 v[88:91], v28, s[8:11], s6 offen sc1
    s_mov_b32 s6, 347328
    buffer_load_dwordx4 v[92:95], v28, s[8:11], s6 offen sc1
    s_mov_b32 s6, 3264
    buffer_load_dwordx4 v[96:99], v29, s[8:11], s6 offen sc1
    s_mov_b32 s6, 60608
    buffer_load_dwordx4 v[100:103], v29, s[8:11], s6 offen sc1
    s_waitcnt vmcnt(9) lgkmcnt(0)
    v_mfma_f32_16x16x32_bf16 a[168:171], v[32:35], v[60:63], a[168:171]
    v_mfma_f32_16x16x32_bf16 a[172:175], v[32:35], v[64:67], a[172:175]
    v_mfma_f32_16x16x32_bf16 a[176:179], v[36:39], v[60:63], a[176:179]
    v_mfma_f32_16x16x32_bf16 a[180:183], v[36:39], v[64:67], a[180:183]
    v_mfma_f32_16x16x32_bf16 a[184:187], v[40:43], v[60:63], a[184:187]
    v_mfma_f32_16x16x32_bf16 a[188:191], v[40:43], v[64:67], a[188:191]
    v_mfma_f32_16x16x32_bf16 a[192:195], v[44:47], v[60:63], a[192:195]
    v_mfma_f32_16x16x32_bf16 a[196:199], v[44:47], v[64:67], a[196:199]
    v_mfma_f32_16x16x32_bf16 a[200:203], v[48:51], v[60:63], a[200:203]
    v_mfma_f32_16x16x32_bf16 a[204:207], v[48:51], v[64:67], a[204:207]
    v_mfma_f32_16x16x32_bf16 a[208:211], v[52:55], v[60:63], a[208:211]
    v_mfma_f32_16x16x32_bf16 a[212:215], v[52:55], v[64:67], a[212:215]
    v_mfma_f32_16x16x32_bf16 a[216:219], v[56:59], v[60:63], a[216:219]
    v_mfma_f32_16x16x32_bf16 a[220:223], v[56:59], v[64:67], a[220:223]
    s_mov_b32 s6, 3328
    buffer_load_dwordx4 v[32:35], v28, s[8:11], s6 offen sc1
    s_mov_b32 s6, 60672
    buffer_load_dwordx4 v[36:39], v28, s[8:11], s6 offen sc1
    s_mov_b32 s6, 118016
    buffer_load_dwordx4 v[40:43], v28, s[8:11], s6 offen sc1
    s_mov_b32 s6, 175360
    buffer_load_dwordx4 v[44:47], v28, s[8:11], s6 offen sc1
    s_mov_b32 s6, 232704
    buffer_load_dwordx4 v[48:51], v28, s[8:11], s6 offen sc1
    s_mov_b32 s6, 290048
    buffer_load_dwordx4 v[52:55], v28, s[8:11], s6 offen sc1
    s_mov_b32 s6, 347392
    buffer_load_dwordx4 v[56:59], v28, s[8:11], s6 offen sc1
    s_mov_b32 s6, 3328
    buffer_load_dwordx4 v[60:63], v29, s[8:11], s6 offen sc1
    s_mov_b32 s6, 60672
    buffer_load_dwordx4 v[64:67], v29, s[8:11], s6 offen sc1
    s_waitcnt vmcnt(9) lgkmcnt(0)
    v_mfma_f32_16x16x32_bf16 a[168:171], v[68:71], v[96:99], a[168:171]
    v_mfma_f32_16x16x32_bf16 a[172:175], v[68:71], v[100:103], a[172:175]
    v_mfma_f32_16x16x32_bf16 a[176:179], v[72:75], v[96:99], a[176:179]
    v_mfma_f32_16x16x32_bf16 a[180:183], v[72:75], v[100:103], a[180:183]
    v_mfma_f32_16x16x32_bf16 a[184:187], v[76:79], v[96:99], a[184:187]
    v_mfma_f32_16x16x32_bf16 a[188:191], v[76:79], v[100:103], a[188:191]
    v_mfma_f32_16x16x32_bf16 a[192:195], v[80:83], v[96:99], a[192:195]
    v_mfma_f32_16x16x32_bf16 a[196:199], v[80:83], v[100:103], a[196:199]
    v_mfma_f32_16x16x32_bf16 a[200:203], v[84:87], v[96:99], a[200:203]
    v_mfma_f32_16x16x32_bf16 a[204:207], v[84:87], v[100:103], a[204:207]
    v_mfma_f32_16x16x32_bf16 a[208:211], v[88:91], v[96:99], a[208:211]
    v_mfma_f32_16x16x32_bf16 a[212:215], v[88:91], v[100:103], a[212:215]
    v_mfma_f32_16x16x32_bf16 a[216:219], v[92:95], v[96:99], a[216:219]
    v_mfma_f32_16x16x32_bf16 a[220:223], v[92:95], v[100:103], a[220:223]
    s_mov_b32 s6, 3392
    buffer_load_dwordx4 v[68:71], v28, s[8:11], s6 offen sc1
    s_mov_b32 s6, 60736
    buffer_load_dwordx4 v[72:75], v28, s[8:11], s6 offen sc1
    s_mov_b32 s6, 118080
    buffer_load_dwordx4 v[76:79], v28, s[8:11], s6 offen sc1
    s_mov_b32 s6, 175424
    buffer_load_dwordx4 v[80:83], v28, s[8:11], s6 offen sc1
    s_mov_b32 s6, 232768
    buffer_load_dwordx4 v[84:87], v28, s[8:11], s6 offen sc1
    s_mov_b32 s6, 290112
    buffer_load_dwordx4 v[88:91], v28, s[8:11], s6 offen sc1
    s_mov_b32 s6, 347456
    buffer_load_dwordx4 v[92:95], v28, s[8:11], s6 offen sc1
    s_mov_b32 s6, 3392
    buffer_load_dwordx4 v[96:99], v29, s[8:11], s6 offen sc1
    s_mov_b32 s6, 60736
    buffer_load_dwordx4 v[100:103], v29, s[8:11], s6 offen sc1
    s_waitcnt vmcnt(9) lgkmcnt(0)
    v_mfma_f32_16x16x32_bf16 a[168:171], v[32:35], v[60:63], a[168:171]
    v_mfma_f32_16x16x32_bf16 a[172:175], v[32:35], v[64:67], a[172:175]
    v_mfma_f32_16x16x32_bf16 a[176:179], v[36:39], v[60:63], a[176:179]
    v_mfma_f32_16x16x32_bf16 a[180:183], v[36:39], v[64:67], a[180:183]
    v_mfma_f32_16x16x32_bf16 a[184:187], v[40:43], v[60:63], a[184:187]
    v_mfma_f32_16x16x32_bf16 a[188:191], v[40:43], v[64:67], a[188:191]
    v_mfma_f32_16x16x32_bf16 a[192:195], v[44:47], v[60:63], a[192:195]
    v_mfma_f32_16x16x32_bf16 a[196:199], v[44:47], v[64:67], a[196:199]
    v_mfma_f32_16x16x32_bf16 a[200:203], v[48:51], v[60:63], a[200:203]
    v_mfma_f32_16x16x32_bf16 a[204:207], v[48:51], v[64:67], a[204:207]
    v_mfma_f32_16x16x32_bf16 a[208:211], v[52:55], v[60:63], a[208:211]
    v_mfma_f32_16x16x32_bf16 a[212:215], v[52:55], v[64:67], a[212:215]
    v_mfma_f32_16x16x32_bf16 a[216:219], v[56:59], v[60:63], a[216:219]
    v_mfma_f32_16x16x32_bf16 a[220:223], v[56:59], v[64:67], a[220:223]
    s_mov_b32 s6, 3456
    buffer_load_dwordx4 v[32:35], v28, s[8:11], s6 offen sc1
    s_mov_b32 s6, 60800
    buffer_load_dwordx4 v[36:39], v28, s[8:11], s6 offen sc1
    s_mov_b32 s6, 118144
    buffer_load_dwordx4 v[40:43], v28, s[8:11], s6 offen sc1
    s_mov_b32 s6, 175488
    buffer_load_dwordx4 v[44:47], v28, s[8:11], s6 offen sc1
    s_mov_b32 s6, 232832
    buffer_load_dwordx4 v[48:51], v28, s[8:11], s6 offen sc1
    s_mov_b32 s6, 290176
    buffer_load_dwordx4 v[52:55], v28, s[8:11], s6 offen sc1
    s_mov_b32 s6, 347520
    buffer_load_dwordx4 v[56:59], v28, s[8:11], s6 offen sc1
    s_mov_b32 s6, 3456
    buffer_load_dwordx4 v[60:63], v29, s[8:11], s6 offen sc1
    s_mov_b32 s6, 60800
    buffer_load_dwordx4 v[64:67], v29, s[8:11], s6 offen sc1
    s_waitcnt vmcnt(9) lgkmcnt(0)
    v_mfma_f32_16x16x32_bf16 a[168:171], v[68:71], v[96:99], a[168:171]
    v_mfma_f32_16x16x32_bf16 a[172:175], v[68:71], v[100:103], a[172:175]
    v_mfma_f32_16x16x32_bf16 a[176:179], v[72:75], v[96:99], a[176:179]
    v_mfma_f32_16x16x32_bf16 a[180:183], v[72:75], v[100:103], a[180:183]
    v_mfma_f32_16x16x32_bf16 a[184:187], v[76:79], v[96:99], a[184:187]
    v_mfma_f32_16x16x32_bf16 a[188:191], v[76:79], v[100:103], a[188:191]
    v_mfma_f32_16x16x32_bf16 a[192:195], v[80:83], v[96:99], a[192:195]
    v_mfma_f32_16x16x32_bf16 a[196:199], v[80:83], v[100:103], a[196:199]
    v_mfma_f32_16x16x32_bf16 a[200:203], v[84:87], v[96:99], a[200:203]
    v_mfma_f32_16x16x32_bf16 a[204:207], v[84:87], v[100:103], a[204:207]
    v_mfma_f32_16x16x32_bf16 a[208:211], v[88:91], v[96:99], a[208:211]
    v_mfma_f32_16x16x32_bf16 a[212:215], v[88:91], v[100:103], a[212:215]
    v_mfma_f32_16x16x32_bf16 a[216:219], v[92:95], v[96:99], a[216:219]
    v_mfma_f32_16x16x32_bf16 a[220:223], v[92:95], v[100:103], a[220:223]
    s_mov_b32 s6, 3520
    buffer_load_dwordx4 v[68:71], v28, s[8:11], s6 offen sc1
    s_mov_b32 s6, 60864
    buffer_load_dwordx4 v[72:75], v28, s[8:11], s6 offen sc1
    s_mov_b32 s6, 118208
    buffer_load_dwordx4 v[76:79], v28, s[8:11], s6 offen sc1
    s_mov_b32 s6, 175552
    buffer_load_dwordx4 v[80:83], v28, s[8:11], s6 offen sc1
    s_mov_b32 s6, 232896
    buffer_load_dwordx4 v[84:87], v28, s[8:11], s6 offen sc1
    s_mov_b32 s6, 290240
    buffer_load_dwordx4 v[88:91], v28, s[8:11], s6 offen sc1
    s_mov_b32 s6, 347584
    buffer_load_dwordx4 v[92:95], v28, s[8:11], s6 offen sc1
    s_mov_b32 s6, 3520
    buffer_load_dwordx4 v[96:99], v29, s[8:11], s6 offen sc1
    s_mov_b32 s6, 60864
    buffer_load_dwordx4 v[100:103], v29, s[8:11], s6 offen sc1
    s_waitcnt vmcnt(9) lgkmcnt(0)
    v_mfma_f32_16x16x32_bf16 a[168:171], v[32:35], v[60:63], a[168:171]
    v_mfma_f32_16x16x32_bf16 a[172:175], v[32:35], v[64:67], a[172:175]
    v_mfma_f32_16x16x32_bf16 a[176:179], v[36:39], v[60:63], a[176:179]
    v_mfma_f32_16x16x32_bf16 a[180:183], v[36:39], v[64:67], a[180:183]
    v_mfma_f32_16x16x32_bf16 a[184:187], v[40:43], v[60:63], a[184:187]
    v_mfma_f32_16x16x32_bf16 a[188:191], v[40:43], v[64:67], a[188:191]
    v_mfma_f32_16x16x32_bf16 a[192:195], v[44:47], v[60:63], a[192:195]
    v_mfma_f32_16x16x32_bf16 a[196:199], v[44:47], v[64:67], a[196:199]
    v_mfma_f32_16x16x32_bf16 a[200:203], v[48:51], v[60:63], a[200:203]
    v_mfma_f32_16x16x32_bf16 a[204:207], v[48:51], v[64:67], a[204:207]
    v_mfma_f32_16x16x32_bf16 a[208:211], v[52:55], v[60:63], a[208:211]
    v_mfma_f32_16x16x32_bf16 a[212:215], v[52:55], v[64:67], a[212:215]
    v_mfma_f32_16x16x32_bf16 a[216:219], v[56:59], v[60:63], a[216:219]
    v_mfma_f32_16x16x32_bf16 a[220:223], v[56:59], v[64:67], a[220:223]
    s_waitcnt vmcnt(0) lgkmcnt(0)
    v_mfma_f32_16x16x32_bf16 a[168:171], v[68:71], v[96:99], a[168:171]
    v_mfma_f32_16x16x32_bf16 a[172:175], v[68:71], v[100:103], a[172:175]
    v_mfma_f32_16x16x32_bf16 a[176:179], v[72:75], v[96:99], a[176:179]
    v_mfma_f32_16x16x32_bf16 a[180:183], v[72:75], v[100:103], a[180:183]
    v_mfma_f32_16x16x32_bf16 a[184:187], v[76:79], v[96:99], a[184:187]
    v_mfma_f32_16x16x32_bf16 a[188:191], v[76:79], v[100:103], a[188:191]
    v_mfma_f32_16x16x32_bf16 a[192:195], v[80:83], v[96:99], a[192:195]
    v_mfma_f32_16x16x32_bf16 a[196:199], v[80:83], v[100:103], a[196:199]
    v_mfma_f32_16x16x32_bf16 a[200:203], v[84:87], v[96:99], a[200:203]
    v_mfma_f32_16x16x32_bf16 a[204:207], v[84:87], v[100:103], a[204:207]
    v_mfma_f32_16x16x32_bf16 a[208:211], v[88:91], v[96:99], a[208:211]
    v_mfma_f32_16x16x32_bf16 a[212:215], v[88:91], v[100:103], a[212:215]
    v_mfma_f32_16x16x32_bf16 a[216:219], v[92:95], v[96:99], a[216:219]
    v_mfma_f32_16x16x32_bf16 a[220:223], v[92:95], v[100:103], a[220:223]
    s_mul_i32 s30, s2, 14336
    s_add_u32 s30, s30, 89143296
K5n_poll:
    s_sleep 8
    s_add_u32 s28, s30, s34
    buffer_load_dwordx4 v[4:7], v2, s[8:11], s28 offen sc1
    s_add_u32 s28, s30, s35
    buffer_load_dwordx4 v[8:11], v2, s[8:11], s28 offen sc1
    s_add_u32 s28, s30, s36
    buffer_load_dwordx4 v[12:15], v2, s[8:11], s28 offen sc1
    s_add_u32 s28, s30, s37
    buffer_load_dwordx4 v[16:19], v2, s[8:11], s28 offen sc1
    s_waitcnt vmcnt(0)
    v_and_b32 v20, v4, v5
    v_and_b32 v20, v20, v6
    v_and_b32 v20, v20, v7
    v_and_b32 v20, v20, v8
    v_and_b32 v20, v20, v9
    v_and_b32 v20, v20, v10
    v_and_b32 v20, v20, v11
    v_and_b32 v20, v20, v12
    v_and_b32 v20, v20, v13
    v_and_b32 v20, v20, v14
    v_and_b32 v20, v20, v15
    v_and_b32 v20, v20, v16
    v_and_b32 v20, v20, v17
    v_and_b32 v20, v20, v18
    v_and_b32 v20, v20, v19
    v_and_b32 v20, 0xffff, v20
    v_cmp_ne_u32 vcc, 23130, v20
    s_add_u32 s42, s42, 1
    s_cmp_gt_u32 s42, 0x400000
    s_cbranch_scc1 K5n_pout
    s_cbranch_vccnz K5n_poll
K5n_pout:
    v_perm_b32 v20, v5, v4, s29
    v_perm_b32 v21, v7, v6, s29
    v_add_u32 v22, s38, v3
    ds_write_b64 v22, v[20:21]
    v_perm_b32 v20, v9, v8, s29
    v_perm_b32 v21, v11, v10, s29
    v_add_u32 v22, s39, v3
    ds_write_b64 v22, v[20:21]
    v_perm_b32 v20, v13, v12, s29
    v_perm_b32 v21, v15, v14, s29
    v_add_u32 v22, s40, v3
    ds_write_b64 v22, v[20:21]
    v_perm_b32 v20, v17, v16, s29
    v_perm_b32 v21, v19, v18, s29
    v_add_u32 v22, s41, v3
    ds_write_b64 v22, v[20:21]
    s_waitcnt lgkmcnt(0)
    s_barrier
    s_mul_i32 s30, s2, 14336
    s_add_u32 s30, s30, 89128960
K5_poll:
    s_sleep 8
    s_add_u32 s28, s30, s34
    buffer_load_dwordx4 v[4:7], v2, s[8:11], s28 offen sc1
    s_add_u32 s28, s30, s35
    buffer_load_dwordx4 v[8:11], v2, s[8:11], s28 offen sc1
    s_add_u32 s28, s30, s36
    buffer_load_dwordx4 v[12:15], v2, s[8:11], s28 offen sc1
    s_add_u32 s28, s30, s37
    buffer_load_dwordx4 v[16:19], v2, s[8:11], s28 offen sc1
    s_waitcnt vmcnt(0)
    v_and_b32 v20, v4, v5
    v_and_b32 v20, v20, v6
    v_and_b32 v20, v20, v7
    v_and_b32 v20, v20, v8
    v_and_b32 v20, v20, v9
    v_and_b32 v20, v20, v10
    v_and_b32 v20, v20, v11
    v_and_b32 v20, v20, v12
    v_and_b32 v20, v20, v13
    v_and_b32 v20, v20, v14
    v_and_b32 v20, v20, v15
    v_and_b32 v20, v20, v16
    v_and_b32 v20, v20, v17
    v_and_b32 v20, v20, v18
    v_and_b32 v20, v20, v19
    v_and_b32 v20, 0xffff, v20
    v_cmp_ne_u32 vcc, 23130, v20
    s_add_u32 s42, s42, 1
    s_cmp_gt_u32 s42, 0x400000
    s_cbranch_scc1 K5_pout
    s_cbranch_vccnz K5_poll
K5_pout:
    v_perm_b32 v20, v5, v4, s29
    v_perm_b32 v21, v7, v6, s29
    v_add_u32 v22, s38, v3
    ds_write_b64 v22, v[20:21]
    v_perm_b32 v20, v9, v8, s29
    v_perm_b32 v21, v11, v10, s29
    v_add_u32 v22, s39, v3
    ds_write_b64 v22, v[20:21]
    v_perm_b32 v20, v13, v12, s29
    v_perm_b32 v21, v15, v14, s29
    v_add_u32 v22, s40, v3
    ds_write_b64 v22, v[20:21]
    v_perm_b32 v20, v17, v16, s29
    v_perm_b32 v21, v19, v18, s29
    v_add_u32 v22, s41, v3
    ds_write_b64 v22, v[20:21]
    s_lshl_b32 s5, s4, 3
    s_lshl_b32 s6, s2, 5
    s_add_u32 s6, s6, s5
    s_mul_i32 s6, s6, 896
    s_add_u32 s5, s5, 8
    s_mul_i32 s5, s5, 912
    v_add_u32 v118, s5, v2
    v_cmp_gt_u32 vcc, 56, v0
    s_and_saveexec_b64 s[20:21], vcc
    buffer_load_dwordx4 v[32:35], v2, s[8:11], s6 offen
    s_add_u32 s6, s6, 896
    buffer_load_dwordx4 v[36:39], v2, s[8:11], s6 offen
    s_add_u32 s6, s6, 896
    buffer_load_dwordx4 v[40:43], v2, s[8:11], s6 offen
    s_add_u32 s6, s6, 896
    buffer_load_dwordx4 v[44:47], v2, s[8:11], s6 offen
    s_add_u32 s6, s6, 896
    buffer_load_dwordx4 v[48:51], v2, s[8:11], s6 offen
    s_add_u32 s6, s6, 896
    buffer_load_dwordx4 v[52:55], v2, s[8:11], s6 offen
    s_add_u32 s6, s6, 896
    buffer_load_dwordx4 v[56:59], v2, s[8:11], s6 offen
    s_add_u32 s6, s6, 896
    buffer_load_dwordx4 v[60:63], v2, s[8:11], s6 offen
    s_add_u32 s6, s6, 896
    s_waitcnt vmcnt(7)
    ds_write_b128 v118, v[32:35] offset:0
    s_waitcnt vmcnt(6)
    ds_write_b128 v118, v[36:39] offset:912
    s_waitcnt vmcnt(5)
    ds_write_b128 v118, v[40:43] offset:1824
    s_waitcnt vmcnt(4)
    ds_write_b128 v118, v[44:47] offset:2736
    s_waitcnt vmcnt(3)
    ds_write_b128 v118, v[48:51] offset:3648
    s_waitcnt vmcnt(2)
    ds_write_b128 v118, v[52:55] offset:4560
    s_waitcnt vmcnt(1)
    ds_write_b128 v118, v[56:59] offset:5472
    s_waitcnt vmcnt(0)
    ds_write_b128 v118, v[60:63] offset:6384
    s_mov_b64 exec, s[20:21]
    s_waitcnt lgkmcnt(0)
    s_barrier
    v_mul_u32_u24 v119, 912, v116
    v_lshl_add_u32 v119, v117, 4, v119
    ds_read_b128 a[0:3], v119 offset:0
    ds_read_b128 a[4:7], v119 offset:64
    ds_read_b128 a[8:11], v119 offset:128
    ds_read_b128 a[12:15], v119 offset:192
    ds_read_b128 a[16:19], v119 offset:256
    ds_read_b128 a[20:23], v119 offset:320
    ds_read_b128 a[24:27], v119 offset:384
    ds_read_b128 a[28:31], v119 offset:448
    ds_read_b128 a[32:35], v119 offset:512
    ds_read_b128 a[36:39], v119 offset:576
    ds_read_b128 a[40:43], v119 offset:640
    ds_read_b128 a[44:47], v119 offset:704
    ds_read_b128 a[48:51], v119 offset:768
    ds_read_b128 a[52:55], v119 offset:832
    s_waitcnt lgkmcnt(0)
    ds_read_b128 a[56:59], v119 offset:14592
    ds_read_b128 a[60:63], v119 offset:14656
    ds_read_b128 a[64:67], v119 offset:14720
    ds_read_b128 a[68:71], v119 offset:14784
    ds_read_b128 a[72:75], v119 offset:14848
    ds_read_b128 a[76:79], v119 offset:14912
    ds_read_b128 a[80:83], v119 offset:14976
    ds_read_b128 a[84:87], v119 offset:15040
    ds_read_b128 a[88:91], v119 offset:15104
    ds_read_b128 a[92:95], v119 offset:15168
    ds_read_b128 a[96:99], v119 offset:15232
    ds_read_b128 a[100:103], v119 offset:15296
    ds_read_b128 a[104:107], v119 offset:15360
    ds_read_b128 a[108:111], v119 offset:15424
    s_waitcnt lgkmcnt(0)
    ds_read_b128 a[112:115], v119 offset:29184
    ds_read_b128 a[116:119], v119 offset:29248
    ds_read_b128 a[120:123], v119 offset:29312
    ds_read_b128 a[124:127], v119 offset:29376
    ds_read_b128 a[128:131], v119 offset:29440
    ds_read_b128 a[132:135], v119 offset:29504
    ds_read_b128 a[136:139], v119 offset:29568
    ds_read_b128 a[140:143], v119 offset:29632
    ds_read_b128 a[144:147], v119 offset:29696
    ds_read_b128 a[148:151], v119 offset:29760
    ds_read_b128 a[152:155], v119 offset:29824
    ds_read_b128 a[156:159], v119 offset:29888
    ds_read_b128 a[160:163], v119 offset:29952
    ds_read_b128 a[164:167], v119 offset:30016
    s_waitcnt lgkmcnt(0)
    s_lshl_b32 s6, s2, 5
    v_add_u32 v23, s6, v116
    v_mul_u32_u24 v23, 14336, v23
    v_lshl_add_u32 v23, v117, 4, v23
    s_mul_i32 s6, s4, 3584
    s_add_u32 s6, s6, 23068672
    v_add_u32 v23, s6, v23
    v_add_u32 v24, 229376, v23
    v_lshl_add_u32 v120, v117, 2, 0
    v_lshl_add_u32 v121, v117, 2, 1
    v_lshl_add_u32 v122, v117, 2, 2
    v_lshl_add_u32 v123, v117, 2, 3
    v_lshl_add_u32 v124, v117, 2, 16
    v_lshl_add_u32 v125, v117, 2, 17
    v_lshl_add_u32 v126, v117, 2, 18
    v_lshl_add_u32 v127, v117, 2, 19
    v_lshl_add_u32 v128, v117, 2, 32
    v_lshl_add_u32 v129, v117, 2, 33
    v_lshl_add_u32 v130, v117, 2, 34
    v_lshl_add_u32 v131, v117, 2, 35
    v_add_u32 v132, 8, v116
    v_add_u32 v133, 24, v116
    v_xor_b32 v134, 16, v0
    v_lshlrev_b32 v134, 2, v134
    v_xor_b32 v135, 32, v0
    v_lshlrev_b32 v135, 2, v135
    v_mov_b32 v136, 0xff800000
    s_mul_i32 s6, s4, 12288
    s_add_u32 s6, s6, 45056
    v_mul_u32_u24 v25, 96, v116
    v_lshl_add_u32 v25, v117, 3, v25
    v_add_u32 v25, s6, v25
    buffer_load_dwordx4 v[140:143], v23, s[8:11], 0 offen offset:0 sc1
    buffer_load_dwordx4 v[144:147], v23, s[8:11], 0 offen offset:64 sc1
    buffer_load_dwordx4 v[148:151], v23, s[8:11], 0 offen offset:128 sc1
    buffer_load_dwordx4 v[152:155], v23, s[8:11], 0 offen offset:192 sc1
    buffer_load_dwordx4 v[156:159], v23, s[8:11], 0 offen offset:256 sc1
    buffer_load_dwordx4 v[160:163], v23, s[8:11], 0 offen offset:320 sc1
    buffer_load_dwordx4 v[164:167], v23, s[8:11], 0 offen offset:384 sc1
    buffer_load_dwordx4 v[168:171], v23, s[8:11], 0 offen offset:448 sc1
    buffer_load_dwordx4 v[172:175], v23, s[8:11], 0 offen offset:512 sc1
    buffer_load_dwordx4 v[176:179], v23, s[8:11], 0 offen offset:576 sc1
    buffer_load_dwordx4 v[180:183], v23, s[8:11], 0 offen offset:640 sc1
    buffer_load_dwordx4 v[184:187], v23, s[8:11], 0 offen offset:704 sc1
    buffer_load_dwordx4 v[188:191], v23, s[8:11], 0 offen offset:768 sc1
    buffer_load_dwordx4 v[192:195], v23, s[8:11], 0 offen offset:832 sc1
    buffer_load_dwordx4 v[196:199], v24, s[8:11], 0 offen offset:0 sc1
    buffer_load_dwordx4 v[200:203], v24, s[8:11], 0 offen offset:64 sc1
    buffer_load_dwordx4 v[204:207], v24, s[8:11], 0 offen offset:128 sc1
    buffer_load_dwordx4 v[208:211], v24, s[8:11], 0 offen offset:192 sc1
    buffer_load_dwordx4 v[212:215], v24, s[8:11], 0 offen offset:256 sc1
    buffer_load_dwordx4 v[216:219], v24, s[8:11], 0 offen offset:320 sc1
    buffer_load_dwordx4 v[220:223], v24, s[8:11], 0 offen offset:384 sc1
    buffer_load_dwordx4 v[224:227], v24, s[8:11], 0 offen offset:448 sc1
    buffer_load_dwordx4 v[228:231], v24, s[8:11], 0 offen offset:512 sc1
    buffer_load_dwordx4 v[232:235], v24, s[8:11], 0 offen offset:576 sc1
    buffer_load_dwordx4 v[236:239], v24, s[8:11], 0 offen offset:640 sc1
    buffer_load_dwordx4 v[240:243], v24, s[8:11], 0 offen offset:704 sc1
    buffer_load_dwordx4 v[244:247], v24, s[8:11], 0 offen offset:768 sc1
    buffer_load_dwordx4 v[248:251], v24, s[8:11], 0 offen offset:832 sc1
    v_mov_b32 v32, 0
    v_mov_b32 v33, 0
    v_mov_b32 v34, 0
    v_mov_b32 v35, 0
    v_mov_b32 v36, 0
    v_mov_b32 v37, 0
    v_mov_b32 v38, 0
    v_mov_b32 v39, 0
    v_mov_b32 v40, 0
    v_mov_b32 v41, 0
    v_mov_b32 v42, 0
    v_mov_b32 v43, 0
    s_waitcnt vmcnt(14)
    v_mfma_f32_16x16x32_bf16 v[32:35], a[0:3], v[140:143], v[32:35]
    v_mfma_f32_16x16x32_bf16 v[36:39], a[56:59], v[140:143], v[36:39]
    v_mfma_f32_16x16x32_bf16 v[40:43], a[112:115], v[140:143], v[40:43]
    v_mfma_f32_16x16x32_bf16 v[32:35], a[4:7], v[144:147], v[32:35]
    v_mfma_f32_16x16x32_bf16 v[36:39], a[60:63], v[144:147], v[36:39]
    v_mfma_f32_16x16x32_bf16 v[40:43], a[116:119], v[144:147], v[40:43]
    v_mfma_f32_16x16x32_bf16 v[32:35], a[8:11], v[148:151], v[32:35]
    v_mfma_f32_16x16x32_bf16 v[36:39], a[64:67], v[148:151], v[36:39]
    v_mfma_f32_16x16x32_bf16 v[40:43], a[120:123], v[148:151], v[40:43]
    v_mfma_f32_16x16x32_bf16 v[32:35], a[12:15], v[152:155], v[32:35]
    v_mfma_f32_16x16x32_bf16 v[36:39], a[68:71], v[152:155], v[36:39]
    v_mfma_f32_16x16x32_bf16 v[40:43], a[124:127], v[152:155], v[40:43]
    v_mfma_f32_16x16x32_bf16 v[32:35], a[16:19], v[156:159], v[32:35]
    v_mfma_f32_16x16x32_bf16 v[36:39], a[72:75], v[156:159], v[36:39]
    v_mfma_f32_16x16x32_bf16 v[40:43], a[128:131], v[156:159], v[40:43]
    v_mfma_f32_16x16x32_bf16 v[32:35], a[20:23], v[160:163], v[32:35]
    v_mfma_f32_16x16x32_bf16 v[36:39], a[76:79], v[160:163], v[36:39]
    v_mfma_f32_16x16x32_bf16 v[40:43], a[132:135], v[160:163], v[40:43]
    v_mfma_f32_16x16x32_bf16 v[32:35], a[24:27], v[164:167], v[32:35]
    v_mfma_f32_16x16x32_bf16 v[36:39], a[80:83], v[164:167], v[36:39]
    v_mfma_f32_16x16x32_bf16 v[40:43], a[136:139], v[164:167], v[40:43]
    v_mfma_f32_16x16x32_bf16 v[32:35], a[28:31], v[168:171], v[32:35]
    v_mfma_f32_16x16x32_bf16 v[36:39], a[84:87], v[168:171], v[36:39]
    v_mfma_f32_16x16x32_bf16 v[40:43], a[140:143], v[168:171], v[40:43]
    v_mfma_f32_16x16x32_bf16 v[32:35], a[32:35], v[172:175], v[32:35]
    v_mfma_f32_16x16x32_bf16 v[36:39], a[88:91], v[172:175], v[36:39]
    v_mfma_f32_16x16x32_bf16 v[40:43], a[144:147], v[172:175], v[40:43]
    v_mfma_f32_16x16x32_bf16 v[32:35], a[36:39], v[176:179], v[32:35]
    v_mfma_f32_16x16x32_bf16 v[36:39], a[92:95], v[176:179], v[36:39]
    v_mfma_f32_16x16x32_bf16 v[40:43], a[148:151], v[176:179], v[40:43]
    v_mfma_f32_16x16x32_bf16 v[32:35], a[40:43], v[180:183], v[32:35]
    v_mfma_f32_16x16x32_bf16 v[36:39], a[96:99], v[180:183], v[36:39]
    v_mfma_f32_16x16x32_bf16 v[40:43], a[152:155], v[180:183], v[40:43]
    v_mfma_f32_16x16x32_bf16 v[32:35], a[44:47], v[184:187], v[32:35]
    v_mfma_f32_16x16x32_bf16 v[36:39], a[100:103], v[184:187], v[36:39]
    v_mfma_f32_16x16x32_bf16 v[40:43], a[156:159], v[184:187], v[40:43]
    v_mfma_f32_16x16x32_bf16 v[32:35], a[48:51], v[188:191], v[32:35]
    v_mfma_f32_16x16x32_bf16 v[36:39], a[104:107], v[188:191], v[36:39]
    v_mfma_f32_16x16x32_bf16 v[40:43], a[160:163], v[188:191], v[40:43]
    v_mfma_f32_16x16x32_bf16 v[32:35], a[52:55], v[192:195], v[32:35]
    v_mfma_f32_16x16x32_bf16 v[36:39], a[108:111], v[192:195], v[36:39]
    v_mfma_f32_16x16x32_bf16 v[40:43], a[164:167], v[192:195], v[40:43]
    s_nop 7
    s_nop 1
    v_cmp_le_u32 vcc, v120, v132
    s_nop 1
    v_cndmask_b32 v32, v136, v32, vcc
    v_cmp_le_u32 vcc, v121, v132
    s_nop 1
    v_cndmask_b32 v33, v136, v33, vcc
    v_cmp_le_u32 vcc, v122, v132
    s_nop 1
    v_cndmask_b32 v34, v136, v34, vcc
    v_cmp_le_u32 vcc, v123, v132
    s_nop 1
    v_cndmask_b32 v35, v136, v35, vcc
    v_cmp_le_u32 vcc, v124, v132
    s_nop 1
    v_cndmask_b32 v36, v136, v36, vcc
    v_cmp_le_u32 vcc, v125, v132
    s_nop 1
    v_cndmask_b32 v37, v136, v37, vcc
    v_cmp_le_u32 vcc, v126, v132
    s_nop 1
    v_cndmask_b32 v38, v136, v38, vcc
    v_cmp_le_u32 vcc, v127, v132
    s_nop 1
    v_cndmask_b32 v39, v136, v39, vcc
    v_cmp_le_u32 vcc, v128, v132
    s_nop 1
    v_cndmask_b32 v40, v136, v40, vcc
    v_cmp_le_u32 vcc, v129, v132
    s_nop 1
    v_cndmask_b32 v41, v136, v41, vcc
    v_cmp_le_u32 vcc, v130, v132
    s_nop 1
    v_cndmask_b32 v42, v136, v42, vcc
    v_cmp_le_u32 vcc, v131, v132
    s_nop 1
    v_cndmask_b32 v43, v136, v43, vcc
    v_max_f32 v20, v32, v33
    v_max_f32 v20, v20, v34
    v_max_f32 v20, v20, v35
    v_max_f32 v20, v20, v36
    v_max_f32 v20, v20, v37
    v_max_f32 v20, v20, v38
    v_max_f32 v20, v20, v39
    v_max_f32 v20, v20, v40
    v_max_f32 v20, v20, v41
    v_max_f32 v20, v20, v42
    v_max_f32 v20, v20, v43
    ds_bpermute_b32 v21, v134, v20
    s_waitcnt lgkmcnt(0)
    v_max_f32 v20, v20, v21
    ds_bpermute_b32 v21, v135, v20
    s_waitcnt lgkmcnt(0)
    v_max_f32 v20, v20, v21
    v_mov_b32 v21, 0
    v_sub_f32 v32, v32, v20
    v_mul_f32 v32, 0x3db8aa3b, v32
    v_exp_f32 v32, v32
    s_nop 0
    v_add_f32 v21, v21, v32
    v_sub_f32 v33, v33, v20
    v_mul_f32 v33, 0x3db8aa3b, v33
    v_exp_f32 v33, v33
    s_nop 0
    v_add_f32 v21, v21, v33
    v_sub_f32 v34, v34, v20
    v_mul_f32 v34, 0x3db8aa3b, v34
    v_exp_f32 v34, v34
    s_nop 0
    v_add_f32 v21, v21, v34
    v_sub_f32 v35, v35, v20
    v_mul_f32 v35, 0x3db8aa3b, v35
    v_exp_f32 v35, v35
    s_nop 0
    v_add_f32 v21, v21, v35
    v_sub_f32 v36, v36, v20
    v_mul_f32 v36, 0x3db8aa3b, v36
    v_exp_f32 v36, v36
    s_nop 0
    v_add_f32 v21, v21, v36
    v_sub_f32 v37, v37, v20
    v_mul_f32 v37, 0x3db8aa3b, v37
    v_exp_f32 v37, v37
    s_nop 0
    v_add_f32 v21, v21, v37
    v_sub_f32 v38, v38, v20
    v_mul_f32 v38, 0x3db8aa3b, v38
    v_exp_f32 v38, v38
    s_nop 0
    v_add_f32 v21, v21, v38
    v_sub_f32 v39, v39, v20
    v_mul_f32 v39, 0x3db8aa3b, v39
    v_exp_f32 v39, v39
    s_nop 0
    v_add_f32 v21, v21, v39
    v_sub_f32 v40, v40, v20
    v_mul_f32 v40, 0x3db8aa3b, v40
    v_exp_f32 v40, v40
    s_nop 0
    v_add_f32 v21, v21, v40
    v_sub_f32 v41, v41, v20
    v_mul_f32 v41, 0x3db8aa3b, v41
    v_exp_f32 v41, v41
    s_nop 0
    v_add_f32 v21, v21, v41
    v_sub_f32 v42, v42, v20
    v_mul_f32 v42, 0x3db8aa3b, v42
    v_exp_f32 v42, v42
    s_nop 0
    v_add_f32 v21, v21, v42
    v_sub_f32 v43, v43, v20
    v_mul_f32 v43, 0x3db8aa3b, v43
    v_exp_f32 v43, v43
    s_nop 0
    v_add_f32 v21, v21, v43
    ds_bpermute_b32 v22, v134, v21
    s_waitcnt lgkmcnt(0)
    v_add_f32 v21, v21, v22
    ds_bpermute_b32 v22, v135, v21
    s_waitcnt lgkmcnt(0)
    v_add_f32 v21, v21, v22
    v_rcp_f32 v21, v21
    s_nop 0
    v_mul_f32 v32, v32, v21
    v_mul_f32 v33, v33, v21
    v_mul_f32 v34, v34, v21
    v_mul_f32 v35, v35, v21
    v_mul_f32 v36, v36, v21
    v_mul_f32 v37, v37, v21
    v_mul_f32 v38, v38, v21
    v_mul_f32 v39, v39, v21
    v_mul_f32 v40, v40, v21
    v_mul_f32 v41, v41, v21
    v_mul_f32 v42, v42, v21
    v_mul_f32 v43, v43, v21
    v_cvt_pk_bf16_f32 v44, v32, v33
    v_cvt_pk_bf16_f32 v45, v34, v35
    ds_write_b64 v25, v[44:45] offset:0
    v_cvt_pk_bf16_f32 v46, v36, v37
    v_cvt_pk_bf16_f32 v47, v38, v39
    ds_write_b64 v25, v[46:47] offset:32
    v_cvt_pk_bf16_f32 v48, v40, v41
    v_cvt_pk_bf16_f32 v49, v42, v43
    v_cmp_gt_u32 vcc, 2, v117
    s_and_saveexec_b64 s[20:21], vcc
    ds_write_b64 v25, v[48:49] offset:64
    s_mov_b64 exec, s[20:21]
    v_mov_b32 v32, 0
    v_mov_b32 v33, 0
    v_mov_b32 v34, 0
    v_mov_b32 v35, 0
    v_mov_b32 v36, 0
    v_mov_b32 v37, 0
    v_mov_b32 v38, 0
    v_mov_b32 v39, 0
    v_mov_b32 v40, 0
    v_mov_b32 v41, 0
    v_mov_b32 v42, 0
    v_mov_b32 v43, 0
    s_waitcnt vmcnt(0)
    v_mfma_f32_16x16x32_bf16 v[32:35], a[0:3], v[196:199], v[32:35]
    v_mfma_f32_16x16x32_bf16 v[36:39], a[56:59], v[196:199], v[36:39]
    v_mfma_f32_16x16x32_bf16 v[40:43], a[112:115], v[196:199], v[40:43]
    v_mfma_f32_16x16x32_bf16 v[32:35], a[4:7], v[200:203], v[32:35]
    v_mfma_f32_16x16x32_bf16 v[36:39], a[60:63], v[200:203], v[36:39]
    v_mfma_f32_16x16x32_bf16 v[40:43], a[116:119], v[200:203], v[40:43]
    v_mfma_f32_16x16x32_bf16 v[32:35], a[8:11], v[204:207], v[32:35]
    v_mfma_f32_16x16x32_bf16 v[36:39], a[64:67], v[204:207], v[36:39]
    v_mfma_f32_16x16x32_bf16 v[40:43], a[120:123], v[204:207], v[40:43]
    v_mfma_f32_16x16x32_bf16 v[32:35], a[12:15], v[208:211], v[32:35]
    v_mfma_f32_16x16x32_bf16 v[36:39], a[68:71], v[208:211], v[36:39]
    v_mfma_f32_16x16x32_bf16 v[40:43], a[124:127], v[208:211], v[40:43]
    v_mfma_f32_16x16x32_bf16 v[32:35], a[16:19], v[212:215], v[32:35]
    v_mfma_f32_16x16x32_bf16 v[36:39], a[72:75], v[212:215], v[36:39]
    v_mfma_f32_16x16x32_bf16 v[40:43], a[128:131], v[212:215], v[40:43]
    v_mfma_f32_16x16x32_bf16 v[32:35], a[20:23], v[216:219], v[32:35]
    v_mfma_f32_16x16x32_bf16 v[36:39], a[76:79], v[216:219], v[36:39]
    v_mfma_f32_16x16x32_bf16 v[40:43], a[132:135], v[216:219], v[40:43]
    v_mfma_f32_16x16x32_bf16 v[32:35], a[24:27], v[220:223], v[32:35]
    v_mfma_f32_16x16x32_bf16 v[36:39], a[80:83], v[220:223], v[36:39]
    v_mfma_f32_16x16x32_bf16 v[40:43], a[136:139], v[220:223], v[40:43]
    v_mfma_f32_16x16x32_bf16 v[32:35], a[28:31], v[224:227], v[32:35]
    v_mfma_f32_16x16x32_bf16 v[36:39], a[84:87], v[224:227], v[36:39]
    v_mfma_f32_16x16x32_bf16 v[40:43], a[140:143], v[224:227], v[40:43]
    v_mfma_f32_16x16x32_bf16 v[32:35], a[32:35], v[228:231], v[32:35]
    v_mfma_f32_16x16x32_bf16 v[36:39], a[88:91], v[228:231], v[36:39]
    v_mfma_f32_16x16x32_bf16 v[40:43], a[144:147], v[228:231], v[40:43]
    v_mfma_f32_16x16x32_bf16 v[32:35], a[36:39], v[232:235], v[32:35]
    v_mfma_f32_16x16x32_bf16 v[36:39], a[92:95], v[232:235], v[36:39]
    v_mfma_f32_16x16x32_bf16 v[40:43], a[148:151], v[232:235], v[40:43]
    v_mfma_f32_16x16x32_bf16 v[32:35], a[40:43], v[236:239], v[32:35]
    v_mfma_f32_16x16x32_bf16 v[36:39], a[96:99], v[236:239], v[36:39]
    v_mfma_f32_16x16x32_bf16 v[40:43], a[152:155], v[236:239], v[40:43]
    v_mfma_f32_16x16x32_bf16 v[32:35], a[44:47], v[240:243], v[32:35]
    v_mfma_f32_16x16x32_bf16 v[36:39], a[100:103], v[240:243], v[36:39]
    v_mfma_f32_16x16x32_bf16 v[40:43], a[156:159], v[240:243], v[40:43]
    v_mfma_f32_16x16x32_bf16 v[32:35], a[48:51], v[244:247], v[32:35]
    v_mfma_f32_16x16x32_bf16 v[36:39], a[104:107], v[244:247], v[36:39]
    v_mfma_f32_16x16x32_bf16 v[40:43], a[160:163], v[244:247], v[40:43]
    v_mfma_f32_16x16x32_bf16 v[32:35], a[52:55], v[248:251], v[32:35]
    v_mfma_f32_16x16x32_bf16 v[36:39], a[108:111], v[248:251], v[36:39]
    v_mfma_f32_16x16x32_bf16 v[40:43], a[164:167], v[248:251], v[40:43]
    s_nop 7
    s_nop 1
    v_cmp_le_u32 vcc, v120, v133
    s_nop 1
    v_cndmask_b32 v32, v136, v32, vcc
    v_cmp_le_u32 vcc, v121, v133
    s_nop 1
    v_cndmask_b32 v33, v136, v33, vcc
    v_cmp_le_u32 vcc, v122, v133
    s_nop 1
    v_cndmask_b32 v34, v136, v34, vcc
    v_cmp_le_u32 vcc, v123, v133
    s_nop 1
    v_cndmask_b32 v35, v136, v35, vcc
    v_cmp_le_u32 vcc, v124, v133
    s_nop 1
    v_cndmask_b32 v36, v136, v36, vcc
    v_cmp_le_u32 vcc, v125, v133
    s_nop 1
    v_cndmask_b32 v37, v136, v37, vcc
    v_cmp_le_u32 vcc, v126, v133
    s_nop 1
    v_cndmask_b32 v38, v136, v38, vcc
    v_cmp_le_u32 vcc, v127, v133
    s_nop 1
    v_cndmask_b32 v39, v136, v39, vcc
    v_cmp_le_u32 vcc, v128, v133
    s_nop 1
    v_cndmask_b32 v40, v136, v40, vcc
    v_cmp_le_u32 vcc, v129, v133
    s_nop 1
    v_cndmask_b32 v41, v136, v41, vcc
    v_cmp_le_u32 vcc, v130, v133
    s_nop 1
    v_cndmask_b32 v42, v136, v42, vcc
    v_cmp_le_u32 vcc, v131, v133
    s_nop 1
    v_cndmask_b32 v43, v136, v43, vcc
    v_max_f32 v20, v32, v33
    v_max_f32 v20, v20, v34
    v_max_f32 v20, v20, v35
    v_max_f32 v20, v20, v36
    v_max_f32 v20, v20, v37
    v_max_f32 v20, v20, v38
    v_max_f32 v20, v20, v39
    v_max_f32 v20, v20, v40
    v_max_f32 v20, v20, v41
    v_max_f32 v20, v20, v42
    v_max_f32 v20, v20, v43
    ds_bpermute_b32 v21, v134, v20
    s_waitcnt lgkmcnt(0)
    v_max_f32 v20, v20, v21
    ds_bpermute_b32 v21, v135, v20
    s_waitcnt lgkmcnt(0)
    v_max_f32 v20, v20, v21
    v_mov_b32 v21, 0
    v_sub_f32 v32, v32, v20
    v_mul_f32 v32, 0x3db8aa3b, v32
    v_exp_f32 v32, v32
    s_nop 0
    v_add_f32 v21, v21, v32
    v_sub_f32 v33, v33, v20
    v_mul_f32 v33, 0x3db8aa3b, v33
    v_exp_f32 v33, v33
    s_nop 0
    v_add_f32 v21, v21, v33
    v_sub_f32 v34, v34, v20
    v_mul_f32 v34, 0x3db8aa3b, v34
    v_exp_f32 v34, v34
    s_nop 0
    v_add_f32 v21, v21, v34
    v_sub_f32 v35, v35, v20
    v_mul_f32 v35, 0x3db8aa3b, v35
    v_exp_f32 v35, v35
    s_nop 0
    v_add_f32 v21, v21, v35
    v_sub_f32 v36, v36, v20
    v_mul_f32 v36, 0x3db8aa3b, v36
    v_exp_f32 v36, v36
    s_nop 0
    v_add_f32 v21, v21, v36
    v_sub_f32 v37, v37, v20
    v_mul_f32 v37, 0x3db8aa3b, v37
    v_exp_f32 v37, v37
    s_nop 0
    v_add_f32 v21, v21, v37
    v_sub_f32 v38, v38, v20
    v_mul_f32 v38, 0x3db8aa3b, v38
    v_exp_f32 v38, v38
    s_nop 0
    v_add_f32 v21, v21, v38
    v_sub_f32 v39, v39, v20
    v_mul_f32 v39, 0x3db8aa3b, v39
    v_exp_f32 v39, v39
    s_nop 0
    v_add_f32 v21, v21, v39
    v_sub_f32 v40, v40, v20
    v_mul_f32 v40, 0x3db8aa3b, v40
    v_exp_f32 v40, v40
    s_nop 0
    v_add_f32 v21, v21, v40
    v_sub_f32 v41, v41, v20
    v_mul_f32 v41, 0x3db8aa3b, v41
    v_exp_f32 v41, v41
    s_nop 0
    v_add_f32 v21, v21, v41
    v_sub_f32 v42, v42, v20
    v_mul_f32 v42, 0x3db8aa3b, v42
    v_exp_f32 v42, v42
    s_nop 0
    v_add_f32 v21, v21, v42
    v_sub_f32 v43, v43, v20
    v_mul_f32 v43, 0x3db8aa3b, v43
    v_exp_f32 v43, v43
    s_nop 0
    v_add_f32 v21, v21, v43
    ds_bpermute_b32 v22, v134, v21
    s_waitcnt lgkmcnt(0)
    v_add_f32 v21, v21, v22
    ds_bpermute_b32 v22, v135, v21
    s_waitcnt lgkmcnt(0)
    v_add_f32 v21, v21, v22
    v_rcp_f32 v21, v21
    s_nop 0
    v_mul_f32 v32, v32, v21
    v_mul_f32 v33, v33, v21
    v_mul_f32 v34, v34, v21
    v_mul_f32 v35, v35, v21
    v_mul_f32 v36, v36, v21
    v_mul_f32 v37, v37, v21
    v_mul_f32 v38, v38, v21
    v_mul_f32 v39, v39, v21
    v_mul_f32 v40, v40, v21
    v_mul_f32 v41, v41, v21
    v_mul_f32 v42, v42, v21
    v_mul_f32 v43, v43, v21
    v_cvt_pk_bf16_f32 v44, v32, v33
    v_cvt_pk_bf16_f32 v45, v34, v35
    ds_write_b64 v25, v[44:45] offset:1536
    v_cvt_pk_bf16_f32 v46, v36, v37
    v_cvt_pk_bf16_f32 v47, v38, v39
    ds_write_b64 v25, v[46:47] offset:1568
    v_cvt_pk_bf16_f32 v48, v40, v41
    v_cvt_pk_bf16_f32 v49, v42, v43
    v_cmp_gt_u32 vcc, 2, v117
    s_and_saveexec_b64 s[20:21], vcc
    ds_write_b64 v25, v[48:49] offset:1600
    s_mov_b64 exec, s[20:21]
    buffer_load_dwordx4 v[140:143], v23, s[8:11], 0 offen offset:896 sc1
    buffer_load_dwordx4 v[144:147], v23, s[8:11], 0 offen offset:960 sc1
    buffer_load_dwordx4 v[148:151], v23, s[8:11], 0 offen offset:1024 sc1
    buffer_load_dwordx4 v[152:155], v23, s[8:11], 0 offen offset:1088 sc1
    buffer_load_dwordx4 v[156:159], v23, s[8:11], 0 offen offset:1152 sc1
    buffer_load_dwordx4 v[160:163], v23, s[8:11], 0 offen offset:1216 sc1
    buffer_load_dwordx4 v[164:167], v23, s[8:11], 0 offen offset:1280 sc1
    buffer_load_dwordx4 v[168:171], v23, s[8:11], 0 offen offset:1344 sc1
    buffer_load_dwordx4 v[172:175], v23, s[8:11], 0 offen offset:1408 sc1
    buffer_load_dwordx4 v[176:179], v23, s[8:11], 0 offen offset:1472 sc1
    buffer_load_dwordx4 v[180:183], v23, s[8:11], 0 offen offset:1536 sc1
    buffer_load_dwordx4 v[184:187], v23, s[8:11], 0 offen offset:1600 sc1
    buffer_load_dwordx4 v[188:191], v23, s[8:11], 0 offen offset:1664 sc1
    buffer_load_dwordx4 v[192:195], v23, s[8:11], 0 offen offset:1728 sc1
    buffer_load_dwordx4 v[196:199], v24, s[8:11], 0 offen offset:896 sc1
    buffer_load_dwordx4 v[200:203], v24, s[8:11], 0 offen offset:960 sc1
    buffer_load_dwordx4 v[204:207], v24, s[8:11], 0 offen offset:1024 sc1
    buffer_load_dwordx4 v[208:211], v24, s[8:11], 0 offen offset:1088 sc1
    buffer_load_dwordx4 v[212:215], v24, s[8:11], 0 offen offset:1152 sc1
    buffer_load_dwordx4 v[216:219], v24, s[8:11], 0 offen offset:1216 sc1
    buffer_load_dwordx4 v[220:223], v24, s[8:11], 0 offen offset:1280 sc1
    buffer_load_dwordx4 v[224:227], v24, s[8:11], 0 offen offset:1344 sc1
    buffer_load_dwordx4 v[228:231], v24, s[8:11], 0 offen offset:1408 sc1
    buffer_load_dwordx4 v[232:235], v24, s[8:11], 0 offen offset:1472 sc1
    buffer_load_dwordx4 v[236:239], v24, s[8:11], 0 offen offset:1536 sc1
    buffer_load_dwordx4 v[240:243], v24, s[8:11], 0 offen offset:1600 sc1
    buffer_load_dwordx4 v[244:247], v24, s[8:11], 0 offen offset:1664 sc1
    buffer_load_dwordx4 v[248:251], v24, s[8:11], 0 offen offset:1728 sc1
    v_mov_b32 v32, 0
    v_mov_b32 v33, 0
    v_mov_b32 v34, 0
    v_mov_b32 v35, 0
    v_mov_b32 v36, 0
    v_mov_b32 v37, 0
    v_mov_b32 v38, 0
    v_mov_b32 v39, 0
    v_mov_b32 v40, 0
    v_mov_b32 v41, 0
    v_mov_b32 v42, 0
    v_mov_b32 v43, 0
    s_waitcnt vmcnt(14)
    v_mfma_f32_16x16x32_bf16 v[32:35], a[0:3], v[140:143], v[32:35]
    v_mfma_f32_16x16x32_bf16 v[36:39], a[56:59], v[140:143], v[36:39]
    v_mfma_f32_16x16x32_bf16 v[40:43], a[112:115], v[140:143], v[40:43]
    v_mfma_f32_16x16x32_bf16 v[32:35], a[4:7], v[144:147], v[32:35]
    v_mfma_f32_16x16x32_bf16 v[36:39], a[60:63], v[144:147], v[36:39]
    v_mfma_f32_16x16x32_bf16 v[40:43], a[116:119], v[144:147], v[40:43]
    v_mfma_f32_16x16x32_bf16 v[32:35], a[8:11], v[148:151], v[32:35]
    v_mfma_f32_16x16x32_bf16 v[36:39], a[64:67], v[148:151], v[36:39]
    v_mfma_f32_16x16x32_bf16 v[40:43], a[120:123], v[148:151], v[40:43]
    v_mfma_f32_16x16x32_bf16 v[32:35], a[12:15], v[152:155], v[32:35]
    v_mfma_f32_16x16x32_bf16 v[36:39], a[68:71], v[152:155], v[36:39]
    v_mfma_f32_16x16x32_bf16 v[40:43], a[124:127], v[152:155], v[40:43]
    v_mfma_f32_16x16x32_bf16 v[32:35], a[16:19], v[156:159], v[32:35]
    v_mfma_f32_16x16x32_bf16 v[36:39], a[72:75], v[156:159], v[36:39]
    v_mfma_f32_16x16x32_bf16 v[40:43], a[128:131], v[156:159], v[40:43]
    v_mfma_f32_16x16x32_bf16 v[32:35], a[20:23], v[160:163], v[32:35]
    v_mfma_f32_16x16x32_bf16 v[36:39], a[76:79], v[160:163], v[36:39]
    v_mfma_f32_16x16x32_bf16 v[40:43], a[132:135], v[160:163], v[40:43]
    v_mfma_f32_16x16x32_bf16 v[32:35], a[24:27], v[164:167], v[32:35]
    v_mfma_f32_16x16x32_bf16 v[36:39], a[80:83], v[164:167], v[36:39]
    v_mfma_f32_16x16x32_bf16 v[40:43], a[136:139], v[164:167], v[40:43]
    v_mfma_f32_16x16x32_bf16 v[32:35], a[28:31], v[168:171], v[32:35]
    v_mfma_f32_16x16x32_bf16 v[36:39], a[84:87], v[168:171], v[36:39]
    v_mfma_f32_16x16x32_bf16 v[40:43], a[140:143], v[168:171], v[40:43]
    v_mfma_f32_16x16x32_bf16 v[32:35], a[32:35], v[172:175], v[32:35]
    v_mfma_f32_16x16x32_bf16 v[36:39], a[88:91], v[172:175], v[36:39]
    v_mfma_f32_16x16x32_bf16 v[40:43], a[144:147], v[172:175], v[40:43]
    v_mfma_f32_16x16x32_bf16 v[32:35], a[36:39], v[176:179], v[32:35]
    v_mfma_f32_16x16x32_bf16 v[36:39], a[92:95], v[176:179], v[36:39]
    v_mfma_f32_16x16x32_bf16 v[40:43], a[148:151], v[176:179], v[40:43]
    v_mfma_f32_16x16x32_bf16 v[32:35], a[40:43], v[180:183], v[32:35]
    v_mfma_f32_16x16x32_bf16 v[36:39], a[96:99], v[180:183], v[36:39]
    v_mfma_f32_16x16x32_bf16 v[40:43], a[152:155], v[180:183], v[40:43]
    v_mfma_f32_16x16x32_bf16 v[32:35], a[44:47], v[184:187], v[32:35]
    v_mfma_f32_16x16x32_bf16 v[36:39], a[100:103], v[184:187], v[36:39]
    v_mfma_f32_16x16x32_bf16 v[40:43], a[156:159], v[184:187], v[40:43]
    v_mfma_f32_16x16x32_bf16 v[32:35], a[48:51], v[188:191], v[32:35]
    v_mfma_f32_16x16x32_bf16 v[36:39], a[104:107], v[188:191], v[36:39]
    v_mfma_f32_16x16x32_bf16 v[40:43], a[160:163], v[188:191], v[40:43]
    v_mfma_f32_16x16x32_bf16 v[32:35], a[52:55], v[192:195], v[32:35]
    v_mfma_f32_16x16x32_bf16 v[36:39], a[108:111], v[192:195], v[36:39]
    v_mfma_f32_16x16x32_bf16 v[40:43], a[164:167], v[192:195], v[40:43]
    s_nop 7
    s_nop 1
    v_cmp_le_u32 vcc, v120, v132
    s_nop 1
    v_cndmask_b32 v32, v136, v32, vcc
    v_cmp_le_u32 vcc, v121, v132
    s_nop 1
    v_cndmask_b32 v33, v136, v33, vcc
    v_cmp_le_u32 vcc, v122, v132
    s_nop 1
    v_cndmask_b32 v34, v136, v34, vcc
    v_cmp_le_u32 vcc, v123, v132
    s_nop 1
    v_cndmask_b32 v35, v136, v35, vcc
    v_cmp_le_u32 vcc, v124, v132
    s_nop 1
    v_cndmask_b32 v36, v136, v36, vcc
    v_cmp_le_u32 vcc, v125, v132
    s_nop 1
    v_cndmask_b32 v37, v136, v37, vcc
    v_cmp_le_u32 vcc, v126, v132
    s_nop 1
    v_cndmask_b32 v38, v136, v38, vcc
    v_cmp_le_u32 vcc, v127, v132
    s_nop 1
    v_cndmask_b32 v39, v136, v39, vcc
    v_cmp_le_u32 vcc, v128, v132
    s_nop 1
    v_cndmask_b32 v40, v136, v40, vcc
    v_cmp_le_u32 vcc, v129, v132
    s_nop 1
    v_cndmask_b32 v41, v136, v41, vcc
    v_cmp_le_u32 vcc, v130, v132
    s_nop 1
    v_cndmask_b32 v42, v136, v42, vcc
    v_cmp_le_u32 vcc, v131, v132
    s_nop 1
    v_cndmask_b32 v43, v136, v43, vcc
    v_max_f32 v20, v32, v33
    v_max_f32 v20, v20, v34
    v_max_f32 v20, v20, v35
    v_max_f32 v20, v20, v36
    v_max_f32 v20, v20, v37
    v_max_f32 v20, v20, v38
    v_max_f32 v20, v20, v39
    v_max_f32 v20, v20, v40
    v_max_f32 v20, v20, v41
    v_max_f32 v20, v20, v42
    v_max_f32 v20, v20, v43
    ds_bpermute_b32 v21, v134, v20
    s_waitcnt lgkmcnt(0)
    v_max_f32 v20, v20, v21
    ds_bpermute_b32 v21, v135, v20
    s_waitcnt lgkmcnt(0)
    v_max_f32 v20, v20, v21
    v_mov_b32 v21, 0
    v_sub_f32 v32, v32, v20
    v_mul_f32 v32, 0x3db8aa3b, v32
    v_exp_f32 v32, v32
    s_nop 0
    v_add_f32 v21, v21, v32
    v_sub_f32 v33, v33, v20
    v_mul_f32 v33, 0x3db8aa3b, v33
    v_exp_f32 v33, v33
    s_nop 0
    v_add_f32 v21, v21, v33
    v_sub_f32 v34, v34, v20
    v_mul_f32 v34, 0x3db8aa3b, v34
    v_exp_f32 v34, v34
    s_nop 0
    v_add_f32 v21, v21, v34
    v_sub_f32 v35, v35, v20
    v_mul_f32 v35, 0x3db8aa3b, v35
    v_exp_f32 v35, v35
    s_nop 0
    v_add_f32 v21, v21, v35
    v_sub_f32 v36, v36, v20
    v_mul_f32 v36, 0x3db8aa3b, v36
    v_exp_f32 v36, v36
    s_nop 0
    v_add_f32 v21, v21, v36
    v_sub_f32 v37, v37, v20
    v_mul_f32 v37, 0x3db8aa3b, v37
    v_exp_f32 v37, v37
    s_nop 0
    v_add_f32 v21, v21, v37
    v_sub_f32 v38, v38, v20
    v_mul_f32 v38, 0x3db8aa3b, v38
    v_exp_f32 v38, v38
    s_nop 0
    v_add_f32 v21, v21, v38
    v_sub_f32 v39, v39, v20
    v_mul_f32 v39, 0x3db8aa3b, v39
    v_exp_f32 v39, v39
    s_nop 0
    v_add_f32 v21, v21, v39
    v_sub_f32 v40, v40, v20
    v_mul_f32 v40, 0x3db8aa3b, v40
    v_exp_f32 v40, v40
    s_nop 0
    v_add_f32 v21, v21, v40
    v_sub_f32 v41, v41, v20
    v_mul_f32 v41, 0x3db8aa3b, v41
    v_exp_f32 v41, v41
    s_nop 0
    v_add_f32 v21, v21, v41
    v_sub_f32 v42, v42, v20
    v_mul_f32 v42, 0x3db8aa3b, v42
    v_exp_f32 v42, v42
    s_nop 0
    v_add_f32 v21, v21, v42
    v_sub_f32 v43, v43, v20
    v_mul_f32 v43, 0x3db8aa3b, v43
    v_exp_f32 v43, v43
    s_nop 0
    v_add_f32 v21, v21, v43
    ds_bpermute_b32 v22, v134, v21
    s_waitcnt lgkmcnt(0)
    v_add_f32 v21, v21, v22
    ds_bpermute_b32 v22, v135, v21
    s_waitcnt lgkmcnt(0)
    v_add_f32 v21, v21, v22
    v_rcp_f32 v21, v21
    s_nop 0
    v_mul_f32 v32, v32, v21
    v_mul_f32 v33, v33, v21
    v_mul_f32 v34, v34, v21
    v_mul_f32 v35, v35, v21
    v_mul_f32 v36, v36, v21
    v_mul_f32 v37, v37, v21
    v_mul_f32 v38, v38, v21
    v_mul_f32 v39, v39, v21
    v_mul_f32 v40, v40, v21
    v_mul_f32 v41, v41, v21
    v_mul_f32 v42, v42, v21
    v_mul_f32 v43, v43, v21
    v_cvt_pk_bf16_f32 v44, v32, v33
    v_cvt_pk_bf16_f32 v45, v34, v35
    ds_write_b64 v25, v[44:45] offset:3072
    v_cvt_pk_bf16_f32 v46, v36, v37
    v_cvt_pk_bf16_f32 v47, v38, v39
    ds_write_b64 v25, v[46:47] offset:3104
    v_cvt_pk_bf16_f32 v48, v40, v41
    v_cvt_pk_bf16_f32 v49, v42, v43
    v_cmp_gt_u32 vcc, 2, v117
    s_and_saveexec_b64 s[20:21], vcc
    ds_write_b64 v25, v[48:49] offset:3136
    s_mov_b64 exec, s[20:21]
    v_mov_b32 v32, 0
    v_mov_b32 v33, 0
    v_mov_b32 v34, 0
    v_mov_b32 v35, 0
    v_mov_b32 v36, 0
    v_mov_b32 v37, 0
    v_mov_b32 v38, 0
    v_mov_b32 v39, 0
    v_mov_b32 v40, 0
    v_mov_b32 v41, 0
    v_mov_b32 v42, 0
    v_mov_b32 v43, 0
    s_waitcnt vmcnt(0)
    v_mfma_f32_16x16x32_bf16 v[32:35], a[0:3], v[196:199], v[32:35]
    v_mfma_f32_16x16x32_bf16 v[36:39], a[56:59], v[196:199], v[36:39]
    v_mfma_f32_16x16x32_bf16 v[40:43], a[112:115], v[196:199], v[40:43]
    v_mfma_f32_16x16x32_bf16 v[32:35], a[4:7], v[200:203], v[32:35]
    v_mfma_f32_16x16x32_bf16 v[36:39], a[60:63], v[200:203], v[36:39]
    v_mfma_f32_16x16x32_bf16 v[40:43], a[116:119], v[200:203], v[40:43]
    v_mfma_f32_16x16x32_bf16 v[32:35], a[8:11], v[204:207], v[32:35]
    v_mfma_f32_16x16x32_bf16 v[36:39], a[64:67], v[204:207], v[36:39]
    v_mfma_f32_16x16x32_bf16 v[40:43], a[120:123], v[204:207], v[40:43]
    v_mfma_f32_16x16x32_bf16 v[32:35], a[12:15], v[208:211], v[32:35]
    v_mfma_f32_16x16x32_bf16 v[36:39], a[68:71], v[208:211], v[36:39]
    v_mfma_f32_16x16x32_bf16 v[40:43], a[124:127], v[208:211], v[40:43]
    v_mfma_f32_16x16x32_bf16 v[32:35], a[16:19], v[212:215], v[32:35]
    v_mfma_f32_16x16x32_bf16 v[36:39], a[72:75], v[212:215], v[36:39]
    v_mfma_f32_16x16x32_bf16 v[40:43], a[128:131], v[212:215], v[40:43]
    v_mfma_f32_16x16x32_bf16 v[32:35], a[20:23], v[216:219], v[32:35]
    v_mfma_f32_16x16x32_bf16 v[36:39], a[76:79], v[216:219], v[36:39]
    v_mfma_f32_16x16x32_bf16 v[40:43], a[132:135], v[216:219], v[40:43]
    v_mfma_f32_16x16x32_bf16 v[32:35], a[24:27], v[220:223], v[32:35]
    v_mfma_f32_16x16x32_bf16 v[36:39], a[80:83], v[220:223], v[36:39]
    v_mfma_f32_16x16x32_bf16 v[40:43], a[136:139], v[220:223], v[40:43]
    v_mfma_f32_16x16x32_bf16 v[32:35], a[28:31], v[224:227], v[32:35]
    v_mfma_f32_16x16x32_bf16 v[36:39], a[84:87], v[224:227], v[36:39]
    v_mfma_f32_16x16x32_bf16 v[40:43], a[140:143], v[224:227], v[40:43]
    v_mfma_f32_16x16x32_bf16 v[32:35], a[32:35], v[228:231], v[32:35]
    v_mfma_f32_16x16x32_bf16 v[36:39], a[88:91], v[228:231], v[36:39]
    v_mfma_f32_16x16x32_bf16 v[40:43], a[144:147], v[228:231], v[40:43]
    v_mfma_f32_16x16x32_bf16 v[32:35], a[36:39], v[232:235], v[32:35]
    v_mfma_f32_16x16x32_bf16 v[36:39], a[92:95], v[232:235], v[36:39]
    v_mfma_f32_16x16x32_bf16 v[40:43], a[148:151], v[232:235], v[40:43]
    v_mfma_f32_16x16x32_bf16 v[32:35], a[40:43], v[236:239], v[32:35]
    v_mfma_f32_16x16x32_bf16 v[36:39], a[96:99], v[236:239], v[36:39]
    v_mfma_f32_16x16x32_bf16 v[40:43], a[152:155], v[236:239], v[40:43]
    v_mfma_f32_16x16x32_bf16 v[32:35], a[44:47], v[240:243], v[32:35]
    v_mfma_f32_16x16x32_bf16 v[36:39], a[100:103], v[240:243], v[36:39]
    v_mfma_f32_16x16x32_bf16 v[40:43], a[156:159], v[240:243], v[40:43]
    v_mfma_f32_16x16x32_bf16 v[32:35], a[48:51], v[244:247], v[32:35]
    v_mfma_f32_16x16x32_bf16 v[36:39], a[104:107], v[244:247], v[36:39]
    v_mfma_f32_16x16x32_bf16 v[40:43], a[160:163], v[244:247], v[40:43]
    v_mfma_f32_16x16x32_bf16 v[32:35], a[52:55], v[248:251], v[32:35]
    v_mfma_f32_16x16x32_bf16 v[36:39], a[108:111], v[248:251], v[36:39]
    v_mfma_f32_16x16x32_bf16 v[40:43], a[164:167], v[248:251], v[40:43]
    s_nop 7
    s_nop 1
    v_cmp_le_u32 vcc, v120, v133
    s_nop 1
    v_cndmask_b32 v32, v136, v32, vcc
    v_cmp_le_u32 vcc, v121, v133
    s_nop 1
    v_cndmask_b32 v33, v136, v33, vcc
    v_cmp_le_u32 vcc, v122, v133
    s_nop 1
    v_cndmask_b32 v34, v136, v34, vcc
    v_cmp_le_u32 vcc, v123, v133
    s_nop 1
    v_cndmask_b32 v35, v136, v35, vcc
    v_cmp_le_u32 vcc, v124, v133
    s_nop 1
    v_cndmask_b32 v36, v136, v36, vcc
    v_cmp_le_u32 vcc, v125, v133
    s_nop 1
    v_cndmask_b32 v37, v136, v37, vcc
    v_cmp_le_u32 vcc, v126, v133
    s_nop 1
    v_cndmask_b32 v38, v136, v38, vcc
    v_cmp_le_u32 vcc, v127, v133
    s_nop 1
    v_cndmask_b32 v39, v136, v39, vcc
    v_cmp_le_u32 vcc, v128, v133
    s_nop 1
    v_cndmask_b32 v40, v136, v40, vcc
    v_cmp_le_u32 vcc, v129, v133
    s_nop 1
    v_cndmask_b32 v41, v136, v41, vcc
    v_cmp_le_u32 vcc, v130, v133
    s_nop 1
    v_cndmask_b32 v42, v136, v42, vcc
    v_cmp_le_u32 vcc, v131, v133
    s_nop 1
    v_cndmask_b32 v43, v136, v43, vcc
    v_max_f32 v20, v32, v33
    v_max_f32 v20, v20, v34
    v_max_f32 v20, v20, v35
    v_max_f32 v20, v20, v36
    v_max_f32 v20, v20, v37
    v_max_f32 v20, v20, v38
    v_max_f32 v20, v20, v39
    v_max_f32 v20, v20, v40
    v_max_f32 v20, v20, v41
    v_max_f32 v20, v20, v42
    v_max_f32 v20, v20, v43
    ds_bpermute_b32 v21, v134, v20
    s_waitcnt lgkmcnt(0)
    v_max_f32 v20, v20, v21
    ds_bpermute_b32 v21, v135, v20
    s_waitcnt lgkmcnt(0)
    v_max_f32 v20, v20, v21
    v_mov_b32 v21, 0
    v_sub_f32 v32, v32, v20
    v_mul_f32 v32, 0x3db8aa3b, v32
    v_exp_f32 v32, v32
    s_nop 0
    v_add_f32 v21, v21, v32
    v_sub_f32 v33, v33, v20
    v_mul_f32 v33, 0x3db8aa3b, v33
    v_exp_f32 v33, v33
    s_nop 0
    v_add_f32 v21, v21, v33
    v_sub_f32 v34, v34, v20
    v_mul_f32 v34, 0x3db8aa3b, v34
    v_exp_f32 v34, v34
    s_nop 0
    v_add_f32 v21, v21, v34
    v_sub_f32 v35, v35, v20
    v_mul_f32 v35, 0x3db8aa3b, v35
    v_exp_f32 v35, v35
    s_nop 0
    v_add_f32 v21, v21, v35
    v_sub_f32 v36, v36, v20
    v_mul_f32 v36, 0x3db8aa3b, v36
    v_exp_f32 v36, v36
    s_nop 0
    v_add_f32 v21, v21, v36
    v_sub_f32 v37, v37, v20
    v_mul_f32 v37, 0x3db8aa3b, v37
    v_exp_f32 v37, v37
    s_nop 0
    v_add_f32 v21, v21, v37
    v_sub_f32 v38, v38, v20
    v_mul_f32 v38, 0x3db8aa3b, v38
    v_exp_f32 v38, v38
    s_nop 0
    v_add_f32 v21, v21, v38
    v_sub_f32 v39, v39, v20
    v_mul_f32 v39, 0x3db8aa3b, v39
    v_exp_f32 v39, v39
    s_nop 0
    v_add_f32 v21, v21, v39
    v_sub_f32 v40, v40, v20
    v_mul_f32 v40, 0x3db8aa3b, v40
    v_exp_f32 v40, v40
    s_nop 0
    v_add_f32 v21, v21, v40
    v_sub_f32 v41, v41, v20
    v_mul_f32 v41, 0x3db8aa3b, v41
    v_exp_f32 v41, v41
    s_nop 0
    v_add_f32 v21, v21, v41
    v_sub_f32 v42, v42, v20
    v_mul_f32 v42, 0x3db8aa3b, v42
    v_exp_f32 v42, v42
    s_nop 0
    v_add_f32 v21, v21, v42
    v_sub_f32 v43, v43, v20
    v_mul_f32 v43, 0x3db8aa3b, v43
    v_exp_f32 v43, v43
    s_nop 0
    v_add_f32 v21, v21, v43
    ds_bpermute_b32 v22, v134, v21
    s_waitcnt lgkmcnt(0)
    v_add_f32 v21, v21, v22
    ds_bpermute_b32 v22, v135, v21
    s_waitcnt lgkmcnt(0)
    v_add_f32 v21, v21, v22
    v_rcp_f32 v21, v21
    s_nop 0
    v_mul_f32 v32, v32, v21
    v_mul_f32 v33, v33, v21
    v_mul_f32 v34, v34, v21
    v_mul_f32 v35, v35, v21
    v_mul_f32 v36, v36, v21
    v_mul_f32 v37, v37, v21
    v_mul_f32 v38, v38, v21
    v_mul_f32 v39, v39, v21
    v_mul_f32 v40, v40, v21
    v_mul_f32 v41, v41, v21
    v_mul_f32 v42, v42, v21
    v_mul_f32 v43, v43, v21
    v_cvt_pk_bf16_f32 v44, v32, v33
    v_cvt_pk_bf16_f32 v45, v34, v35
    ds_write_b64 v25, v[44:45] offset:4608
    v_cvt_pk_bf16_f32 v46, v36, v37
    v_cvt_pk_bf16_f32 v47, v38, v39
    ds_write_b64 v25, v[46:47] offset:4640
    v_cvt_pk_bf16_f32 v48, v40, v41
    v_cvt_pk_bf16_f32 v49, v42, v43
    v_cmp_gt_u32 vcc, 2, v117
    s_and_saveexec_b64 s[20:21], vcc
    ds_write_b64 v25, v[48:49] offset:4672
    s_mov_b64 exec, s[20:21]
    buffer_load_dwordx4 v[140:143], v23, s[8:11], 0 offen offset:1792 sc1
    buffer_load_dwordx4 v[144:147], v23, s[8:11], 0 offen offset:1856 sc1
    buffer_load_dwordx4 v[148:151], v23, s[8:11], 0 offen offset:1920 sc1
    buffer_load_dwordx4 v[152:155], v23, s[8:11], 0 offen offset:1984 sc1
    buffer_load_dwordx4 v[156:159], v23, s[8:11], 0 offen offset:2048 sc1
    buffer_load_dwordx4 v[160:163], v23, s[8:11], 0 offen offset:2112 sc1
    buffer_load_dwordx4 v[164:167], v23, s[8:11], 0 offen offset:2176 sc1
    buffer_load_dwordx4 v[168:171], v23, s[8:11], 0 offen offset:2240 sc1
    buffer_load_dwordx4 v[172:175], v23, s[8:11], 0 offen offset:2304 sc1
    buffer_load_dwordx4 v[176:179], v23, s[8:11], 0 offen offset:2368 sc1
    buffer_load_dwordx4 v[180:183], v23, s[8:11], 0 offen offset:2432 sc1
    buffer_load_dwordx4 v[184:187], v23, s[8:11], 0 offen offset:2496 sc1
    buffer_load_dwordx4 v[188:191], v23, s[8:11], 0 offen offset:2560 sc1
    buffer_load_dwordx4 v[192:195], v23, s[8:11], 0 offen offset:2624 sc1
    buffer_load_dwordx4 v[196:199], v24, s[8:11], 0 offen offset:1792 sc1
    buffer_load_dwordx4 v[200:203], v24, s[8:11], 0 offen offset:1856 sc1
    buffer_load_dwordx4 v[204:207], v24, s[8:11], 0 offen offset:1920 sc1
    buffer_load_dwordx4 v[208:211], v24, s[8:11], 0 offen offset:1984 sc1
    buffer_load_dwordx4 v[212:215], v24, s[8:11], 0 offen offset:2048 sc1
    buffer_load_dwordx4 v[216:219], v24, s[8:11], 0 offen offset:2112 sc1
    buffer_load_dwordx4 v[220:223], v24, s[8:11], 0 offen offset:2176 sc1
    buffer_load_dwordx4 v[224:227], v24, s[8:11], 0 offen offset:2240 sc1
    buffer_load_dwordx4 v[228:231], v24, s[8:11], 0 offen offset:2304 sc1
    buffer_load_dwordx4 v[232:235], v24, s[8:11], 0 offen offset:2368 sc1
    buffer_load_dwordx4 v[236:239], v24, s[8:11], 0 offen offset:2432 sc1
    buffer_load_dwordx4 v[240:243], v24, s[8:11], 0 offen offset:2496 sc1
    buffer_load_dwordx4 v[244:247], v24, s[8:11], 0 offen offset:2560 sc1
    buffer_load_dwordx4 v[248:251], v24, s[8:11], 0 offen offset:2624 sc1
    v_mov_b32 v32, 0
    v_mov_b32 v33, 0
    v_mov_b32 v34, 0
    v_mov_b32 v35, 0
    v_mov_b32 v36, 0
    v_mov_b32 v37, 0
    v_mov_b32 v38, 0
    v_mov_b32 v39, 0
    v_mov_b32 v40, 0
    v_mov_b32 v41, 0
    v_mov_b32 v42, 0
    v_mov_b32 v43, 0
    s_waitcnt vmcnt(14)
    v_mfma_f32_16x16x32_bf16 v[32:35], a[0:3], v[140:143], v[32:35]
    v_mfma_f32_16x16x32_bf16 v[36:39], a[56:59], v[140:143], v[36:39]
    v_mfma_f32_16x16x32_bf16 v[40:43], a[112:115], v[140:143], v[40:43]
    v_mfma_f32_16x16x32_bf16 v[32:35], a[4:7], v[144:147], v[32:35]
    v_mfma_f32_16x16x32_bf16 v[36:39], a[60:63], v[144:147], v[36:39]
    v_mfma_f32_16x16x32_bf16 v[40:43], a[116:119], v[144:147], v[40:43]
    v_mfma_f32_16x16x32_bf16 v[32:35], a[8:11], v[148:151], v[32:35]
    v_mfma_f32_16x16x32_bf16 v[36:39], a[64:67], v[148:151], v[36:39]
    v_mfma_f32_16x16x32_bf16 v[40:43], a[120:123], v[148:151], v[40:43]
    v_mfma_f32_16x16x32_bf16 v[32:35], a[12:15], v[152:155], v[32:35]
    v_mfma_f32_16x16x32_bf16 v[36:39], a[68:71], v[152:155], v[36:39]
    v_mfma_f32_16x16x32_bf16 v[40:43], a[124:127], v[152:155], v[40:43]
    v_mfma_f32_16x16x32_bf16 v[32:35], a[16:19], v[156:159], v[32:35]
    v_mfma_f32_16x16x32_bf16 v[36:39], a[72:75], v[156:159], v[36:39]
    v_mfma_f32_16x16x32_bf16 v[40:43], a[128:131], v[156:159], v[40:43]
    v_mfma_f32_16x16x32_bf16 v[32:35], a[20:23], v[160:163], v[32:35]
    v_mfma_f32_16x16x32_bf16 v[36:39], a[76:79], v[160:163], v[36:39]
    v_mfma_f32_16x16x32_bf16 v[40:43], a[132:135], v[160:163], v[40:43]
    v_mfma_f32_16x16x32_bf16 v[32:35], a[24:27], v[164:167], v[32:35]
    v_mfma_f32_16x16x32_bf16 v[36:39], a[80:83], v[164:167], v[36:39]
    v_mfma_f32_16x16x32_bf16 v[40:43], a[136:139], v[164:167], v[40:43]
    v_mfma_f32_16x16x32_bf16 v[32:35], a[28:31], v[168:171], v[32:35]
    v_mfma_f32_16x16x32_bf16 v[36:39], a[84:87], v[168:171], v[36:39]
    v_mfma_f32_16x16x32_bf16 v[40:43], a[140:143], v[168:171], v[40:43]
    v_mfma_f32_16x16x32_bf16 v[32:35], a[32:35], v[172:175], v[32:35]
    v_mfma_f32_16x16x32_bf16 v[36:39], a[88:91], v[172:175], v[36:39]
    v_mfma_f32_16x16x32_bf16 v[40:43], a[144:147], v[172:175], v[40:43]
    v_mfma_f32_16x16x32_bf16 v[32:35], a[36:39], v[176:179], v[32:35]
    v_mfma_f32_16x16x32_bf16 v[36:39], a[92:95], v[176:179], v[36:39]
    v_mfma_f32_16x16x32_bf16 v[40:43], a[148:151], v[176:179], v[40:43]
    v_mfma_f32_16x16x32_bf16 v[32:35], a[40:43], v[180:183], v[32:35]
    v_mfma_f32_16x16x32_bf16 v[36:39], a[96:99], v[180:183], v[36:39]
    v_mfma_f32_16x16x32_bf16 v[40:43], a[152:155], v[180:183], v[40:43]
    v_mfma_f32_16x16x32_bf16 v[32:35], a[44:47], v[184:187], v[32:35]
    v_mfma_f32_16x16x32_bf16 v[36:39], a[100:103], v[184:187], v[36:39]
    v_mfma_f32_16x16x32_bf16 v[40:43], a[156:159], v[184:187], v[40:43]
    v_mfma_f32_16x16x32_bf16 v[32:35], a[48:51], v[188:191], v[32:35]
    v_mfma_f32_16x16x32_bf16 v[36:39], a[104:107], v[188:191], v[36:39]
    v_mfma_f32_16x16x32_bf16 v[40:43], a[160:163], v[188:191], v[40:43]
    v_mfma_f32_16x16x32_bf16 v[32:35], a[52:55], v[192:195], v[32:35]
    v_mfma_f32_16x16x32_bf16 v[36:39], a[108:111], v[192:195], v[36:39]
    v_mfma_f32_16x16x32_bf16 v[40:43], a[164:167], v[192:195], v[40:43]
    s_nop 7
    s_nop 1
    v_cmp_le_u32 vcc, v120, v132
    s_nop 1
    v_cndmask_b32 v32, v136, v32, vcc
    v_cmp_le_u32 vcc, v121, v132
    s_nop 1
    v_cndmask_b32 v33, v136, v33, vcc
    v_cmp_le_u32 vcc, v122, v132
    s_nop 1
    v_cndmask_b32 v34, v136, v34, vcc
    v_cmp_le_u32 vcc, v123, v132
    s_nop 1
    v_cndmask_b32 v35, v136, v35, vcc
    v_cmp_le_u32 vcc, v124, v132
    s_nop 1
    v_cndmask_b32 v36, v136, v36, vcc
    v_cmp_le_u32 vcc, v125, v132
    s_nop 1
    v_cndmask_b32 v37, v136, v37, vcc
    v_cmp_le_u32 vcc, v126, v132
    s_nop 1
    v_cndmask_b32 v38, v136, v38, vcc
    v_cmp_le_u32 vcc, v127, v132
    s_nop 1
    v_cndmask_b32 v39, v136, v39, vcc
    v_cmp_le_u32 vcc, v128, v132
    s_nop 1
    v_cndmask_b32 v40, v136, v40, vcc
    v_cmp_le_u32 vcc, v129, v132
    s_nop 1
    v_cndmask_b32 v41, v136, v41, vcc
    v_cmp_le_u32 vcc, v130, v132
    s_nop 1
    v_cndmask_b32 v42, v136, v42, vcc
    v_cmp_le_u32 vcc, v131, v132
    s_nop 1
    v_cndmask_b32 v43, v136, v43, vcc
    v_max_f32 v20, v32, v33
    v_max_f32 v20, v20, v34
    v_max_f32 v20, v20, v35
    v_max_f32 v20, v20, v36
    v_max_f32 v20, v20, v37
    v_max_f32 v20, v20, v38
    v_max_f32 v20, v20, v39
    v_max_f32 v20, v20, v40
    v_max_f32 v20, v20, v41
    v_max_f32 v20, v20, v42
    v_max_f32 v20, v20, v43
    ds_bpermute_b32 v21, v134, v20
    s_waitcnt lgkmcnt(0)
    v_max_f32 v20, v20, v21
    ds_bpermute_b32 v21, v135, v20
    s_waitcnt lgkmcnt(0)
    v_max_f32 v20, v20, v21
    v_mov_b32 v21, 0
    v_sub_f32 v32, v32, v20
    v_mul_f32 v32, 0x3db8aa3b, v32
    v_exp_f32 v32, v32
    s_nop 0
    v_add_f32 v21, v21, v32
    v_sub_f32 v33, v33, v20
    v_mul_f32 v33, 0x3db8aa3b, v33
    v_exp_f32 v33, v33
    s_nop 0
    v_add_f32 v21, v21, v33
    v_sub_f32 v34, v34, v20
    v_mul_f32 v34, 0x3db8aa3b, v34
    v_exp_f32 v34, v34
    s_nop 0
    v_add_f32 v21, v21, v34
    v_sub_f32 v35, v35, v20
    v_mul_f32 v35, 0x3db8aa3b, v35
    v_exp_f32 v35, v35
    s_nop 0
    v_add_f32 v21, v21, v35
    v_sub_f32 v36, v36, v20
    v_mul_f32 v36, 0x3db8aa3b, v36
    v_exp_f32 v36, v36
    s_nop 0
    v_add_f32 v21, v21, v36
    v_sub_f32 v37, v37, v20
    v_mul_f32 v37, 0x3db8aa3b, v37
    v_exp_f32 v37, v37
    s_nop 0
    v_add_f32 v21, v21, v37
    v_sub_f32 v38, v38, v20
    v_mul_f32 v38, 0x3db8aa3b, v38
    v_exp_f32 v38, v38
    s_nop 0
    v_add_f32 v21, v21, v38
    v_sub_f32 v39, v39, v20
    v_mul_f32 v39, 0x3db8aa3b, v39
    v_exp_f32 v39, v39
    s_nop 0
    v_add_f32 v21, v21, v39
    v_sub_f32 v40, v40, v20
    v_mul_f32 v40, 0x3db8aa3b, v40
    v_exp_f32 v40, v40
    s_nop 0
    v_add_f32 v21, v21, v40
    v_sub_f32 v41, v41, v20
    v_mul_f32 v41, 0x3db8aa3b, v41
    v_exp_f32 v41, v41
    s_nop 0
    v_add_f32 v21, v21, v41
    v_sub_f32 v42, v42, v20
    v_mul_f32 v42, 0x3db8aa3b, v42
    v_exp_f32 v42, v42
    s_nop 0
    v_add_f32 v21, v21, v42
    v_sub_f32 v43, v43, v20
    v_mul_f32 v43, 0x3db8aa3b, v43
    v_exp_f32 v43, v43
    s_nop 0
    v_add_f32 v21, v21, v43
    ds_bpermute_b32 v22, v134, v21
    s_waitcnt lgkmcnt(0)
    v_add_f32 v21, v21, v22
    ds_bpermute_b32 v22, v135, v21
    s_waitcnt lgkmcnt(0)
    v_add_f32 v21, v21, v22
    v_rcp_f32 v21, v21
    s_nop 0
    v_mul_f32 v32, v32, v21
    v_mul_f32 v33, v33, v21
    v_mul_f32 v34, v34, v21
    v_mul_f32 v35, v35, v21
    v_mul_f32 v36, v36, v21
    v_mul_f32 v37, v37, v21
    v_mul_f32 v38, v38, v21
    v_mul_f32 v39, v39, v21
    v_mul_f32 v40, v40, v21
    v_mul_f32 v41, v41, v21
    v_mul_f32 v42, v42, v21
    v_mul_f32 v43, v43, v21
    v_cvt_pk_bf16_f32 v44, v32, v33
    v_cvt_pk_bf16_f32 v45, v34, v35
    ds_write_b64 v25, v[44:45] offset:6144
    v_cvt_pk_bf16_f32 v46, v36, v37
    v_cvt_pk_bf16_f32 v47, v38, v39
    ds_write_b64 v25, v[46:47] offset:6176
    v_cvt_pk_bf16_f32 v48, v40, v41
    v_cvt_pk_bf16_f32 v49, v42, v43
    v_cmp_gt_u32 vcc, 2, v117
    s_and_saveexec_b64 s[20:21], vcc
    ds_write_b64 v25, v[48:49] offset:6208
    s_mov_b64 exec, s[20:21]
    v_mov_b32 v32, 0
    v_mov_b32 v33, 0
    v_mov_b32 v34, 0
    v_mov_b32 v35, 0
    v_mov_b32 v36, 0
    v_mov_b32 v37, 0
    v_mov_b32 v38, 0
    v_mov_b32 v39, 0
    v_mov_b32 v40, 0
    v_mov_b32 v41, 0
    v_mov_b32 v42, 0
    v_mov_b32 v43, 0
    s_waitcnt vmcnt(0)
    v_mfma_f32_16x16x32_bf16 v[32:35], a[0:3], v[196:199], v[32:35]
    v_mfma_f32_16x16x32_bf16 v[36:39], a[56:59], v[196:199], v[36:39]
    v_mfma_f32_16x16x32_bf16 v[40:43], a[112:115], v[196:199], v[40:43]
    v_mfma_f32_16x16x32_bf16 v[32:35], a[4:7], v[200:203], v[32:35]
    v_mfma_f32_16x16x32_bf16 v[36:39], a[60:63], v[200:203], v[36:39]
    v_mfma_f32_16x16x32_bf16 v[40:43], a[116:119], v[200:203], v[40:43]
    v_mfma_f32_16x16x32_bf16 v[32:35], a[8:11], v[204:207], v[32:35]
    v_mfma_f32_16x16x32_bf16 v[36:39], a[64:67], v[204:207], v[36:39]
    v_mfma_f32_16x16x32_bf16 v[40:43], a[120:123], v[204:207], v[40:43]
    v_mfma_f32_16x16x32_bf16 v[32:35], a[12:15], v[208:211], v[32:35]
    v_mfma_f32_16x16x32_bf16 v[36:39], a[68:71], v[208:211], v[36:39]
    v_mfma_f32_16x16x32_bf16 v[40:43], a[124:127], v[208:211], v[40:43]
    v_mfma_f32_16x16x32_bf16 v[32:35], a[16:19], v[212:215], v[32:35]
    v_mfma_f32_16x16x32_bf16 v[36:39], a[72:75], v[212:215], v[36:39]
    v_mfma_f32_16x16x32_bf16 v[40:43], a[128:131], v[212:215], v[40:43]
    v_mfma_f32_16x16x32_bf16 v[32:35], a[20:23], v[216:219], v[32:35]
    v_mfma_f32_16x16x32_bf16 v[36:39], a[76:79], v[216:219], v[36:39]
    v_mfma_f32_16x16x32_bf16 v[40:43], a[132:135], v[216:219], v[40:43]
    v_mfma_f32_16x16x32_bf16 v[32:35], a[24:27], v[220:223], v[32:35]
    v_mfma_f32_16x16x32_bf16 v[36:39], a[80:83], v[220:223], v[36:39]
    v_mfma_f32_16x16x32_bf16 v[40:43], a[136:139], v[220:223], v[40:43]
    v_mfma_f32_16x16x32_bf16 v[32:35], a[28:31], v[224:227], v[32:35]
    v_mfma_f32_16x16x32_bf16 v[36:39], a[84:87], v[224:227], v[36:39]
    v_mfma_f32_16x16x32_bf16 v[40:43], a[140:143], v[224:227], v[40:43]
    v_mfma_f32_16x16x32_bf16 v[32:35], a[32:35], v[228:231], v[32:35]
    v_mfma_f32_16x16x32_bf16 v[36:39], a[88:91], v[228:231], v[36:39]
    v_mfma_f32_16x16x32_bf16 v[40:43], a[144:147], v[228:231], v[40:43]
    v_mfma_f32_16x16x32_bf16 v[32:35], a[36:39], v[232:235], v[32:35]
    v_mfma_f32_16x16x32_bf16 v[36:39], a[92:95], v[232:235], v[36:39]
    v_mfma_f32_16x16x32_bf16 v[40:43], a[148:151], v[232:235], v[40:43]
    v_mfma_f32_16x16x32_bf16 v[32:35], a[40:43], v[236:239], v[32:35]
    v_mfma_f32_16x16x32_bf16 v[36:39], a[96:99], v[236:239], v[36:39]
    v_mfma_f32_16x16x32_bf16 v[40:43], a[152:155], v[236:239], v[40:43]
    v_mfma_f32_16x16x32_bf16 v[32:35], a[44:47], v[240:243], v[32:35]
    v_mfma_f32_16x16x32_bf16 v[36:39], a[100:103], v[240:243], v[36:39]
    v_mfma_f32_16x16x32_bf16 v[40:43], a[156:159], v[240:243], v[40:43]
    v_mfma_f32_16x16x32_bf16 v[32:35], a[48:51], v[244:247], v[32:35]
    v_mfma_f32_16x16x32_bf16 v[36:39], a[104:107], v[244:247], v[36:39]
    v_mfma_f32_16x16x32_bf16 v[40:43], a[160:163], v[244:247], v[40:43]
    v_mfma_f32_16x16x32_bf16 v[32:35], a[52:55], v[248:251], v[32:35]
    v_mfma_f32_16x16x32_bf16 v[36:39], a[108:111], v[248:251], v[36:39]
    v_mfma_f32_16x16x32_bf16 v[40:43], a[164:167], v[248:251], v[40:43]
    s_nop 7
    s_nop 1
    v_cmp_le_u32 vcc, v120, v133
    s_nop 1
    v_cndmask_b32 v32, v136, v32, vcc
    v_cmp_le_u32 vcc, v121, v133
    s_nop 1
    v_cndmask_b32 v33, v136, v33, vcc
    v_cmp_le_u32 vcc, v122, v133
    s_nop 1
    v_cndmask_b32 v34, v136, v34, vcc
    v_cmp_le_u32 vcc, v123, v133
    s_nop 1
    v_cndmask_b32 v35, v136, v35, vcc
    v_cmp_le_u32 vcc, v124, v133
    s_nop 1
    v_cndmask_b32 v36, v136, v36, vcc
    v_cmp_le_u32 vcc, v125, v133
    s_nop 1
    v_cndmask_b32 v37, v136, v37, vcc
    v_cmp_le_u32 vcc, v126, v133
    s_nop 1
    v_cndmask_b32 v38, v136, v38, vcc
    v_cmp_le_u32 vcc, v127, v133
    s_nop 1
    v_cndmask_b32 v39, v136, v39, vcc
    v_cmp_le_u32 vcc, v128, v133
    s_nop 1
    v_cndmask_b32 v40, v136, v40, vcc
    v_cmp_le_u32 vcc, v129, v133
    s_nop 1
    v_cndmask_b32 v41, v136, v41, vcc
    v_cmp_le_u32 vcc, v130, v133
    s_nop 1
    v_cndmask_b32 v42, v136, v42, vcc
    v_cmp_le_u32 vcc, v131, v133
    s_nop 1
    v_cndmask_b32 v43, v136, v43, vcc
    v_max_f32 v20, v32, v33
    v_max_f32 v20, v20, v34
    v_max_f32 v20, v20, v35
    v_max_f32 v20, v20, v36
    v_max_f32 v20, v20, v37
    v_max_f32 v20, v20, v38
    v_max_f32 v20, v20, v39
    v_max_f32 v20, v20, v40
    v_max_f32 v20, v20, v41
    v_max_f32 v20, v20, v42
    v_max_f32 v20, v20, v43
    ds_bpermute_b32 v21, v134, v20
    s_waitcnt lgkmcnt(0)
    v_max_f32 v20, v20, v21
    ds_bpermute_b32 v21, v135, v20
    s_waitcnt lgkmcnt(0)
    v_max_f32 v20, v20, v21
    v_mov_b32 v21, 0
    v_sub_f32 v32, v32, v20
    v_mul_f32 v32, 0x3db8aa3b, v32
    v_exp_f32 v32, v32
    s_nop 0
    v_add_f32 v21, v21, v32
    v_sub_f32 v33, v33, v20
    v_mul_f32 v33, 0x3db8aa3b, v33
    v_exp_f32 v33, v33
    s_nop 0
    v_add_f32 v21, v21, v33
    v_sub_f32 v34, v34, v20
    v_mul_f32 v34, 0x3db8aa3b, v34
    v_exp_f32 v34, v34
    s_nop 0
    v_add_f32 v21, v21, v34
    v_sub_f32 v35, v35, v20
    v_mul_f32 v35, 0x3db8aa3b, v35
    v_exp_f32 v35, v35
    s_nop 0
    v_add_f32 v21, v21, v35
    v_sub_f32 v36, v36, v20
    v_mul_f32 v36, 0x3db8aa3b, v36
    v_exp_f32 v36, v36
    s_nop 0
    v_add_f32 v21, v21, v36
    v_sub_f32 v37, v37, v20
    v_mul_f32 v37, 0x3db8aa3b, v37
    v_exp_f32 v37, v37
    s_nop 0
    v_add_f32 v21, v21, v37
    v_sub_f32 v38, v38, v20
    v_mul_f32 v38, 0x3db8aa3b, v38
    v_exp_f32 v38, v38
    s_nop 0
    v_add_f32 v21, v21, v38
    v_sub_f32 v39, v39, v20
    v_mul_f32 v39, 0x3db8aa3b, v39
    v_exp_f32 v39, v39
    s_nop 0
    v_add_f32 v21, v21, v39
    v_sub_f32 v40, v40, v20
    v_mul_f32 v40, 0x3db8aa3b, v40
    v_exp_f32 v40, v40
    s_nop 0
    v_add_f32 v21, v21, v40
    v_sub_f32 v41, v41, v20
    v_mul_f32 v41, 0x3db8aa3b, v41
    v_exp_f32 v41, v41
    s_nop 0
    v_add_f32 v21, v21, v41
    v_sub_f32 v42, v42, v20
    v_mul_f32 v42, 0x3db8aa3b, v42
    v_exp_f32 v42, v42
    s_nop 0
    v_add_f32 v21, v21, v42
    v_sub_f32 v43, v43, v20
    v_mul_f32 v43, 0x3db8aa3b, v43
    v_exp_f32 v43, v43
    s_nop 0
    v_add_f32 v21, v21, v43
    ds_bpermute_b32 v22, v134, v21
    s_waitcnt lgkmcnt(0)
    v_add_f32 v21, v21, v22
    ds_bpermute_b32 v22, v135, v21
    s_waitcnt lgkmcnt(0)
    v_add_f32 v21, v21, v22
    v_rcp_f32 v21, v21
    s_nop 0
    v_mul_f32 v32, v32, v21
    v_mul_f32 v33, v33, v21
    v_mul_f32 v34, v34, v21
    v_mul_f32 v35, v35, v21
    v_mul_f32 v36, v36, v21
    v_mul_f32 v37, v37, v21
    v_mul_f32 v38, v38, v21
    v_mul_f32 v39, v39, v21
    v_mul_f32 v40, v40, v21
    v_mul_f32 v41, v41, v21
    v_mul_f32 v42, v42, v21
    v_mul_f32 v43, v43, v21
    v_cvt_pk_bf16_f32 v44, v32, v33
    v_cvt_pk_bf16_f32 v45, v34, v35
    ds_write_b64 v25, v[44:45] offset:7680
    v_cvt_pk_bf16_f32 v46, v36, v37
    v_cvt_pk_bf16_f32 v47, v38, v39
    ds_write_b64 v25, v[46:47] offset:7712
    v_cvt_pk_bf16_f32 v48, v40, v41
    v_cvt_pk_bf16_f32 v49, v42, v43
    v_cmp_gt_u32 vcc, 2, v117
    s_and_saveexec_b64 s[20:21], vcc
    ds_write_b64 v25, v[48:49] offset:7744
    s_mov_b64 exec, s[20:21]
    buffer_load_dwordx4 v[140:143], v23, s[8:11], 0 offen offset:2688 sc1
    buffer_load_dwordx4 v[144:147], v23, s[8:11], 0 offen offset:2752 sc1
    buffer_load_dwordx4 v[148:151], v23, s[8:11], 0 offen offset:2816 sc1
    buffer_load_dwordx4 v[152:155], v23, s[8:11], 0 offen offset:2880 sc1
    buffer_load_dwordx4 v[156:159], v23, s[8:11], 0 offen offset:2944 sc1
    buffer_load_dwordx4 v[160:163], v23, s[8:11], 0 offen offset:3008 sc1
    buffer_load_dwordx4 v[164:167], v23, s[8:11], 0 offen offset:3072 sc1
    buffer_load_dwordx4 v[168:171], v23, s[8:11], 0 offen offset:3136 sc1
    buffer_load_dwordx4 v[172:175], v23, s[8:11], 0 offen offset:3200 sc1
    buffer_load_dwordx4 v[176:179], v23, s[8:11], 0 offen offset:3264 sc1
    buffer_load_dwordx4 v[180:183], v23, s[8:11], 0 offen offset:3328 sc1
    buffer_load_dwordx4 v[184:187], v23, s[8:11], 0 offen offset:3392 sc1
    buffer_load_dwordx4 v[188:191], v23, s[8:11], 0 offen offset:3456 sc1
    buffer_load_dwordx4 v[192:195], v23, s[8:11], 0 offen offset:3520 sc1
    buffer_load_dwordx4 v[196:199], v24, s[8:11], 0 offen offset:2688 sc1
    buffer_load_dwordx4 v[200:203], v24, s[8:11], 0 offen offset:2752 sc1
    buffer_load_dwordx4 v[204:207], v24, s[8:11], 0 offen offset:2816 sc1
    buffer_load_dwordx4 v[208:211], v24, s[8:11], 0 offen offset:2880 sc1
    buffer_load_dwordx4 v[212:215], v24, s[8:11], 0 offen offset:2944 sc1
    buffer_load_dwordx4 v[216:219], v24, s[8:11], 0 offen offset:3008 sc1
    buffer_load_dwordx4 v[220:223], v24, s[8:11], 0 offen offset:3072 sc1
    buffer_load_dwordx4 v[224:227], v24, s[8:11], 0 offen offset:3136 sc1
    buffer_load_dwordx4 v[228:231], v24, s[8:11], 0 offen offset:3200 sc1
    buffer_load_dwordx4 v[232:235], v24, s[8:11], 0 offen offset:3264 sc1
    buffer_load_dwordx4 v[236:239], v24, s[8:11], 0 offen offset:3328 sc1
    buffer_load_dwordx4 v[240:243], v24, s[8:11], 0 offen offset:3392 sc1
    buffer_load_dwordx4 v[244:247], v24, s[8:11], 0 offen offset:3456 sc1
    buffer_load_dwordx4 v[248:251], v24, s[8:11], 0 offen offset:3520 sc1
    v_mov_b32 v32, 0
    v_mov_b32 v33, 0
    v_mov_b32 v34, 0
    v_mov_b32 v35, 0
    v_mov_b32 v36, 0
    v_mov_b32 v37, 0
    v_mov_b32 v38, 0
    v_mov_b32 v39, 0
    v_mov_b32 v40, 0
    v_mov_b32 v41, 0
    v_mov_b32 v42, 0
    v_mov_b32 v43, 0
    s_waitcnt vmcnt(14)
    v_mfma_f32_16x16x32_bf16 v[32:35], a[0:3], v[140:143], v[32:35]
    v_mfma_f32_16x16x32_bf16 v[36:39], a[56:59], v[140:143], v[36:39]
    v_mfma_f32_16x16x32_bf16 v[40:43], a[112:115], v[140:143], v[40:43]
    v_mfma_f32_16x16x32_bf16 v[32:35], a[4:7], v[144:147], v[32:35]
    v_mfma_f32_16x16x32_bf16 v[36:39], a[60:63], v[144:147], v[36:39]
    v_mfma_f32_16x16x32_bf16 v[40:43], a[116:119], v[144:147], v[40:43]
    v_mfma_f32_16x16x32_bf16 v[32:35], a[8:11], v[148:151], v[32:35]
    v_mfma_f32_16x16x32_bf16 v[36:39], a[64:67], v[148:151], v[36:39]
    v_mfma_f32_16x16x32_bf16 v[40:43], a[120:123], v[148:151], v[40:43]
    v_mfma_f32_16x16x32_bf16 v[32:35], a[12:15], v[152:155], v[32:35]
    v_mfma_f32_16x16x32_bf16 v[36:39], a[68:71], v[152:155], v[36:39]
    v_mfma_f32_16x16x32_bf16 v[40:43], a[124:127], v[152:155], v[40:43]
    v_mfma_f32_16x16x32_bf16 v[32:35], a[16:19], v[156:159], v[32:35]
    v_mfma_f32_16x16x32_bf16 v[36:39], a[72:75], v[156:159], v[36:39]
    v_mfma_f32_16x16x32_bf16 v[40:43], a[128:131], v[156:159], v[40:43]
    v_mfma_f32_16x16x32_bf16 v[32:35], a[20:23], v[160:163], v[32:35]
    v_mfma_f32_16x16x32_bf16 v[36:39], a[76:79], v[160:163], v[36:39]
    v_mfma_f32_16x16x32_bf16 v[40:43], a[132:135], v[160:163], v[40:43]
    v_mfma_f32_16x16x32_bf16 v[32:35], a[24:27], v[164:167], v[32:35]
    v_mfma_f32_16x16x32_bf16 v[36:39], a[80:83], v[164:167], v[36:39]
    v_mfma_f32_16x16x32_bf16 v[40:43], a[136:139], v[164:167], v[40:43]
    v_mfma_f32_16x16x32_bf16 v[32:35], a[28:31], v[168:171], v[32:35]
    v_mfma_f32_16x16x32_bf16 v[36:39], a[84:87], v[168:171], v[36:39]
    v_mfma_f32_16x16x32_bf16 v[40:43], a[140:143], v[168:171], v[40:43]
    v_mfma_f32_16x16x32_bf16 v[32:35], a[32:35], v[172:175], v[32:35]
    v_mfma_f32_16x16x32_bf16 v[36:39], a[88:91], v[172:175], v[36:39]
    v_mfma_f32_16x16x32_bf16 v[40:43], a[144:147], v[172:175], v[40:43]
    v_mfma_f32_16x16x32_bf16 v[32:35], a[36:39], v[176:179], v[32:35]
    v_mfma_f32_16x16x32_bf16 v[36:39], a[92:95], v[176:179], v[36:39]
    v_mfma_f32_16x16x32_bf16 v[40:43], a[148:151], v[176:179], v[40:43]
    v_mfma_f32_16x16x32_bf16 v[32:35], a[40:43], v[180:183], v[32:35]
    v_mfma_f32_16x16x32_bf16 v[36:39], a[96:99], v[180:183], v[36:39]
    v_mfma_f32_16x16x32_bf16 v[40:43], a[152:155], v[180:183], v[40:43]
    v_mfma_f32_16x16x32_bf16 v[32:35], a[44:47], v[184:187], v[32:35]
    v_mfma_f32_16x16x32_bf16 v[36:39], a[100:103], v[184:187], v[36:39]
    v_mfma_f32_16x16x32_bf16 v[40:43], a[156:159], v[184:187], v[40:43]
    v_mfma_f32_16x16x32_bf16 v[32:35], a[48:51], v[188:191], v[32:35]
    v_mfma_f32_16x16x32_bf16 v[36:39], a[104:107], v[188:191], v[36:39]
    v_mfma_f32_16x16x32_bf16 v[40:43], a[160:163], v[188:191], v[40:43]
    v_mfma_f32_16x16x32_bf16 v[32:35], a[52:55], v[192:195], v[32:35]
    v_mfma_f32_16x16x32_bf16 v[36:39], a[108:111], v[192:195], v[36:39]
    v_mfma_f32_16x16x32_bf16 v[40:43], a[164:167], v[192:195], v[40:43]
    s_nop 7
    s_nop 1
    v_cmp_le_u32 vcc, v120, v132
    s_nop 1
    v_cndmask_b32 v32, v136, v32, vcc
    v_cmp_le_u32 vcc, v121, v132
    s_nop 1
    v_cndmask_b32 v33, v136, v33, vcc
    v_cmp_le_u32 vcc, v122, v132
    s_nop 1
    v_cndmask_b32 v34, v136, v34, vcc
    v_cmp_le_u32 vcc, v123, v132
    s_nop 1
    v_cndmask_b32 v35, v136, v35, vcc
    v_cmp_le_u32 vcc, v124, v132
    s_nop 1
    v_cndmask_b32 v36, v136, v36, vcc
    v_cmp_le_u32 vcc, v125, v132
    s_nop 1
    v_cndmask_b32 v37, v136, v37, vcc
    v_cmp_le_u32 vcc, v126, v132
    s_nop 1
    v_cndmask_b32 v38, v136, v38, vcc
    v_cmp_le_u32 vcc, v127, v132
    s_nop 1
    v_cndmask_b32 v39, v136, v39, vcc
    v_cmp_le_u32 vcc, v128, v132
    s_nop 1
    v_cndmask_b32 v40, v136, v40, vcc
    v_cmp_le_u32 vcc, v129, v132
    s_nop 1
    v_cndmask_b32 v41, v136, v41, vcc
    v_cmp_le_u32 vcc, v130, v132
    s_nop 1
    v_cndmask_b32 v42, v136, v42, vcc
    v_cmp_le_u32 vcc, v131, v132
    s_nop 1
    v_cndmask_b32 v43, v136, v43, vcc
    v_max_f32 v20, v32, v33
    v_max_f32 v20, v20, v34
    v_max_f32 v20, v20, v35
    v_max_f32 v20, v20, v36
    v_max_f32 v20, v20, v37
    v_max_f32 v20, v20, v38
    v_max_f32 v20, v20, v39
    v_max_f32 v20, v20, v40
    v_max_f32 v20, v20, v41
    v_max_f32 v20, v20, v42
    v_max_f32 v20, v20, v43
    ds_bpermute_b32 v21, v134, v20
    s_waitcnt lgkmcnt(0)
    v_max_f32 v20, v20, v21
    ds_bpermute_b32 v21, v135, v20
    s_waitcnt lgkmcnt(0)
    v_max_f32 v20, v20, v21
    v_mov_b32 v21, 0
    v_sub_f32 v32, v32, v20
    v_mul_f32 v32, 0x3db8aa3b, v32
    v_exp_f32 v32, v32
    s_nop 0
    v_add_f32 v21, v21, v32
    v_sub_f32 v33, v33, v20
    v_mul_f32 v33, 0x3db8aa3b, v33
    v_exp_f32 v33, v33
    s_nop 0
    v_add_f32 v21, v21, v33
    v_sub_f32 v34, v34, v20
    v_mul_f32 v34, 0x3db8aa3b, v34
    v_exp_f32 v34, v34
    s_nop 0
    v_add_f32 v21, v21, v34
    v_sub_f32 v35, v35, v20
    v_mul_f32 v35, 0x3db8aa3b, v35
    v_exp_f32 v35, v35
    s_nop 0
    v_add_f32 v21, v21, v35
    v_sub_f32 v36, v36, v20
    v_mul_f32 v36, 0x3db8aa3b, v36
    v_exp_f32 v36, v36
    s_nop 0
    v_add_f32 v21, v21, v36
    v_sub_f32 v37, v37, v20
    v_mul_f32 v37, 0x3db8aa3b, v37
    v_exp_f32 v37, v37
    s_nop 0
    v_add_f32 v21, v21, v37
    v_sub_f32 v38, v38, v20
    v_mul_f32 v38, 0x3db8aa3b, v38
    v_exp_f32 v38, v38
    s_nop 0
    v_add_f32 v21, v21, v38
    v_sub_f32 v39, v39, v20
    v_mul_f32 v39, 0x3db8aa3b, v39
    v_exp_f32 v39, v39
    s_nop 0
    v_add_f32 v21, v21, v39
    v_sub_f32 v40, v40, v20
    v_mul_f32 v40, 0x3db8aa3b, v40
    v_exp_f32 v40, v40
    s_nop 0
    v_add_f32 v21, v21, v40
    v_sub_f32 v41, v41, v20
    v_mul_f32 v41, 0x3db8aa3b, v41
    v_exp_f32 v41, v41
    s_nop 0
    v_add_f32 v21, v21, v41
    v_sub_f32 v42, v42, v20
    v_mul_f32 v42, 0x3db8aa3b, v42
    v_exp_f32 v42, v42
    s_nop 0
    v_add_f32 v21, v21, v42
    v_sub_f32 v43, v43, v20
    v_mul_f32 v43, 0x3db8aa3b, v43
    v_exp_f32 v43, v43
    s_nop 0
    v_add_f32 v21, v21, v43
    ds_bpermute_b32 v22, v134, v21
    s_waitcnt lgkmcnt(0)
    v_add_f32 v21, v21, v22
    ds_bpermute_b32 v22, v135, v21
    s_waitcnt lgkmcnt(0)
    v_add_f32 v21, v21, v22
    v_rcp_f32 v21, v21
    s_nop 0
    v_mul_f32 v32, v32, v21
    v_mul_f32 v33, v33, v21
    v_mul_f32 v34, v34, v21
    v_mul_f32 v35, v35, v21
    v_mul_f32 v36, v36, v21
    v_mul_f32 v37, v37, v21
    v_mul_f32 v38, v38, v21
    v_mul_f32 v39, v39, v21
    v_mul_f32 v40, v40, v21
    v_mul_f32 v41, v41, v21
    v_mul_f32 v42, v42, v21
    v_mul_f32 v43, v43, v21
    v_cvt_pk_bf16_f32 v44, v32, v33
    v_cvt_pk_bf16_f32 v45, v34, v35
    ds_write_b64 v25, v[44:45] offset:9216
    v_cvt_pk_bf16_f32 v46, v36, v37
    v_cvt_pk_bf16_f32 v47, v38, v39
    ds_write_b64 v25, v[46:47] offset:9248
    v_cvt_pk_bf16_f32 v48, v40, v41
    v_cvt_pk_bf16_f32 v49, v42, v43
    v_cmp_gt_u32 vcc, 2, v117
    s_and_saveexec_b64 s[20:21], vcc
    ds_write_b64 v25, v[48:49] offset:9280
    s_mov_b64 exec, s[20:21]
    v_mov_b32 v32, 0
    v_mov_b32 v33, 0
    v_mov_b32 v34, 0
    v_mov_b32 v35, 0
    v_mov_b32 v36, 0
    v_mov_b32 v37, 0
    v_mov_b32 v38, 0
    v_mov_b32 v39, 0
    v_mov_b32 v40, 0
    v_mov_b32 v41, 0
    v_mov_b32 v42, 0
    v_mov_b32 v43, 0
    s_waitcnt vmcnt(0)
    v_mfma_f32_16x16x32_bf16 v[32:35], a[0:3], v[196:199], v[32:35]
    v_mfma_f32_16x16x32_bf16 v[36:39], a[56:59], v[196:199], v[36:39]
    v_mfma_f32_16x16x32_bf16 v[40:43], a[112:115], v[196:199], v[40:43]
    v_mfma_f32_16x16x32_bf16 v[32:35], a[4:7], v[200:203], v[32:35]
    v_mfma_f32_16x16x32_bf16 v[36:39], a[60:63], v[200:203], v[36:39]
    v_mfma_f32_16x16x32_bf16 v[40:43], a[116:119], v[200:203], v[40:43]
    v_mfma_f32_16x16x32_bf16 v[32:35], a[8:11], v[204:207], v[32:35]
    v_mfma_f32_16x16x32_bf16 v[36:39], a[64:67], v[204:207], v[36:39]
    v_mfma_f32_16x16x32_bf16 v[40:43], a[120:123], v[204:207], v[40:43]
    v_mfma_f32_16x16x32_bf16 v[32:35], a[12:15], v[208:211], v[32:35]
    v_mfma_f32_16x16x32_bf16 v[36:39], a[68:71], v[208:211], v[36:39]
    v_mfma_f32_16x16x32_bf16 v[40:43], a[124:127], v[208:211], v[40:43]
    v_mfma_f32_16x16x32_bf16 v[32:35], a[16:19], v[212:215], v[32:35]
    v_mfma_f32_16x16x32_bf16 v[36:39], a[72:75], v[212:215], v[36:39]
    v_mfma_f32_16x16x32_bf16 v[40:43], a[128:131], v[212:215], v[40:43]
    v_mfma_f32_16x16x32_bf16 v[32:35], a[20:23], v[216:219], v[32:35]
    v_mfma_f32_16x16x32_bf16 v[36:39], a[76:79], v[216:219], v[36:39]
    v_mfma_f32_16x16x32_bf16 v[40:43], a[132:135], v[216:219], v[40:43]
    v_mfma_f32_16x16x32_bf16 v[32:35], a[24:27], v[220:223], v[32:35]
    v_mfma_f32_16x16x32_bf16 v[36:39], a[80:83], v[220:223], v[36:39]
    v_mfma_f32_16x16x32_bf16 v[40:43], a[136:139], v[220:223], v[40:43]
    v_mfma_f32_16x16x32_bf16 v[32:35], a[28:31], v[224:227], v[32:35]
    v_mfma_f32_16x16x32_bf16 v[36:39], a[84:87], v[224:227], v[36:39]
    v_mfma_f32_16x16x32_bf16 v[40:43], a[140:143], v[224:227], v[40:43]
    v_mfma_f32_16x16x32_bf16 v[32:35], a[32:35], v[228:231], v[32:35]
    v_mfma_f32_16x16x32_bf16 v[36:39], a[88:91], v[228:231], v[36:39]
    v_mfma_f32_16x16x32_bf16 v[40:43], a[144:147], v[228:231], v[40:43]
    v_mfma_f32_16x16x32_bf16 v[32:35], a[36:39], v[232:235], v[32:35]
    v_mfma_f32_16x16x32_bf16 v[36:39], a[92:95], v[232:235], v[36:39]
    v_mfma_f32_16x16x32_bf16 v[40:43], a[148:151], v[232:235], v[40:43]
    v_mfma_f32_16x16x32_bf16 v[32:35], a[40:43], v[236:239], v[32:35]
    v_mfma_f32_16x16x32_bf16 v[36:39], a[96:99], v[236:239], v[36:39]
    v_mfma_f32_16x16x32_bf16 v[40:43], a[152:155], v[236:239], v[40:43]
    v_mfma_f32_16x16x32_bf16 v[32:35], a[44:47], v[240:243], v[32:35]
    v_mfma_f32_16x16x32_bf16 v[36:39], a[100:103], v[240:243], v[36:39]
    v_mfma_f32_16x16x32_bf16 v[40:43], a[156:159], v[240:243], v[40:43]
    v_mfma_f32_16x16x32_bf16 v[32:35], a[48:51], v[244:247], v[32:35]
    v_mfma_f32_16x16x32_bf16 v[36:39], a[104:107], v[244:247], v[36:39]
    v_mfma_f32_16x16x32_bf16 v[40:43], a[160:163], v[244:247], v[40:43]
    v_mfma_f32_16x16x32_bf16 v[32:35], a[52:55], v[248:251], v[32:35]
    v_mfma_f32_16x16x32_bf16 v[36:39], a[108:111], v[248:251], v[36:39]
    v_mfma_f32_16x16x32_bf16 v[40:43], a[164:167], v[248:251], v[40:43]
    s_nop 7
    s_nop 1
    v_cmp_le_u32 vcc, v120, v133
    s_nop 1
    v_cndmask_b32 v32, v136, v32, vcc
    v_cmp_le_u32 vcc, v121, v133
    s_nop 1
    v_cndmask_b32 v33, v136, v33, vcc
    v_cmp_le_u32 vcc, v122, v133
    s_nop 1
    v_cndmask_b32 v34, v136, v34, vcc
    v_cmp_le_u32 vcc, v123, v133
    s_nop 1
    v_cndmask_b32 v35, v136, v35, vcc
    v_cmp_le_u32 vcc, v124, v133
    s_nop 1
    v_cndmask_b32 v36, v136, v36, vcc
    v_cmp_le_u32 vcc, v125, v133
    s_nop 1
    v_cndmask_b32 v37, v136, v37, vcc
    v_cmp_le_u32 vcc, v126, v133
    s_nop 1
    v_cndmask_b32 v38, v136, v38, vcc
    v_cmp_le_u32 vcc, v127, v133
    s_nop 1
    v_cndmask_b32 v39, v136, v39, vcc
    v_cmp_le_u32 vcc, v128, v133
    s_nop 1
    v_cndmask_b32 v40, v136, v40, vcc
    v_cmp_le_u32 vcc, v129, v133
    s_nop 1
    v_cndmask_b32 v41, v136, v41, vcc
    v_cmp_le_u32 vcc, v130, v133
    s_nop 1
    v_cndmask_b32 v42, v136, v42, vcc
    v_cmp_le_u32 vcc, v131, v133
    s_nop 1
    v_cndmask_b32 v43, v136, v43, vcc
    v_max_f32 v20, v32, v33
    v_max_f32 v20, v20, v34
    v_max_f32 v20, v20, v35
    v_max_f32 v20, v20, v36
    v_max_f32 v20, v20, v37
    v_max_f32 v20, v20, v38
    v_max_f32 v20, v20, v39
    v_max_f32 v20, v20, v40
    v_max_f32 v20, v20, v41
    v_max_f32 v20, v20, v42
    v_max_f32 v20, v20, v43
    ds_bpermute_b32 v21, v134, v20
    s_waitcnt lgkmcnt(0)
    v_max_f32 v20, v20, v21
    ds_bpermute_b32 v21, v135, v20
    s_waitcnt lgkmcnt(0)
    v_max_f32 v20, v20, v21
    v_mov_b32 v21, 0
    v_sub_f32 v32, v32, v20
    v_mul_f32 v32, 0x3db8aa3b, v32
    v_exp_f32 v32, v32
    s_nop 0
    v_add_f32 v21, v21, v32
    v_sub_f32 v33, v33, v20
    v_mul_f32 v33, 0x3db8aa3b, v33
    v_exp_f32 v33, v33
    s_nop 0
    v_add_f32 v21, v21, v33
    v_sub_f32 v34, v34, v20
    v_mul_f32 v34, 0x3db8aa3b, v34
    v_exp_f32 v34, v34
    s_nop 0
    v_add_f32 v21, v21, v34
    v_sub_f32 v35, v35, v20
    v_mul_f32 v35, 0x3db8aa3b, v35
    v_exp_f32 v35, v35
    s_nop 0
    v_add_f32 v21, v21, v35
    v_sub_f32 v36, v36, v20
    v_mul_f32 v36, 0x3db8aa3b, v36
    v_exp_f32 v36, v36
    s_nop 0
    v_add_f32 v21, v21, v36
    v_sub_f32 v37, v37, v20
    v_mul_f32 v37, 0x3db8aa3b, v37
    v_exp_f32 v37, v37
    s_nop 0
    v_add_f32 v21, v21, v37
    v_sub_f32 v38, v38, v20
    v_mul_f32 v38, 0x3db8aa3b, v38
    v_exp_f32 v38, v38
    s_nop 0
    v_add_f32 v21, v21, v38
    v_sub_f32 v39, v39, v20
    v_mul_f32 v39, 0x3db8aa3b, v39
    v_exp_f32 v39, v39
    s_nop 0
    v_add_f32 v21, v21, v39
    v_sub_f32 v40, v40, v20
    v_mul_f32 v40, 0x3db8aa3b, v40
    v_exp_f32 v40, v40
    s_nop 0
    v_add_f32 v21, v21, v40
    v_sub_f32 v41, v41, v20
    v_mul_f32 v41, 0x3db8aa3b, v41
    v_exp_f32 v41, v41
    s_nop 0
    v_add_f32 v21, v21, v41
    v_sub_f32 v42, v42, v20
    v_mul_f32 v42, 0x3db8aa3b, v42
    v_exp_f32 v42, v42
    s_nop 0
    v_add_f32 v21, v21, v42
    v_sub_f32 v43, v43, v20
    v_mul_f32 v43, 0x3db8aa3b, v43
    v_exp_f32 v43, v43
    s_nop 0
    v_add_f32 v21, v21, v43
    ds_bpermute_b32 v22, v134, v21
    s_waitcnt lgkmcnt(0)
    v_add_f32 v21, v21, v22
    ds_bpermute_b32 v22, v135, v21
    s_waitcnt lgkmcnt(0)
    v_add_f32 v21, v21, v22
    v_rcp_f32 v21, v21
    s_nop 0
    v_mul_f32 v32, v32, v21
    v_mul_f32 v33, v33, v21
    v_mul_f32 v34, v34, v21
    v_mul_f32 v35, v35, v21
    v_mul_f32 v36, v36, v21
    v_mul_f32 v37, v37, v21
    v_mul_f32 v38, v38, v21
    v_mul_f32 v39, v39, v21
    v_mul_f32 v40, v40, v21
    v_mul_f32 v41, v41, v21
    v_mul_f32 v42, v42, v21
    v_mul_f32 v43, v43, v21
    v_cvt_pk_bf16_f32 v44, v32, v33
    v_cvt_pk_bf16_f32 v45, v34, v35
    ds_write_b64 v25, v[44:45] offset:10752
    v_cvt_pk_bf16_f32 v46, v36, v37
    v_cvt_pk_bf16_f32 v47, v38, v39
    ds_write_b64 v25, v[46:47] offset:10784
    v_cvt_pk_bf16_f32 v48, v40, v41
    v_cvt_pk_bf16_f32 v49, v42, v43
    v_cmp_gt_u32 vcc, 2, v117
    s_and_saveexec_b64 s[20:21], vcc
    ds_write_b64 v25, v[48:49] offset:10816
    s_mov_b64 exec, s[20:21]
    s_waitcnt lgkmcnt(0)
    s_barrier
    v_accvgpr_write_b32 a0, 0
    v_accvgpr_write_b32 a1, 0
    v_accvgpr_write_b32 a2, 0
    v_accvgpr_write_b32 a3, 0
    v_accvgpr_write_b32 a4, 0
    v_accvgpr_write_b32 a5, 0
    v_accvgpr_write_b32 a6, 0
    v_accvgpr_write_b32 a7, 0
    v_accvgpr_write_b32 a8, 0
    v_accvgpr_write_b32 a9, 0
    v_accvgpr_write_b32 a10, 0
    v_accvgpr_write_b32 a11, 0
    v_accvgpr_write_b32 a12, 0
    v_accvgpr_write_b32 a13, 0
    v_accvgpr_write_b32 a14, 0
    v_accvgpr_write_b32 a15, 0
    v_accvgpr_write_b32 a16, 0
    v_accvgpr_write_b32 a17, 0
    v_accvgpr_write_b32 a18, 0
    v_accvgpr_write_b32 a19, 0
    v_accvgpr_write_b32 a20, 0
    v_accvgpr_write_b32 a21, 0
    v_accvgpr_write_b32 a22, 0
    v_accvgpr_write_b32 a23, 0
    v_accvgpr_write_b32 a24, 0
    v_accvgpr_write_b32 a25, 0
    v_accvgpr_write_b32 a26, 0
    v_accvgpr_write_b32 a27, 0
    v_accvgpr_write_b32 a28, 0
    v_accvgpr_write_b32 a29, 0
    v_accvgpr_write_b32 a30, 0
    v_accvgpr_write_b32 a31, 0
    v_accvgpr_write_b32 a32, 0
    v_accvgpr_write_b32 a33, 0
    v_accvgpr_write_b32 a34, 0
    v_accvgpr_write_b32 a35, 0
    v_accvgpr_write_b32 a36, 0
    v_accvgpr_write_b32 a37, 0
    v_accvgpr_write_b32 a38, 0
    v_accvgpr_write_b32 a39, 0
    v_accvgpr_write_b32 a40, 0
    v_accvgpr_write_b32 a41, 0
    v_accvgpr_write_b32 a42, 0
    v_accvgpr_write_b32 a43, 0
    v_accvgpr_write_b32 a44, 0
    v_accvgpr_write_b32 a45, 0
    v_accvgpr_write_b32 a46, 0
    v_accvgpr_write_b32 a47, 0
    v_accvgpr_write_b32 a48, 0
    v_accvgpr_write_b32 a49, 0
    v_accvgpr_write_b32 a50, 0
    v_accvgpr_write_b32 a51, 0
    v_accvgpr_write_b32 a52, 0
    v_accvgpr_write_b32 a53, 0
    v_accvgpr_write_b32 a54, 0
    v_accvgpr_write_b32 a55, 0
    s_add_u32 s6, s31, 0
    buffer_load_dwordx4 v[32:35], v26, s[8:11], s6 offen sc1
    s_add_u32 s6, s31, 16384
    buffer_load_dwordx4 v[36:39], v26, s[8:11], s6 offen sc1
    s_add_u32 s6, s31, 32768
    buffer_load_dwordx4 v[40:43], v26, s[8:11], s6 offen sc1
    s_add_u32 s6, s31, 49152
    buffer_load_dwordx4 v[44:47], v26, s[8:11], s6 offen sc1
    s_add_u32 s6, s31, 65536
    buffer_load_dwordx4 v[48:51], v26, s[8:11], s6 offen sc1
    s_add_u32 s6, s31, 81920
    buffer_load_dwordx4 v[52:55], v26, s[8:11], s6 offen sc1
    s_add_u32 s6, s31, 98304
    buffer_load_dwordx4 v[56:59], v26, s[8:11], s6 offen sc1
    ds_read_b128 v[60:63], v30 offset:0
    ds_read_b128 v[64:67], v30 offset:1536
    s_add_u32 s6, s31, 1024
    buffer_load_dwordx4 v[68:71], v26, s[8:11], s6 offen sc1
    s_add_u32 s6, s31, 17408
    buffer_load_dwordx4 v[72:75], v26, s[8:11], s6 offen sc1
    s_add_u32 s6, s31, 33792
    buffer_load_dwordx4 v[76:79], v26, s[8:11], s6 offen sc1
    s_add_u32 s6, s31, 50176
    buffer_load_dwordx4 v[80:83], v26, s[8:11], s6 offen sc1
    s_add_u32 s6, s31, 66560
    buffer_load_dwordx4 v[84:87], v26, s[8:11], s6 offen sc1
    s_add_u32 s6, s31, 82944
    buffer_load_dwordx4 v[88:91], v26, s[8:11], s6 offen sc1
    s_add_u32 s6, s31, 99328
    buffer_load_dwordx4 v[92:95], v26, s[8:11], s6 offen sc1
    ds_read_b128 v[96:99], v30 offset:3072
    ds_read_b128 v[100:103], v30 offset:4608
    s_waitcnt vmcnt(7) lgkmcnt(2)
    v_mfma_f32_16x16x32_bf16 a[0:3], v[32:35], v[60:63], a[0:3]
    v_mfma_f32_16x16x32_bf16 a[4:7], v[32:35], v[64:67], a[4:7]
    v_mfma_f32_16x16x32_bf16 a[8:11], v[36:39], v[60:63], a[8:11]
    v_mfma_f32_16x16x32_bf16 a[12:15], v[36:39], v[64:67], a[12:15]
    v_mfma_f32_16x16x32_bf16 a[16:19], v[40:43], v[60:63], a[16:19]
    v_mfma_f32_16x16x32_bf16 a[20:23], v[40:43], v[64:67], a[20:23]
    v_mfma_f32_16x16x32_bf16 a[24:27], v[44:47], v[60:63], a[24:27]
    v_mfma_f32_16x16x32_bf16 a[28:31], v[44:47], v[64:67], a[28:31]
    v_mfma_f32_16x16x32_bf16 a[32:35], v[48:51], v[60:63], a[32:35]
    v_mfma_f32_16x16x32_bf16 a[36:39], v[48:51], v[64:67], a[36:39]
    v_mfma_f32_16x16x32_bf16 a[40:43], v[52:55], v[60:63], a[40:43]
    v_mfma_f32_16x16x32_bf16 a[44:47], v[52:55], v[64:67], a[44:47]
    v_mfma_f32_16x16x32_bf16 a[48:51], v[56:59], v[60:63], a[48:51]
    v_mfma_f32_16x16x32_bf16 a[52:55], v[56:59], v[64:67], a[52:55]
    s_add_u32 s6, s31, 2048
    buffer_load_dwordx4 v[32:35], v26, s[8:11], s6 offen sc1
    s_add_u32 s6, s31, 18432
    buffer_load_dwordx4 v[36:39], v26, s[8:11], s6 offen sc1
    s_add_u32 s6, s31, 34816
    buffer_load_dwordx4 v[40:43], v26, s[8:11], s6 offen sc1
    s_add_u32 s6, s31, 51200
    buffer_load_dwordx4 v[44:47], v26, s[8:11], s6 offen sc1
    s_add_u32 s6, s31, 67584
    buffer_load_dwordx4 v[48:51], v26, s[8:11], s6 offen sc1
    s_add_u32 s6, s31, 83968
    buffer_load_dwordx4 v[52:55], v26, s[8:11], s6 offen sc1
    s_add_u32 s6, s31, 100352
    buffer_load_dwordx4 v[56:59], v26, s[8:11], s6 offen sc1
    ds_read_b128 v[60:63], v30 offset:6144
    ds_read_b128 v[64:67], v30 offset:7680
    s_waitcnt vmcnt(7) lgkmcnt(2)
    v_mfma_f32_16x16x32_bf16 a[0:3], v[68:71], v[96:99], a[0:3]
    v_mfma_f32_16x16x32_bf16 a[4:7], v[68:71], v[100:103], a[4:7]
    v_mfma_f32_16x16x32_bf16 a[8:11], v[72:75], v[96:99], a[8:11]
    v_mfma_f32_16x16x32_bf16 a[12:15], v[72:75], v[100:103], a[12:15]
    v_mfma_f32_16x16x32_bf16 a[16:19], v[76:79], v[96:99], a[16:19]
    v_mfma_f32_16x16x32_bf16 a[20:23], v[76:79], v[100:103], a[20:23]
    v_mfma_f32_16x16x32_bf16 a[24:27], v[80:83], v[96:99], a[24:27]
    v_mfma_f32_16x16x32_bf16 a[28:31], v[80:83], v[100:103], a[28:31]
    v_mfma_f32_16x16x32_bf16 a[32:35], v[84:87], v[96:99], a[32:35]
    v_mfma_f32_16x16x32_bf16 a[36:39], v[84:87], v[100:103], a[36:39]
    v_mfma_f32_16x16x32_bf16 a[40:43], v[88:91], v[96:99], a[40:43]
    v_mfma_f32_16x16x32_bf16 a[44:47], v[88:91], v[100:103], a[44:47]
    v_mfma_f32_16x16x32_bf16 a[48:51], v[92:95], v[96:99], a[48:51]
    v_mfma_f32_16x16x32_bf16 a[52:55], v[92:95], v[100:103], a[52:55]
    s_add_u32 s6, s31, 3072
    buffer_load_dwordx4 v[68:71], v26, s[8:11], s6 offen sc1
    s_add_u32 s6, s31, 19456
    buffer_load_dwordx4 v[72:75], v26, s[8:11], s6 offen sc1
    s_add_u32 s6, s31, 35840
    buffer_load_dwordx4 v[76:79], v26, s[8:11], s6 offen sc1
    s_add_u32 s6, s31, 52224
    buffer_load_dwordx4 v[80:83], v26, s[8:11], s6 offen sc1
    s_add_u32 s6, s31, 68608
    buffer_load_dwordx4 v[84:87], v26, s[8:11], s6 offen sc1
    s_add_u32 s6, s31, 84992
    buffer_load_dwordx4 v[88:91], v26, s[8:11], s6 offen sc1
    s_add_u32 s6, s31, 101376
    buffer_load_dwordx4 v[92:95], v26, s[8:11], s6 offen sc1
    ds_read_b128 v[96:99], v30 offset:9216
    ds_read_b128 v[100:103], v30 offset:10752
    s_waitcnt vmcnt(7) lgkmcnt(2)
    v_mfma_f32_16x16x32_bf16 a[0:3], v[32:35], v[60:63], a[0:3]
    v_mfma_f32_16x16x32_bf16 a[4:7], v[32:35], v[64:67], a[4:7]
    v_mfma_f32_16x16x32_bf16 a[8:11], v[36:39], v[60:63], a[8:11]
    v_mfma_f32_16x16x32_bf16 a[12:15], v[36:39], v[64:67], a[12:15]
    v_mfma_f32_16x16x32_bf16 a[16:19], v[40:43], v[60:63], a[16:19]
    v_mfma_f32_16x16x32_bf16 a[20:23], v[40:43], v[64:67], a[20:23]
    v_mfma_f32_16x16x32_bf16 a[24:27], v[44:47], v[60:63], a[24:27]
    v_mfma_f32_16x16x32_bf16 a[28:31], v[44:47], v[64:67], a[28:31]
    v_mfma_f32_16x16x32_bf16 a[32:35], v[48:51], v[60:63], a[32:35]
    v_mfma_f32_16x16x32_bf16 a[36:39], v[48:51], v[64:67], a[36:39]
    v_mfma_f32_16x16x32_bf16 a[40:43], v[52:55], v[60:63], a[40:43]
    v_mfma_f32_16x16x32_bf16 a[44:47], v[52:55], v[64:67], a[44:47]
    v_mfma_f32_16x16x32_bf16 a[48:51], v[56:59], v[60:63], a[48:51]
    v_mfma_f32_16x16x32_bf16 a[52:55], v[56:59], v[64:67], a[52:55]
    s_add_u32 s6, s31, 4096
    buffer_load_dwordx4 v[32:35], v26, s[8:11], s6 offen sc1
    s_add_u32 s6, s31, 20480
    buffer_load_dwordx4 v[36:39], v26, s[8:11], s6 offen sc1
    s_add_u32 s6, s31, 36864
    buffer_load_dwordx4 v[40:43], v26, s[8:11], s6 offen sc1
    s_add_u32 s6, s31, 53248
    buffer_load_dwordx4 v[44:47], v26, s[8:11], s6 offen sc1
    s_add_u32 s6, s31, 69632
    buffer_load_dwordx4 v[48:51], v26, s[8:11], s6 offen sc1
    s_add_u32 s6, s31, 86016
    buffer_load_dwordx4 v[52:55], v26, s[8:11], s6 offen sc1
    s_add_u32 s6, s31, 102400
    buffer_load_dwordx4 v[56:59], v26, s[8:11], s6 offen sc1
    ds_read_b128 v[60:63], v30 offset:12288
    ds_read_b128 v[64:67], v30 offset:13824
    s_waitcnt vmcnt(7) lgkmcnt(2)
    v_mfma_f32_16x16x32_bf16 a[0:3], v[68:71], v[96:99], a[0:3]
    v_mfma_f32_16x16x32_bf16 a[4:7], v[68:71], v[100:103], a[4:7]
    v_mfma_f32_16x16x32_bf16 a[8:11], v[72:75], v[96:99], a[8:11]
    v_mfma_f32_16x16x32_bf16 a[12:15], v[72:75], v[100:103], a[12:15]
    v_mfma_f32_16x16x32_bf16 a[16:19], v[76:79], v[96:99], a[16:19]
    v_mfma_f32_16x16x32_bf16 a[20:23], v[76:79], v[100:103], a[20:23]
    v_mfma_f32_16x16x32_bf16 a[24:27], v[80:83], v[96:99], a[24:27]
    v_mfma_f32_16x16x32_bf16 a[28:31], v[80:83], v[100:103], a[28:31]
    v_mfma_f32_16x16x32_bf16 a[32:35], v[84:87], v[96:99], a[32:35]
    v_mfma_f32_16x16x32_bf16 a[36:39], v[84:87], v[100:103], a[36:39]
    v_mfma_f32_16x16x32_bf16 a[40:43], v[88:91], v[96:99], a[40:43]
    v_mfma_f32_16x16x32_bf16 a[44:47], v[88:91], v[100:103], a[44:47]
    v_mfma_f32_16x16x32_bf16 a[48:51], v[92:95], v[96:99], a[48:51]
    v_mfma_f32_16x16x32_bf16 a[52:55], v[92:95], v[100:103], a[52:55]
    s_add_u32 s6, s31, 5120
    buffer_load_dwordx4 v[68:71], v26, s[8:11], s6 offen sc1
    s_add_u32 s6, s31, 21504
    buffer_load_dwordx4 v[72:75], v26, s[8:11], s6 offen sc1
    s_add_u32 s6, s31, 37888
    buffer_load_dwordx4 v[76:79], v26, s[8:11], s6 offen sc1
    s_add_u32 s6, s31, 54272
    buffer_load_dwordx4 v[80:83], v26, s[8:11], s6 offen sc1
    s_add_u32 s6, s31, 70656
    buffer_load_dwordx4 v[84:87], v26, s[8:11], s6 offen sc1
    s_add_u32 s6, s31, 87040
    buffer_load_dwordx4 v[88:91], v26, s[8:11], s6 offen sc1
    s_add_u32 s6, s31, 103424
    buffer_load_dwordx4 v[92:95], v26, s[8:11], s6 offen sc1
    ds_read_b128 v[96:99], v30 offset:15360
    ds_read_b128 v[100:103], v30 offset:16896
    s_waitcnt vmcnt(7) lgkmcnt(2)
    v_mfma_f32_16x16x32_bf16 a[0:3], v[32:35], v[60:63], a[0:3]
    v_mfma_f32_16x16x32_bf16 a[4:7], v[32:35], v[64:67], a[4:7]
    v_mfma_f32_16x16x32_bf16 a[8:11], v[36:39], v[60:63], a[8:11]
    v_mfma_f32_16x16x32_bf16 a[12:15], v[36:39], v[64:67], a[12:15]
    v_mfma_f32_16x16x32_bf16 a[16:19], v[40:43], v[60:63], a[16:19]
    v_mfma_f32_16x16x32_bf16 a[20:23], v[40:43], v[64:67], a[20:23]
    v_mfma_f32_16x16x32_bf16 a[24:27], v[44:47], v[60:63], a[24:27]
    v_mfma_f32_16x16x32_bf16 a[28:31], v[44:47], v[64:67], a[28:31]
    v_mfma_f32_16x16x32_bf16 a[32:35], v[48:51], v[60:63], a[32:35]
    v_mfma_f32_16x16x32_bf16 a[36:39], v[48:51], v[64:67], a[36:39]
    v_mfma_f32_16x16x32_bf16 a[40:43], v[52:55], v[60:63], a[40:43]
    v_mfma_f32_16x16x32_bf16 a[44:47], v[52:55], v[64:67], a[44:47]
    v_mfma_f32_16x16x32_bf16 a[48:51], v[56:59], v[60:63], a[48:51]
    v_mfma_f32_16x16x32_bf16 a[52:55], v[56:59], v[64:67], a[52:55]
    s_add_u32 s6, s31, 6144
    buffer_load_dwordx4 v[32:35], v26, s[8:11], s6 offen sc1
    s_add_u32 s6, s31, 22528
    buffer_load_dwordx4 v[36:39], v26, s[8:11], s6 offen sc1
    s_add_u32 s6, s31, 38912
    buffer_load_dwordx4 v[40:43], v26, s[8:11], s6 offen sc1
    s_add_u32 s6, s31, 55296
    buffer_load_dwordx4 v[44:47], v26, s[8:11], s6 offen sc1
    s_add_u32 s6, s31, 71680
    buffer_load_dwordx4 v[48:51], v26, s[8:11], s6 offen sc1
    s_add_u32 s6, s31, 88064
    buffer_load_dwordx4 v[52:55], v26, s[8:11], s6 offen sc1
    s_add_u32 s6, s31, 104448
    buffer_load_dwordx4 v[56:59], v26, s[8:11], s6 offen sc1
    ds_read_b128 v[60:63], v30 offset:18432
    ds_read_b128 v[64:67], v30 offset:19968
    s_waitcnt vmcnt(7) lgkmcnt(2)
    v_mfma_f32_16x16x32_bf16 a[0:3], v[68:71], v[96:99], a[0:3]
    v_mfma_f32_16x16x32_bf16 a[4:7], v[68:71], v[100:103], a[4:7]
    v_mfma_f32_16x16x32_bf16 a[8:11], v[72:75], v[96:99], a[8:11]
    v_mfma_f32_16x16x32_bf16 a[12:15], v[72:75], v[100:103], a[12:15]
    v_mfma_f32_16x16x32_bf16 a[16:19], v[76:79], v[96:99], a[16:19]
    v_mfma_f32_16x16x32_bf16 a[20:23], v[76:79], v[100:103], a[20:23]
    v_mfma_f32_16x16x32_bf16 a[24:27], v[80:83], v[96:99], a[24:27]
    v_mfma_f32_16x16x32_bf16 a[28:31], v[80:83], v[100:103], a[28:31]
    v_mfma_f32_16x16x32_bf16 a[32:35], v[84:87], v[96:99], a[32:35]
    v_mfma_f32_16x16x32_bf16 a[36:39], v[84:87], v[100:103], a[36:39]
    v_mfma_f32_16x16x32_bf16 a[40:43], v[88:91], v[96:99], a[40:43]
    v_mfma_f32_16x16x32_bf16 a[44:47], v[88:91], v[100:103], a[44:47]
    v_mfma_f32_16x16x32_bf16 a[48:51], v[92:95], v[96:99], a[48:51]
    v_mfma_f32_16x16x32_bf16 a[52:55], v[92:95], v[100:103], a[52:55]
    s_add_u32 s6, s31, 7168
    buffer_load_dwordx4 v[68:71], v26, s[8:11], s6 offen sc1
    s_add_u32 s6, s31, 23552
    buffer_load_dwordx4 v[72:75], v26, s[8:11], s6 offen sc1
    s_add_u32 s6, s31, 39936
    buffer_load_dwordx4 v[76:79], v26, s[8:11], s6 offen sc1
    s_add_u32 s6, s31, 56320
    buffer_load_dwordx4 v[80:83], v26, s[8:11], s6 offen sc1
    s_add_u32 s6, s31, 72704
    buffer_load_dwordx4 v[84:87], v26, s[8:11], s6 offen sc1
    s_add_u32 s6, s31, 89088
    buffer_load_dwordx4 v[88:91], v26, s[8:11], s6 offen sc1
    s_add_u32 s6, s31, 105472
    buffer_load_dwordx4 v[92:95], v26, s[8:11], s6 offen sc1
    ds_read_b128 v[96:99], v30 offset:21504
    ds_read_b128 v[100:103], v30 offset:23040
    s_waitcnt vmcnt(7) lgkmcnt(2)
    v_mfma_f32_16x16x32_bf16 a[0:3], v[32:35], v[60:63], a[0:3]
    v_mfma_f32_16x16x32_bf16 a[4:7], v[32:35], v[64:67], a[4:7]
    v_mfma_f32_16x16x32_bf16 a[8:11], v[36:39], v[60:63], a[8:11]
    v_mfma_f32_16x16x32_bf16 a[12:15], v[36:39], v[64:67], a[12:15]
    v_mfma_f32_16x16x32_bf16 a[16:19], v[40:43], v[60:63], a[16:19]
    v_mfma_f32_16x16x32_bf16 a[20:23], v[40:43], v[64:67], a[20:23]
    v_mfma_f32_16x16x32_bf16 a[24:27], v[44:47], v[60:63], a[24:27]
    v_mfma_f32_16x16x32_bf16 a[28:31], v[44:47], v[64:67], a[28:31]
    v_mfma_f32_16x16x32_bf16 a[32:35], v[48:51], v[60:63], a[32:35]
    v_mfma_f32_16x16x32_bf16 a[36:39], v[48:51], v[64:67], a[36:39]
    v_mfma_f32_16x16x32_bf16 a[40:43], v[52:55], v[60:63], a[40:43]
    v_mfma_f32_16x16x32_bf16 a[44:47], v[52:55], v[64:67], a[44:47]
    v_mfma_f32_16x16x32_bf16 a[48:51], v[56:59], v[60:63], a[48:51]
    v_mfma_f32_16x16x32_bf16 a[52:55], v[56:59], v[64:67], a[52:55]
    s_add_u32 s6, s31, 8192
    buffer_load_dwordx4 v[32:35], v26, s[8:11], s6 offen sc1
    s_add_u32 s6, s31, 24576
    buffer_load_dwordx4 v[36:39], v26, s[8:11], s6 offen sc1
    s_add_u32 s6, s31, 40960
    buffer_load_dwordx4 v[40:43], v26, s[8:11], s6 offen sc1
    s_add_u32 s6, s31, 57344
    buffer_load_dwordx4 v[44:47], v26, s[8:11], s6 offen sc1
    s_add_u32 s6, s31, 73728
    buffer_load_dwordx4 v[48:51], v26, s[8:11], s6 offen sc1
    s_add_u32 s6, s31, 90112
    buffer_load_dwordx4 v[52:55], v26, s[8:11], s6 offen sc1
    s_add_u32 s6, s31, 106496
    buffer_load_dwordx4 v[56:59], v26, s[8:11], s6 offen sc1
    ds_read_b128 v[60:63], v30 offset:24576
    ds_read_b128 v[64:67], v30 offset:26112
    s_waitcnt vmcnt(7) lgkmcnt(2)
    v_mfma_f32_16x16x32_bf16 a[0:3], v[68:71], v[96:99], a[0:3]
    v_mfma_f32_16x16x32_bf16 a[4:7], v[68:71], v[100:103], a[4:7]
    v_mfma_f32_16x16x32_bf16 a[8:11], v[72:75], v[96:99], a[8:11]
    v_mfma_f32_16x16x32_bf16 a[12:15], v[72:75], v[100:103], a[12:15]
    v_mfma_f32_16x16x32_bf16 a[16:19], v[76:79], v[96:99], a[16:19]
    v_mfma_f32_16x16x32_bf16 a[20:23], v[76:79], v[100:103], a[20:23]
    v_mfma_f32_16x16x32_bf16 a[24:27], v[80:83], v[96:99], a[24:27]
    v_mfma_f32_16x16x32_bf16 a[28:31], v[80:83], v[100:103], a[28:31]
    v_mfma_f32_16x16x32_bf16 a[32:35], v[84:87], v[96:99], a[32:35]
    v_mfma_f32_16x16x32_bf16 a[36:39], v[84:87], v[100:103], a[36:39]
    v_mfma_f32_16x16x32_bf16 a[40:43], v[88:91], v[96:99], a[40:43]
    v_mfma_f32_16x16x32_bf16 a[44:47], v[88:91], v[100:103], a[44:47]
    v_mfma_f32_16x16x32_bf16 a[48:51], v[92:95], v[96:99], a[48:51]
    v_mfma_f32_16x16x32_bf16 a[52:55], v[92:95], v[100:103], a[52:55]
    s_add_u32 s6, s31, 9216
    buffer_load_dwordx4 v[68:71], v26, s[8:11], s6 offen sc1
    s_add_u32 s6, s31, 25600
    buffer_load_dwordx4 v[72:75], v26, s[8:11], s6 offen sc1
    s_add_u32 s6, s31, 41984
    buffer_load_dwordx4 v[76:79], v26, s[8:11], s6 offen sc1
    s_add_u32 s6, s31, 58368
    buffer_load_dwordx4 v[80:83], v26, s[8:11], s6 offen sc1
    s_add_u32 s6, s31, 74752
    buffer_load_dwordx4 v[84:87], v26, s[8:11], s6 offen sc1
    s_add_u32 s6, s31, 91136
    buffer_load_dwordx4 v[88:91], v26, s[8:11], s6 offen sc1
    s_add_u32 s6, s31, 107520
    buffer_load_dwordx4 v[92:95], v26, s[8:11], s6 offen sc1
    ds_read_b128 v[96:99], v30 offset:27648
    ds_read_b128 v[100:103], v30 offset:29184
    s_waitcnt vmcnt(7) lgkmcnt(2)
    v_mfma_f32_16x16x32_bf16 a[0:3], v[32:35], v[60:63], a[0:3]
    v_mfma_f32_16x16x32_bf16 a[4:7], v[32:35], v[64:67], a[4:7]
    v_mfma_f32_16x16x32_bf16 a[8:11], v[36:39], v[60:63], a[8:11]
    v_mfma_f32_16x16x32_bf16 a[12:15], v[36:39], v[64:67], a[12:15]
    v_mfma_f32_16x16x32_bf16 a[16:19], v[40:43], v[60:63], a[16:19]
    v_mfma_f32_16x16x32_bf16 a[20:23], v[40:43], v[64:67], a[20:23]
    v_mfma_f32_16x16x32_bf16 a[24:27], v[44:47], v[60:63], a[24:27]
    v_mfma_f32_16x16x32_bf16 a[28:31], v[44:47], v[64:67], a[28:31]
    v_mfma_f32_16x16x32_bf16 a[32:35], v[48:51], v[60:63], a[32:35]
    v_mfma_f32_16x16x32_bf16 a[36:39], v[48:51], v[64:67], a[36:39]
    v_mfma_f32_16x16x32_bf16 a[40:43], v[52:55], v[60:63], a[40:43]
    v_mfma_f32_16x16x32_bf16 a[44:47], v[52:55], v[64:67], a[44:47]
    v_mfma_f32_16x16x32_bf16 a[48:51], v[56:59], v[60:63], a[48:51]
    v_mfma_f32_16x16x32_bf16 a[52:55], v[56:59], v[64:67], a[52:55]
    s_add_u32 s6, s31, 10240
    buffer_load_dwordx4 v[32:35], v26, s[8:11], s6 offen sc1
    s_add_u32 s6, s31, 26624
    buffer_load_dwordx4 v[36:39], v26, s[8:11], s6 offen sc1
    s_add_u32 s6, s31, 43008
    buffer_load_dwordx4 v[40:43], v26, s[8:11], s6 offen sc1
    s_add_u32 s6, s31, 59392
    buffer_load_dwordx4 v[44:47], v26, s[8:11], s6 offen sc1
    s_add_u32 s6, s31, 75776
    buffer_load_dwordx4 v[48:51], v26, s[8:11], s6 offen sc1
    s_add_u32 s6, s31, 92160
    buffer_load_dwordx4 v[52:55], v26, s[8:11], s6 offen sc1
    s_add_u32 s6, s31, 108544
    buffer_load_dwordx4 v[56:59], v26, s[8:11], s6 offen sc1
    ds_read_b128 v[60:63], v30 offset:30720
    ds_read_b128 v[64:67], v30 offset:32256
    s_waitcnt vmcnt(7) lgkmcnt(2)
    v_mfma_f32_16x16x32_bf16 a[0:3], v[68:71], v[96:99], a[0:3]
    v_mfma_f32_16x16x32_bf16 a[4:7], v[68:71], v[100:103], a[4:7]
    v_mfma_f32_16x16x32_bf16 a[8:11], v[72:75], v[96:99], a[8:11]
    v_mfma_f32_16x16x32_bf16 a[12:15], v[72:75], v[100:103], a[12:15]
    v_mfma_f32_16x16x32_bf16 a[16:19], v[76:79], v[96:99], a[16:19]
    v_mfma_f32_16x16x32_bf16 a[20:23], v[76:79], v[100:103], a[20:23]
    v_mfma_f32_16x16x32_bf16 a[24:27], v[80:83], v[96:99], a[24:27]
    v_mfma_f32_16x16x32_bf16 a[28:31], v[80:83], v[100:103], a[28:31]
    v_mfma_f32_16x16x32_bf16 a[32:35], v[84:87], v[96:99], a[32:35]
    v_mfma_f32_16x16x32_bf16 a[36:39], v[84:87], v[100:103], a[36:39]
    v_mfma_f32_16x16x32_bf16 a[40:43], v[88:91], v[96:99], a[40:43]
    v_mfma_f32_16x16x32_bf16 a[44:47], v[88:91], v[100:103], a[44:47]
    v_mfma_f32_16x16x32_bf16 a[48:51], v[92:95], v[96:99], a[48:51]
    v_mfma_f32_16x16x32_bf16 a[52:55], v[92:95], v[100:103], a[52:55]
    s_add_u32 s6, s31, 11264
    buffer_load_dwordx4 v[68:71], v26, s[8:11], s6 offen sc1
    s_add_u32 s6, s31, 27648
    buffer_load_dwordx4 v[72:75], v26, s[8:11], s6 offen sc1
    s_add_u32 s6, s31, 44032
    buffer_load_dwordx4 v[76:79], v26, s[8:11], s6 offen sc1
    s_add_u32 s6, s31, 60416
    buffer_load_dwordx4 v[80:83], v26, s[8:11], s6 offen sc1
    s_add_u32 s6, s31, 76800
    buffer_load_dwordx4 v[84:87], v26, s[8:11], s6 offen sc1
    s_add_u32 s6, s31, 93184
    buffer_load_dwordx4 v[88:91], v26, s[8:11], s6 offen sc1
    s_add_u32 s6, s31, 109568
    buffer_load_dwordx4 v[92:95], v26, s[8:11], s6 offen sc1
    ds_read_b128 v[96:99], v30 offset:33792
    ds_read_b128 v[100:103], v30 offset:35328
    s_waitcnt vmcnt(7) lgkmcnt(2)
    v_mfma_f32_16x16x32_bf16 a[0:3], v[32:35], v[60:63], a[0:3]
    v_mfma_f32_16x16x32_bf16 a[4:7], v[32:35], v[64:67], a[4:7]
    v_mfma_f32_16x16x32_bf16 a[8:11], v[36:39], v[60:63], a[8:11]
    v_mfma_f32_16x16x32_bf16 a[12:15], v[36:39], v[64:67], a[12:15]
    v_mfma_f32_16x16x32_bf16 a[16:19], v[40:43], v[60:63], a[16:19]
    v_mfma_f32_16x16x32_bf16 a[20:23], v[40:43], v[64:67], a[20:23]
    v_mfma_f32_16x16x32_bf16 a[24:27], v[44:47], v[60:63], a[24:27]
    v_mfma_f32_16x16x32_bf16 a[28:31], v[44:47], v[64:67], a[28:31]
    v_mfma_f32_16x16x32_bf16 a[32:35], v[48:51], v[60:63], a[32:35]
    v_mfma_f32_16x16x32_bf16 a[36:39], v[48:51], v[64:67], a[36:39]
    v_mfma_f32_16x16x32_bf16 a[40:43], v[52:55], v[60:63], a[40:43]
    v_mfma_f32_16x16x32_bf16 a[44:47], v[52:55], v[64:67], a[44:47]
    v_mfma_f32_16x16x32_bf16 a[48:51], v[56:59], v[60:63], a[48:51]
    v_mfma_f32_16x16x32_bf16 a[52:55], v[56:59], v[64:67], a[52:55]
    s_add_u32 s6, s31, 12288
    buffer_load_dwordx4 v[32:35], v26, s[8:11], s6 offen sc1
    s_add_u32 s6, s31, 28672
    buffer_load_dwordx4 v[36:39], v26, s[8:11], s6 offen sc1
    s_add_u32 s6, s31, 45056
    buffer_load_dwordx4 v[40:43], v26, s[8:11], s6 offen sc1
    s_add_u32 s6, s31, 61440
    buffer_load_dwordx4 v[44:47], v26, s[8:11], s6 offen sc1
    s_add_u32 s6, s31, 77824
    buffer_load_dwordx4 v[48:51], v26, s[8:11], s6 offen sc1
    s_add_u32 s6, s31, 94208
    buffer_load_dwordx4 v[52:55], v26, s[8:11], s6 offen sc1
    s_add_u32 s6, s31, 110592
    buffer_load_dwordx4 v[56:59], v26, s[8:11], s6 offen sc1
    ds_read_b128 v[60:63], v30 offset:36864
    ds_read_b128 v[64:67], v30 offset:38400
    s_waitcnt vmcnt(7) lgkmcnt(2)
    v_mfma_f32_16x16x32_bf16 a[0:3], v[68:71], v[96:99], a[0:3]
    v_mfma_f32_16x16x32_bf16 a[4:7], v[68:71], v[100:103], a[4:7]
    v_mfma_f32_16x16x32_bf16 a[8:11], v[72:75], v[96:99], a[8:11]
    v_mfma_f32_16x16x32_bf16 a[12:15], v[72:75], v[100:103], a[12:15]
    v_mfma_f32_16x16x32_bf16 a[16:19], v[76:79], v[96:99], a[16:19]
    v_mfma_f32_16x16x32_bf16 a[20:23], v[76:79], v[100:103], a[20:23]
    v_mfma_f32_16x16x32_bf16 a[24:27], v[80:83], v[96:99], a[24:27]
    v_mfma_f32_16x16x32_bf16 a[28:31], v[80:83], v[100:103], a[28:31]
    v_mfma_f32_16x16x32_bf16 a[32:35], v[84:87], v[96:99], a[32:35]
    v_mfma_f32_16x16x32_bf16 a[36:39], v[84:87], v[100:103], a[36:39]
    v_mfma_f32_16x16x32_bf16 a[40:43], v[88:91], v[96:99], a[40:43]
    v_mfma_f32_16x16x32_bf16 a[44:47], v[88:91], v[100:103], a[44:47]
    v_mfma_f32_16x16x32_bf16 a[48:51], v[92:95], v[96:99], a[48:51]
    v_mfma_f32_16x16x32_bf16 a[52:55], v[92:95], v[100:103], a[52:55]
    s_add_u32 s6, s31, 13312
    buffer_load_dwordx4 v[68:71], v26, s[8:11], s6 offen sc1
    s_add_u32 s6, s31, 29696
    buffer_load_dwordx4 v[72:75], v26, s[8:11], s6 offen sc1
    s_add_u32 s6, s31, 46080
    buffer_load_dwordx4 v[76:79], v26, s[8:11], s6 offen sc1
    s_add_u32 s6, s31, 62464
    buffer_load_dwordx4 v[80:83], v26, s[8:11], s6 offen sc1
    s_add_u32 s6, s31, 78848
    buffer_load_dwordx4 v[84:87], v26, s[8:11], s6 offen sc1
    s_add_u32 s6, s31, 95232
    buffer_load_dwordx4 v[88:91], v26, s[8:11], s6 offen sc1
    s_add_u32 s6, s31, 111616
    buffer_load_dwordx4 v[92:95], v26, s[8:11], s6 offen sc1
    ds_read_b128 v[96:99], v30 offset:39936
    ds_read_b128 v[100:103], v30 offset:41472
    s_waitcnt vmcnt(7) lgkmcnt(2)
    v_mfma_f32_16x16x32_bf16 a[0:3], v[32:35], v[60:63], a[0:3]
    v_mfma_f32_16x16x32_bf16 a[4:7], v[32:35], v[64:67], a[4:7]
    v_mfma_f32_16x16x32_bf16 a[8:11], v[36:39], v[60:63], a[8:11]
    v_mfma_f32_16x16x32_bf16 a[12:15], v[36:39], v[64:67], a[12:15]
    v_mfma_f32_16x16x32_bf16 a[16:19], v[40:43], v[60:63], a[16:19]
    v_mfma_f32_16x16x32_bf16 a[20:23], v[40:43], v[64:67], a[20:23]
    v_mfma_f32_16x16x32_bf16 a[24:27], v[44:47], v[60:63], a[24:27]
    v_mfma_f32_16x16x32_bf16 a[28:31], v[44:47], v[64:67], a[28:31]
    v_mfma_f32_16x16x32_bf16 a[32:35], v[48:51], v[60:63], a[32:35]
    v_mfma_f32_16x16x32_bf16 a[36:39], v[48:51], v[64:67], a[36:39]
    v_mfma_f32_16x16x32_bf16 a[40:43], v[52:55], v[60:63], a[40:43]
    v_mfma_f32_16x16x32_bf16 a[44:47], v[52:55], v[64:67], a[44:47]
    v_mfma_f32_16x16x32_bf16 a[48:51], v[56:59], v[60:63], a[48:51]
    v_mfma_f32_16x16x32_bf16 a[52:55], v[56:59], v[64:67], a[52:55]
    s_add_u32 s6, s31, 14336
    buffer_load_dwordx4 v[32:35], v26, s[8:11], s6 offen sc1
    s_add_u32 s6, s31, 30720
    buffer_load_dwordx4 v[36:39], v26, s[8:11], s6 offen sc1
    s_add_u32 s6, s31, 47104
    buffer_load_dwordx4 v[40:43], v26, s[8:11], s6 offen sc1
    s_add_u32 s6, s31, 63488
    buffer_load_dwordx4 v[44:47], v26, s[8:11], s6 offen sc1
    s_add_u32 s6, s31, 79872
    buffer_load_dwordx4 v[48:51], v26, s[8:11], s6 offen sc1
    s_add_u32 s6, s31, 96256
    buffer_load_dwordx4 v[52:55], v26, s[8:11], s6 offen sc1
    s_add_u32 s6, s31, 112640
    buffer_load_dwordx4 v[56:59], v26, s[8:11], s6 offen sc1
    ds_read_b128 v[60:63], v30 offset:43008
    ds_read_b128 v[64:67], v30 offset:44544
    s_waitcnt vmcnt(7) lgkmcnt(2)
    v_mfma_f32_16x16x32_bf16 a[0:3], v[68:71], v[96:99], a[0:3]
    v_mfma_f32_16x16x32_bf16 a[4:7], v[68:71], v[100:103], a[4:7]
    v_mfma_f32_16x16x32_bf16 a[8:11], v[72:75], v[96:99], a[8:11]
    v_mfma_f32_16x16x32_bf16 a[12:15], v[72:75], v[100:103], a[12:15]
    v_mfma_f32_16x16x32_bf16 a[16:19], v[76:79], v[96:99], a[16:19]
    v_mfma_f32_16x16x32_bf16 a[20:23], v[76:79], v[100:103], a[20:23]
    v_mfma_f32_16x16x32_bf16 a[24:27], v[80:83], v[96:99], a[24:27]
    v_mfma_f32_16x16x32_bf16 a[28:31], v[80:83], v[100:103], a[28:31]
    v_mfma_f32_16x16x32_bf16 a[32:35], v[84:87], v[96:99], a[32:35]
    v_mfma_f32_16x16x32_bf16 a[36:39], v[84:87], v[100:103], a[36:39]
    v_mfma_f32_16x16x32_bf16 a[40:43], v[88:91], v[96:99], a[40:43]
    v_mfma_f32_16x16x32_bf16 a[44:47], v[88:91], v[100:103], a[44:47]
    v_mfma_f32_16x16x32_bf16 a[48:51], v[92:95], v[96:99], a[48:51]
    v_mfma_f32_16x16x32_bf16 a[52:55], v[92:95], v[100:103], a[52:55]
    s_add_u32 s6, s31, 15360
    buffer_load_dwordx4 v[68:71], v26, s[8:11], s6 offen sc1
    s_add_u32 s6, s31, 31744
    buffer_load_dwordx4 v[72:75], v26, s[8:11], s6 offen sc1
    s_add_u32 s6, s31, 48128
    buffer_load_dwordx4 v[76:79], v26, s[8:11], s6 offen sc1
    s_add_u32 s6, s31, 64512
    buffer_load_dwordx4 v[80:83], v26, s[8:11], s6 offen sc1
    s_add_u32 s6, s31, 80896
    buffer_load_dwordx4 v[84:87], v26, s[8:11], s6 offen sc1
    s_add_u32 s6, s31, 97280
    buffer_load_dwordx4 v[88:91], v26, s[8:11], s6 offen sc1
    s_add_u32 s6, s31, 113664
    buffer_load_dwordx4 v[92:95], v26, s[8:11], s6 offen sc1
    ds_read_b128 v[96:99], v30 offset:46080
    ds_read_b128 v[100:103], v30 offset:47616
    s_waitcnt vmcnt(7) lgkmcnt(2)
    v_mfma_f32_16x16x32_bf16 a[0:3], v[32:35], v[60:63], a[0:3]
    v_mfma_f32_16x16x32_bf16 a[4:7], v[32:35], v[64:67], a[4:7]
    v_mfma_f32_16x16x32_bf16 a[8:11], v[36:39], v[60:63], a[8:11]
    v_mfma_f32_16x16x32_bf16 a[12:15], v[36:39], v[64:67], a[12:15]
    v_mfma_f32_16x16x32_bf16 a[16:19], v[40:43], v[60:63], a[16:19]
    v_mfma_f32_16x16x32_bf16 a[20:23], v[40:43], v[64:67], a[20:23]
    v_mfma_f32_16x16x32_bf16 a[24:27], v[44:47], v[60:63], a[24:27]
    v_mfma_f32_16x16x32_bf16 a[28:31], v[44:47], v[64:67], a[28:31]
    v_mfma_f32_16x16x32_bf16 a[32:35], v[48:51], v[60:63], a[32:35]
    v_mfma_f32_16x16x32_bf16 a[36:39], v[48:51], v[64:67], a[36:39]
    v_mfma_f32_16x16x32_bf16 a[40:43], v[52:55], v[60:63], a[40:43]
    v_mfma_f32_16x16x32_bf16 a[44:47], v[52:55], v[64:67], a[44:47]
    v_mfma_f32_16x16x32_bf16 a[48:51], v[56:59], v[60:63], a[48:51]
    v_mfma_f32_16x16x32_bf16 a[52:55], v[56:59], v[64:67], a[52:55]
    s_add_u32 s6, s32, 0
    buffer_load_dwordx4 v[32:35], v27, s[8:11], s6 offen sc1
    s_add_u32 s6, s32, 4096
    buffer_load_dwordx4 v[36:39], v27, s[8:11], s6 offen sc1
    s_add_u32 s6, s32, 8192
    buffer_load_dwordx4 v[40:43], v27, s[8:11], s6 offen sc1
    s_add_u32 s6, s32, 12288
    buffer_load_dwordx4 v[44:47], v27, s[8:11], s6 offen sc1
    s_add_u32 s6, s32, 16384
    buffer_load_dwordx4 v[48:51], v27, s[8:11], s6 offen sc1
    s_add_u32 s6, s32, 20480
    buffer_load_dwordx4 v[52:55], v27, s[8:11], s6 offen sc1
    s_add_u32 s6, s32, 24576
    buffer_load_dwordx4 v[56:59], v27, s[8:11], s6 offen sc1
    ds_read_b128 v[60:63], v31 offset:0
    ds_read_b128 v[64:67], v31 offset:1536
    s_waitcnt vmcnt(7) lgkmcnt(2)
    v_mfma_f32_16x16x32_bf16 a[0:3], v[68:71], v[96:99], a[0:3]
    v_mfma_f32_16x16x32_bf16 a[4:7], v[68:71], v[100:103], a[4:7]
    v_mfma_f32_16x16x32_bf16 a[8:11], v[72:75], v[96:99], a[8:11]
    v_mfma_f32_16x16x32_bf16 a[12:15], v[72:75], v[100:103], a[12:15]
    v_mfma_f32_16x16x32_bf16 a[16:19], v[76:79], v[96:99], a[16:19]
    v_mfma_f32_16x16x32_bf16 a[20:23], v[76:79], v[100:103], a[20:23]
    v_mfma_f32_16x16x32_bf16 a[24:27], v[80:83], v[96:99], a[24:27]
    v_mfma_f32_16x16x32_bf16 a[28:31], v[80:83], v[100:103], a[28:31]
    v_mfma_f32_16x16x32_bf16 a[32:35], v[84:87], v[96:99], a[32:35]
    v_mfma_f32_16x16x32_bf16 a[36:39], v[84:87], v[100:103], a[36:39]
    v_mfma_f32_16x16x32_bf16 a[40:43], v[88:91], v[96:99], a[40:43]
    v_mfma_f32_16x16x32_bf16 a[44:47], v[88:91], v[100:103], a[44:47]
    v_mfma_f32_16x16x32_bf16 a[48:51], v[92:95], v[96:99], a[48:51]
    v_mfma_f32_16x16x32_bf16 a[52:55], v[92:95], v[100:103], a[52:55]
    s_add_u32 s6, s32, 1024
    buffer_load_dwordx4 v[68:71], v27, s[8:11], s6 offen sc1
    s_add_u32 s6, s32, 5120
    buffer_load_dwordx4 v[72:75], v27, s[8:11], s6 offen sc1
    s_add_u32 s6, s32, 9216
    buffer_load_dwordx4 v[76:79], v27, s[8:11], s6 offen sc1
    s_add_u32 s6, s32, 13312
    buffer_load_dwordx4 v[80:83], v27, s[8:11], s6 offen sc1
    s_add_u32 s6, s32, 17408
    buffer_load_dwordx4 v[84:87], v27, s[8:11], s6 offen sc1
    s_add_u32 s6, s32, 21504
    buffer_load_dwordx4 v[88:91], v27, s[8:11], s6 offen sc1
    s_add_u32 s6, s32, 25600
    buffer_load_dwordx4 v[92:95], v27, s[8:11], s6 offen sc1
    ds_read_b128 v[96:99], v31 offset:12288
    ds_read_b128 v[100:103], v31 offset:13824
    s_waitcnt vmcnt(7) lgkmcnt(2)
    v_mfma_f32_16x16x32_bf16 a[0:3], v[32:35], v[60:63], a[0:3]
    v_mfma_f32_16x16x32_bf16 a[4:7], v[32:35], v[64:67], a[4:7]
    v_mfma_f32_16x16x32_bf16 a[8:11], v[36:39], v[60:63], a[8:11]
    v_mfma_f32_16x16x32_bf16 a[12:15], v[36:39], v[64:67], a[12:15]
    v_mfma_f32_16x16x32_bf16 a[16:19], v[40:43], v[60:63], a[16:19]
    v_mfma_f32_16x16x32_bf16 a[20:23], v[40:43], v[64:67], a[20:23]
    v_mfma_f32_16x16x32_bf16 a[24:27], v[44:47], v[60:63], a[24:27]
    v_mfma_f32_16x16x32_bf16 a[28:31], v[44:47], v[64:67], a[28:31]
    v_mfma_f32_16x16x32_bf16 a[32:35], v[48:51], v[60:63], a[32:35]
    v_mfma_f32_16x16x32_bf16 a[36:39], v[48:51], v[64:67], a[36:39]
    v_mfma_f32_16x16x32_bf16 a[40:43], v[52:55], v[60:63], a[40:43]
    v_mfma_f32_16x16x32_bf16 a[44:47], v[52:55], v[64:67], a[44:47]
    v_mfma_f32_16x16x32_bf16 a[48:51], v[56:59], v[60:63], a[48:51]
    v_mfma_f32_16x16x32_bf16 a[52:55], v[56:59], v[64:67], a[52:55]
    s_add_u32 s6, s32, 2048
    buffer_load_dwordx4 v[32:35], v27, s[8:11], s6 offen sc1
    s_add_u32 s6, s32, 6144
    buffer_load_dwordx4 v[36:39], v27, s[8:11], s6 offen sc1
    s_add_u32 s6, s32, 10240
    buffer_load_dwordx4 v[40:43], v27, s[8:11], s6 offen sc1
    s_add_u32 s6, s32, 14336
    buffer_load_dwordx4 v[44:47], v27, s[8:11], s6 offen sc1
    s_add_u32 s6, s32, 18432
    buffer_load_dwordx4 v[48:51], v27, s[8:11], s6 offen sc1
    s_add_u32 s6, s32, 22528
    buffer_load_dwordx4 v[52:55], v27, s[8:11], s6 offen sc1
    s_add_u32 s6, s32, 26624
    buffer_load_dwordx4 v[56:59], v27, s[8:11], s6 offen sc1
    ds_read_b128 v[60:63], v31 offset:24576
    ds_read_b128 v[64:67], v31 offset:26112
    s_waitcnt vmcnt(7) lgkmcnt(2)
    v_mfma_f32_16x16x32_bf16 a[0:3], v[68:71], v[96:99], a[0:3]
    v_mfma_f32_16x16x32_bf16 a[4:7], v[68:71], v[100:103], a[4:7]
    v_mfma_f32_16x16x32_bf16 a[8:11], v[72:75], v[96:99], a[8:11]
    v_mfma_f32_16x16x32_bf16 a[12:15], v[72:75], v[100:103], a[12:15]
    v_mfma_f32_16x16x32_bf16 a[16:19], v[76:79], v[96:99], a[16:19]
    v_mfma_f32_16x16x32_bf16 a[20:23], v[76:79], v[100:103], a[20:23]
    v_mfma_f32_16x16x32_bf16 a[24:27], v[80:83], v[96:99], a[24:27]
    v_mfma_f32_16x16x32_bf16 a[28:31], v[80:83], v[100:103], a[28:31]
    v_mfma_f32_16x16x32_bf16 a[32:35], v[84:87], v[96:99], a[32:35]
    v_mfma_f32_16x16x32_bf16 a[36:39], v[84:87], v[100:103], a[36:39]
    v_mfma_f32_16x16x32_bf16 a[40:43], v[88:91], v[96:99], a[40:43]
    v_mfma_f32_16x16x32_bf16 a[44:47], v[88:91], v[100:103], a[44:47]
    v_mfma_f32_16x16x32_bf16 a[48:51], v[92:95], v[96:99], a[48:51]
    v_mfma_f32_16x16x32_bf16 a[52:55], v[92:95], v[100:103], a[52:55]
    s_add_u32 s6, s32, 3072
    buffer_load_dwordx4 v[68:71], v27, s[8:11], s6 offen sc1
    s_add_u32 s6, s32, 7168
    buffer_load_dwordx4 v[72:75], v27, s[8:11], s6 offen sc1
    s_add_u32 s6, s32, 11264
    buffer_load_dwordx4 v[76:79], v27, s[8:11], s6 offen sc1
    s_add_u32 s6, s32, 15360
    buffer_load_dwordx4 v[80:83], v27, s[8:11], s6 offen sc1
    s_add_u32 s6, s32, 19456
    buffer_load_dwordx4 v[84:87], v27, s[8:11], s6 offen sc1
    s_add_u32 s6, s32, 23552
    buffer_load_dwordx4 v[88:91], v27, s[8:11], s6 offen sc1
    s_add_u32 s6, s32, 27648
    buffer_load_dwordx4 v[92:95], v27, s[8:11], s6 offen sc1
    ds_read_b128 v[96:99], v31 offset:36864
    ds_read_b128 v[100:103], v31 offset:38400
    s_waitcnt vmcnt(7) lgkmcnt(2)
    v_mfma_f32_16x16x32_bf16 a[0:3], v[32:35], v[60:63], a[0:3]
    v_mfma_f32_16x16x32_bf16 a[4:7], v[32:35], v[64:67], a[4:7]
    v_mfma_f32_16x16x32_bf16 a[8:11], v[36:39], v[60:63], a[8:11]
    v_mfma_f32_16x16x32_bf16 a[12:15], v[36:39], v[64:67], a[12:15]
    v_mfma_f32_16x16x32_bf16 a[16:19], v[40:43], v[60:63], a[16:19]
    v_mfma_f32_16x16x32_bf16 a[20:23], v[40:43], v[64:67], a[20:23]
    v_mfma_f32_16x16x32_bf16 a[24:27], v[44:47], v[60:63], a[24:27]
    v_mfma_f32_16x16x32_bf16 a[28:31], v[44:47], v[64:67], a[28:31]
    v_mfma_f32_16x16x32_bf16 a[32:35], v[48:51], v[60:63], a[32:35]
    v_mfma_f32_16x16x32_bf16 a[36:39], v[48:51], v[64:67], a[36:39]
    v_mfma_f32_16x16x32_bf16 a[40:43], v[52:55], v[60:63], a[40:43]
    v_mfma_f32_16x16x32_bf16 a[44:47], v[52:55], v[64:67], a[44:47]
    v_mfma_f32_16x16x32_bf16 a[48:51], v[56:59], v[60:63], a[48:51]
    v_mfma_f32_16x16x32_bf16 a[52:55], v[56:59], v[64:67], a[52:55]
    s_waitcnt vmcnt(0) lgkmcnt(0)
    v_mfma_f32_16x16x32_bf16 a[0:3], v[68:71], v[96:99], a[0:3]
    v_mfma_f32_16x16x32_bf16 a[4:7], v[68:71], v[100:103], a[4:7]
    v_mfma_f32_16x16x32_bf16 a[8:11], v[72:75], v[96:99], a[8:11]
    v_mfma_f32_16x16x32_bf16 a[12:15], v[72:75], v[100:103], a[12:15]
    v_mfma_f32_16x16x32_bf16 a[16:19], v[76:79], v[96:99], a[16:19]
    v_mfma_f32_16x16x32_bf16 a[20:23], v[76:79], v[100:103], a[20:23]
    v_mfma_f32_16x16x32_bf16 a[24:27], v[80:83], v[96:99], a[24:27]
    v_mfma_f32_16x16x32_bf16 a[28:31], v[80:83], v[100:103], a[28:31]
    v_mfma_f32_16x16x32_bf16 a[32:35], v[84:87], v[96:99], a[32:35]
    v_mfma_f32_16x16x32_bf16 a[36:39], v[84:87], v[100:103], a[36:39]
    v_mfma_f32_16x16x32_bf16 a[40:43], v[88:91], v[96:99], a[40:43]
    v_mfma_f32_16x16x32_bf16 a[44:47], v[88:91], v[100:103], a[44:47]
    v_mfma_f32_16x16x32_bf16 a[48:51], v[92:95], v[96:99], a[48:51]
    v_mfma_f32_16x16x32_bf16 a[52:55], v[92:95], v[100:103], a[52:55]
    s_nop 7
    s_nop 7
    s_mul_i32 s6, s4, 224
    v_lshlrev_b32 v24, 3, v117
    v_add_u32 v24, s6, v24
    s_lshl_b32 s6, s2, 5
    v_add_u32 v23, s6, v116
    v_mul_u32_u24 v23, 896, v23
    v_add_u32 v23, v23, v24
    buffer_load_dwordx2 v[32:33], v24, s[16:19], 0 offen offset:0
    s_mov_b32 s6, 0
    buffer_load_dwordx2 v[34:35], v23, s[12:15], s6 offen
    s_waitcnt vmcnt(0)
    v_lshlrev_b32 v40, 16, v32
    v_lshlrev_b32 v41, 16, v34
    v_accvgpr_read_b32 v42, a0
    v_accvgpr_read_b32 v43, a168
    v_cvt_pk_bf16_f32 v42, v42, v42
    v_lshlrev_b32 v42, 16, v42
    v_cvt_pk_bf16_f32 v43, v43, v43
    v_lshlrev_b32 v43, 16, v43
    v_add_f32 v43, v43, v40
    v_cvt_pk_bf16_f32 v43, v43, v43
    v_lshlrev_b32 v43, 16, v43
    v_add_f32 v42, v42, v41
    v_cvt_pk_bf16_f32 v42, v42, v42
    v_lshlrev_b32 v42, 16, v42
    v_add_f32 v44, v42, v43
    v_and_b32 v40, 0xffff0000, v32
    v_and_b32 v41, 0xffff0000, v34
    v_accvgpr_read_b32 v42, a1
    v_accvgpr_read_b32 v43, a169
    v_cvt_pk_bf16_f32 v42, v42, v42
    v_lshlrev_b32 v42, 16, v42
    v_cvt_pk_bf16_f32 v43, v43, v43
    v_lshlrev_b32 v43, 16, v43
    v_add_f32 v43, v43, v40
    v_cvt_pk_bf16_f32 v43, v43, v43
    v_lshlrev_b32 v43, 16, v43
    v_add_f32 v42, v42, v41
    v_cvt_pk_bf16_f32 v42, v42, v42
    v_lshlrev_b32 v42, 16, v42
    v_add_f32 v45, v42, v43
    v_lshlrev_b32 v40, 16, v33
    v_lshlrev_b32 v41, 16, v35
    v_accvgpr_read_b32 v42, a2
    v_accvgpr_read_b32 v43, a170
    v_cvt_pk_bf16_f32 v42, v42, v42
    v_lshlrev_b32 v42, 16, v42
    v_cvt_pk_bf16_f32 v43, v43, v43
    v_lshlrev_b32 v43, 16, v43
    v_add_f32 v43, v43, v40
    v_cvt_pk_bf16_f32 v43, v43, v43
    v_lshlrev_b32 v43, 16, v43
    v_add_f32 v42, v42, v41
    v_cvt_pk_bf16_f32 v42, v42, v42
    v_lshlrev_b32 v42, 16, v42
    v_add_f32 v46, v42, v43
    v_and_b32 v40, 0xffff0000, v33
    v_and_b32 v41, 0xffff0000, v35
    v_accvgpr_read_b32 v42, a3
    v_accvgpr_read_b32 v43, a171
    v_cvt_pk_bf16_f32 v42, v42, v42
    v_lshlrev_b32 v42, 16, v42
    v_cvt_pk_bf16_f32 v43, v43, v43
    v_lshlrev_b32 v43, 16, v43
    v_add_f32 v43, v43, v40
    v_cvt_pk_bf16_f32 v43, v43, v43
    v_lshlrev_b32 v43, 16, v43
    v_add_f32 v42, v42, v41
    v_cvt_pk_bf16_f32 v42, v42, v42
    v_lshlrev_b32 v42, 16, v42
    v_add_f32 v47, v42, v43
    v_cvt_pk_bf16_f32 v48, v44, v45
    v_cvt_pk_bf16_f32 v49, v46, v47
    buffer_store_dwordx2 v[48:49], v23, s[24:27], s6 offen
    s_nop 1
    s_mov_b32 s6, 14336
    buffer_load_dwordx2 v[34:35], v23, s[12:15], s6 offen
    s_waitcnt vmcnt(0)
    v_lshlrev_b32 v40, 16, v32
    v_lshlrev_b32 v41, 16, v34
    v_accvgpr_read_b32 v42, a4
    v_accvgpr_read_b32 v43, a172
    v_cvt_pk_bf16_f32 v42, v42, v42
    v_lshlrev_b32 v42, 16, v42
    v_cvt_pk_bf16_f32 v43, v43, v43
    v_lshlrev_b32 v43, 16, v43
    v_add_f32 v43, v43, v40
    v_cvt_pk_bf16_f32 v43, v43, v43
    v_lshlrev_b32 v43, 16, v43
    v_add_f32 v42, v42, v41
    v_cvt_pk_bf16_f32 v42, v42, v42
    v_lshlrev_b32 v42, 16, v42
    v_add_f32 v44, v42, v43
    v_and_b32 v40, 0xffff0000, v32
    v_and_b32 v41, 0xffff0000, v34
    v_accvgpr_read_b32 v42, a5
    v_accvgpr_read_b32 v43, a173
    v_cvt_pk_bf16_f32 v42, v42, v42
    v_lshlrev_b32 v42, 16, v42
    v_cvt_pk_bf16_f32 v43, v43, v43
    v_lshlrev_b32 v43, 16, v43
    v_add_f32 v43, v43, v40
    v_cvt_pk_bf16_f32 v43, v43, v43
    v_lshlrev_b32 v43, 16, v43
    v_add_f32 v42, v42, v41
    v_cvt_pk_bf16_f32 v42, v42, v42
    v_lshlrev_b32 v42, 16, v42
    v_add_f32 v45, v42, v43
    v_lshlrev_b32 v40, 16, v33
    v_lshlrev_b32 v41, 16, v35
    v_accvgpr_read_b32 v42, a6
    v_accvgpr_read_b32 v43, a174
    v_cvt_pk_bf16_f32 v42, v42, v42
    v_lshlrev_b32 v42, 16, v42
    v_cvt_pk_bf16_f32 v43, v43, v43
    v_lshlrev_b32 v43, 16, v43
    v_add_f32 v43, v43, v40
    v_cvt_pk_bf16_f32 v43, v43, v43
    v_lshlrev_b32 v43, 16, v43
    v_add_f32 v42, v42, v41
    v_cvt_pk_bf16_f32 v42, v42, v42
    v_lshlrev_b32 v42, 16, v42
    v_add_f32 v46, v42, v43
    v_and_b32 v40, 0xffff0000, v33
    v_and_b32 v41, 0xffff0000, v35
    v_accvgpr_read_b32 v42, a7
    v_accvgpr_read_b32 v43, a175
    v_cvt_pk_bf16_f32 v42, v42, v42
    v_lshlrev_b32 v42, 16, v42
    v_cvt_pk_bf16_f32 v43, v43, v43
    v_lshlrev_b32 v43, 16, v43
    v_add_f32 v43, v43, v40
    v_cvt_pk_bf16_f32 v43, v43, v43
    v_lshlrev_b32 v43, 16, v43
    v_add_f32 v42, v42, v41
    v_cvt_pk_bf16_f32 v42, v42, v42
    v_lshlrev_b32 v42, 16, v42
    v_add_f32 v47, v42, v43
    v_cvt_pk_bf16_f32 v48, v44, v45
    v_cvt_pk_bf16_f32 v49, v46, v47
    buffer_store_dwordx2 v[48:49], v23, s[24:27], s6 offen
    s_nop 1
    buffer_load_dwordx2 v[32:33], v24, s[16:19], 0 offen offset:32
    s_mov_b32 s6, 32
    buffer_load_dwordx2 v[34:35], v23, s[12:15], s6 offen
    s_waitcnt vmcnt(0)
    v_lshlrev_b32 v40, 16, v32
    v_lshlrev_b32 v41, 16, v34
    v_accvgpr_read_b32 v42, a8
    v_accvgpr_read_b32 v43, a176
    v_cvt_pk_bf16_f32 v42, v42, v42
    v_lshlrev_b32 v42, 16, v42
    v_cvt_pk_bf16_f32 v43, v43, v43
    v_lshlrev_b32 v43, 16, v43
    v_add_f32 v43, v43, v40
    v_cvt_pk_bf16_f32 v43, v43, v43
    v_lshlrev_b32 v43, 16, v43
    v_add_f32 v42, v42, v41
    v_cvt_pk_bf16_f32 v42, v42, v42
    v_lshlrev_b32 v42, 16, v42
    v_add_f32 v44, v42, v43
    v_and_b32 v40, 0xffff0000, v32
    v_and_b32 v41, 0xffff0000, v34
    v_accvgpr_read_b32 v42, a9
    v_accvgpr_read_b32 v43, a177
    v_cvt_pk_bf16_f32 v42, v42, v42
    v_lshlrev_b32 v42, 16, v42
    v_cvt_pk_bf16_f32 v43, v43, v43
    v_lshlrev_b32 v43, 16, v43
    v_add_f32 v43, v43, v40
    v_cvt_pk_bf16_f32 v43, v43, v43
    v_lshlrev_b32 v43, 16, v43
    v_add_f32 v42, v42, v41
    v_cvt_pk_bf16_f32 v42, v42, v42
    v_lshlrev_b32 v42, 16, v42
    v_add_f32 v45, v42, v43
    v_lshlrev_b32 v40, 16, v33
    v_lshlrev_b32 v41, 16, v35
    v_accvgpr_read_b32 v42, a10
    v_accvgpr_read_b32 v43, a178
    v_cvt_pk_bf16_f32 v42, v42, v42
    v_lshlrev_b32 v42, 16, v42
    v_cvt_pk_bf16_f32 v43, v43, v43
    v_lshlrev_b32 v43, 16, v43
    v_add_f32 v43, v43, v40
    v_cvt_pk_bf16_f32 v43, v43, v43
    v_lshlrev_b32 v43, 16, v43
    v_add_f32 v42, v42, v41
    v_cvt_pk_bf16_f32 v42, v42, v42
    v_lshlrev_b32 v42, 16, v42
    v_add_f32 v46, v42, v43
    v_and_b32 v40, 0xffff0000, v33
    v_and_b32 v41, 0xffff0000, v35
    v_accvgpr_read_b32 v42, a11
    v_accvgpr_read_b32 v43, a179
    v_cvt_pk_bf16_f32 v42, v42, v42
    v_lshlrev_b32 v42, 16, v42
    v_cvt_pk_bf16_f32 v43, v43, v43
    v_lshlrev_b32 v43, 16, v43
    v_add_f32 v43, v43, v40
    v_cvt_pk_bf16_f32 v43, v43, v43
    v_lshlrev_b32 v43, 16, v43
    v_add_f32 v42, v42, v41
    v_cvt_pk_bf16_f32 v42, v42, v42
    v_lshlrev_b32 v42, 16, v42
    v_add_f32 v47, v42, v43
    v_cvt_pk_bf16_f32 v48, v44, v45
    v_cvt_pk_bf16_f32 v49, v46, v47
    buffer_store_dwordx2 v[48:49], v23, s[24:27], s6 offen
    s_nop 1
    s_mov_b32 s6, 14368
    buffer_load_dwordx2 v[34:35], v23, s[12:15], s6 offen
    s_waitcnt vmcnt(0)
    v_lshlrev_b32 v40, 16, v32
    v_lshlrev_b32 v41, 16, v34
    v_accvgpr_read_b32 v42, a12
    v_accvgpr_read_b32 v43, a180
    v_cvt_pk_bf16_f32 v42, v42, v42
    v_lshlrev_b32 v42, 16, v42
    v_cvt_pk_bf16_f32 v43, v43, v43
    v_lshlrev_b32 v43, 16, v43
    v_add_f32 v43, v43, v40
    v_cvt_pk_bf16_f32 v43, v43, v43
    v_lshlrev_b32 v43, 16, v43
    v_add_f32 v42, v42, v41
    v_cvt_pk_bf16_f32 v42, v42, v42
    v_lshlrev_b32 v42, 16, v42
    v_add_f32 v44, v42, v43
    v_and_b32 v40, 0xffff0000, v32
    v_and_b32 v41, 0xffff0000, v34
    v_accvgpr_read_b32 v42, a13
    v_accvgpr_read_b32 v43, a181
    v_cvt_pk_bf16_f32 v42, v42, v42
    v_lshlrev_b32 v42, 16, v42
    v_cvt_pk_bf16_f32 v43, v43, v43
    v_lshlrev_b32 v43, 16, v43
    v_add_f32 v43, v43, v40
    v_cvt_pk_bf16_f32 v43, v43, v43
    v_lshlrev_b32 v43, 16, v43
    v_add_f32 v42, v42, v41
    v_cvt_pk_bf16_f32 v42, v42, v42
    v_lshlrev_b32 v42, 16, v42
    v_add_f32 v45, v42, v43
    v_lshlrev_b32 v40, 16, v33
    v_lshlrev_b32 v41, 16, v35
    v_accvgpr_read_b32 v42, a14
    v_accvgpr_read_b32 v43, a182
    v_cvt_pk_bf16_f32 v42, v42, v42
    v_lshlrev_b32 v42, 16, v42
    v_cvt_pk_bf16_f32 v43, v43, v43
    v_lshlrev_b32 v43, 16, v43
    v_add_f32 v43, v43, v40
    v_cvt_pk_bf16_f32 v43, v43, v43
    v_lshlrev_b32 v43, 16, v43
    v_add_f32 v42, v42, v41
    v_cvt_pk_bf16_f32 v42, v42, v42
    v_lshlrev_b32 v42, 16, v42
    v_add_f32 v46, v42, v43
    v_and_b32 v40, 0xffff0000, v33
    v_and_b32 v41, 0xffff0000, v35
    v_accvgpr_read_b32 v42, a15
    v_accvgpr_read_b32 v43, a183
    v_cvt_pk_bf16_f32 v42, v42, v42
    v_lshlrev_b32 v42, 16, v42
    v_cvt_pk_bf16_f32 v43, v43, v43
    v_lshlrev_b32 v43, 16, v43
    v_add_f32 v43, v43, v40
    v_cvt_pk_bf16_f32 v43, v43, v43
    v_lshlrev_b32 v43, 16, v43
    v_add_f32 v42, v42, v41
    v_cvt_pk_bf16_f32 v42, v42, v42
    v_lshlrev_b32 v42, 16, v42
    v_add_f32 v47, v42, v43
    v_cvt_pk_bf16_f32 v48, v44, v45
    v_cvt_pk_bf16_f32 v49, v46, v47
    buffer_store_dwordx2 v[48:49], v23, s[24:27], s6 offen
    s_nop 1
    buffer_load_dwordx2 v[32:33], v24, s[16:19], 0 offen offset:64
    s_mov_b32 s6, 64
    buffer_load_dwordx2 v[34:35], v23, s[12:15], s6 offen
    s_waitcnt vmcnt(0)
    v_lshlrev_b32 v40, 16, v32
    v_lshlrev_b32 v41, 16, v34
    v_accvgpr_read_b32 v42, a16
    v_accvgpr_read_b32 v43, a184
    v_cvt_pk_bf16_f32 v42, v42, v42
    v_lshlrev_b32 v42, 16, v42
    v_cvt_pk_bf16_f32 v43, v43, v43
    v_lshlrev_b32 v43, 16, v43
    v_add_f32 v43, v43, v40
    v_cvt_pk_bf16_f32 v43, v43, v43
    v_lshlrev_b32 v43, 16, v43
    v_add_f32 v42, v42, v41
    v_cvt_pk_bf16_f32 v42, v42, v42
    v_lshlrev_b32 v42, 16, v42
    v_add_f32 v44, v42, v43
    v_and_b32 v40, 0xffff0000, v32
    v_and_b32 v41, 0xffff0000, v34
    v_accvgpr_read_b32 v42, a17
    v_accvgpr_read_b32 v43, a185
    v_cvt_pk_bf16_f32 v42, v42, v42
    v_lshlrev_b32 v42, 16, v42
    v_cvt_pk_bf16_f32 v43, v43, v43
    v_lshlrev_b32 v43, 16, v43
    v_add_f32 v43, v43, v40
    v_cvt_pk_bf16_f32 v43, v43, v43
    v_lshlrev_b32 v43, 16, v43
    v_add_f32 v42, v42, v41
    v_cvt_pk_bf16_f32 v42, v42, v42
    v_lshlrev_b32 v42, 16, v42
    v_add_f32 v45, v42, v43
    v_lshlrev_b32 v40, 16, v33
    v_lshlrev_b32 v41, 16, v35
    v_accvgpr_read_b32 v42, a18
    v_accvgpr_read_b32 v43, a186
    v_cvt_pk_bf16_f32 v42, v42, v42
    v_lshlrev_b32 v42, 16, v42
    v_cvt_pk_bf16_f32 v43, v43, v43
    v_lshlrev_b32 v43, 16, v43
    v_add_f32 v43, v43, v40
    v_cvt_pk_bf16_f32 v43, v43, v43
    v_lshlrev_b32 v43, 16, v43
    v_add_f32 v42, v42, v41
    v_cvt_pk_bf16_f32 v42, v42, v42
    v_lshlrev_b32 v42, 16, v42
    v_add_f32 v46, v42, v43
    v_and_b32 v40, 0xffff0000, v33
    v_and_b32 v41, 0xffff0000, v35
    v_accvgpr_read_b32 v42, a19
    v_accvgpr_read_b32 v43, a187
    v_cvt_pk_bf16_f32 v42, v42, v42
    v_lshlrev_b32 v42, 16, v42
    v_cvt_pk_bf16_f32 v43, v43, v43
    v_lshlrev_b32 v43, 16, v43
    v_add_f32 v43, v43, v40
    v_cvt_pk_bf16_f32 v43, v43, v43
    v_lshlrev_b32 v43, 16, v43
    v_add_f32 v42, v42, v41
    v_cvt_pk_bf16_f32 v42, v42, v42
    v_lshlrev_b32 v42, 16, v42
    v_add_f32 v47, v42, v43
    v_cvt_pk_bf16_f32 v48, v44, v45
    v_cvt_pk_bf16_f32 v49, v46, v47
    buffer_store_dwordx2 v[48:49], v23, s[24:27], s6 offen
    s_nop 1
    s_mov_b32 s6, 14400
    buffer_load_dwordx2 v[34:35], v23, s[12:15], s6 offen
    s_waitcnt vmcnt(0)
    v_lshlrev_b32 v40, 16, v32
    v_lshlrev_b32 v41, 16, v34
    v_accvgpr_read_b32 v42, a20
    v_accvgpr_read_b32 v43, a188
    v_cvt_pk_bf16_f32 v42, v42, v42
    v_lshlrev_b32 v42, 16, v42
    v_cvt_pk_bf16_f32 v43, v43, v43
    v_lshlrev_b32 v43, 16, v43
    v_add_f32 v43, v43, v40
    v_cvt_pk_bf16_f32 v43, v43, v43
    v_lshlrev_b32 v43, 16, v43
    v_add_f32 v42, v42, v41
    v_cvt_pk_bf16_f32 v42, v42, v42
    v_lshlrev_b32 v42, 16, v42
    v_add_f32 v44, v42, v43
    v_and_b32 v40, 0xffff0000, v32
    v_and_b32 v41, 0xffff0000, v34
    v_accvgpr_read_b32 v42, a21
    v_accvgpr_read_b32 v43, a189
    v_cvt_pk_bf16_f32 v42, v42, v42
    v_lshlrev_b32 v42, 16, v42
    v_cvt_pk_bf16_f32 v43, v43, v43
    v_lshlrev_b32 v43, 16, v43
    v_add_f32 v43, v43, v40
    v_cvt_pk_bf16_f32 v43, v43, v43
    v_lshlrev_b32 v43, 16, v43
    v_add_f32 v42, v42, v41
    v_cvt_pk_bf16_f32 v42, v42, v42
    v_lshlrev_b32 v42, 16, v42
    v_add_f32 v45, v42, v43
    v_lshlrev_b32 v40, 16, v33
    v_lshlrev_b32 v41, 16, v35
    v_accvgpr_read_b32 v42, a22
    v_accvgpr_read_b32 v43, a190
    v_cvt_pk_bf16_f32 v42, v42, v42
    v_lshlrev_b32 v42, 16, v42
    v_cvt_pk_bf16_f32 v43, v43, v43
    v_lshlrev_b32 v43, 16, v43
    v_add_f32 v43, v43, v40
    v_cvt_pk_bf16_f32 v43, v43, v43
    v_lshlrev_b32 v43, 16, v43
    v_add_f32 v42, v42, v41
    v_cvt_pk_bf16_f32 v42, v42, v42
    v_lshlrev_b32 v42, 16, v42
    v_add_f32 v46, v42, v43
    v_and_b32 v40, 0xffff0000, v33
    v_and_b32 v41, 0xffff0000, v35
    v_accvgpr_read_b32 v42, a23
    v_accvgpr_read_b32 v43, a191
    v_cvt_pk_bf16_f32 v42, v42, v42
    v_lshlrev_b32 v42, 16, v42
    v_cvt_pk_bf16_f32 v43, v43, v43
    v_lshlrev_b32 v43, 16, v43
    v_add_f32 v43, v43, v40
    v_cvt_pk_bf16_f32 v43, v43, v43
    v_lshlrev_b32 v43, 16, v43
    v_add_f32 v42, v42, v41
    v_cvt_pk_bf16_f32 v42, v42, v42
    v_lshlrev_b32 v42, 16, v42
    v_add_f32 v47, v42, v43
    v_cvt_pk_bf16_f32 v48, v44, v45
    v_cvt_pk_bf16_f32 v49, v46, v47
    buffer_store_dwordx2 v[48:49], v23, s[24:27], s6 offen
    s_nop 1
    buffer_load_dwordx2 v[32:33], v24, s[16:19], 0 offen offset:96
    s_mov_b32 s6, 96
    buffer_load_dwordx2 v[34:35], v23, s[12:15], s6 offen
    s_waitcnt vmcnt(0)
    v_lshlrev_b32 v40, 16, v32
    v_lshlrev_b32 v41, 16, v34
    v_accvgpr_read_b32 v42, a24
    v_accvgpr_read_b32 v43, a192
    v_cvt_pk_bf16_f32 v42, v42, v42
    v_lshlrev_b32 v42, 16, v42
    v_cvt_pk_bf16_f32 v43, v43, v43
    v_lshlrev_b32 v43, 16, v43
    v_add_f32 v43, v43, v40
    v_cvt_pk_bf16_f32 v43, v43, v43
    v_lshlrev_b32 v43, 16, v43
    v_add_f32 v42, v42, v41
    v_cvt_pk_bf16_f32 v42, v42, v42
    v_lshlrev_b32 v42, 16, v42
    v_add_f32 v44, v42, v43
    v_and_b32 v40, 0xffff0000, v32
    v_and_b32 v41, 0xffff0000, v34
    v_accvgpr_read_b32 v42, a25
    v_accvgpr_read_b32 v43, a193
    v_cvt_pk_bf16_f32 v42, v42, v42
    v_lshlrev_b32 v42, 16, v42
    v_cvt_pk_bf16_f32 v43, v43, v43
    v_lshlrev_b32 v43, 16, v43
    v_add_f32 v43, v43, v40
    v_cvt_pk_bf16_f32 v43, v43, v43
    v_lshlrev_b32 v43, 16, v43
    v_add_f32 v42, v42, v41
    v_cvt_pk_bf16_f32 v42, v42, v42
    v_lshlrev_b32 v42, 16, v42
    v_add_f32 v45, v42, v43
    v_lshlrev_b32 v40, 16, v33
    v_lshlrev_b32 v41, 16, v35
    v_accvgpr_read_b32 v42, a26
    v_accvgpr_read_b32 v43, a194
    v_cvt_pk_bf16_f32 v42, v42, v42
    v_lshlrev_b32 v42, 16, v42
    v_cvt_pk_bf16_f32 v43, v43, v43
    v_lshlrev_b32 v43, 16, v43
    v_add_f32 v43, v43, v40
    v_cvt_pk_bf16_f32 v43, v43, v43
    v_lshlrev_b32 v43, 16, v43
    v_add_f32 v42, v42, v41
    v_cvt_pk_bf16_f32 v42, v42, v42
    v_lshlrev_b32 v42, 16, v42
    v_add_f32 v46, v42, v43
    v_and_b32 v40, 0xffff0000, v33
    v_and_b32 v41, 0xffff0000, v35
    v_accvgpr_read_b32 v42, a27
    v_accvgpr_read_b32 v43, a195
    v_cvt_pk_bf16_f32 v42, v42, v42
    v_lshlrev_b32 v42, 16, v42
    v_cvt_pk_bf16_f32 v43, v43, v43
    v_lshlrev_b32 v43, 16, v43
    v_add_f32 v43, v43, v40
    v_cvt_pk_bf16_f32 v43, v43, v43
    v_lshlrev_b32 v43, 16, v43
    v_add_f32 v42, v42, v41
    v_cvt_pk_bf16_f32 v42, v42, v42
    v_lshlrev_b32 v42, 16, v42
    v_add_f32 v47, v42, v43
    v_cvt_pk_bf16_f32 v48, v44, v45
    v_cvt_pk_bf16_f32 v49, v46, v47
    buffer_store_dwordx2 v[48:49], v23, s[24:27], s6 offen
    s_nop 1
    s_mov_b32 s6, 14432
    buffer_load_dwordx2 v[34:35], v23, s[12:15], s6 offen
    s_waitcnt vmcnt(0)
    v_lshlrev_b32 v40, 16, v32
    v_lshlrev_b32 v41, 16, v34
    v_accvgpr_read_b32 v42, a28
    v_accvgpr_read_b32 v43, a196
    v_cvt_pk_bf16_f32 v42, v42, v42
    v_lshlrev_b32 v42, 16, v42
    v_cvt_pk_bf16_f32 v43, v43, v43
    v_lshlrev_b32 v43, 16, v43
    v_add_f32 v43, v43, v40
    v_cvt_pk_bf16_f32 v43, v43, v43
    v_lshlrev_b32 v43, 16, v43
    v_add_f32 v42, v42, v41
    v_cvt_pk_bf16_f32 v42, v42, v42
    v_lshlrev_b32 v42, 16, v42
    v_add_f32 v44, v42, v43
    v_and_b32 v40, 0xffff0000, v32
    v_and_b32 v41, 0xffff0000, v34
    v_accvgpr_read_b32 v42, a29
    v_accvgpr_read_b32 v43, a197
    v_cvt_pk_bf16_f32 v42, v42, v42
    v_lshlrev_b32 v42, 16, v42
    v_cvt_pk_bf16_f32 v43, v43, v43
    v_lshlrev_b32 v43, 16, v43
    v_add_f32 v43, v43, v40
    v_cvt_pk_bf16_f32 v43, v43, v43
    v_lshlrev_b32 v43, 16, v43
    v_add_f32 v42, v42, v41
    v_cvt_pk_bf16_f32 v42, v42, v42
    v_lshlrev_b32 v42, 16, v42
    v_add_f32 v45, v42, v43
    v_lshlrev_b32 v40, 16, v33
    v_lshlrev_b32 v41, 16, v35
    v_accvgpr_read_b32 v42, a30
    v_accvgpr_read_b32 v43, a198
    v_cvt_pk_bf16_f32 v42, v42, v42
    v_lshlrev_b32 v42, 16, v42
    v_cvt_pk_bf16_f32 v43, v43, v43
    v_lshlrev_b32 v43, 16, v43
    v_add_f32 v43, v43, v40
    v_cvt_pk_bf16_f32 v43, v43, v43
    v_lshlrev_b32 v43, 16, v43
    v_add_f32 v42, v42, v41
    v_cvt_pk_bf16_f32 v42, v42, v42
    v_lshlrev_b32 v42, 16, v42
    v_add_f32 v46, v42, v43
    v_and_b32 v40, 0xffff0000, v33
    v_and_b32 v41, 0xffff0000, v35
    v_accvgpr_read_b32 v42, a31
    v_accvgpr_read_b32 v43, a199
    v_cvt_pk_bf16_f32 v42, v42, v42
    v_lshlrev_b32 v42, 16, v42
    v_cvt_pk_bf16_f32 v43, v43, v43
    v_lshlrev_b32 v43, 16, v43
    v_add_f32 v43, v43, v40
    v_cvt_pk_bf16_f32 v43, v43, v43
    v_lshlrev_b32 v43, 16, v43
    v_add_f32 v42, v42, v41
    v_cvt_pk_bf16_f32 v42, v42, v42
    v_lshlrev_b32 v42, 16, v42
    v_add_f32 v47, v42, v43
    v_cvt_pk_bf16_f32 v48, v44, v45
    v_cvt_pk_bf16_f32 v49, v46, v47
    buffer_store_dwordx2 v[48:49], v23, s[24:27], s6 offen
    s_nop 1
    buffer_load_dwordx2 v[32:33], v24, s[16:19], 0 offen offset:128
    s_mov_b32 s6, 128
    buffer_load_dwordx2 v[34:35], v23, s[12:15], s6 offen
    s_waitcnt vmcnt(0)
    v_lshlrev_b32 v40, 16, v32
    v_lshlrev_b32 v41, 16, v34
    v_accvgpr_read_b32 v42, a32
    v_accvgpr_read_b32 v43, a200
    v_cvt_pk_bf16_f32 v42, v42, v42
    v_lshlrev_b32 v42, 16, v42
    v_cvt_pk_bf16_f32 v43, v43, v43
    v_lshlrev_b32 v43, 16, v43
    v_add_f32 v43, v43, v40
    v_cvt_pk_bf16_f32 v43, v43, v43
    v_lshlrev_b32 v43, 16, v43
    v_add_f32 v42, v42, v41
    v_cvt_pk_bf16_f32 v42, v42, v42
    v_lshlrev_b32 v42, 16, v42
    v_add_f32 v44, v42, v43
    v_and_b32 v40, 0xffff0000, v32
    v_and_b32 v41, 0xffff0000, v34
    v_accvgpr_read_b32 v42, a33
    v_accvgpr_read_b32 v43, a201
    v_cvt_pk_bf16_f32 v42, v42, v42
    v_lshlrev_b32 v42, 16, v42
    v_cvt_pk_bf16_f32 v43, v43, v43
    v_lshlrev_b32 v43, 16, v43
    v_add_f32 v43, v43, v40
    v_cvt_pk_bf16_f32 v43, v43, v43
    v_lshlrev_b32 v43, 16, v43
    v_add_f32 v42, v42, v41
    v_cvt_pk_bf16_f32 v42, v42, v42
    v_lshlrev_b32 v42, 16, v42
    v_add_f32 v45, v42, v43
    v_lshlrev_b32 v40, 16, v33
    v_lshlrev_b32 v41, 16, v35
    v_accvgpr_read_b32 v42, a34
    v_accvgpr_read_b32 v43, a202
    v_cvt_pk_bf16_f32 v42, v42, v42
    v_lshlrev_b32 v42, 16, v42
    v_cvt_pk_bf16_f32 v43, v43, v43
    v_lshlrev_b32 v43, 16, v43
    v_add_f32 v43, v43, v40
    v_cvt_pk_bf16_f32 v43, v43, v43
    v_lshlrev_b32 v43, 16, v43
    v_add_f32 v42, v42, v41
    v_cvt_pk_bf16_f32 v42, v42, v42
    v_lshlrev_b32 v42, 16, v42
    v_add_f32 v46, v42, v43
    v_and_b32 v40, 0xffff0000, v33
    v_and_b32 v41, 0xffff0000, v35
    v_accvgpr_read_b32 v42, a35
    v_accvgpr_read_b32 v43, a203
    v_cvt_pk_bf16_f32 v42, v42, v42
    v_lshlrev_b32 v42, 16, v42
    v_cvt_pk_bf16_f32 v43, v43, v43
    v_lshlrev_b32 v43, 16, v43
    v_add_f32 v43, v43, v40
    v_cvt_pk_bf16_f32 v43, v43, v43
    v_lshlrev_b32 v43, 16, v43
    v_add_f32 v42, v42, v41
    v_cvt_pk_bf16_f32 v42, v42, v42
    v_lshlrev_b32 v42, 16, v42
    v_add_f32 v47, v42, v43
    v_cvt_pk_bf16_f32 v48, v44, v45
    v_cvt_pk_bf16_f32 v49, v46, v47
    buffer_store_dwordx2 v[48:49], v23, s[24:27], s6 offen
    s_nop 1
    s_mov_b32 s6, 14464
    buffer_load_dwordx2 v[34:35], v23, s[12:15], s6 offen
    s_waitcnt vmcnt(0)
    v_lshlrev_b32 v40, 16, v32
    v_lshlrev_b32 v41, 16, v34
    v_accvgpr_read_b32 v42, a36
    v_accvgpr_read_b32 v43, a204
    v_cvt_pk_bf16_f32 v42, v42, v42
    v_lshlrev_b32 v42, 16, v42
    v_cvt_pk_bf16_f32 v43, v43, v43
    v_lshlrev_b32 v43, 16, v43
    v_add_f32 v43, v43, v40
    v_cvt_pk_bf16_f32 v43, v43, v43
    v_lshlrev_b32 v43, 16, v43
    v_add_f32 v42, v42, v41
    v_cvt_pk_bf16_f32 v42, v42, v42
    v_lshlrev_b32 v42, 16, v42
    v_add_f32 v44, v42, v43
    v_and_b32 v40, 0xffff0000, v32
    v_and_b32 v41, 0xffff0000, v34
    v_accvgpr_read_b32 v42, a37
    v_accvgpr_read_b32 v43, a205
    v_cvt_pk_bf16_f32 v42, v42, v42
    v_lshlrev_b32 v42, 16, v42
    v_cvt_pk_bf16_f32 v43, v43, v43
    v_lshlrev_b32 v43, 16, v43
    v_add_f32 v43, v43, v40
    v_cvt_pk_bf16_f32 v43, v43, v43
    v_lshlrev_b32 v43, 16, v43
    v_add_f32 v42, v42, v41
    v_cvt_pk_bf16_f32 v42, v42, v42
    v_lshlrev_b32 v42, 16, v42
    v_add_f32 v45, v42, v43
    v_lshlrev_b32 v40, 16, v33
    v_lshlrev_b32 v41, 16, v35
    v_accvgpr_read_b32 v42, a38
    v_accvgpr_read_b32 v43, a206
    v_cvt_pk_bf16_f32 v42, v42, v42
    v_lshlrev_b32 v42, 16, v42
    v_cvt_pk_bf16_f32 v43, v43, v43
    v_lshlrev_b32 v43, 16, v43
    v_add_f32 v43, v43, v40
    v_cvt_pk_bf16_f32 v43, v43, v43
    v_lshlrev_b32 v43, 16, v43
    v_add_f32 v42, v42, v41
    v_cvt_pk_bf16_f32 v42, v42, v42
    v_lshlrev_b32 v42, 16, v42
    v_add_f32 v46, v42, v43
    v_and_b32 v40, 0xffff0000, v33
    v_and_b32 v41, 0xffff0000, v35
    v_accvgpr_read_b32 v42, a39
    v_accvgpr_read_b32 v43, a207
    v_cvt_pk_bf16_f32 v42, v42, v42
    v_lshlrev_b32 v42, 16, v42
    v_cvt_pk_bf16_f32 v43, v43, v43
    v_lshlrev_b32 v43, 16, v43
    v_add_f32 v43, v43, v40
    v_cvt_pk_bf16_f32 v43, v43, v43
    v_lshlrev_b32 v43, 16, v43
    v_add_f32 v42, v42, v41
    v_cvt_pk_bf16_f32 v42, v42, v42
    v_lshlrev_b32 v42, 16, v42
    v_add_f32 v47, v42, v43
    v_cvt_pk_bf16_f32 v48, v44, v45
    v_cvt_pk_bf16_f32 v49, v46, v47
    buffer_store_dwordx2 v[48:49], v23, s[24:27], s6 offen
    s_nop 1
    buffer_load_dwordx2 v[32:33], v24, s[16:19], 0 offen offset:160
    s_mov_b32 s6, 160
    buffer_load_dwordx2 v[34:35], v23, s[12:15], s6 offen
    s_waitcnt vmcnt(0)
    v_lshlrev_b32 v40, 16, v32
    v_lshlrev_b32 v41, 16, v34
    v_accvgpr_read_b32 v42, a40
    v_accvgpr_read_b32 v43, a208
    v_cvt_pk_bf16_f32 v42, v42, v42
    v_lshlrev_b32 v42, 16, v42
    v_cvt_pk_bf16_f32 v43, v43, v43
    v_lshlrev_b32 v43, 16, v43
    v_add_f32 v43, v43, v40
    v_cvt_pk_bf16_f32 v43, v43, v43
    v_lshlrev_b32 v43, 16, v43
    v_add_f32 v42, v42, v41
    v_cvt_pk_bf16_f32 v42, v42, v42
    v_lshlrev_b32 v42, 16, v42
    v_add_f32 v44, v42, v43
    v_and_b32 v40, 0xffff0000, v32
    v_and_b32 v41, 0xffff0000, v34
    v_accvgpr_read_b32 v42, a41
    v_accvgpr_read_b32 v43, a209
    v_cvt_pk_bf16_f32 v42, v42, v42
    v_lshlrev_b32 v42, 16, v42
    v_cvt_pk_bf16_f32 v43, v43, v43
    v_lshlrev_b32 v43, 16, v43
    v_add_f32 v43, v43, v40
    v_cvt_pk_bf16_f32 v43, v43, v43
    v_lshlrev_b32 v43, 16, v43
    v_add_f32 v42, v42, v41
    v_cvt_pk_bf16_f32 v42, v42, v42
    v_lshlrev_b32 v42, 16, v42
    v_add_f32 v45, v42, v43
    v_lshlrev_b32 v40, 16, v33
    v_lshlrev_b32 v41, 16, v35
    v_accvgpr_read_b32 v42, a42
    v_accvgpr_read_b32 v43, a210
    v_cvt_pk_bf16_f32 v42, v42, v42
    v_lshlrev_b32 v42, 16, v42
    v_cvt_pk_bf16_f32 v43, v43, v43
    v_lshlrev_b32 v43, 16, v43
    v_add_f32 v43, v43, v40
    v_cvt_pk_bf16_f32 v43, v43, v43
    v_lshlrev_b32 v43, 16, v43
    v_add_f32 v42, v42, v41
    v_cvt_pk_bf16_f32 v42, v42, v42
    v_lshlrev_b32 v42, 16, v42
    v_add_f32 v46, v42, v43
    v_and_b32 v40, 0xffff0000, v33
    v_and_b32 v41, 0xffff0000, v35
    v_accvgpr_read_b32 v42, a43
    v_accvgpr_read_b32 v43, a211
    v_cvt_pk_bf16_f32 v42, v42, v42
    v_lshlrev_b32 v42, 16, v42
    v_cvt_pk_bf16_f32 v43, v43, v43
    v_lshlrev_b32 v43, 16, v43
    v_add_f32 v43, v43, v40
    v_cvt_pk_bf16_f32 v43, v43, v43
    v_lshlrev_b32 v43, 16, v43
    v_add_f32 v42, v42, v41
    v_cvt_pk_bf16_f32 v42, v42, v42
    v_lshlrev_b32 v42, 16, v42
    v_add_f32 v47, v42, v43
    v_cvt_pk_bf16_f32 v48, v44, v45
    v_cvt_pk_bf16_f32 v49, v46, v47
    buffer_store_dwordx2 v[48:49], v23, s[24:27], s6 offen
    s_nop 1
    s_mov_b32 s6, 14496
    buffer_load_dwordx2 v[34:35], v23, s[12:15], s6 offen
    s_waitcnt vmcnt(0)
    v_lshlrev_b32 v40, 16, v32
    v_lshlrev_b32 v41, 16, v34
    v_accvgpr_read_b32 v42, a44
    v_accvgpr_read_b32 v43, a212
    v_cvt_pk_bf16_f32 v42, v42, v42
    v_lshlrev_b32 v42, 16, v42
    v_cvt_pk_bf16_f32 v43, v43, v43
    v_lshlrev_b32 v43, 16, v43
    v_add_f32 v43, v43, v40
    v_cvt_pk_bf16_f32 v43, v43, v43
    v_lshlrev_b32 v43, 16, v43
    v_add_f32 v42, v42, v41
    v_cvt_pk_bf16_f32 v42, v42, v42
    v_lshlrev_b32 v42, 16, v42
    v_add_f32 v44, v42, v43
    v_and_b32 v40, 0xffff0000, v32
    v_and_b32 v41, 0xffff0000, v34
    v_accvgpr_read_b32 v42, a45
    v_accvgpr_read_b32 v43, a213
    v_cvt_pk_bf16_f32 v42, v42, v42
    v_lshlrev_b32 v42, 16, v42
    v_cvt_pk_bf16_f32 v43, v43, v43
    v_lshlrev_b32 v43, 16, v43
    v_add_f32 v43, v43, v40
    v_cvt_pk_bf16_f32 v43, v43, v43
    v_lshlrev_b32 v43, 16, v43
    v_add_f32 v42, v42, v41
    v_cvt_pk_bf16_f32 v42, v42, v42
    v_lshlrev_b32 v42, 16, v42
    v_add_f32 v45, v42, v43
    v_lshlrev_b32 v40, 16, v33
    v_lshlrev_b32 v41, 16, v35
    v_accvgpr_read_b32 v42, a46
    v_accvgpr_read_b32 v43, a214
    v_cvt_pk_bf16_f32 v42, v42, v42
    v_lshlrev_b32 v42, 16, v42
    v_cvt_pk_bf16_f32 v43, v43, v43
    v_lshlrev_b32 v43, 16, v43
    v_add_f32 v43, v43, v40
    v_cvt_pk_bf16_f32 v43, v43, v43
    v_lshlrev_b32 v43, 16, v43
    v_add_f32 v42, v42, v41
    v_cvt_pk_bf16_f32 v42, v42, v42
    v_lshlrev_b32 v42, 16, v42
    v_add_f32 v46, v42, v43
    v_and_b32 v40, 0xffff0000, v33
    v_and_b32 v41, 0xffff0000, v35
    v_accvgpr_read_b32 v42, a47
    v_accvgpr_read_b32 v43, a215
    v_cvt_pk_bf16_f32 v42, v42, v42
    v_lshlrev_b32 v42, 16, v42
    v_cvt_pk_bf16_f32 v43, v43, v43
    v_lshlrev_b32 v43, 16, v43
    v_add_f32 v43, v43, v40
    v_cvt_pk_bf16_f32 v43, v43, v43
    v_lshlrev_b32 v43, 16, v43
    v_add_f32 v42, v42, v41
    v_cvt_pk_bf16_f32 v42, v42, v42
    v_lshlrev_b32 v42, 16, v42
    v_add_f32 v47, v42, v43
    v_cvt_pk_bf16_f32 v48, v44, v45
    v_cvt_pk_bf16_f32 v49, v46, v47
    buffer_store_dwordx2 v[48:49], v23, s[24:27], s6 offen
    s_nop 1
    buffer_load_dwordx2 v[32:33], v24, s[16:19], 0 offen offset:192
    s_mov_b32 s6, 192
    buffer_load_dwordx2 v[34:35], v23, s[12:15], s6 offen
    s_waitcnt vmcnt(0)
    v_lshlrev_b32 v40, 16, v32
    v_lshlrev_b32 v41, 16, v34
    v_accvgpr_read_b32 v42, a48
    v_accvgpr_read_b32 v43, a216
    v_cvt_pk_bf16_f32 v42, v42, v42
    v_lshlrev_b32 v42, 16, v42
    v_cvt_pk_bf16_f32 v43, v43, v43
    v_lshlrev_b32 v43, 16, v43
    v_add_f32 v43, v43, v40
    v_cvt_pk_bf16_f32 v43, v43, v43
    v_lshlrev_b32 v43, 16, v43
    v_add_f32 v42, v42, v41
    v_cvt_pk_bf16_f32 v42, v42, v42
    v_lshlrev_b32 v42, 16, v42
    v_add_f32 v44, v42, v43
    v_and_b32 v40, 0xffff0000, v32
    v_and_b32 v41, 0xffff0000, v34
    v_accvgpr_read_b32 v42, a49
    v_accvgpr_read_b32 v43, a217
    v_cvt_pk_bf16_f32 v42, v42, v42
    v_lshlrev_b32 v42, 16, v42
    v_cvt_pk_bf16_f32 v43, v43, v43
    v_lshlrev_b32 v43, 16, v43
    v_add_f32 v43, v43, v40
    v_cvt_pk_bf16_f32 v43, v43, v43
    v_lshlrev_b32 v43, 16, v43
    v_add_f32 v42, v42, v41
    v_cvt_pk_bf16_f32 v42, v42, v42
    v_lshlrev_b32 v42, 16, v42
    v_add_f32 v45, v42, v43
    v_lshlrev_b32 v40, 16, v33
    v_lshlrev_b32 v41, 16, v35
    v_accvgpr_read_b32 v42, a50
    v_accvgpr_read_b32 v43, a218
    v_cvt_pk_bf16_f32 v42, v42, v42
    v_lshlrev_b32 v42, 16, v42
    v_cvt_pk_bf16_f32 v43, v43, v43
    v_lshlrev_b32 v43, 16, v43
    v_add_f32 v43, v43, v40
    v_cvt_pk_bf16_f32 v43, v43, v43
    v_lshlrev_b32 v43, 16, v43
    v_add_f32 v42, v42, v41
    v_cvt_pk_bf16_f32 v42, v42, v42
    v_lshlrev_b32 v42, 16, v42
    v_add_f32 v46, v42, v43
    v_and_b32 v40, 0xffff0000, v33
    v_and_b32 v41, 0xffff0000, v35
    v_accvgpr_read_b32 v42, a51
    v_accvgpr_read_b32 v43, a219
    v_cvt_pk_bf16_f32 v42, v42, v42
    v_lshlrev_b32 v42, 16, v42
    v_cvt_pk_bf16_f32 v43, v43, v43
    v_lshlrev_b32 v43, 16, v43
    v_add_f32 v43, v43, v40
    v_cvt_pk_bf16_f32 v43, v43, v43
    v_lshlrev_b32 v43, 16, v43
    v_add_f32 v42, v42, v41
    v_cvt_pk_bf16_f32 v42, v42, v42
    v_lshlrev_b32 v42, 16, v42
    v_add_f32 v47, v42, v43
    v_cvt_pk_bf16_f32 v48, v44, v45
    v_cvt_pk_bf16_f32 v49, v46, v47
    buffer_store_dwordx2 v[48:49], v23, s[24:27], s6 offen
    s_nop 1
    s_mov_b32 s6, 14528
    buffer_load_dwordx2 v[34:35], v23, s[12:15], s6 offen
    s_waitcnt vmcnt(0)
    v_lshlrev_b32 v40, 16, v32
    v_lshlrev_b32 v41, 16, v34
    v_accvgpr_read_b32 v42, a52
    v_accvgpr_read_b32 v43, a220
    v_cvt_pk_bf16_f32 v42, v42, v42
    v_lshlrev_b32 v42, 16, v42
    v_cvt_pk_bf16_f32 v43, v43, v43
    v_lshlrev_b32 v43, 16, v43
    v_add_f32 v43, v43, v40
    v_cvt_pk_bf16_f32 v43, v43, v43
    v_lshlrev_b32 v43, 16, v43
    v_add_f32 v42, v42, v41
    v_cvt_pk_bf16_f32 v42, v42, v42
    v_lshlrev_b32 v42, 16, v42
    v_add_f32 v44, v42, v43
    v_and_b32 v40, 0xffff0000, v32
    v_and_b32 v41, 0xffff0000, v34
    v_accvgpr_read_b32 v42, a53
    v_accvgpr_read_b32 v43, a221
    v_cvt_pk_bf16_f32 v42, v42, v42
    v_lshlrev_b32 v42, 16, v42
    v_cvt_pk_bf16_f32 v43, v43, v43
    v_lshlrev_b32 v43, 16, v43
    v_add_f32 v43, v43, v40
    v_cvt_pk_bf16_f32 v43, v43, v43
    v_lshlrev_b32 v43, 16, v43
    v_add_f32 v42, v42, v41
    v_cvt_pk_bf16_f32 v42, v42, v42
    v_lshlrev_b32 v42, 16, v42
    v_add_f32 v45, v42, v43
    v_lshlrev_b32 v40, 16, v33
    v_lshlrev_b32 v41, 16, v35
    v_accvgpr_read_b32 v42, a54
    v_accvgpr_read_b32 v43, a222
    v_cvt_pk_bf16_f32 v42, v42, v42
    v_lshlrev_b32 v42, 16, v42
    v_cvt_pk_bf16_f32 v43, v43, v43
    v_lshlrev_b32 v43, 16, v43
    v_add_f32 v43, v43, v40
    v_cvt_pk_bf16_f32 v43, v43, v43
    v_lshlrev_b32 v43, 16, v43
    v_add_f32 v42, v42, v41
    v_cvt_pk_bf16_f32 v42, v42, v42
    v_lshlrev_b32 v42, 16, v42
    v_add_f32 v46, v42, v43
    v_and_b32 v40, 0xffff0000, v33
    v_and_b32 v41, 0xffff0000, v35
    v_accvgpr_read_b32 v42, a55
    v_accvgpr_read_b32 v43, a223
    v_cvt_pk_bf16_f32 v42, v42, v42
    v_lshlrev_b32 v42, 16, v42
    v_cvt_pk_bf16_f32 v43, v43, v43
    v_lshlrev_b32 v43, 16, v43
    v_add_f32 v43, v43, v40
    v_cvt_pk_bf16_f32 v43, v43, v43
    v_lshlrev_b32 v43, 16, v43
    v_add_f32 v42, v42, v41
    v_cvt_pk_bf16_f32 v42, v42, v42
    v_lshlrev_b32 v42, 16, v42
    v_add_f32 v47, v42, v43
    v_cvt_pk_bf16_f32 v48, v44, v45
    v_cvt_pk_bf16_f32 v49, v46, v47
    buffer_store_dwordx2 v[48:49], v23, s[24:27], s6 offen
    s_nop 1
K5_done:
    s_endpgm
.section .rodata,"a"
.p2align 6
.amdhsa_kernel prep_kernel
  .amdhsa_next_free_vgpr 32
  .amdhsa_next_free_sgpr 102
  .amdhsa_accum_offset 32
  .amdhsa_group_segment_fixed_size 0
  .amdhsa_kernarg_size 120
  .amdhsa_user_sgpr_count 2
  .amdhsa_user_sgpr_kernarg_segment_ptr 1
  .amdhsa_system_sgpr_workgroup_id_x 1
.end_amdhsa_kernel
.p2align 6
.amdhsa_kernel wprod_kernel
  .amdhsa_next_free_vgpr 356
  .amdhsa_next_free_sgpr 102
  .amdhsa_accum_offset 160
  .amdhsa_group_segment_fixed_size 0
  .amdhsa_kernarg_size 120
  .amdhsa_user_sgpr_count 2
  .amdhsa_user_sgpr_kernarg_segment_ptr 1
  .amdhsa_system_sgpr_workgroup_id_x 1
.end_amdhsa_kernel
.p2align 6
.amdhsa_kernel main_kernel
  .amdhsa_next_free_vgpr 512
  .amdhsa_next_free_sgpr 102
  .amdhsa_accum_offset 256
  .amdhsa_group_segment_fixed_size 0
  .amdhsa_kernarg_size 120
  .amdhsa_user_sgpr_count 2
  .amdhsa_user_sgpr_kernarg_segment_ptr 1
  .amdhsa_system_sgpr_workgroup_id_x 1
.end_amdhsa_kernel
```
